```python
import torch

def _softmax(x, axis=-1):
    return torch.softmax(x, dim=axis)
def _gelu(x):
    return torch.nn.functional.gelu(x, approximate="tanh")
def _silu(x):
    return torch.nn.functional.silu(x)
def _sigmoid(x):
    return torch.sigmoid(x)
def _layernorm(x, axis=-1, eps=1e-5):
    m = x.mean(dim=axis, keepdim=True)
    v = x.var(dim=axis, keepdim=True, unbiased=False)
    return (x - m) / torch.sqrt(v + eps)
def _scatter_add(tgt, idx, src, axis=0):
    return tgt.clone().index_add_(axis, idx, src)
def _segment_sum(src, seg, n):
    out = torch.zeros((n,) + src.shape[1:], dtype=src.dtype)
    return out.index_add_(0, seg, src)
def _pad(x, pw):
    flat = tuple(v for pair in reversed(pw) for v in pair)
    return torch.nn.functional.pad(x, flat)

kernel_name = 'standalone__gqa_softmax__near_ridge'

def setup_inputs():

    _w = (lambda a: (lambda t: t.to(torch.bfloat16) if t.is_floating_point() else t)(torch.as_tensor(a)))
    B, Hq, Hkv, Sq, Sk, D = 8, 32, 32, 736, 736, 128
    return {
        "q": _w((lambda *s: torch.randn(*s, dtype=torch.bfloat16) * 0.8)(B, Hq, Sq, D)),
        "k": _w((lambda *s: torch.randn(*s, dtype=torch.bfloat16) * 0.8)(B, Hkv, Sk, D)),
        "v": _w((lambda *s: torch.randn(*s, dtype=torch.bfloat16) * 0.05)(B, Hkv, Sk, D)),
    }

def reference(q, k, v):
    B, Hq, Sq, D = q.shape
    Hkv = k.shape[1]
    rep = Hq // Hkv
    k = (lambda x, n, axis: torch.repeat_interleave(x, n, dim=axis))(k, rep, axis=1)
    v = (lambda x, n, axis: torch.repeat_interleave(x, n, dim=axis))(v, rep, axis=1)
    scale = D ** -0.5
    scores = torch.einsum("bhqd,bhkd->bhqk", q, k) * scale
    p = _softmax(scores, axis=-1)
    return torch.einsum("bhqk,bhkd->bhqd", p, v)
```

```asm
; @launch grid=(256,1,1) block=(256,1,1) lds=163840
.amdgcn_target "amdgcn-amd-amdhsa--gfx950"
.text
.globl standalone__gqa_softmax__near_ridge_kernel
.p2align 8
.type standalone__gqa_softmax__near_ridge_kernel,@function
standalone__gqa_softmax__near_ridge_kernel:
    s_load_dwordx8 s[40:47], s[0:1], 0
    s_cmp_ge_u32 s2, 256
    s_cbranch_scc1 L_done
    s_getpc_b64 s[58:59]
L_pc0:
    v_lshlrev_b32 v16, 7, v0
    v_cmp_lt_u32 vcc, 127, v0
    v_mov_b32 v17, L_start_w3-L_pc0-16384
    s_nop 0
    v_cndmask_b32 v17, 0, v17, vcc
    v_add_u32 v16, v16, v17
    global_load_dword v17, v16, s[58:59]
    v_lshrrev_b32 v11, 6, v0
    v_and_b32 v12, 63, v0
    v_readfirstlane_b32 s24, v11
    v_and_b32 v13, 15, v12
    v_lshrrev_b32 v14, 4, v12
    s_and_b32 s3, s2, 7
    s_lshr_b32 s4, s2, 3
    s_lshr_b32 s5, s4, 1
    s_and_b32 s4, s4, 1
    s_lshl_b32 s3, s3, 5
    s_add_u32 s3, s3, s5
    s_mul_i32 s25, s3, 188416
    s_add_u32 s26, s25, 3014656
    s_mul_i32 s63, s4, 94208
    s_mul_i32 s5, s24, 24576
    s_add_u32 s50, s63, s5
    s_add_u32 s51, s5, 65536
    s_add_u32 s53, s25, s50
    s_mov_b32 s54, s51
    v_lshlrev_b32 v15, 8, v14
    v_add_u32 v5, 0, v14
    v_xor_b32 v5, v5, v13
    v_lshl_add_u32 v96, v5, 4, v15
    v_add_u32 v5, 4, v14
    v_xor_b32 v5, v5, v13
    v_lshl_add_u32 v97, v5, 4, v15
    v_add_u32 v5, 8, v14
    v_xor_b32 v5, v5, v13
    v_lshl_add_u32 v98, v5, 4, v15
    v_add_u32 v5, 12, v14
    v_xor_b32 v5, v5, v13
    v_lshl_add_u32 v99, v5, 4, v15
    v_lshl_add_u32 v5, v11, 2, v14
    v_xor_b32 v6, v5, v13
    v_lshl_add_u32 v103, v6, 4, v15
    v_and_b32 v5, 7, v5
    v_xor_b32 v6, v5, v13
    v_lshl_add_u32 v104, v6, 4, v15
    s_lshl_b32 s6, s24, 10
    s_add_u32 s7, s25, s6
    s_waitcnt lgkmcnt(0)
    s_mov_b32 s8, s40
    s_and_b32 s9, s41, 0xffff
    s_mov_b32 s10, 48234496
    s_mov_b32 s11, 0x20000
    s_mov_b32 s12, s42
    s_and_b32 s13, s43, 0xffff
    s_mov_b32 s14, 48234496
    s_mov_b32 s15, 0x20000
    s_mov_b32 m0, s54
    s_add_u32 s54, s54, 4096
    buffer_load_dwordx4 v96, s[8:11], s53 offen offset:0 nt lds
    buffer_load_dwordx4 v97, s[8:11], s53 offen offset:1024 nt lds
    buffer_load_dwordx4 v98, s[8:11], s53 offen offset:2048 nt lds
    buffer_load_dwordx4 v99, s[8:11], s53 offen offset:3072 nt lds
    s_add_u32 s53, s53, 4096
    s_add_u32 m0, s6, 0
    s_add_u32 s29, s7, 0
    buffer_load_dwordx4 v103, s[12:15], s29 offen nt lds
    s_add_u32 m0, s6, 4096
    s_add_u32 s29, s7, 4096
    buffer_load_dwordx4 v103, s[12:15], s29 offen nt lds
    s_add_u32 m0, s6, 8192
    s_add_u32 s29, s7, 8192
    buffer_load_dwordx4 v103, s[12:15], s29 offen nt lds
    s_add_u32 m0, s6, 12288
    s_add_u32 s29, s7, 12288
    buffer_load_dwordx4 v103, s[12:15], s29 offen nt lds
    v_add_u32 v5, 0, v14
    v_xor_b32 v5, v5, v13
    v_lshlrev_b32 v5, 4, v5
    v_lshl_add_u32 v240, v13, 8, v5
    v_add_u32 v5, 4, v14
    v_xor_b32 v5, v5, v13
    v_lshlrev_b32 v5, 4, v5
    v_lshl_add_u32 v241, v13, 8, v5
    v_add_u32 v5, 8, v14
    v_xor_b32 v5, v5, v13
    v_lshlrev_b32 v5, 4, v5
    v_lshl_add_u32 v242, v13, 8, v5
    v_add_u32 v5, 12, v14
    v_xor_b32 v5, v5, v13
    v_lshlrev_b32 v5, 4, v5
    v_lshl_add_u32 v243, v13, 8, v5
    v_lshrrev_b32 v6, 2, v12
    v_and_b32 v7, 1, v12
    v_bfe_u32 v9, v12, 1, 1
    v_lshlrev_b32 v7, 3, v7
    v_lshl_add_u32 v7, v9, 7, v7
    v_lshl_add_u32 v8, v6, 8, v7
    v_add_u32 v8, 32768, v8
    v_and_b32 v10, 7, v6
    v_xor_b32 v5, 0, v10
    v_lshl_add_u32 v244, v5, 4, v8
    v_xor_b32 v5, 1, v10
    v_lshl_add_u32 v245, v5, 4, v8
    v_xor_b32 v5, 2, v10
    v_lshl_add_u32 v246, v5, 4, v8
    v_xor_b32 v5, 3, v10
    v_lshl_add_u32 v247, v5, 4, v8
    v_xor_b32 v5, 4, v10
    v_lshl_add_u32 v248, v5, 4, v8
    v_xor_b32 v5, 5, v10
    v_lshl_add_u32 v249, v5, 4, v8
    v_xor_b32 v5, 6, v10
    v_lshl_add_u32 v250, v5, 4, v8
    v_xor_b32 v5, 7, v10
    v_lshl_add_u32 v251, v5, 4, v8
    v_lshlrev_b32 v102, 4, v12
    v_lshlrev_b32 v5, 10, v14
    v_lshl_add_u32 v5, v13, 4, v5
    v_add_u32 v2, s51, v5
    v_xor_b32 v3, 64, v2
    v_and_b32 v6, 3, v6
    v_lshl_add_u32 v7, v6, 4, v7
    v_lshl_add_u32 v7, v14, 8, v7
    v_and_b32 v5, 1, v14
    v_lshl_add_u32 v7, v5, 6, v7
    v_add_u32 v6, s51, v7
    v_xor_b32 v7, 64, v6
    v_add_u32 v8, s51, v240
    v_add_u32 v9, s51, v241
    v_add_u32 v10, s51, v242
    v_add_u32 v11, s51, v243
    v_lshlrev_b32 v4, 4, v14
    v_and_b32 v15, 3, v12
    v_lshlrev_b32 v15, 4, v15
    s_mov_b32 s30, 0x3e03
    s_mov_b32 s31, 0
    v_lshlrev_b64 v[12:13], v15, s[30:31]
    s_mov_b32 s30, 0xb9d8
    v_lshlrev_b64 v[14:15], v15, s[30:31]
    s_mov_b32 s57, 0x22000000
    s_mov_b32 s36, 0x3d800000
    s_mov_b32 s27, 0
    s_mov_b32 s61, 0xc22c0000
    s_add_u32 s55, s26, s50
    s_mov_b32 s16, s44
    s_and_b32 s17, s45, 0xffff
    s_mov_b32 s18, 48234496
    s_mov_b32 s19, 0x20000
    s_mov_b32 s20, s46
    s_and_b32 s21, s47, 0xffff
    s_mov_b32 s22, 48234496
    s_mov_b32 s23, 0x20000
    s_mov_b32 m0, s54
    s_add_u32 s54, s54, 4096
    buffer_load_dwordx4 v96, s[8:11], s53 offen offset:0 nt lds
    buffer_load_dwordx4 v97, s[8:11], s53 offen offset:1024 nt lds
    buffer_load_dwordx4 v98, s[8:11], s53 offen offset:2048 nt lds
    buffer_load_dwordx4 v99, s[8:11], s53 offen offset:3072 nt lds
    s_add_u32 s53, s53, 4096
    s_add_u32 m0, s6, 32768
    s_add_u32 s29, s7, 0
    buffer_load_dwordx4 v104, s[16:19], s29 offen nt lds
    s_add_u32 m0, s6, 36864
    s_add_u32 s29, s7, 4096
    buffer_load_dwordx4 v104, s[16:19], s29 offen nt lds
    s_add_u32 m0, s6, 40960
    s_add_u32 s29, s7, 8192
    buffer_load_dwordx4 v104, s[16:19], s29 offen nt lds
    s_add_u32 m0, s6, 45056
    s_add_u32 s29, s7, 12288
    buffer_load_dwordx4 v104, s[16:19], s29 offen nt lds
    s_cmp_eq_u32 s24, 3
    s_cbranch_scc1 L_start_w3
L_start_w0:
    s_waitcnt vmcnt(12)
    ds_read_b128 v[16:19], v8 offset:0
    ds_read_b128 v[20:23], v9 offset:0
    ds_read_b128 v[24:27], v10 offset:0
    ds_read_b128 v[28:31], v11 offset:0
    s_mov_b32 m0, s54
    s_add_u32 s54, s54, 4096
    buffer_load_dwordx4 v96, s[8:11], s53 offen offset:0 nt lds
    buffer_load_dwordx4 v97, s[8:11], s53 offen offset:1024 nt lds
    buffer_load_dwordx4 v98, s[8:11], s53 offen offset:2048 nt lds
    buffer_load_dwordx4 v99, s[8:11], s53 offen offset:3072 nt lds
    s_add_u32 s53, s53, 4096
    s_waitcnt lgkmcnt(0)
.p2align 3
    v_mfma_f32_4x4x4_16b_bf16 v[184:187], v[12:13], v[16:17], 0
    v_mfma_f32_4x4x4_16b_bf16 v[188:191], v[12:13], v[18:19], 0
    s_nop 0
.p2align 3
    v_mfma_f32_4x4x4_16b_bf16 v[184:187], v[14:15], v[16:17], v[184:187]
    v_mfma_f32_4x4x4_16b_bf16 v[192:195], v[12:13], v[20:21], 0
    v_mfma_f32_4x4x4_16b_bf16 v[188:191], v[14:15], v[18:19], v[188:191]
    v_mfma_f32_4x4x4_16b_bf16 v[216:219], v[12:13], v[22:23], 0
    s_nop 1
.p2align 3
    v_cvt_pk_bf16_f32 v16, v184, v185
    v_mfma_f32_4x4x4_16b_bf16 v[192:195], v[14:15], v[20:21], v[192:195]
    v_cvt_pk_bf16_f32 v17, v186, v187
    v_mfma_f32_4x4x4_16b_bf16 v[184:187], v[12:13], v[24:25], 0
    v_cvt_pk_bf16_f32 v18, v188, v189
    v_mfma_f32_4x4x4_16b_bf16 v[216:219], v[14:15], v[22:23], v[216:219]
    v_cvt_pk_bf16_f32 v19, v190, v191
    v_mfma_f32_4x4x4_16b_bf16 v[188:191], v[12:13], v[26:27], 0
    v_cvt_pk_bf16_f32 v20, v192, v193
    v_mfma_f32_4x4x4_16b_bf16 v[184:187], v[14:15], v[24:25], v[184:187]
    v_cvt_pk_bf16_f32 v21, v194, v195
    v_mfma_f32_4x4x4_16b_bf16 v[192:195], v[12:13], v[28:29], 0
    v_cvt_pk_bf16_f32 v22, v216, v217
    v_mfma_f32_4x4x4_16b_bf16 v[188:191], v[14:15], v[26:27], v[188:191]
    v_cvt_pk_bf16_f32 v23, v218, v219
    v_mfma_f32_4x4x4_16b_bf16 v[216:219], v[12:13], v[30:31], 0
    v_cvt_pk_bf16_f32 v24, v184, v185
    v_mfma_f32_4x4x4_16b_bf16 v[192:195], v[14:15], v[28:29], v[192:195]
    v_cvt_pk_bf16_f32 v25, v186, v187
    v_cvt_pk_bf16_f32 v26, v188, v189
    v_mfma_f32_4x4x4_16b_bf16 v[216:219], v[14:15], v[30:31], v[216:219]
    v_cvt_pk_bf16_f32 v27, v190, v191
    s_nop 0
.p2align 3
    v_cvt_pk_bf16_f32 v28, v192, v193
    v_cvt_pk_bf16_f32 v29, v194, v195
    s_nop 0
.p2align 3
    v_cvt_pk_bf16_f32 v30, v216, v217
    v_cvt_pk_bf16_f32 v31, v218, v219
    s_waitcnt vmcnt(12)
    s_barrier
    ds_read_b128 v[160:163], v4 offset:0
    ds_read_b128 v[164:167], v4 offset:64
    ds_read_b128 v[168:171], v4 offset:128
    ds_read_b128 v[172:175], v4 offset:192
    ds_read_b128 a[128:131], v240 offset:0
    ds_read_b128 a[132:135], v241 offset:0
    ds_read_b128 a[136:139], v242 offset:0
    ds_read_b128 a[140:143], v243 offset:0
    ds_read_b128 a[144:147], v240 offset:4096
    ds_read_b128 a[148:151], v241 offset:4096
    ds_read_b128 a[152:155], v242 offset:4096
    ds_read_b128 a[156:159], v243 offset:4096
    s_mov_b32 m0, s54
    s_add_u32 s54, s54, 4096
    buffer_load_dwordx4 v96, s[8:11], s53 offen offset:0 nt lds
    buffer_load_dwordx4 v97, s[8:11], s53 offen offset:1024 nt lds
    buffer_load_dwordx4 v98, s[8:11], s53 offen offset:2048 nt lds
    buffer_load_dwordx4 v99, s[8:11], s53 offen offset:3072 nt lds
    s_add_u32 s53, s53, 4096
    s_waitcnt lgkmcnt(8)
    v_mfma_f32_16x16x32_bf16 v[216:219], v[160:163], v[16:19], 0
    ds_read_b128 a[160:163], v240 offset:8192
    ds_read_b128 a[164:167], v241 offset:8192
    v_mfma_f32_16x16x32_bf16 v[216:219], v[164:167], v[20:23], v[216:219]
    ds_read_b128 a[168:171], v242 offset:8192
    ds_read_b128 a[172:175], v243 offset:8192
    v_mfma_f32_16x16x32_bf16 v[216:219], v[168:171], v[24:27], v[216:219]
    ds_read_b128 a[176:179], v240 offset:12288
    ds_read_b128 a[180:183], v241 offset:12288
    v_mfma_f32_16x16x32_bf16 v[216:219], v[172:175], v[28:31], v[216:219]
    ds_read_b128 a[184:187], v242 offset:12288
    ds_read_b128 a[188:191], v243 offset:12288
    s_nop 5
    v_sub_f32 v216, s61, v216
    v_sub_f32 v217, s61, v217
    v_sub_f32 v218, s61, v218
    v_sub_f32 v219, s61, v219
    s_waitcnt lgkmcnt(8)
    s_nop 0
    v_mfma_f32_16x16x32_bf16 v[176:179], a[128:131], v[16:19], v[216:219]
    v_mfma_f32_16x16x32_bf16 v[176:179], a[132:135], v[20:23], v[176:179]
    v_mfma_f32_16x16x32_bf16 v[176:179], a[136:139], v[24:27], v[176:179]
    v_mfma_f32_16x16x32_bf16 v[176:179], a[140:143], v[28:31], v[176:179]
    s_waitcnt vmcnt(12)
    ds_read_b128 v[32:35], v8 offset:4096
    ds_read_b128 v[36:39], v9 offset:4096
    v_mfma_f32_16x16x32_bf16 v[180:183], a[156:159], v[28:31], v[216:219]
    v_mfma_f32_16x16x32_bf16 v[180:183], a[152:155], v[24:27], v[180:183]
    ds_read_b128 v[40:43], v10 offset:4096
    ds_read_b128 v[44:47], v11 offset:4096
    v_mfma_f32_16x16x32_bf16 v[180:183], a[148:151], v[20:23], v[180:183]
    v_mfma_f32_16x16x32_bf16 v[180:183], a[144:147], v[16:19], v[180:183]
    s_waitcnt lgkmcnt(0)
.p2align 3
    v_mfma_f32_4x4x4_16b_bf16 v[184:187], v[12:13], v[32:33], 0
    v_mfma_f32_4x4x4_16b_bf16 v[188:191], v[12:13], v[34:35], 0
    s_nop 0
.p2align 3
    v_mfma_f32_4x4x4_16b_bf16 v[184:187], v[14:15], v[32:33], v[184:187]
    v_mfma_f32_4x4x4_16b_bf16 v[192:195], v[12:13], v[36:37], 0
    v_mfma_f32_4x4x4_16b_bf16 v[188:191], v[14:15], v[34:35], v[188:191]
    v_mfma_f32_4x4x4_16b_bf16 v[220:223], v[12:13], v[38:39], 0
    s_nop 1
.p2align 3
    v_cvt_pk_bf16_f32 v32, v184, v185
    v_mfma_f32_4x4x4_16b_bf16 v[192:195], v[14:15], v[36:37], v[192:195]
    v_cvt_pk_bf16_f32 v33, v186, v187
    v_mfma_f32_4x4x4_16b_bf16 v[184:187], v[12:13], v[40:41], 0
    v_cvt_pk_bf16_f32 v34, v188, v189
    v_mfma_f32_4x4x4_16b_bf16 v[220:223], v[14:15], v[38:39], v[220:223]
    v_cvt_pk_bf16_f32 v35, v190, v191
    v_mfma_f32_4x4x4_16b_bf16 v[188:191], v[12:13], v[42:43], 0
    v_cvt_pk_bf16_f32 v36, v192, v193
    v_mfma_f32_4x4x4_16b_bf16 v[184:187], v[14:15], v[40:41], v[184:187]
    v_cvt_pk_bf16_f32 v37, v194, v195
    v_mfma_f32_4x4x4_16b_bf16 v[192:195], v[12:13], v[44:45], 0
    v_cvt_pk_bf16_f32 v38, v220, v221
    v_mfma_f32_4x4x4_16b_bf16 v[188:191], v[14:15], v[42:43], v[188:191]
    v_cvt_pk_bf16_f32 v39, v222, v223
    v_mfma_f32_4x4x4_16b_bf16 v[220:223], v[12:13], v[46:47], 0
    v_cvt_pk_bf16_f32 v40, v184, v185
    v_mfma_f32_4x4x4_16b_bf16 v[192:195], v[14:15], v[44:45], v[192:195]
    v_cvt_pk_bf16_f32 v41, v186, v187
    v_cvt_pk_bf16_f32 v42, v188, v189
    v_mfma_f32_4x4x4_16b_bf16 v[220:223], v[14:15], v[46:47], v[220:223]
    v_cvt_pk_bf16_f32 v43, v190, v191
    s_nop 0
.p2align 3
    v_cvt_pk_bf16_f32 v44, v192, v193
    v_cvt_pk_bf16_f32 v45, v194, v195
    s_nop 0
.p2align 3
    v_cvt_pk_bf16_f32 v46, v220, v221
    v_cvt_pk_bf16_f32 v47, v222, v223
    s_waitcnt vmcnt(8)
    s_barrier
    v_mfma_f32_16x16x32_bf16 v[220:223], v[160:163], v[32:35], 0
    s_mov_b32 m0, s54
    s_add_u32 s54, s54, 4096
    buffer_load_dwordx4 v96, s[8:11], s53 offen offset:0 nt lds
    ds_read_b64_tr_b16 a[192:193], v244 offset:0
    ds_read_b64_tr_b16 a[194:195], v244 offset:4096
    ds_read_b64_tr_b16 a[196:197], v245 offset:0
    v_mfma_f32_16x16x32_bf16 v[220:223], v[164:167], v[36:39], v[220:223]
    buffer_load_dwordx4 v97, s[8:11], s53 offen offset:1024 nt lds
    ds_read_b64_tr_b16 a[198:199], v245 offset:4096
    ds_read_b64_tr_b16 a[200:201], v246 offset:0
    ds_read_b64_tr_b16 a[202:203], v246 offset:4096
    v_mfma_f32_16x16x32_bf16 v[220:223], v[168:171], v[40:43], v[220:223]
    buffer_load_dwordx4 v98, s[8:11], s53 offen offset:2048 nt lds
    ds_read_b64_tr_b16 a[204:205], v247 offset:0
    ds_read_b64_tr_b16 a[206:207], v247 offset:4096
    v_mfma_f32_16x16x32_bf16 v[220:223], v[172:175], v[44:47], v[220:223]
    buffer_load_dwordx4 v99, s[8:11], s53 offen offset:3072 nt lds
    s_add_u32 s53, s53, 4096
    ds_read_b64_tr_b16 a[208:209], v248 offset:0
    ds_read_b64_tr_b16 a[210:211], v248 offset:4096
    ds_read_b64_tr_b16 a[212:213], v249 offset:0
    v_mfma_f32_16x16x32_bf16 v[184:187], a[160:163], v[16:19], v[216:219]
    ds_read_b64_tr_b16 a[214:215], v249 offset:4096
    ds_read_b64_tr_b16 a[216:217], v250 offset:0
    ds_read_b64_tr_b16 a[218:219], v250 offset:4096
    v_mfma_f32_16x16x32_bf16 v[184:187], a[164:167], v[20:23], v[184:187]
    ds_read_b64_tr_b16 a[220:221], v251 offset:0
    ds_read_b64_tr_b16 a[222:223], v251 offset:4096
    v_exp_f32 v176, v176
    v_exp_f32 v177, v177
    v_mfma_f32_16x16x32_bf16 v[184:187], a[168:171], v[24:27], v[184:187]
    ds_read_b64_tr_b16 a[224:225], v244 offset:8192
    ds_read_b64_tr_b16 a[226:227], v244 offset:12288
    ds_read_b64_tr_b16 a[228:229], v245 offset:8192
    v_exp_f32 v178, v178
    v_mov_b32 v252, v176
    v_add_f32 v252, v252, v177
    v_mfma_f32_16x16x32_bf16 v[184:187], a[172:175], v[28:31], v[184:187]
    ds_read_b64_tr_b16 a[230:231], v245 offset:12288
    ds_read_b64_tr_b16 a[232:233], v246 offset:8192
    ds_read_b64_tr_b16 a[234:235], v246 offset:12288
    v_exp_f32 v179, v179
    v_cvt_pk_bf16_f32 v192, v176, v177
    v_add_f32 v252, v252, v178
    v_sub_f32 v220, s61, v220
    v_mfma_f32_16x16x32_bf16 v[188:191], a[188:191], v[28:31], v[216:219]
    ds_read_b64_tr_b16 a[236:237], v247 offset:8192
    ds_read_b64_tr_b16 a[238:239], v247 offset:12288
    v_exp_f32 v180, v180
    v_add_f32 v252, v252, v179
    v_cvt_pk_bf16_f32 v193, v178, v179
    v_sub_f32 v221, s61, v221
    v_mfma_f32_16x16x32_bf16 v[188:191], a[184:187], v[24:27], v[188:191]
    ds_read_b64_tr_b16 a[240:241], v248 offset:8192
    ds_read_b64_tr_b16 a[242:243], v248 offset:12288
    ds_read_b64_tr_b16 a[244:245], v249 offset:8192
    v_exp_f32 v181, v181
    v_exp_f32 v182, v182
    v_sub_f32 v222, s61, v222
    v_mfma_f32_16x16x32_bf16 v[188:191], a[180:183], v[20:23], v[188:191]
    ds_read_b64_tr_b16 a[246:247], v249 offset:12288
    ds_read_b64_tr_b16 a[248:249], v250 offset:8192
    ds_read_b64_tr_b16 a[250:251], v250 offset:12288
    v_add_f32 v252, v252, v180
    v_add_f32 v252, v252, v181
    v_exp_f32 v183, v183
    v_sub_f32 v223, s61, v223
    v_mfma_f32_16x16x32_bf16 v[188:191], a[176:179], v[16:19], v[188:191]
    ds_read_b64_tr_b16 a[252:253], v251 offset:8192
    ds_read_b64_tr_b16 a[254:255], v251 offset:12288
    v_cvt_pk_bf16_f32 v194, v180, v181
    v_add_f32 v252, v252, v182
    v_add_f32 v252, v252, v183
    v_cvt_pk_bf16_f32 v195, v182, v183
    s_nop 7
    v_mfma_f32_16x16x32_bf16 v[176:179], a[128:131], v[32:35], v[220:223]
    v_mfma_f32_16x16x32_bf16 v[176:179], a[132:135], v[36:39], v[176:179]
    v_exp_f32 v184, v184
    v_mfma_f32_16x16x32_bf16 v[176:179], a[136:139], v[40:43], v[176:179]
    v_mfma_f32_16x16x32_bf16 v[176:179], a[140:143], v[44:47], v[176:179]
    v_exp_f32 v185, v185
    v_mfma_f32_16x16x32_bf16 v[180:183], a[156:159], v[44:47], v[220:223]
    v_exp_f32 v186, v186
    v_mfma_f32_16x16x32_bf16 v[180:183], a[152:155], v[40:43], v[180:183]
    v_add_f32 v252, v252, v184
    v_add_f32 v252, v252, v185
    v_mfma_f32_16x16x32_bf16 v[180:183], a[148:151], v[36:39], v[180:183]
    v_exp_f32 v187, v187
    v_mfma_f32_16x16x32_bf16 v[180:183], a[144:147], v[32:35], v[180:183]
    s_waitcnt lgkmcnt(0)
    v_cvt_pk_bf16_f32 v212, v184, v185
    v_add_f32 v252, v252, v186
    v_mfma_f32_16x16x32_bf16 a[0:3], v[192:195], a[192:195], 0
    v_exp_f32 v188, v188
    v_mfma_f32_16x16x32_bf16 a[4:7], v[192:195], a[196:199], 0
    v_add_f32 v252, v252, v187
    v_cvt_pk_bf16_f32 v213, v186, v187
    v_mfma_f32_16x16x32_bf16 a[8:11], v[192:195], a[200:203], 0
    v_exp_f32 v189, v189
    v_mfma_f32_16x16x32_bf16 a[12:15], v[192:195], a[204:207], 0
    s_waitcnt vmcnt(8)
    ds_read_b128 v[48:51], v8 offset:8192
    ds_read_b128 v[52:55], v9 offset:8192
    v_exp_f32 v190, v190
    v_mfma_f32_16x16x32_bf16 a[16:19], v[192:195], a[208:211], 0
    v_add_f32 v252, v252, v188
    v_add_f32 v252, v252, v189
    v_mfma_f32_16x16x32_bf16 a[20:23], v[192:195], a[212:215], 0
    ds_read_b128 v[56:59], v10 offset:8192
    ds_read_b128 v[60:63], v11 offset:8192
    v_exp_f32 v191, v191
    v_mfma_f32_16x16x32_bf16 a[24:27], v[192:195], a[216:219], 0
    v_cvt_pk_bf16_f32 v214, v188, v189
    v_add_f32 v252, v252, v190
    v_mfma_f32_16x16x32_bf16 a[28:31], v[192:195], a[220:223], 0
    v_add_f32 v252, v252, v191
    v_cvt_pk_bf16_f32 v215, v190, v191
    s_barrier
    s_waitcnt lgkmcnt(0)
.p2align 3
    v_mfma_f32_4x4x4_16b_bf16 v[184:187], v[12:13], v[48:49], 0
    v_mfma_f32_4x4x4_16b_bf16 v[188:191], v[12:13], v[50:51], 0
    s_nop 0
.p2align 3
    v_mfma_f32_4x4x4_16b_bf16 v[184:187], v[14:15], v[48:49], v[184:187]
    v_mfma_f32_4x4x4_16b_bf16 v[192:195], v[12:13], v[52:53], 0
    v_mfma_f32_4x4x4_16b_bf16 v[188:191], v[14:15], v[50:51], v[188:191]
    v_mfma_f32_4x4x4_16b_bf16 v[224:227], v[12:13], v[54:55], 0
    s_nop 1
.p2align 3
    v_cvt_pk_bf16_f32 v48, v184, v185
    v_mfma_f32_4x4x4_16b_bf16 v[192:195], v[14:15], v[52:53], v[192:195]
    v_cvt_pk_bf16_f32 v49, v186, v187
    v_mfma_f32_4x4x4_16b_bf16 v[184:187], v[12:13], v[56:57], 0
    v_cvt_pk_bf16_f32 v50, v188, v189
    v_mfma_f32_4x4x4_16b_bf16 v[224:227], v[14:15], v[54:55], v[224:227]
    v_cvt_pk_bf16_f32 v51, v190, v191
    v_mfma_f32_4x4x4_16b_bf16 v[188:191], v[12:13], v[58:59], 0
    v_cvt_pk_bf16_f32 v52, v192, v193
    v_mfma_f32_4x4x4_16b_bf16 v[184:187], v[14:15], v[56:57], v[184:187]
    v_cvt_pk_bf16_f32 v53, v194, v195
    v_mfma_f32_4x4x4_16b_bf16 v[192:195], v[12:13], v[60:61], 0
    v_cvt_pk_bf16_f32 v54, v224, v225
    v_mfma_f32_4x4x4_16b_bf16 v[188:191], v[14:15], v[58:59], v[188:191]
    v_cvt_pk_bf16_f32 v55, v226, v227
    v_mfma_f32_4x4x4_16b_bf16 v[224:227], v[12:13], v[62:63], 0
    v_cvt_pk_bf16_f32 v56, v184, v185
    v_mfma_f32_4x4x4_16b_bf16 v[192:195], v[14:15], v[60:61], v[192:195]
    v_cvt_pk_bf16_f32 v57, v186, v187
    v_cvt_pk_bf16_f32 v58, v188, v189
    v_mfma_f32_4x4x4_16b_bf16 v[224:227], v[14:15], v[62:63], v[224:227]
    v_cvt_pk_bf16_f32 v59, v190, v191
    s_nop 0
.p2align 3
    v_cvt_pk_bf16_f32 v60, v192, v193
    v_cvt_pk_bf16_f32 v61, v194, v195
    s_nop 0
.p2align 3
    v_cvt_pk_bf16_f32 v62, v224, v225
    v_cvt_pk_bf16_f32 v63, v226, v227
    v_mfma_f32_16x16x32_bf16 v[224:227], v[160:163], v[48:51], 0
    s_mov_b32 m0, s54
    s_add_u32 s54, s54, 4096
    buffer_load_dwordx4 v96, s[8:11], s53 offen offset:0 nt lds
    v_mfma_f32_16x16x32_bf16 v[224:227], v[164:167], v[52:55], v[224:227]
    buffer_load_dwordx4 v97, s[8:11], s53 offen offset:1024 nt lds
    v_mfma_f32_16x16x32_bf16 v[224:227], v[168:171], v[56:59], v[224:227]
    buffer_load_dwordx4 v98, s[8:11], s53 offen offset:2048 nt lds
    v_mfma_f32_16x16x32_bf16 v[224:227], v[172:175], v[60:63], v[224:227]
    buffer_load_dwordx4 v99, s[8:11], s53 offen offset:3072 nt lds
    s_add_u32 s53, s53, 4096
    v_mfma_f32_16x16x32_bf16 v[184:187], a[160:163], v[32:35], v[220:223]
    v_mfma_f32_16x16x32_bf16 v[184:187], a[164:167], v[36:39], v[184:187]
    v_exp_f32 v176, v176
    v_exp_f32 v177, v177
    v_mfma_f32_16x16x32_bf16 v[184:187], a[168:171], v[40:43], v[184:187]
    v_exp_f32 v178, v178
    v_mov_b32 v253, v176
    v_add_f32 v253, v253, v177
    v_mfma_f32_16x16x32_bf16 v[184:187], a[172:175], v[44:47], v[184:187]
    v_exp_f32 v179, v179
    v_cvt_pk_bf16_f32 v192, v176, v177
    v_add_f32 v253, v253, v178
    v_sub_f32 v224, s61, v224
    v_mfma_f32_16x16x32_bf16 v[188:191], a[188:191], v[44:47], v[220:223]
    v_exp_f32 v180, v180
    v_add_f32 v253, v253, v179
    v_cvt_pk_bf16_f32 v193, v178, v179
    v_sub_f32 v225, s61, v225
    v_mfma_f32_16x16x32_bf16 v[188:191], a[184:187], v[40:43], v[188:191]
    v_exp_f32 v181, v181
    v_exp_f32 v182, v182
    v_sub_f32 v226, s61, v226
    v_mfma_f32_16x16x32_bf16 v[188:191], a[180:183], v[36:39], v[188:191]
    v_add_f32 v253, v253, v180
    v_add_f32 v253, v253, v181
    v_exp_f32 v183, v183
    v_sub_f32 v227, s61, v227
    v_mfma_f32_16x16x32_bf16 v[188:191], a[176:179], v[32:35], v[188:191]
    v_cvt_pk_bf16_f32 v194, v180, v181
    v_add_f32 v253, v253, v182
    v_add_f32 v253, v253, v183
    v_cvt_pk_bf16_f32 v195, v182, v183
    s_nop 7
    v_mfma_f32_16x16x32_bf16 v[176:179], a[128:131], v[48:51], v[224:227]
    v_mfma_f32_16x16x32_bf16 v[176:179], a[132:135], v[52:55], v[176:179]
    v_exp_f32 v184, v184
    v_mfma_f32_16x16x32_bf16 v[176:179], a[136:139], v[56:59], v[176:179]
    v_mfma_f32_16x16x32_bf16 v[176:179], a[140:143], v[60:63], v[176:179]
    v_exp_f32 v185, v185
    v_mfma_f32_16x16x32_bf16 v[180:183], a[156:159], v[60:63], v[224:227]
    v_exp_f32 v186, v186
    v_mfma_f32_16x16x32_bf16 v[180:183], a[152:155], v[56:59], v[180:183]
    v_add_f32 v253, v253, v184
    v_add_f32 v253, v253, v185
    v_mfma_f32_16x16x32_bf16 v[180:183], a[148:151], v[52:55], v[180:183]
    v_exp_f32 v187, v187
    v_mfma_f32_16x16x32_bf16 v[180:183], a[144:147], v[48:51], v[180:183]
    v_cvt_pk_bf16_f32 v196, v184, v185
    v_add_f32 v253, v253, v186
    v_mfma_f32_16x16x32_bf16 a[32:35], v[192:195], a[192:195], 0
    v_exp_f32 v188, v188
    v_mfma_f32_16x16x32_bf16 a[36:39], v[192:195], a[196:199], 0
    v_add_f32 v253, v253, v187
    v_cvt_pk_bf16_f32 v197, v186, v187
    v_mfma_f32_16x16x32_bf16 a[40:43], v[192:195], a[200:203], 0
    v_exp_f32 v189, v189
    v_mfma_f32_16x16x32_bf16 a[44:47], v[192:195], a[204:207], 0
    s_waitcnt vmcnt(8)
    ds_read_b128 v[64:67], v8 offset:12288
    ds_read_b128 v[68:71], v9 offset:12288
    v_exp_f32 v190, v190
    v_mfma_f32_16x16x32_bf16 a[48:51], v[192:195], a[208:211], 0
    v_add_f32 v253, v253, v188
    v_add_f32 v253, v253, v189
    v_mfma_f32_16x16x32_bf16 a[52:55], v[192:195], a[212:215], 0
    ds_read_b128 v[72:75], v10 offset:12288
    ds_read_b128 v[76:79], v11 offset:12288
    v_exp_f32 v191, v191
    v_mfma_f32_16x16x32_bf16 a[56:59], v[192:195], a[216:219], 0
    v_cvt_pk_bf16_f32 v198, v188, v189
    v_add_f32 v253, v253, v190
    v_mfma_f32_16x16x32_bf16 a[60:63], v[192:195], a[220:223], 0
    v_add_f32 v253, v253, v191
    v_cvt_pk_bf16_f32 v199, v190, v191
    s_waitcnt lgkmcnt(0)
.p2align 3
    v_mfma_f32_4x4x4_16b_bf16 v[184:187], v[12:13], v[64:65], 0
    v_mfma_f32_4x4x4_16b_bf16 v[188:191], v[12:13], v[66:67], 0
    s_nop 0
.p2align 3
    v_mfma_f32_4x4x4_16b_bf16 v[184:187], v[14:15], v[64:65], v[184:187]
    v_mfma_f32_4x4x4_16b_bf16 v[192:195], v[12:13], v[68:69], 0
    v_mfma_f32_4x4x4_16b_bf16 v[188:191], v[14:15], v[66:67], v[188:191]
    v_mfma_f32_4x4x4_16b_bf16 v[228:231], v[12:13], v[70:71], 0
    s_nop 1
.p2align 3
    v_cvt_pk_bf16_f32 v64, v184, v185
    v_mfma_f32_4x4x4_16b_bf16 v[192:195], v[14:15], v[68:69], v[192:195]
    v_cvt_pk_bf16_f32 v65, v186, v187
    v_mfma_f32_4x4x4_16b_bf16 v[184:187], v[12:13], v[72:73], 0
    v_cvt_pk_bf16_f32 v66, v188, v189
    v_mfma_f32_4x4x4_16b_bf16 v[228:231], v[14:15], v[70:71], v[228:231]
    v_cvt_pk_bf16_f32 v67, v190, v191
    v_mfma_f32_4x4x4_16b_bf16 v[188:191], v[12:13], v[74:75], 0
    v_cvt_pk_bf16_f32 v68, v192, v193
    v_mfma_f32_4x4x4_16b_bf16 v[184:187], v[14:15], v[72:73], v[184:187]
    v_cvt_pk_bf16_f32 v69, v194, v195
    v_mfma_f32_4x4x4_16b_bf16 v[192:195], v[12:13], v[76:77], 0
    v_cvt_pk_bf16_f32 v70, v228, v229
    v_mfma_f32_4x4x4_16b_bf16 v[188:191], v[14:15], v[74:75], v[188:191]
    v_cvt_pk_bf16_f32 v71, v230, v231
    v_mfma_f32_4x4x4_16b_bf16 v[228:231], v[12:13], v[78:79], 0
    v_cvt_pk_bf16_f32 v72, v184, v185
    v_mfma_f32_4x4x4_16b_bf16 v[192:195], v[14:15], v[76:77], v[192:195]
    v_cvt_pk_bf16_f32 v73, v186, v187
    v_cvt_pk_bf16_f32 v74, v188, v189
    v_mfma_f32_4x4x4_16b_bf16 v[228:231], v[14:15], v[78:79], v[228:231]
    v_cvt_pk_bf16_f32 v75, v190, v191
    s_nop 0
.p2align 3
    v_cvt_pk_bf16_f32 v76, v192, v193
    v_cvt_pk_bf16_f32 v77, v194, v195
    s_nop 0
.p2align 3
    v_cvt_pk_bf16_f32 v78, v228, v229
    v_cvt_pk_bf16_f32 v79, v230, v231
    v_mfma_f32_16x16x32_bf16 v[228:231], v[160:163], v[64:67], 0
    s_add_u32 m0, s6, 16384
    s_add_u32 s29, s7, 16384
    buffer_load_dwordx4 v103, s[12:15], s29 offen nt lds
    v_mfma_f32_16x16x32_bf16 v[228:231], v[164:167], v[68:71], v[228:231]
    s_add_u32 m0, s6, 20480
    s_add_u32 s29, s7, 20480
    buffer_load_dwordx4 v103, s[12:15], s29 offen nt lds
    v_mfma_f32_16x16x32_bf16 v[228:231], v[168:171], v[72:75], v[228:231]
    s_add_u32 m0, s6, 24576
    s_add_u32 s29, s7, 24576
    buffer_load_dwordx4 v103, s[12:15], s29 offen nt lds
    v_mfma_f32_16x16x32_bf16 v[228:231], v[172:175], v[76:79], v[228:231]
    s_add_u32 m0, s6, 28672
    s_add_u32 s29, s7, 28672
    buffer_load_dwordx4 v103, s[12:15], s29 offen nt lds
    v_mfma_f32_16x16x32_bf16 v[184:187], a[160:163], v[48:51], v[224:227]
    v_mfma_f32_16x16x32_bf16 v[184:187], a[164:167], v[52:55], v[184:187]
    v_exp_f32 v176, v176
    v_mfma_f32_16x16x32_bf16 v[184:187], a[168:171], v[56:59], v[184:187]
    v_mfma_f32_16x16x32_bf16 v[184:187], a[172:175], v[60:63], v[184:187]
    v_exp_f32 v177, v177
    v_mfma_f32_16x16x32_bf16 v[188:191], a[188:191], v[60:63], v[224:227]
    v_exp_f32 v178, v178
    v_mfma_f32_16x16x32_bf16 v[188:191], a[184:187], v[56:59], v[188:191]
    v_mov_b32 v254, v176
    v_add_f32 v254, v254, v177
    v_mfma_f32_16x16x32_bf16 v[188:191], a[180:183], v[52:55], v[188:191]
    v_exp_f32 v179, v179
    v_mfma_f32_16x16x32_bf16 v[188:191], a[176:179], v[48:51], v[188:191]
    v_cvt_pk_bf16_f32 v192, v176, v177
    v_add_f32 v254, v254, v178
    v_mfma_f32_16x16x32_bf16 a[32:35], v[196:199], a[224:227], a[32:35]
    v_exp_f32 v180, v180
    v_mfma_f32_16x16x32_bf16 a[36:39], v[196:199], a[228:231], a[36:39]
    v_add_f32 v254, v254, v179
    v_cvt_pk_bf16_f32 v193, v178, v179
    v_mfma_f32_16x16x32_bf16 a[40:43], v[196:199], a[232:235], a[40:43]
    v_exp_f32 v181, v181
    v_mfma_f32_16x16x32_bf16 a[44:47], v[196:199], a[236:239], a[44:47]
    v_exp_f32 v182, v182
    v_sub_f32 v228, s61, v228
    v_mfma_f32_16x16x32_bf16 a[48:51], v[196:199], a[240:243], a[48:51]
    v_add_f32 v254, v254, v180
    v_add_f32 v254, v254, v181
    v_sub_f32 v229, s61, v229
    v_mfma_f32_16x16x32_bf16 a[52:55], v[196:199], a[244:247], a[52:55]
    v_exp_f32 v183, v183
    v_sub_f32 v230, s61, v230
    v_mfma_f32_16x16x32_bf16 a[56:59], v[196:199], a[248:251], a[56:59]
    v_cvt_pk_bf16_f32 v194, v180, v181
    v_add_f32 v254, v254, v182
    v_sub_f32 v231, s61, v231
    v_mfma_f32_16x16x32_bf16 a[60:63], v[196:199], a[252:255], a[60:63]
    v_add_f32 v254, v254, v183
    v_cvt_pk_bf16_f32 v195, v182, v183
    v_mfma_f32_16x16x32_bf16 v[176:179], a[128:131], v[64:67], v[228:231]
    v_mfma_f32_16x16x32_bf16 v[176:179], a[132:135], v[68:71], v[176:179]
    v_exp_f32 v184, v184
    v_mfma_f32_16x16x32_bf16 v[176:179], a[136:139], v[72:75], v[176:179]
    v_mfma_f32_16x16x32_bf16 v[176:179], a[140:143], v[76:79], v[176:179]
    v_exp_f32 v185, v185
    v_mfma_f32_16x16x32_bf16 v[180:183], a[156:159], v[76:79], v[228:231]
    v_exp_f32 v186, v186
    v_mfma_f32_16x16x32_bf16 v[180:183], a[152:155], v[72:75], v[180:183]
    v_add_f32 v254, v254, v184
    v_add_f32 v254, v254, v185
    v_mfma_f32_16x16x32_bf16 v[180:183], a[148:151], v[68:71], v[180:183]
    v_exp_f32 v187, v187
    v_mfma_f32_16x16x32_bf16 v[180:183], a[144:147], v[64:67], v[180:183]
    v_cvt_pk_bf16_f32 v200, v184, v185
    v_add_f32 v254, v254, v186
    v_mfma_f32_16x16x32_bf16 a[64:67], v[192:195], a[192:195], 0
    v_exp_f32 v188, v188
    v_mfma_f32_16x16x32_bf16 a[68:71], v[192:195], a[196:199], 0
    v_add_f32 v254, v254, v187
    v_cvt_pk_bf16_f32 v201, v186, v187
    v_mfma_f32_16x16x32_bf16 a[72:75], v[192:195], a[200:203], 0
    v_exp_f32 v189, v189
    v_mfma_f32_16x16x32_bf16 a[76:79], v[192:195], a[204:207], 0
    s_waitcnt vmcnt(8)
    ds_read_b128 v[80:83], v8 offset:16384
    ds_read_b128 v[84:87], v9 offset:16384
    v_exp_f32 v190, v190
    v_mfma_f32_16x16x32_bf16 a[80:83], v[192:195], a[208:211], 0
    v_add_f32 v254, v254, v188
    v_add_f32 v254, v254, v189
    v_mfma_f32_16x16x32_bf16 a[84:87], v[192:195], a[212:215], 0
    ds_read_b128 v[88:91], v10 offset:16384
    ds_read_b128 v[92:95], v11 offset:16384
    v_exp_f32 v191, v191
    v_mfma_f32_16x16x32_bf16 a[88:91], v[192:195], a[216:219], 0
    v_cvt_pk_bf16_f32 v202, v188, v189
    v_add_f32 v254, v254, v190
    v_mfma_f32_16x16x32_bf16 a[92:95], v[192:195], a[220:223], 0
    v_add_f32 v254, v254, v191
    v_cvt_pk_bf16_f32 v203, v190, v191
    s_waitcnt lgkmcnt(0)
.p2align 3
    v_mfma_f32_4x4x4_16b_bf16 v[184:187], v[12:13], v[80:81], 0
    v_mfma_f32_4x4x4_16b_bf16 v[188:191], v[12:13], v[82:83], 0
    s_nop 0
.p2align 3
    v_mfma_f32_4x4x4_16b_bf16 v[184:187], v[14:15], v[80:81], v[184:187]
    v_mfma_f32_4x4x4_16b_bf16 v[192:195], v[12:13], v[84:85], 0
    v_mfma_f32_4x4x4_16b_bf16 v[188:191], v[14:15], v[82:83], v[188:191]
    v_mfma_f32_4x4x4_16b_bf16 v[232:235], v[12:13], v[86:87], 0
    s_nop 1
.p2align 3
    v_cvt_pk_bf16_f32 v80, v184, v185
    v_mfma_f32_4x4x4_16b_bf16 v[192:195], v[14:15], v[84:85], v[192:195]
    v_cvt_pk_bf16_f32 v81, v186, v187
    v_mfma_f32_4x4x4_16b_bf16 v[184:187], v[12:13], v[88:89], 0
    v_cvt_pk_bf16_f32 v82, v188, v189
    v_mfma_f32_4x4x4_16b_bf16 v[232:235], v[14:15], v[86:87], v[232:235]
    v_cvt_pk_bf16_f32 v83, v190, v191
    v_mfma_f32_4x4x4_16b_bf16 v[188:191], v[12:13], v[90:91], 0
    v_cvt_pk_bf16_f32 v84, v192, v193
    v_mfma_f32_4x4x4_16b_bf16 v[184:187], v[14:15], v[88:89], v[184:187]
    v_cvt_pk_bf16_f32 v85, v194, v195
    v_mfma_f32_4x4x4_16b_bf16 v[192:195], v[12:13], v[92:93], 0
    v_cvt_pk_bf16_f32 v86, v232, v233
    v_mfma_f32_4x4x4_16b_bf16 v[188:191], v[14:15], v[90:91], v[188:191]
    v_cvt_pk_bf16_f32 v87, v234, v235
    v_mfma_f32_4x4x4_16b_bf16 v[232:235], v[12:13], v[94:95], 0
    v_cvt_pk_bf16_f32 v88, v184, v185
    v_mfma_f32_4x4x4_16b_bf16 v[192:195], v[14:15], v[92:93], v[192:195]
    v_cvt_pk_bf16_f32 v89, v186, v187
    v_cvt_pk_bf16_f32 v90, v188, v189
    v_mfma_f32_4x4x4_16b_bf16 v[232:235], v[14:15], v[94:95], v[232:235]
    v_cvt_pk_bf16_f32 v91, v190, v191
    s_nop 0
.p2align 3
    v_cvt_pk_bf16_f32 v92, v192, v193
    v_cvt_pk_bf16_f32 v93, v194, v195
    s_nop 0
.p2align 3
    v_cvt_pk_bf16_f32 v94, v232, v233
    v_cvt_pk_bf16_f32 v95, v234, v235
    v_mfma_f32_16x16x32_bf16 v[232:235], v[160:163], v[80:83], 0
    s_add_u32 m0, s6, 49152
    s_add_u32 s29, s7, 16384
    buffer_load_dwordx4 v104, s[16:19], s29 offen nt lds
    v_mfma_f32_16x16x32_bf16 v[232:235], v[164:167], v[84:87], v[232:235]
    s_add_u32 m0, s6, 53248
    s_add_u32 s29, s7, 20480
    buffer_load_dwordx4 v104, s[16:19], s29 offen nt lds
    v_mfma_f32_16x16x32_bf16 v[232:235], v[168:171], v[88:91], v[232:235]
    s_add_u32 m0, s6, 57344
    s_add_u32 s29, s7, 24576
    buffer_load_dwordx4 v104, s[16:19], s29 offen nt lds
    v_mfma_f32_16x16x32_bf16 v[232:235], v[172:175], v[92:95], v[232:235]
    s_add_u32 m0, s6, 61440
    s_add_u32 s29, s7, 28672
    buffer_load_dwordx4 v104, s[16:19], s29 offen nt lds
    v_mfma_f32_16x16x32_bf16 v[184:187], a[160:163], v[64:67], v[228:231]
    v_mfma_f32_16x16x32_bf16 v[184:187], a[164:167], v[68:71], v[184:187]
    v_exp_f32 v176, v176
    v_exp_f32 v177, v177
    v_mfma_f32_16x16x32_bf16 v[184:187], a[168:171], v[72:75], v[184:187]
    v_exp_f32 v178, v178
    v_mov_b32 v255, v176
    v_add_f32 v255, v255, v177
    v_mfma_f32_16x16x32_bf16 v[184:187], a[172:175], v[76:79], v[184:187]
    v_exp_f32 v179, v179
    v_cvt_pk_bf16_f32 v192, v176, v177
    v_add_f32 v255, v255, v178
    v_sub_f32 v232, s61, v232
    v_mfma_f32_16x16x32_bf16 v[188:191], a[188:191], v[76:79], v[228:231]
    v_exp_f32 v180, v180
    v_add_f32 v255, v255, v179
    v_cvt_pk_bf16_f32 v193, v178, v179
    v_sub_f32 v233, s61, v233
    v_mfma_f32_16x16x32_bf16 v[188:191], a[184:187], v[72:75], v[188:191]
    v_exp_f32 v181, v181
    v_exp_f32 v182, v182
    v_sub_f32 v234, s61, v234
    v_mfma_f32_16x16x32_bf16 v[188:191], a[180:183], v[68:71], v[188:191]
    v_add_f32 v255, v255, v180
    v_add_f32 v255, v255, v181
    v_exp_f32 v183, v183
    v_sub_f32 v235, s61, v235
    v_mfma_f32_16x16x32_bf16 v[188:191], a[176:179], v[64:67], v[188:191]
    v_cvt_pk_bf16_f32 v194, v180, v181
    v_add_f32 v255, v255, v182
    v_add_f32 v255, v255, v183
    v_cvt_pk_bf16_f32 v195, v182, v183
    s_nop 7
    v_mfma_f32_16x16x32_bf16 v[176:179], a[128:131], v[80:83], v[232:235]
    v_mfma_f32_16x16x32_bf16 v[176:179], a[132:135], v[84:87], v[176:179]
    v_exp_f32 v184, v184
    v_mfma_f32_16x16x32_bf16 v[176:179], a[136:139], v[88:91], v[176:179]
    v_mfma_f32_16x16x32_bf16 v[176:179], a[140:143], v[92:95], v[176:179]
    v_exp_f32 v185, v185
    v_mfma_f32_16x16x32_bf16 v[180:183], a[156:159], v[92:95], v[232:235]
    v_exp_f32 v186, v186
    v_mfma_f32_16x16x32_bf16 v[180:183], a[152:155], v[88:91], v[180:183]
    v_add_f32 v255, v255, v184
    v_add_f32 v255, v255, v185
    v_mfma_f32_16x16x32_bf16 v[180:183], a[148:151], v[84:87], v[180:183]
    v_exp_f32 v187, v187
    v_mfma_f32_16x16x32_bf16 v[180:183], a[144:147], v[80:83], v[180:183]
    v_cvt_pk_bf16_f32 v196, v184, v185
    v_add_f32 v255, v255, v186
    v_mfma_f32_16x16x32_bf16 a[96:99], v[192:195], a[192:195], 0
    v_exp_f32 v188, v188
    v_mfma_f32_16x16x32_bf16 a[100:103], v[192:195], a[196:199], 0
    v_add_f32 v255, v255, v187
    v_cvt_pk_bf16_f32 v197, v186, v187
    v_mfma_f32_16x16x32_bf16 a[104:107], v[192:195], a[200:203], 0
    v_exp_f32 v189, v189
    v_mfma_f32_16x16x32_bf16 a[108:111], v[192:195], a[204:207], 0
    s_waitcnt vmcnt(8)
    ds_read_b128 v[96:99], v8 offset:20480
    ds_read_b128 v[100:103], v9 offset:20480
    v_exp_f32 v190, v190
    v_mfma_f32_16x16x32_bf16 a[112:115], v[192:195], a[208:211], 0
    v_add_f32 v255, v255, v188
    v_add_f32 v255, v255, v189
    v_mfma_f32_16x16x32_bf16 a[116:119], v[192:195], a[212:215], 0
    ds_read_b128 v[104:107], v10 offset:20480
    ds_read_b128 v[108:111], v11 offset:20480
    v_exp_f32 v191, v191
    v_mfma_f32_16x16x32_bf16 a[120:123], v[192:195], a[216:219], 0
    v_cvt_pk_bf16_f32 v198, v188, v189
    v_add_f32 v255, v255, v190
    v_mfma_f32_16x16x32_bf16 a[124:127], v[192:195], a[220:223], 0
    v_add_f32 v255, v255, v191
    v_cvt_pk_bf16_f32 v199, v190, v191
    s_waitcnt lgkmcnt(0)
.p2align 3
    v_mfma_f32_4x4x4_16b_bf16 v[184:187], v[12:13], v[96:97], 0
    v_mfma_f32_4x4x4_16b_bf16 v[188:191], v[12:13], v[98:99], 0
    s_nop 0
.p2align 3
    v_mfma_f32_4x4x4_16b_bf16 v[184:187], v[14:15], v[96:97], v[184:187]
    v_mfma_f32_4x4x4_16b_bf16 v[192:195], v[12:13], v[100:101], 0
    v_mfma_f32_4x4x4_16b_bf16 v[188:191], v[14:15], v[98:99], v[188:191]
    v_mfma_f32_4x4x4_16b_bf16 v[236:239], v[12:13], v[102:103], 0
    s_nop 1
.p2align 3
    v_cvt_pk_bf16_f32 v96, v184, v185
    v_mfma_f32_4x4x4_16b_bf16 v[192:195], v[14:15], v[100:101], v[192:195]
    v_cvt_pk_bf16_f32 v97, v186, v187
    v_mfma_f32_4x4x4_16b_bf16 v[184:187], v[12:13], v[104:105], 0
    v_cvt_pk_bf16_f32 v98, v188, v189
    v_mfma_f32_4x4x4_16b_bf16 v[236:239], v[14:15], v[102:103], v[236:239]
    v_cvt_pk_bf16_f32 v99, v190, v191
    v_mfma_f32_4x4x4_16b_bf16 v[188:191], v[12:13], v[106:107], 0
    v_cvt_pk_bf16_f32 v100, v192, v193
    v_mfma_f32_4x4x4_16b_bf16 v[184:187], v[14:15], v[104:105], v[184:187]
    v_cvt_pk_bf16_f32 v101, v194, v195
    v_mfma_f32_4x4x4_16b_bf16 v[192:195], v[12:13], v[108:109], 0
    v_cvt_pk_bf16_f32 v102, v236, v237
    v_mfma_f32_4x4x4_16b_bf16 v[188:191], v[14:15], v[106:107], v[188:191]
    v_cvt_pk_bf16_f32 v103, v238, v239
    v_mfma_f32_4x4x4_16b_bf16 v[236:239], v[12:13], v[110:111], 0
    v_cvt_pk_bf16_f32 v104, v184, v185
    v_mfma_f32_4x4x4_16b_bf16 v[192:195], v[14:15], v[108:109], v[192:195]
    v_cvt_pk_bf16_f32 v105, v186, v187
    v_cvt_pk_bf16_f32 v106, v188, v189
    v_mfma_f32_4x4x4_16b_bf16 v[236:239], v[14:15], v[110:111], v[236:239]
    v_cvt_pk_bf16_f32 v107, v190, v191
    s_nop 0
.p2align 3
    v_cvt_pk_bf16_f32 v108, v192, v193
    v_cvt_pk_bf16_f32 v109, v194, v195
    s_nop 0
.p2align 3
    v_cvt_pk_bf16_f32 v110, v236, v237
    v_cvt_pk_bf16_f32 v111, v238, v239
    v_mfma_f32_16x16x32_bf16 v[236:239], v[160:163], v[96:99], 0
    v_mfma_f32_16x16x32_bf16 v[236:239], v[164:167], v[100:103], v[236:239]
    v_mfma_f32_16x16x32_bf16 v[236:239], v[168:171], v[104:107], v[236:239]
    v_mfma_f32_16x16x32_bf16 v[236:239], v[172:175], v[108:111], v[236:239]
    v_mfma_f32_16x16x32_bf16 v[184:187], a[160:163], v[80:83], v[232:235]
    v_mfma_f32_16x16x32_bf16 v[184:187], a[164:167], v[84:87], v[184:187]
    v_exp_f32 v176, v176
    v_mfma_f32_16x16x32_bf16 v[184:187], a[168:171], v[88:91], v[184:187]
    v_mfma_f32_16x16x32_bf16 v[184:187], a[172:175], v[92:95], v[184:187]
    v_exp_f32 v177, v177
    v_mfma_f32_16x16x32_bf16 v[188:191], a[188:191], v[92:95], v[232:235]
    v_exp_f32 v178, v178
    v_mfma_f32_16x16x32_bf16 v[188:191], a[184:187], v[88:91], v[188:191]
    v_mov_b32 v0, v176
    v_add_f32 v0, v0, v177
    v_mfma_f32_16x16x32_bf16 v[188:191], a[180:183], v[84:87], v[188:191]
    v_exp_f32 v179, v179
    v_mfma_f32_16x16x32_bf16 v[188:191], a[176:179], v[80:83], v[188:191]
    v_cvt_pk_bf16_f32 v192, v176, v177
    v_add_f32 v0, v0, v178
    v_mfma_f32_16x16x32_bf16 a[96:99], v[196:199], a[224:227], a[96:99]
    v_exp_f32 v180, v180
    v_mfma_f32_16x16x32_bf16 a[100:103], v[196:199], a[228:231], a[100:103]
    v_add_f32 v0, v0, v179
    v_cvt_pk_bf16_f32 v193, v178, v179
    v_mfma_f32_16x16x32_bf16 a[104:107], v[196:199], a[232:235], a[104:107]
    v_exp_f32 v181, v181
    v_mfma_f32_16x16x32_bf16 a[108:111], v[196:199], a[236:239], a[108:111]
    v_exp_f32 v182, v182
    v_sub_f32 v236, s61, v236
    v_mfma_f32_16x16x32_bf16 a[112:115], v[196:199], a[240:243], a[112:115]
    v_add_f32 v0, v0, v180
    v_add_f32 v0, v0, v181
    v_sub_f32 v237, s61, v237
    v_mfma_f32_16x16x32_bf16 a[116:119], v[196:199], a[244:247], a[116:119]
    v_exp_f32 v183, v183
    v_sub_f32 v238, s61, v238
    v_mfma_f32_16x16x32_bf16 a[120:123], v[196:199], a[248:251], a[120:123]
    v_cvt_pk_bf16_f32 v194, v180, v181
    v_add_f32 v0, v0, v182
    v_sub_f32 v239, s61, v239
    v_mfma_f32_16x16x32_bf16 a[124:127], v[196:199], a[252:255], a[124:127]
    v_add_f32 v0, v0, v183
    v_cvt_pk_bf16_f32 v195, v182, v183
    v_mfma_f32_16x16x32_bf16 v[176:179], a[128:131], v[96:99], v[236:239]
    v_mfma_f32_16x16x32_bf16 v[176:179], a[132:135], v[100:103], v[176:179]
    v_exp_f32 v184, v184
    v_mfma_f32_16x16x32_bf16 v[176:179], a[136:139], v[104:107], v[176:179]
    v_mfma_f32_16x16x32_bf16 v[176:179], a[140:143], v[108:111], v[176:179]
    v_exp_f32 v185, v185
    v_mfma_f32_16x16x32_bf16 v[180:183], a[156:159], v[108:111], v[236:239]
    v_exp_f32 v186, v186
    v_mfma_f32_16x16x32_bf16 v[180:183], a[152:155], v[104:107], v[180:183]
    v_add_f32 v0, v0, v184
    v_add_f32 v0, v0, v185
    v_mfma_f32_16x16x32_bf16 v[180:183], a[148:151], v[100:103], v[180:183]
    v_exp_f32 v187, v187
    v_mfma_f32_16x16x32_bf16 v[180:183], a[144:147], v[96:99], v[180:183]
    s_waitcnt vmcnt(4)
    v_cvt_pk_bf16_f32 v204, v184, v185
    v_add_f32 v0, v0, v186
    v_mfma_f32_16x16x32_bf16 v[112:115], v[192:195], a[192:195], 0
    s_barrier
    ds_read_b128 a[128:131], v240 offset:16384
    v_exp_f32 v188, v188
    v_mfma_f32_16x16x32_bf16 v[116:119], v[192:195], a[196:199], 0
    v_add_f32 v0, v0, v187
    v_cvt_pk_bf16_f32 v205, v186, v187
    v_mfma_f32_16x16x32_bf16 v[120:123], v[192:195], a[200:203], 0
    ds_read_b128 a[132:135], v241 offset:16384
    v_exp_f32 v189, v189
    v_mfma_f32_16x16x32_bf16 v[124:127], v[192:195], a[204:207], 0
    ds_read_b128 a[136:139], v242 offset:16384
    v_exp_f32 v190, v190
    v_mfma_f32_16x16x32_bf16 v[128:131], v[192:195], a[208:211], 0
    v_add_f32 v0, v0, v188
    v_add_f32 v0, v0, v189
    v_mfma_f32_16x16x32_bf16 v[132:135], v[192:195], a[212:215], 0
    ds_read_b128 a[140:143], v243 offset:16384
    v_exp_f32 v191, v191
    v_mfma_f32_16x16x32_bf16 v[136:139], v[192:195], a[216:219], 0
    v_cvt_pk_bf16_f32 v206, v188, v189
    v_add_f32 v0, v0, v190
    v_mfma_f32_16x16x32_bf16 v[140:143], v[192:195], a[220:223], 0
    v_add_f32 v0, v0, v191
    v_cvt_pk_bf16_f32 v207, v190, v191
    v_mfma_f32_16x16x32_bf16 v[184:187], a[160:163], v[96:99], v[236:239]
    ds_read_b128 a[144:147], v240 offset:20480
    ds_read_b128 a[148:151], v241 offset:20480
    v_mfma_f32_16x16x32_bf16 v[184:187], a[164:167], v[100:103], v[184:187]
    ds_read_b128 a[152:155], v242 offset:20480
    ds_read_b128 a[156:159], v243 offset:20480
    v_exp_f32 v176, v176
    v_exp_f32 v177, v177
    v_mfma_f32_16x16x32_bf16 v[184:187], a[168:171], v[104:107], v[184:187]
    v_exp_f32 v178, v178
    v_mov_b32 v1, v176
    v_add_f32 v1, v1, v177
    v_mfma_f32_16x16x32_bf16 v[184:187], a[172:175], v[108:111], v[184:187]
    v_exp_f32 v179, v179
    v_cvt_pk_bf16_f32 v192, v176, v177
    v_add_f32 v1, v1, v178
    v_mfma_f32_16x16x32_bf16 v[188:191], a[188:191], v[108:111], v[236:239]
    v_exp_f32 v180, v180
    v_add_f32 v1, v1, v179
    v_cvt_pk_bf16_f32 v193, v178, v179
    v_mfma_f32_16x16x32_bf16 v[188:191], a[184:187], v[104:107], v[188:191]
    v_exp_f32 v181, v181
    v_exp_f32 v182, v182
    v_mfma_f32_16x16x32_bf16 v[188:191], a[180:183], v[100:103], v[188:191]
    v_add_f32 v1, v1, v180
    v_add_f32 v1, v1, v181
    v_exp_f32 v183, v183
    v_mfma_f32_16x16x32_bf16 v[188:191], a[176:179], v[96:99], v[188:191]
    v_cvt_pk_bf16_f32 v194, v180, v181
    v_add_f32 v1, v1, v182
    v_add_f32 v1, v1, v183
    v_cvt_pk_bf16_f32 v195, v182, v183
    s_nop 7
    s_waitcnt lgkmcnt(0)
    v_mfma_f32_16x16x32_bf16 v[176:179], a[128:131], v[16:19], v[216:219]
    v_mfma_f32_16x16x32_bf16 v[176:179], a[132:135], v[20:23], v[176:179]
    v_exp_f32 v184, v184
    v_mfma_f32_16x16x32_bf16 v[176:179], a[136:139], v[24:27], v[176:179]
    v_mfma_f32_16x16x32_bf16 v[176:179], a[140:143], v[28:31], v[176:179]
    v_exp_f32 v185, v185
    v_mfma_f32_16x16x32_bf16 v[180:183], a[156:159], v[28:31], v[216:219]
    v_exp_f32 v186, v186
    v_mfma_f32_16x16x32_bf16 v[180:183], a[152:155], v[24:27], v[180:183]
    v_add_f32 v1, v1, v184
    v_add_f32 v1, v1, v185
    v_mfma_f32_16x16x32_bf16 v[180:183], a[148:151], v[20:23], v[180:183]
    v_exp_f32 v187, v187
    v_mfma_f32_16x16x32_bf16 v[180:183], a[144:147], v[16:19], v[180:183]
    v_cvt_pk_bf16_f32 v196, v184, v185
    v_add_f32 v1, v1, v186
    v_mfma_f32_16x16x32_bf16 v[144:147], v[192:195], a[192:195], 0
    v_exp_f32 v188, v188
    v_mfma_f32_16x16x32_bf16 v[148:151], v[192:195], a[196:199], 0
    v_add_f32 v1, v1, v187
    v_cvt_pk_bf16_f32 v197, v186, v187
    v_mfma_f32_16x16x32_bf16 v[152:155], v[192:195], a[200:203], 0
    v_exp_f32 v189, v189
    v_mfma_f32_16x16x32_bf16 v[156:159], v[192:195], a[204:207], 0
    v_exp_f32 v190, v190
    v_mfma_f32_16x16x32_bf16 v[160:163], v[192:195], a[208:211], 0
    v_add_f32 v1, v1, v188
    v_add_f32 v1, v1, v189
    v_mfma_f32_16x16x32_bf16 v[164:167], v[192:195], a[212:215], 0
    v_exp_f32 v191, v191
    v_mfma_f32_16x16x32_bf16 v[168:171], v[192:195], a[216:219], 0
    v_cvt_pk_bf16_f32 v198, v188, v189
    v_add_f32 v1, v1, v190
    v_mfma_f32_16x16x32_bf16 v[172:175], v[192:195], a[220:223], 0
    s_waitcnt vmcnt(0)
    v_add_f32 v1, v1, v191
    v_cvt_pk_bf16_f32 v199, v190, v191
    v_mfma_f32_16x16x32_bf16 v[184:187], a[128:131], v[32:35], v[220:223]
    s_barrier
    ds_read_b64_tr_b16 a[192:193], v244 offset:16384
    ds_read_b64_tr_b16 a[194:195], v244 offset:20480
    v_mfma_f32_16x16x32_bf16 v[184:187], a[132:135], v[36:39], v[184:187]
    v_exp_f32 v176, v176
    v_mfma_f32_16x16x32_bf16 v[184:187], a[136:139], v[40:43], v[184:187]
    ds_read_b64_tr_b16 a[196:197], v245 offset:16384
    ds_read_b64_tr_b16 a[198:199], v245 offset:20480
    v_mfma_f32_16x16x32_bf16 v[184:187], a[140:143], v[44:47], v[184:187]
    v_exp_f32 v177, v177
    v_mfma_f32_16x16x32_bf16 v[188:191], a[156:159], v[44:47], v[220:223]
    ds_read_b64_tr_b16 a[200:201], v246 offset:16384
    v_exp_f32 v178, v178
    v_mfma_f32_16x16x32_bf16 v[188:191], a[152:155], v[40:43], v[188:191]
    v_add_f32 v252, v252, v176
    v_add_f32 v252, v252, v177
    v_mfma_f32_16x16x32_bf16 v[188:191], a[148:151], v[36:39], v[188:191]
    ds_read_b64_tr_b16 a[202:203], v246 offset:20480
    v_exp_f32 v179, v179
    v_mfma_f32_16x16x32_bf16 v[188:191], a[144:147], v[32:35], v[188:191]
    v_cvt_pk_bf16_f32 v192, v176, v177
    v_add_f32 v252, v252, v178
    v_mfma_f32_16x16x32_bf16 v[144:147], v[196:199], a[224:227], v[144:147]
    ds_read_b64_tr_b16 a[204:205], v247 offset:16384
    v_exp_f32 v180, v180
    v_mfma_f32_16x16x32_bf16 v[148:151], v[196:199], a[228:231], v[148:151]
    v_add_f32 v252, v252, v179
    v_cvt_pk_bf16_f32 v193, v178, v179
    v_mfma_f32_16x16x32_bf16 v[152:155], v[196:199], a[232:235], v[152:155]
    ds_read_b64_tr_b16 a[206:207], v247 offset:20480
    v_exp_f32 v181, v181
    v_mfma_f32_16x16x32_bf16 v[156:159], v[196:199], a[236:239], v[156:159]
    v_exp_f32 v182, v182
    v_mfma_f32_16x16x32_bf16 v[160:163], v[196:199], a[240:243], v[160:163]
    v_add_f32 v252, v252, v180
    v_add_f32 v252, v252, v181
    v_mfma_f32_16x16x32_bf16 v[164:167], v[196:199], a[244:247], v[164:167]
    v_exp_f32 v183, v183
    v_mfma_f32_16x16x32_bf16 v[168:171], v[196:199], a[248:251], v[168:171]
    v_cvt_pk_bf16_f32 v194, v180, v181
    v_add_f32 v252, v252, v182
    v_mfma_f32_16x16x32_bf16 v[172:175], v[196:199], a[252:255], v[172:175]
    v_add_f32 v252, v252, v183
    v_cvt_pk_bf16_f32 v195, v182, v183
    s_mov_b32 s28, 0
    v_mfma_f32_16x16x32_bf16 v[176:179], a[128:131], v[48:51], v[224:227]
.p2align 6
L_loop_w0:
    ds_read_b64_tr_b16 a[208:209], v248 offset:16384
    ds_read_b64_tr_b16 a[210:211], v248 offset:20480
    v_mfma_f32_16x16x32_bf16 v[176:179], a[132:135], v[52:55], v[176:179]
    v_exp_f32 v184, v184
    v_mfma_f32_16x16x32_bf16 v[176:179], a[136:139], v[56:59], v[176:179]
    ds_read_b64_tr_b16 a[212:213], v249 offset:16384
    ds_read_b64_tr_b16 a[214:215], v249 offset:20480
    v_mfma_f32_16x16x32_bf16 v[176:179], a[140:143], v[60:63], v[176:179]
    v_exp_f32 v185, v185
    v_mfma_f32_16x16x32_bf16 v[180:183], a[156:159], v[60:63], v[224:227]
    v_exp_f32 v186, v186
    v_mfma_f32_16x16x32_bf16 v[180:183], a[152:155], v[56:59], v[180:183]
    v_add_f32 v253, v253, v184
    v_add_f32 v253, v253, v185
    v_mfma_f32_16x16x32_bf16 v[180:183], a[148:151], v[52:55], v[180:183]
    v_exp_f32 v187, v187
    v_mfma_f32_16x16x32_bf16 v[180:183], a[144:147], v[48:51], v[180:183]
    s_waitcnt lgkmcnt(4)
    v_cvt_pk_bf16_f32 v208, v184, v185
    v_add_f32 v253, v253, v186
    v_mfma_f32_16x16x32_bf16 a[0:3], v[212:215], a[224:227], a[0:3]
    v_exp_f32 v188, v188
    v_mfma_f32_16x16x32_bf16 a[0:3], v[192:195], a[192:195], a[0:3]
    v_add_f32 v253, v253, v187
    v_cvt_pk_bf16_f32 v209, v186, v187
    v_mfma_f32_16x16x32_bf16 a[4:7], v[192:195], a[196:199], a[4:7]
    v_exp_f32 v189, v189
    v_mfma_f32_16x16x32_bf16 a[4:7], v[212:215], a[228:231], a[4:7]
    v_exp_f32 v190, v190
    v_mfma_f32_16x16x32_bf16 a[8:11], v[212:215], a[232:235], a[8:11]
    v_add_f32 v253, v253, v188
    v_add_f32 v253, v253, v189
    v_mfma_f32_16x16x32_bf16 a[8:11], v[192:195], a[200:203], a[8:11]
    v_exp_f32 v191, v191
    v_mfma_f32_16x16x32_bf16 a[12:15], v[192:195], a[204:207], a[12:15]
    v_cvt_pk_bf16_f32 v210, v188, v189
    v_add_f32 v253, v253, v190
    v_mfma_f32_16x16x32_bf16 a[12:15], v[212:215], a[236:239], a[12:15]
    v_add_f32 v253, v253, v191
    v_cvt_pk_bf16_f32 v211, v190, v191
    v_mfma_f32_16x16x32_bf16 v[184:187], a[128:131], v[64:67], v[228:231]
    ds_read_b64_tr_b16 a[216:217], v250 offset:16384
    ds_read_b64_tr_b16 a[218:219], v250 offset:20480
    v_mfma_f32_16x16x32_bf16 v[184:187], a[132:135], v[68:71], v[184:187]
    v_exp_f32 v176, v176
    v_mfma_f32_16x16x32_bf16 v[184:187], a[136:139], v[72:75], v[184:187]
    ds_read_b64_tr_b16 a[220:221], v251 offset:16384
    ds_read_b64_tr_b16 a[222:223], v251 offset:20480
    v_mfma_f32_16x16x32_bf16 v[184:187], a[140:143], v[76:79], v[184:187]
    v_exp_f32 v177, v177
    v_mfma_f32_16x16x32_bf16 v[188:191], a[156:159], v[76:79], v[228:231]
    v_exp_f32 v178, v178
    v_mfma_f32_16x16x32_bf16 v[188:191], a[152:155], v[72:75], v[188:191]
    v_add_f32 v254, v254, v176
    v_add_f32 v254, v254, v177
    v_mfma_f32_16x16x32_bf16 v[188:191], a[148:151], v[68:71], v[188:191]
    v_exp_f32 v179, v179
    v_mfma_f32_16x16x32_bf16 v[188:191], a[144:147], v[64:67], v[188:191]
    s_waitcnt lgkmcnt(4)
    v_cvt_pk_bf16_f32 v196, v176, v177
    v_add_f32 v254, v254, v178
    v_mfma_f32_16x16x32_bf16 a[16:19], v[212:215], a[240:243], a[16:19]
    v_exp_f32 v180, v180
    v_mfma_f32_16x16x32_bf16 a[16:19], v[192:195], a[208:211], a[16:19]
    v_add_f32 v254, v254, v179
    v_cvt_pk_bf16_f32 v197, v178, v179
    v_mfma_f32_16x16x32_bf16 a[20:23], v[192:195], a[212:215], a[20:23]
    v_exp_f32 v181, v181
    v_mfma_f32_16x16x32_bf16 a[20:23], v[212:215], a[244:247], a[20:23]
    v_exp_f32 v182, v182
    v_mfma_f32_16x16x32_bf16 a[24:27], v[212:215], a[248:251], a[24:27]
    s_waitcnt lgkmcnt(2)
    v_add_f32 v254, v254, v180
    v_add_f32 v254, v254, v181
    v_mfma_f32_16x16x32_bf16 a[24:27], v[192:195], a[216:219], a[24:27]
    s_waitcnt lgkmcnt(0)
    v_exp_f32 v183, v183
    v_mfma_f32_16x16x32_bf16 a[28:31], v[192:195], a[220:223], a[28:31]
    v_cvt_pk_bf16_f32 v198, v180, v181
    v_add_f32 v254, v254, v182
    v_mfma_f32_16x16x32_bf16 a[28:31], v[212:215], a[252:255], a[28:31]
    v_add_f32 v254, v254, v183
    v_cvt_pk_bf16_f32 v199, v182, v183
    v_mfma_f32_16x16x32_bf16 v[176:179], a[128:131], v[80:83], v[232:235]
    s_barrier
    ds_read_b128 a[160:163], v240 offset:24576
    ds_read_b128 a[164:167], v241 offset:24576
    v_mfma_f32_16x16x32_bf16 v[176:179], a[132:135], v[84:87], v[176:179]
    v_exp_f32 v184, v184
    v_mfma_f32_16x16x32_bf16 v[176:179], a[136:139], v[88:91], v[176:179]
    ds_read_b128 a[168:171], v242 offset:24576
    ds_read_b128 a[172:175], v243 offset:24576
    v_mfma_f32_16x16x32_bf16 v[176:179], a[140:143], v[92:95], v[176:179]
    v_exp_f32 v185, v185
    v_mfma_f32_16x16x32_bf16 v[180:183], a[156:159], v[92:95], v[232:235]
    v_exp_f32 v186, v186
    v_mfma_f32_16x16x32_bf16 v[180:183], a[152:155], v[88:91], v[180:183]
    v_add_f32 v255, v255, v184
    v_add_f32 v255, v255, v185
    v_mfma_f32_16x16x32_bf16 v[180:183], a[148:151], v[84:87], v[180:183]
    v_exp_f32 v187, v187
    v_mfma_f32_16x16x32_bf16 v[180:183], a[144:147], v[80:83], v[180:183]
    v_cvt_pk_bf16_f32 v212, v184, v185
    v_add_f32 v255, v255, v186
    v_mfma_f32_16x16x32_bf16 a[64:67], v[200:203], a[224:227], a[64:67]
    v_exp_f32 v188, v188
    v_mfma_f32_16x16x32_bf16 a[64:67], v[196:199], a[192:195], a[64:67]
    v_add_f32 v255, v255, v187
    v_cvt_pk_bf16_f32 v213, v186, v187
    v_mfma_f32_16x16x32_bf16 a[68:71], v[196:199], a[196:199], a[68:71]
    v_exp_f32 v189, v189
    v_mfma_f32_16x16x32_bf16 a[68:71], v[200:203], a[228:231], a[68:71]
    v_exp_f32 v190, v190
    v_mfma_f32_16x16x32_bf16 a[72:75], v[200:203], a[232:235], a[72:75]
    v_add_f32 v255, v255, v188
    v_add_f32 v255, v255, v189
    v_mfma_f32_16x16x32_bf16 a[72:75], v[196:199], a[200:203], a[72:75]
    v_exp_f32 v191, v191
    v_mfma_f32_16x16x32_bf16 a[76:79], v[196:199], a[204:207], a[76:79]
    v_cvt_pk_bf16_f32 v214, v188, v189
    v_add_f32 v255, v255, v190
    v_mfma_f32_16x16x32_bf16 a[76:79], v[200:203], a[236:239], a[76:79]
    v_add_f32 v255, v255, v191
    v_cvt_pk_bf16_f32 v215, v190, v191
    v_mfma_f32_16x16x32_bf16 v[184:187], a[128:131], v[96:99], v[236:239]
    ds_read_b128 a[176:179], v240 offset:28672
    ds_read_b128 a[180:183], v241 offset:28672
    v_mfma_f32_16x16x32_bf16 v[184:187], a[132:135], v[100:103], v[184:187]
    v_exp_f32 v176, v176
    v_mfma_f32_16x16x32_bf16 v[184:187], a[136:139], v[104:107], v[184:187]
    ds_read_b128 a[184:187], v242 offset:28672
    ds_read_b128 a[188:191], v243 offset:28672
    v_mfma_f32_16x16x32_bf16 v[184:187], a[140:143], v[108:111], v[184:187]
    v_exp_f32 v177, v177
    v_mfma_f32_16x16x32_bf16 v[188:191], a[156:159], v[108:111], v[236:239]
    v_exp_f32 v178, v178
    v_mfma_f32_16x16x32_bf16 v[188:191], a[152:155], v[104:107], v[188:191]
    v_add_f32 v0, v0, v176
    v_add_f32 v0, v0, v177
    v_mfma_f32_16x16x32_bf16 v[188:191], a[148:151], v[100:103], v[188:191]
    v_exp_f32 v179, v179
    v_mfma_f32_16x16x32_bf16 v[188:191], a[144:147], v[96:99], v[188:191]
    v_cvt_pk_bf16_f32 v192, v176, v177
    v_add_f32 v0, v0, v178
    v_mfma_f32_16x16x32_bf16 a[80:83], v[200:203], a[240:243], a[80:83]
    v_exp_f32 v180, v180
    v_mfma_f32_16x16x32_bf16 a[80:83], v[196:199], a[208:211], a[80:83]
    v_add_f32 v0, v0, v179
    v_cvt_pk_bf16_f32 v193, v178, v179
    v_mfma_f32_16x16x32_bf16 a[84:87], v[196:199], a[212:215], a[84:87]
    v_exp_f32 v181, v181
    v_mfma_f32_16x16x32_bf16 a[84:87], v[200:203], a[244:247], a[84:87]
    v_exp_f32 v182, v182
    v_mfma_f32_16x16x32_bf16 a[88:91], v[200:203], a[248:251], a[88:91]
    v_add_f32 v0, v0, v180
    v_add_f32 v0, v0, v181
    v_mfma_f32_16x16x32_bf16 a[88:91], v[196:199], a[216:219], a[88:91]
    v_exp_f32 v183, v183
    v_mfma_f32_16x16x32_bf16 a[92:95], v[196:199], a[220:223], a[92:95]
    v_cvt_pk_bf16_f32 v194, v180, v181
    v_add_f32 v0, v0, v182
    v_mfma_f32_16x16x32_bf16 a[92:95], v[200:203], a[252:255], a[92:95]
    s_waitcnt lgkmcnt(0)
    v_add_f32 v0, v0, v183
    v_cvt_pk_bf16_f32 v195, v182, v183
    v_mfma_f32_16x16x32_bf16 v[176:179], a[160:163], v[32:35], v[220:223]
    v_exp_f32 v184, v184
    v_mfma_f32_16x16x32_bf16 v[176:179], a[164:167], v[36:39], v[176:179]
    v_exp_f32 v185, v185
    v_mfma_f32_16x16x32_bf16 v[176:179], a[168:171], v[40:43], v[176:179]
    v_exp_f32 v186, v186
    v_mfma_f32_16x16x32_bf16 v[176:179], a[172:175], v[44:47], v[176:179]
    v_add_f32 v1, v1, v184
    v_add_f32 v1, v1, v185
    v_mfma_f32_16x16x32_bf16 v[180:183], a[188:191], v[44:47], v[220:223]
    v_exp_f32 v187, v187
    v_mfma_f32_16x16x32_bf16 v[180:183], a[184:187], v[40:43], v[180:183]
    v_cvt_pk_bf16_f32 v200, v184, v185
    v_add_f32 v1, v1, v186
    v_mfma_f32_16x16x32_bf16 v[180:183], a[180:183], v[36:39], v[180:183]
    v_exp_f32 v188, v188
    v_mfma_f32_16x16x32_bf16 v[180:183], a[176:179], v[32:35], v[180:183]
    v_add_f32 v1, v1, v187
    v_cvt_pk_bf16_f32 v201, v186, v187
    v_mfma_f32_16x16x32_bf16 v[112:115], v[204:207], a[224:227], v[112:115]
    v_exp_f32 v189, v189
    v_mfma_f32_16x16x32_bf16 v[112:115], v[192:195], a[192:195], v[112:115]
    v_exp_f32 v190, v190
    v_mfma_f32_16x16x32_bf16 v[116:119], v[192:195], a[196:199], v[116:119]
    v_add_f32 v1, v1, v188
    v_add_f32 v1, v1, v189
    v_mfma_f32_16x16x32_bf16 v[116:119], v[204:207], a[228:231], v[116:119]
    v_exp_f32 v191, v191
    v_mfma_f32_16x16x32_bf16 v[120:123], v[204:207], a[232:235], v[120:123]
    ds_read_b64_tr_b16 a[224:225], v244 offset:24576
    ds_read_b64_tr_b16 a[226:227], v244 offset:28672
    v_mfma_f32_16x16x32_bf16 v[120:123], v[192:195], a[200:203], v[120:123]
    v_cvt_pk_bf16_f32 v202, v188, v189
    v_add_f32 v1, v1, v190
    v_mfma_f32_16x16x32_bf16 v[124:127], v[192:195], a[204:207], v[124:127]
    ds_read_b64_tr_b16 a[228:229], v245 offset:24576
    ds_read_b64_tr_b16 a[230:231], v245 offset:28672
    v_mfma_f32_16x16x32_bf16 v[124:127], v[204:207], a[236:239], v[124:127]
    v_add_f32 v1, v1, v191
    v_cvt_pk_bf16_f32 v203, v190, v191
    v_mfma_f32_16x16x32_bf16 v[184:187], a[160:163], v[16:19], v[216:219]
    ds_read_b64_tr_b16 a[232:233], v246 offset:24576
    ds_read_b64_tr_b16 a[234:235], v246 offset:28672
    v_mfma_f32_16x16x32_bf16 v[184:187], a[164:167], v[20:23], v[184:187]
    v_exp_f32 v176, v176
    v_mfma_f32_16x16x32_bf16 v[184:187], a[168:171], v[24:27], v[184:187]
    ds_read_b64_tr_b16 a[236:237], v247 offset:24576
    ds_read_b64_tr_b16 a[238:239], v247 offset:28672
    v_mfma_f32_16x16x32_bf16 v[184:187], a[172:175], v[28:31], v[184:187]
    v_exp_f32 v177, v177
    v_mfma_f32_16x16x32_bf16 v[188:191], a[188:191], v[28:31], v[216:219]
    v_exp_f32 v178, v178
    v_mfma_f32_16x16x32_bf16 v[188:191], a[184:187], v[24:27], v[188:191]
    v_add_f32 v253, v253, v176
    v_add_f32 v253, v253, v177
    v_mfma_f32_16x16x32_bf16 v[188:191], a[180:183], v[20:23], v[188:191]
    v_exp_f32 v179, v179
    v_mfma_f32_16x16x32_bf16 v[188:191], a[176:179], v[16:19], v[188:191]
    v_cvt_pk_bf16_f32 v196, v176, v177
    v_add_f32 v253, v253, v178
    v_mfma_f32_16x16x32_bf16 v[128:131], v[204:207], a[240:243], v[128:131]
    v_exp_f32 v180, v180
    v_mfma_f32_16x16x32_bf16 v[128:131], v[192:195], a[208:211], v[128:131]
    v_add_f32 v253, v253, v179
    v_cvt_pk_bf16_f32 v197, v178, v179
    v_mfma_f32_16x16x32_bf16 v[132:135], v[192:195], a[212:215], v[132:135]
    v_exp_f32 v181, v181
    v_mfma_f32_16x16x32_bf16 v[132:135], v[204:207], a[244:247], v[132:135]
    v_exp_f32 v182, v182
    v_mfma_f32_16x16x32_bf16 v[136:139], v[204:207], a[248:251], v[136:139]
    v_add_f32 v253, v253, v180
    v_add_f32 v253, v253, v181
    v_mfma_f32_16x16x32_bf16 v[136:139], v[192:195], a[216:219], v[136:139]
    v_exp_f32 v183, v183
    v_mfma_f32_16x16x32_bf16 v[140:143], v[192:195], a[220:223], v[140:143]
    v_cvt_pk_bf16_f32 v198, v180, v181
    v_add_f32 v253, v253, v182
    v_mfma_f32_16x16x32_bf16 v[140:143], v[204:207], a[252:255], v[140:143]
    v_add_f32 v253, v253, v183
    v_cvt_pk_bf16_f32 v199, v182, v183
    v_mfma_f32_16x16x32_bf16 v[176:179], a[160:163], v[64:67], v[228:231]
    ds_read_b64_tr_b16 a[240:241], v248 offset:24576
    ds_read_b64_tr_b16 a[242:243], v248 offset:28672
    v_mfma_f32_16x16x32_bf16 v[176:179], a[164:167], v[68:71], v[176:179]
    v_exp_f32 v184, v184
    v_mfma_f32_16x16x32_bf16 v[176:179], a[168:171], v[72:75], v[176:179]
    ds_read_b64_tr_b16 a[244:245], v249 offset:24576
    ds_read_b64_tr_b16 a[246:247], v249 offset:28672
    v_mfma_f32_16x16x32_bf16 v[176:179], a[172:175], v[76:79], v[176:179]
    v_exp_f32 v185, v185
    v_mfma_f32_16x16x32_bf16 v[180:183], a[188:191], v[76:79], v[228:231]
    v_exp_f32 v186, v186
    v_mfma_f32_16x16x32_bf16 v[180:183], a[184:187], v[72:75], v[180:183]
    v_add_f32 v252, v252, v184
    v_add_f32 v252, v252, v185
    v_mfma_f32_16x16x32_bf16 v[180:183], a[180:183], v[68:71], v[180:183]
    v_exp_f32 v187, v187
    v_mfma_f32_16x16x32_bf16 v[180:183], a[176:179], v[64:67], v[180:183]
    s_waitcnt lgkmcnt(4)
    v_cvt_pk_bf16_f32 v204, v184, v185
    v_add_f32 v252, v252, v186
    v_mfma_f32_16x16x32_bf16 a[32:35], v[208:211], a[192:195], a[32:35]
    v_exp_f32 v188, v188
    v_mfma_f32_16x16x32_bf16 a[32:35], v[196:199], a[224:227], a[32:35]
    v_add_f32 v252, v252, v187
    v_cvt_pk_bf16_f32 v205, v186, v187
    v_mfma_f32_16x16x32_bf16 a[36:39], v[196:199], a[228:231], a[36:39]
    v_exp_f32 v189, v189
    v_mfma_f32_16x16x32_bf16 a[36:39], v[208:211], a[196:199], a[36:39]
    v_exp_f32 v190, v190
    v_mfma_f32_16x16x32_bf16 a[40:43], v[208:211], a[200:203], a[40:43]
    v_add_f32 v252, v252, v188
    v_add_f32 v252, v252, v189
    v_mfma_f32_16x16x32_bf16 a[40:43], v[196:199], a[232:235], a[40:43]
    v_exp_f32 v191, v191
    v_mfma_f32_16x16x32_bf16 a[44:47], v[196:199], a[236:239], a[44:47]
    v_cvt_pk_bf16_f32 v206, v188, v189
    v_add_f32 v252, v252, v190
    v_mfma_f32_16x16x32_bf16 a[44:47], v[208:211], a[204:207], a[44:47]
    v_add_f32 v252, v252, v191
    v_cvt_pk_bf16_f32 v207, v190, v191
    v_mfma_f32_16x16x32_bf16 v[184:187], a[160:163], v[48:51], v[224:227]
    ds_read_b64_tr_b16 a[248:249], v250 offset:24576
    ds_read_b64_tr_b16 a[250:251], v250 offset:28672
    v_mfma_f32_16x16x32_bf16 v[184:187], a[164:167], v[52:55], v[184:187]
    v_exp_f32 v176, v176
    v_mfma_f32_16x16x32_bf16 v[184:187], a[168:171], v[56:59], v[184:187]
    ds_read_b64_tr_b16 a[252:253], v251 offset:24576
    ds_read_b64_tr_b16 a[254:255], v251 offset:28672
    v_mfma_f32_16x16x32_bf16 v[184:187], a[172:175], v[60:63], v[184:187]
    v_exp_f32 v177, v177
    v_mfma_f32_16x16x32_bf16 v[188:191], a[188:191], v[60:63], v[224:227]
    v_exp_f32 v178, v178
    v_mfma_f32_16x16x32_bf16 v[188:191], a[184:187], v[56:59], v[188:191]
    v_add_f32 v255, v255, v176
    v_add_f32 v255, v255, v177
    v_mfma_f32_16x16x32_bf16 v[188:191], a[180:183], v[52:55], v[188:191]
    v_exp_f32 v179, v179
    v_mfma_f32_16x16x32_bf16 v[188:191], a[176:179], v[48:51], v[188:191]
    s_waitcnt lgkmcnt(4)
    v_cvt_pk_bf16_f32 v192, v176, v177
    v_add_f32 v255, v255, v178
    v_mfma_f32_16x16x32_bf16 a[48:51], v[208:211], a[208:211], a[48:51]
    v_exp_f32 v180, v180
    v_mfma_f32_16x16x32_bf16 a[48:51], v[196:199], a[240:243], a[48:51]
    v_add_f32 v255, v255, v179
    v_cvt_pk_bf16_f32 v193, v178, v179
    v_mfma_f32_16x16x32_bf16 a[52:55], v[196:199], a[244:247], a[52:55]
    v_exp_f32 v181, v181
    v_mfma_f32_16x16x32_bf16 a[52:55], v[208:211], a[212:215], a[52:55]
    v_exp_f32 v182, v182
    v_mfma_f32_16x16x32_bf16 a[56:59], v[208:211], a[216:219], a[56:59]
    s_waitcnt lgkmcnt(2)
    v_add_f32 v255, v255, v180
    v_add_f32 v255, v255, v181
    v_mfma_f32_16x16x32_bf16 a[56:59], v[196:199], a[248:251], a[56:59]
    s_waitcnt lgkmcnt(0)
    v_exp_f32 v183, v183
    v_mfma_f32_16x16x32_bf16 a[60:63], v[196:199], a[252:255], a[60:63]
    v_cvt_pk_bf16_f32 v194, v180, v181
    v_add_f32 v255, v255, v182
    v_mfma_f32_16x16x32_bf16 a[60:63], v[208:211], a[220:223], a[60:63]
    v_add_f32 v255, v255, v183
    v_cvt_pk_bf16_f32 v195, v182, v183
    v_mfma_f32_16x16x32_bf16 v[176:179], a[160:163], v[96:99], v[236:239]
    s_barrier
    ds_read_b128 a[128:131], v240 offset:0
    ds_read_b128 a[132:135], v241 offset:0
    v_mfma_f32_16x16x32_bf16 v[176:179], a[164:167], v[100:103], v[176:179]
    v_exp_f32 v184, v184
    v_mfma_f32_16x16x32_bf16 v[176:179], a[168:171], v[104:107], v[176:179]
    ds_read_b128 a[136:139], v242 offset:0
    ds_read_b128 a[140:143], v243 offset:0
    v_mfma_f32_16x16x32_bf16 v[176:179], a[172:175], v[108:111], v[176:179]
    v_exp_f32 v185, v185
    v_mfma_f32_16x16x32_bf16 v[180:183], a[188:191], v[108:111], v[236:239]
    v_exp_f32 v186, v186
    v_mfma_f32_16x16x32_bf16 v[180:183], a[184:187], v[104:107], v[180:183]
    v_add_f32 v254, v254, v184
    v_add_f32 v254, v254, v185
    v_mfma_f32_16x16x32_bf16 v[180:183], a[180:183], v[100:103], v[180:183]
    v_exp_f32 v187, v187
    v_mfma_f32_16x16x32_bf16 v[180:183], a[176:179], v[96:99], v[180:183]
    v_cvt_pk_bf16_f32 v208, v184, v185
    v_add_f32 v254, v254, v186
    v_mfma_f32_16x16x32_bf16 a[96:99], v[212:215], a[192:195], a[96:99]
    v_exp_f32 v188, v188
    v_mfma_f32_16x16x32_bf16 a[96:99], v[192:195], a[224:227], a[96:99]
    v_add_f32 v254, v254, v187
    v_cvt_pk_bf16_f32 v209, v186, v187
    v_mfma_f32_16x16x32_bf16 a[100:103], v[192:195], a[228:231], a[100:103]
    v_exp_f32 v189, v189
    v_mfma_f32_16x16x32_bf16 a[100:103], v[212:215], a[196:199], a[100:103]
    v_exp_f32 v190, v190
    v_mfma_f32_16x16x32_bf16 a[104:107], v[212:215], a[200:203], a[104:107]
    v_add_f32 v254, v254, v188
    v_add_f32 v254, v254, v189
    v_mfma_f32_16x16x32_bf16 a[104:107], v[192:195], a[232:235], a[104:107]
    v_exp_f32 v191, v191
    v_mfma_f32_16x16x32_bf16 a[108:111], v[192:195], a[236:239], a[108:111]
    v_cvt_pk_bf16_f32 v210, v188, v189
    v_add_f32 v254, v254, v190
    v_mfma_f32_16x16x32_bf16 a[108:111], v[212:215], a[204:207], a[108:111]
    v_add_f32 v254, v254, v191
    v_cvt_pk_bf16_f32 v211, v190, v191
    v_mfma_f32_16x16x32_bf16 v[184:187], a[160:163], v[80:83], v[232:235]
    ds_read_b128 a[144:147], v240 offset:4096
    ds_read_b128 a[148:151], v241 offset:4096
    v_mfma_f32_16x16x32_bf16 v[184:187], a[164:167], v[84:87], v[184:187]
    v_exp_f32 v176, v176
    v_mfma_f32_16x16x32_bf16 v[184:187], a[168:171], v[88:91], v[184:187]
    ds_read_b128 a[152:155], v242 offset:4096
    ds_read_b128 a[156:159], v243 offset:4096
    v_mfma_f32_16x16x32_bf16 v[184:187], a[172:175], v[92:95], v[184:187]
    v_exp_f32 v177, v177
    v_mfma_f32_16x16x32_bf16 v[188:191], a[188:191], v[92:95], v[232:235]
    v_exp_f32 v178, v178
    v_mfma_f32_16x16x32_bf16 v[188:191], a[184:187], v[88:91], v[188:191]
    v_add_f32 v1, v1, v176
    v_add_f32 v1, v1, v177
    v_mfma_f32_16x16x32_bf16 v[188:191], a[180:183], v[84:87], v[188:191]
    v_exp_f32 v179, v179
    v_mfma_f32_16x16x32_bf16 v[188:191], a[176:179], v[80:83], v[188:191]
    v_cvt_pk_bf16_f32 v196, v176, v177
    v_add_f32 v1, v1, v178
    v_mfma_f32_16x16x32_bf16 a[112:115], v[212:215], a[208:211], a[112:115]
    v_exp_f32 v180, v180
    v_mfma_f32_16x16x32_bf16 a[112:115], v[192:195], a[240:243], a[112:115]
    v_add_f32 v1, v1, v179
    v_cvt_pk_bf16_f32 v197, v178, v179
    v_mfma_f32_16x16x32_bf16 a[116:119], v[192:195], a[244:247], a[116:119]
    v_exp_f32 v181, v181
    v_mfma_f32_16x16x32_bf16 a[116:119], v[212:215], a[212:215], a[116:119]
    v_exp_f32 v182, v182
    v_mfma_f32_16x16x32_bf16 a[120:123], v[212:215], a[216:219], a[120:123]
    v_add_f32 v1, v1, v180
    v_add_f32 v1, v1, v181
    v_mfma_f32_16x16x32_bf16 a[120:123], v[192:195], a[248:251], a[120:123]
    v_exp_f32 v183, v183
    v_mfma_f32_16x16x32_bf16 a[124:127], v[192:195], a[252:255], a[124:127]
    s_cmp_eq_u32 s28, 10
    v_cvt_pk_bf16_f32 v198, v180, v181
    v_add_f32 v1, v1, v182
    v_mfma_f32_16x16x32_bf16 a[124:127], v[212:215], a[220:223], a[124:127]
    s_waitcnt lgkmcnt(0)
    v_add_f32 v1, v1, v183
    v_cvt_pk_bf16_f32 v199, v182, v183
    s_cbranch_scc1 L_final_w0
    v_mfma_f32_16x16x32_bf16 v[176:179], a[128:131], v[16:19], v[216:219]
    v_exp_f32 v184, v184
    v_mfma_f32_16x16x32_bf16 v[176:179], a[132:135], v[20:23], v[176:179]
    v_exp_f32 v185, v185
    v_mfma_f32_16x16x32_bf16 v[176:179], a[136:139], v[24:27], v[176:179]
    v_exp_f32 v186, v186
    v_mfma_f32_16x16x32_bf16 v[176:179], a[140:143], v[28:31], v[176:179]
    v_add_f32 v0, v0, v184
    v_add_f32 v0, v0, v185
    v_mfma_f32_16x16x32_bf16 v[180:183], a[156:159], v[28:31], v[216:219]
    v_exp_f32 v187, v187
    v_mfma_f32_16x16x32_bf16 v[180:183], a[152:155], v[24:27], v[180:183]
    v_cvt_pk_bf16_f32 v212, v184, v185
    v_add_f32 v0, v0, v186
    v_mfma_f32_16x16x32_bf16 v[180:183], a[148:151], v[20:23], v[180:183]
    v_exp_f32 v188, v188
    v_mfma_f32_16x16x32_bf16 v[180:183], a[144:147], v[16:19], v[180:183]
    v_add_f32 v0, v0, v187
    v_cvt_pk_bf16_f32 v213, v186, v187
    v_mfma_f32_16x16x32_bf16 v[144:147], v[200:203], a[192:195], v[144:147]
    v_exp_f32 v189, v189
    v_mfma_f32_16x16x32_bf16 v[144:147], v[196:199], a[224:227], v[144:147]
    v_exp_f32 v190, v190
    v_mfma_f32_16x16x32_bf16 v[148:151], v[196:199], a[228:231], v[148:151]
    v_add_f32 v0, v0, v188
    v_add_f32 v0, v0, v189
    v_mfma_f32_16x16x32_bf16 v[148:151], v[200:203], a[196:199], v[148:151]
    v_exp_f32 v191, v191
    v_mfma_f32_16x16x32_bf16 v[152:155], v[200:203], a[200:203], v[152:155]
    ds_read_b64_tr_b16 a[192:193], v244 offset:0
    ds_read_b64_tr_b16 a[194:195], v244 offset:4096
    v_mfma_f32_16x16x32_bf16 v[152:155], v[196:199], a[232:235], v[152:155]
    v_cvt_pk_bf16_f32 v214, v188, v189
    v_add_f32 v0, v0, v190
    v_mfma_f32_16x16x32_bf16 v[156:159], v[196:199], a[236:239], v[156:159]
    ds_read_b64_tr_b16 a[196:197], v245 offset:0
    ds_read_b64_tr_b16 a[198:199], v245 offset:4096
    v_mfma_f32_16x16x32_bf16 v[156:159], v[200:203], a[204:207], v[156:159]
    v_add_f32 v0, v0, v191
    v_cvt_pk_bf16_f32 v215, v190, v191
    v_mfma_f32_16x16x32_bf16 v[184:187], a[128:131], v[32:35], v[220:223]
    ds_read_b64_tr_b16 a[200:201], v246 offset:0
    ds_read_b64_tr_b16 a[202:203], v246 offset:4096
    v_mfma_f32_16x16x32_bf16 v[184:187], a[132:135], v[36:39], v[184:187]
    v_exp_f32 v176, v176
    v_mfma_f32_16x16x32_bf16 v[184:187], a[136:139], v[40:43], v[184:187]
    ds_read_b64_tr_b16 a[204:205], v247 offset:0
    ds_read_b64_tr_b16 a[206:207], v247 offset:4096
    v_mfma_f32_16x16x32_bf16 v[184:187], a[140:143], v[44:47], v[184:187]
    v_exp_f32 v177, v177
    v_mfma_f32_16x16x32_bf16 v[188:191], a[156:159], v[44:47], v[220:223]
    v_exp_f32 v178, v178
    v_mfma_f32_16x16x32_bf16 v[188:191], a[152:155], v[40:43], v[188:191]
    v_add_f32 v252, v252, v176
    v_add_f32 v252, v252, v177
    v_mfma_f32_16x16x32_bf16 v[188:191], a[148:151], v[36:39], v[188:191]
    v_exp_f32 v179, v179
    v_mfma_f32_16x16x32_bf16 v[188:191], a[144:147], v[32:35], v[188:191]
    v_cvt_pk_bf16_f32 v192, v176, v177
    v_add_f32 v252, v252, v178
    v_mfma_f32_16x16x32_bf16 v[160:163], v[200:203], a[208:211], v[160:163]
    v_exp_f32 v180, v180
    v_mfma_f32_16x16x32_bf16 v[160:163], v[196:199], a[240:243], v[160:163]
    v_add_f32 v252, v252, v179
    v_cvt_pk_bf16_f32 v193, v178, v179
    v_mfma_f32_16x16x32_bf16 v[164:167], v[196:199], a[244:247], v[164:167]
    v_exp_f32 v181, v181
    v_mfma_f32_16x16x32_bf16 v[164:167], v[200:203], a[212:215], v[164:167]
    v_exp_f32 v182, v182
    v_mfma_f32_16x16x32_bf16 v[168:171], v[200:203], a[216:219], v[168:171]
    v_add_f32 v252, v252, v180
    v_add_f32 v252, v252, v181
    v_mfma_f32_16x16x32_bf16 v[168:171], v[196:199], a[248:251], v[168:171]
    v_exp_f32 v183, v183
    v_mfma_f32_16x16x32_bf16 v[172:175], v[196:199], a[252:255], v[172:175]
    v_cvt_pk_bf16_f32 v194, v180, v181
    v_add_f32 v252, v252, v182
    v_mfma_f32_16x16x32_bf16 v[172:175], v[200:203], a[220:223], v[172:175]
    v_add_f32 v252, v252, v183
    v_cvt_pk_bf16_f32 v195, v182, v183
    v_mfma_f32_16x16x32_bf16 v[176:179], a[128:131], v[48:51], v[224:227]
    ds_read_b64_tr_b16 a[208:209], v248 offset:0
    ds_read_b64_tr_b16 a[210:211], v248 offset:4096
    v_mfma_f32_16x16x32_bf16 v[176:179], a[132:135], v[52:55], v[176:179]
    v_exp_f32 v184, v184
    v_mfma_f32_16x16x32_bf16 v[176:179], a[136:139], v[56:59], v[176:179]
    ds_read_b64_tr_b16 a[212:213], v249 offset:0
    ds_read_b64_tr_b16 a[214:215], v249 offset:4096
    v_mfma_f32_16x16x32_bf16 v[176:179], a[140:143], v[60:63], v[176:179]
    v_exp_f32 v185, v185
    v_mfma_f32_16x16x32_bf16 v[180:183], a[156:159], v[60:63], v[224:227]
    v_exp_f32 v186, v186
    v_mfma_f32_16x16x32_bf16 v[180:183], a[152:155], v[56:59], v[180:183]
    v_add_f32 v253, v253, v184
    v_add_f32 v253, v253, v185
    v_mfma_f32_16x16x32_bf16 v[180:183], a[148:151], v[52:55], v[180:183]
    v_exp_f32 v187, v187
    v_mfma_f32_16x16x32_bf16 v[180:183], a[144:147], v[48:51], v[180:183]
    s_waitcnt lgkmcnt(4)
    v_cvt_pk_bf16_f32 v200, v184, v185
    v_add_f32 v253, v253, v186
    v_mfma_f32_16x16x32_bf16 a[0:3], v[204:207], a[224:227], a[0:3]
    v_exp_f32 v188, v188
    v_mfma_f32_16x16x32_bf16 a[0:3], v[192:195], a[192:195], a[0:3]
    v_add_f32 v253, v253, v187
    v_cvt_pk_bf16_f32 v201, v186, v187
    v_mfma_f32_16x16x32_bf16 a[4:7], v[192:195], a[196:199], a[4:7]
    v_exp_f32 v189, v189
    v_mfma_f32_16x16x32_bf16 a[4:7], v[204:207], a[228:231], a[4:7]
    v_exp_f32 v190, v190
    v_mfma_f32_16x16x32_bf16 a[8:11], v[204:207], a[232:235], a[8:11]
    v_add_f32 v253, v253, v188
    v_add_f32 v253, v253, v189
    v_mfma_f32_16x16x32_bf16 a[8:11], v[192:195], a[200:203], a[8:11]
    v_exp_f32 v191, v191
    v_mfma_f32_16x16x32_bf16 a[12:15], v[192:195], a[204:207], a[12:15]
    v_cvt_pk_bf16_f32 v202, v188, v189
    v_add_f32 v253, v253, v190
    v_mfma_f32_16x16x32_bf16 a[12:15], v[204:207], a[236:239], a[12:15]
    v_add_f32 v253, v253, v191
    v_cvt_pk_bf16_f32 v203, v190, v191
    v_mfma_f32_16x16x32_bf16 v[184:187], a[128:131], v[64:67], v[228:231]
    ds_read_b64_tr_b16 a[216:217], v250 offset:0
    ds_read_b64_tr_b16 a[218:219], v250 offset:4096
    v_mfma_f32_16x16x32_bf16 v[184:187], a[132:135], v[68:71], v[184:187]
    v_exp_f32 v176, v176
    v_mfma_f32_16x16x32_bf16 v[184:187], a[136:139], v[72:75], v[184:187]
    ds_read_b64_tr_b16 a[220:221], v251 offset:0
    ds_read_b64_tr_b16 a[222:223], v251 offset:4096
    v_mfma_f32_16x16x32_bf16 v[184:187], a[140:143], v[76:79], v[184:187]
    v_exp_f32 v177, v177
    v_mfma_f32_16x16x32_bf16 v[188:191], a[156:159], v[76:79], v[228:231]
    v_exp_f32 v178, v178
    v_mfma_f32_16x16x32_bf16 v[188:191], a[152:155], v[72:75], v[188:191]
    v_add_f32 v254, v254, v176
    v_add_f32 v254, v254, v177
    v_mfma_f32_16x16x32_bf16 v[188:191], a[148:151], v[68:71], v[188:191]
    v_exp_f32 v179, v179
    v_mfma_f32_16x16x32_bf16 v[188:191], a[144:147], v[64:67], v[188:191]
    s_waitcnt lgkmcnt(4)
    v_cvt_pk_bf16_f32 v196, v176, v177
    v_add_f32 v254, v254, v178
    v_mfma_f32_16x16x32_bf16 a[16:19], v[204:207], a[240:243], a[16:19]
    v_exp_f32 v180, v180
    v_mfma_f32_16x16x32_bf16 a[16:19], v[192:195], a[208:211], a[16:19]
    v_add_f32 v254, v254, v179
    v_cvt_pk_bf16_f32 v197, v178, v179
    v_mfma_f32_16x16x32_bf16 a[20:23], v[192:195], a[212:215], a[20:23]
    v_exp_f32 v181, v181
    v_mfma_f32_16x16x32_bf16 a[20:23], v[204:207], a[244:247], a[20:23]
    v_exp_f32 v182, v182
    v_mfma_f32_16x16x32_bf16 a[24:27], v[204:207], a[248:251], a[24:27]
    s_waitcnt lgkmcnt(2)
    v_add_f32 v254, v254, v180
    v_add_f32 v254, v254, v181
    v_mfma_f32_16x16x32_bf16 a[24:27], v[192:195], a[216:219], a[24:27]
    s_waitcnt lgkmcnt(0)
    v_exp_f32 v183, v183
    v_mfma_f32_16x16x32_bf16 a[28:31], v[192:195], a[220:223], a[28:31]
    v_cvt_pk_bf16_f32 v198, v180, v181
    v_add_f32 v254, v254, v182
    v_mfma_f32_16x16x32_bf16 a[28:31], v[204:207], a[252:255], a[28:31]
    v_add_f32 v254, v254, v183
    v_cvt_pk_bf16_f32 v199, v182, v183
    v_mfma_f32_16x16x32_bf16 v[176:179], a[128:131], v[80:83], v[232:235]
    s_barrier
    ds_read_b128 a[160:163], v240 offset:8192
    ds_read_b128 a[164:167], v241 offset:8192
    v_mfma_f32_16x16x32_bf16 v[176:179], a[132:135], v[84:87], v[176:179]
    v_exp_f32 v184, v184
    v_mfma_f32_16x16x32_bf16 v[176:179], a[136:139], v[88:91], v[176:179]
    ds_read_b128 a[168:171], v242 offset:8192
    ds_read_b128 a[172:175], v243 offset:8192
    v_mfma_f32_16x16x32_bf16 v[176:179], a[140:143], v[92:95], v[176:179]
    v_exp_f32 v185, v185
    v_mfma_f32_16x16x32_bf16 v[180:183], a[156:159], v[92:95], v[232:235]
    v_exp_f32 v186, v186
    v_mfma_f32_16x16x32_bf16 v[180:183], a[152:155], v[88:91], v[180:183]
    v_add_f32 v255, v255, v184
    v_add_f32 v255, v255, v185
    v_mfma_f32_16x16x32_bf16 v[180:183], a[148:151], v[84:87], v[180:183]
    v_exp_f32 v187, v187
    v_mfma_f32_16x16x32_bf16 v[180:183], a[144:147], v[80:83], v[180:183]
    v_cvt_pk_bf16_f32 v204, v184, v185
    v_add_f32 v255, v255, v186
    v_mfma_f32_16x16x32_bf16 a[64:67], v[208:211], a[224:227], a[64:67]
    v_exp_f32 v188, v188
    v_mfma_f32_16x16x32_bf16 a[64:67], v[196:199], a[192:195], a[64:67]
    v_add_f32 v255, v255, v187
    v_cvt_pk_bf16_f32 v205, v186, v187
    v_mfma_f32_16x16x32_bf16 a[68:71], v[196:199], a[196:199], a[68:71]
    v_exp_f32 v189, v189
    v_mfma_f32_16x16x32_bf16 a[68:71], v[208:211], a[228:231], a[68:71]
    v_exp_f32 v190, v190
    v_mfma_f32_16x16x32_bf16 a[72:75], v[208:211], a[232:235], a[72:75]
    v_add_f32 v255, v255, v188
    v_add_f32 v255, v255, v189
    v_mfma_f32_16x16x32_bf16 a[72:75], v[196:199], a[200:203], a[72:75]
    v_exp_f32 v191, v191
    v_mfma_f32_16x16x32_bf16 a[76:79], v[196:199], a[204:207], a[76:79]
    v_cvt_pk_bf16_f32 v206, v188, v189
    v_add_f32 v255, v255, v190
    v_mfma_f32_16x16x32_bf16 a[76:79], v[208:211], a[236:239], a[76:79]
    v_add_f32 v255, v255, v191
    v_cvt_pk_bf16_f32 v207, v190, v191
    v_mfma_f32_16x16x32_bf16 v[184:187], a[128:131], v[96:99], v[236:239]
    ds_read_b128 a[176:179], v240 offset:12288
    ds_read_b128 a[180:183], v241 offset:12288
    v_mfma_f32_16x16x32_bf16 v[184:187], a[132:135], v[100:103], v[184:187]
    v_exp_f32 v176, v176
    v_mfma_f32_16x16x32_bf16 v[184:187], a[136:139], v[104:107], v[184:187]
    ds_read_b128 a[184:187], v242 offset:12288
    ds_read_b128 a[188:191], v243 offset:12288
    v_mfma_f32_16x16x32_bf16 v[184:187], a[140:143], v[108:111], v[184:187]
    v_exp_f32 v177, v177
    v_mfma_f32_16x16x32_bf16 v[188:191], a[156:159], v[108:111], v[236:239]
    v_exp_f32 v178, v178
    v_mfma_f32_16x16x32_bf16 v[188:191], a[152:155], v[104:107], v[188:191]
    v_add_f32 v0, v0, v176
    v_add_f32 v0, v0, v177
    v_mfma_f32_16x16x32_bf16 v[188:191], a[148:151], v[100:103], v[188:191]
    v_exp_f32 v179, v179
    v_mfma_f32_16x16x32_bf16 v[188:191], a[144:147], v[96:99], v[188:191]
    v_cvt_pk_bf16_f32 v192, v176, v177
    v_add_f32 v0, v0, v178
    v_mfma_f32_16x16x32_bf16 a[80:83], v[208:211], a[240:243], a[80:83]
    v_exp_f32 v180, v180
    v_mfma_f32_16x16x32_bf16 a[80:83], v[196:199], a[208:211], a[80:83]
    v_add_f32 v0, v0, v179
    v_cvt_pk_bf16_f32 v193, v178, v179
    v_mfma_f32_16x16x32_bf16 a[84:87], v[196:199], a[212:215], a[84:87]
    v_exp_f32 v181, v181
    v_mfma_f32_16x16x32_bf16 a[84:87], v[208:211], a[244:247], a[84:87]
    v_exp_f32 v182, v182
    v_mfma_f32_16x16x32_bf16 a[88:91], v[208:211], a[248:251], a[88:91]
    v_add_f32 v0, v0, v180
    v_add_f32 v0, v0, v181
    v_mfma_f32_16x16x32_bf16 a[88:91], v[196:199], a[216:219], a[88:91]
    v_exp_f32 v183, v183
    v_mfma_f32_16x16x32_bf16 a[92:95], v[196:199], a[220:223], a[92:95]
    v_cvt_pk_bf16_f32 v194, v180, v181
    v_add_f32 v0, v0, v182
    v_mfma_f32_16x16x32_bf16 a[92:95], v[208:211], a[252:255], a[92:95]
    s_waitcnt lgkmcnt(0)
    v_add_f32 v0, v0, v183
    v_cvt_pk_bf16_f32 v195, v182, v183
    v_mfma_f32_16x16x32_bf16 v[176:179], a[160:163], v[32:35], v[220:223]
    v_exp_f32 v184, v184
    v_mfma_f32_16x16x32_bf16 v[176:179], a[164:167], v[36:39], v[176:179]
    v_exp_f32 v185, v185
    v_mfma_f32_16x16x32_bf16 v[176:179], a[168:171], v[40:43], v[176:179]
    v_exp_f32 v186, v186
    v_mfma_f32_16x16x32_bf16 v[176:179], a[172:175], v[44:47], v[176:179]
    v_add_f32 v1, v1, v184
    v_add_f32 v1, v1, v185
    v_mfma_f32_16x16x32_bf16 v[180:183], a[188:191], v[44:47], v[220:223]
    v_exp_f32 v187, v187
    v_mfma_f32_16x16x32_bf16 v[180:183], a[184:187], v[40:43], v[180:183]
    v_cvt_pk_bf16_f32 v208, v184, v185
    v_add_f32 v1, v1, v186
    v_mfma_f32_16x16x32_bf16 v[180:183], a[180:183], v[36:39], v[180:183]
    v_exp_f32 v188, v188
    v_mfma_f32_16x16x32_bf16 v[180:183], a[176:179], v[32:35], v[180:183]
    v_add_f32 v1, v1, v187
    v_cvt_pk_bf16_f32 v209, v186, v187
    v_mfma_f32_16x16x32_bf16 v[112:115], v[212:215], a[224:227], v[112:115]
    v_exp_f32 v189, v189
    v_mfma_f32_16x16x32_bf16 v[112:115], v[192:195], a[192:195], v[112:115]
    v_exp_f32 v190, v190
    v_mfma_f32_16x16x32_bf16 v[116:119], v[192:195], a[196:199], v[116:119]
    v_add_f32 v1, v1, v188
    v_add_f32 v1, v1, v189
    v_mfma_f32_16x16x32_bf16 v[116:119], v[212:215], a[228:231], v[116:119]
    v_exp_f32 v191, v191
    v_mfma_f32_16x16x32_bf16 v[120:123], v[212:215], a[232:235], v[120:123]
    ds_read_b64_tr_b16 a[224:225], v244 offset:8192
    ds_read_b64_tr_b16 a[226:227], v244 offset:12288
    v_mfma_f32_16x16x32_bf16 v[120:123], v[192:195], a[200:203], v[120:123]
    v_cvt_pk_bf16_f32 v210, v188, v189
    v_add_f32 v1, v1, v190
    v_mfma_f32_16x16x32_bf16 v[124:127], v[192:195], a[204:207], v[124:127]
    ds_read_b64_tr_b16 a[228:229], v245 offset:8192
    ds_read_b64_tr_b16 a[230:231], v245 offset:12288
    v_mfma_f32_16x16x32_bf16 v[124:127], v[212:215], a[236:239], v[124:127]
    v_add_f32 v1, v1, v191
    v_cvt_pk_bf16_f32 v211, v190, v191
    v_mfma_f32_16x16x32_bf16 v[184:187], a[160:163], v[16:19], v[216:219]
    ds_read_b64_tr_b16 a[232:233], v246 offset:8192
    ds_read_b64_tr_b16 a[234:235], v246 offset:12288
    v_mfma_f32_16x16x32_bf16 v[184:187], a[164:167], v[20:23], v[184:187]
    v_exp_f32 v176, v176
    v_mfma_f32_16x16x32_bf16 v[184:187], a[168:171], v[24:27], v[184:187]
    ds_read_b64_tr_b16 a[236:237], v247 offset:8192
    ds_read_b64_tr_b16 a[238:239], v247 offset:12288
    v_mfma_f32_16x16x32_bf16 v[184:187], a[172:175], v[28:31], v[184:187]
    v_exp_f32 v177, v177
    v_mfma_f32_16x16x32_bf16 v[188:191], a[188:191], v[28:31], v[216:219]
    v_exp_f32 v178, v178
    v_mfma_f32_16x16x32_bf16 v[188:191], a[184:187], v[24:27], v[188:191]
    v_add_f32 v253, v253, v176
    v_add_f32 v253, v253, v177
    v_mfma_f32_16x16x32_bf16 v[188:191], a[180:183], v[20:23], v[188:191]
    v_exp_f32 v179, v179
    v_mfma_f32_16x16x32_bf16 v[188:191], a[176:179], v[16:19], v[188:191]
    v_cvt_pk_bf16_f32 v196, v176, v177
    v_add_f32 v253, v253, v178
    v_mfma_f32_16x16x32_bf16 v[128:131], v[212:215], a[240:243], v[128:131]
    v_exp_f32 v180, v180
    v_mfma_f32_16x16x32_bf16 v[128:131], v[192:195], a[208:211], v[128:131]
    v_add_f32 v253, v253, v179
    v_cvt_pk_bf16_f32 v197, v178, v179
    v_mfma_f32_16x16x32_bf16 v[132:135], v[192:195], a[212:215], v[132:135]
    v_exp_f32 v181, v181
    v_mfma_f32_16x16x32_bf16 v[132:135], v[212:215], a[244:247], v[132:135]
    v_exp_f32 v182, v182
    v_mfma_f32_16x16x32_bf16 v[136:139], v[212:215], a[248:251], v[136:139]
    v_add_f32 v253, v253, v180
    v_add_f32 v253, v253, v181
    v_mfma_f32_16x16x32_bf16 v[136:139], v[192:195], a[216:219], v[136:139]
    v_exp_f32 v183, v183
    v_mfma_f32_16x16x32_bf16 v[140:143], v[192:195], a[220:223], v[140:143]
    v_cvt_pk_bf16_f32 v198, v180, v181
    v_add_f32 v253, v253, v182
    v_mfma_f32_16x16x32_bf16 v[140:143], v[212:215], a[252:255], v[140:143]
    v_add_f32 v253, v253, v183
    v_cvt_pk_bf16_f32 v199, v182, v183
L_loop1_w0:
    v_mfma_f32_16x16x32_bf16 v[176:179], a[160:163], v[64:67], v[228:231]
    ds_read_b64_tr_b16 a[240:241], v248 offset:8192
    ds_read_b64_tr_b16 a[242:243], v248 offset:12288
    v_mfma_f32_16x16x32_bf16 v[176:179], a[164:167], v[68:71], v[176:179]
    v_exp_f32 v184, v184
    v_mfma_f32_16x16x32_bf16 v[176:179], a[168:171], v[72:75], v[176:179]
    ds_read_b64_tr_b16 a[244:245], v249 offset:8192
    ds_read_b64_tr_b16 a[246:247], v249 offset:12288
    v_mfma_f32_16x16x32_bf16 v[176:179], a[172:175], v[76:79], v[176:179]
    v_exp_f32 v185, v185
    v_mfma_f32_16x16x32_bf16 v[180:183], a[188:191], v[76:79], v[228:231]
    v_exp_f32 v186, v186
    v_mfma_f32_16x16x32_bf16 v[180:183], a[184:187], v[72:75], v[180:183]
    v_add_f32 v252, v252, v184
    v_add_f32 v252, v252, v185
    v_mfma_f32_16x16x32_bf16 v[180:183], a[180:183], v[68:71], v[180:183]
    v_exp_f32 v187, v187
    v_mfma_f32_16x16x32_bf16 v[180:183], a[176:179], v[64:67], v[180:183]
    s_waitcnt lgkmcnt(4)
    v_cvt_pk_bf16_f32 v212, v184, v185
    v_add_f32 v252, v252, v186
    v_mfma_f32_16x16x32_bf16 a[32:35], v[200:203], a[192:195], a[32:35]
    v_exp_f32 v188, v188
    v_mfma_f32_16x16x32_bf16 a[32:35], v[196:199], a[224:227], a[32:35]
    v_add_f32 v252, v252, v187
    v_cvt_pk_bf16_f32 v213, v186, v187
    v_mfma_f32_16x16x32_bf16 a[36:39], v[196:199], a[228:231], a[36:39]
    v_exp_f32 v189, v189
    v_mfma_f32_16x16x32_bf16 a[36:39], v[200:203], a[196:199], a[36:39]
    v_exp_f32 v190, v190
    v_mfma_f32_16x16x32_bf16 a[40:43], v[200:203], a[200:203], a[40:43]
    v_add_f32 v252, v252, v188
    v_add_f32 v252, v252, v189
    v_mfma_f32_16x16x32_bf16 a[40:43], v[196:199], a[232:235], a[40:43]
    v_exp_f32 v191, v191
    v_mfma_f32_16x16x32_bf16 a[44:47], v[196:199], a[236:239], a[44:47]
    v_cvt_pk_bf16_f32 v214, v188, v189
    v_add_f32 v252, v252, v190
    v_mfma_f32_16x16x32_bf16 a[44:47], v[200:203], a[204:207], a[44:47]
    v_add_f32 v252, v252, v191
    v_cvt_pk_bf16_f32 v215, v190, v191
    v_mfma_f32_16x16x32_bf16 v[184:187], a[160:163], v[48:51], v[224:227]
    ds_read_b64_tr_b16 a[248:249], v250 offset:8192
    ds_read_b64_tr_b16 a[250:251], v250 offset:12288
    v_mfma_f32_16x16x32_bf16 v[184:187], a[164:167], v[52:55], v[184:187]
    v_exp_f32 v176, v176
    v_mfma_f32_16x16x32_bf16 v[184:187], a[168:171], v[56:59], v[184:187]
    ds_read_b64_tr_b16 a[252:253], v251 offset:8192
    ds_read_b64_tr_b16 a[254:255], v251 offset:12288
    v_mfma_f32_16x16x32_bf16 v[184:187], a[172:175], v[60:63], v[184:187]
    v_exp_f32 v177, v177
    v_mfma_f32_16x16x32_bf16 v[188:191], a[188:191], v[60:63], v[224:227]
    v_exp_f32 v178, v178
    v_mfma_f32_16x16x32_bf16 v[188:191], a[184:187], v[56:59], v[188:191]
    v_add_f32 v255, v255, v176
    v_add_f32 v255, v255, v177
    v_mfma_f32_16x16x32_bf16 v[188:191], a[180:183], v[52:55], v[188:191]
    v_exp_f32 v179, v179
    v_mfma_f32_16x16x32_bf16 v[188:191], a[176:179], v[48:51], v[188:191]
    s_waitcnt lgkmcnt(4)
    v_cvt_pk_bf16_f32 v192, v176, v177
    v_add_f32 v255, v255, v178
    v_mfma_f32_16x16x32_bf16 a[48:51], v[200:203], a[208:211], a[48:51]
    v_exp_f32 v180, v180
    v_mfma_f32_16x16x32_bf16 a[48:51], v[196:199], a[240:243], a[48:51]
    v_add_f32 v255, v255, v179
    v_cvt_pk_bf16_f32 v193, v178, v179
    v_mfma_f32_16x16x32_bf16 a[52:55], v[196:199], a[244:247], a[52:55]
    v_exp_f32 v181, v181
    v_mfma_f32_16x16x32_bf16 a[52:55], v[200:203], a[212:215], a[52:55]
    v_exp_f32 v182, v182
    v_mfma_f32_16x16x32_bf16 a[56:59], v[200:203], a[216:219], a[56:59]
    s_waitcnt lgkmcnt(2)
    v_add_f32 v255, v255, v180
    v_add_f32 v255, v255, v181
    v_mfma_f32_16x16x32_bf16 a[56:59], v[196:199], a[248:251], a[56:59]
    s_waitcnt lgkmcnt(0)
    v_exp_f32 v183, v183
    v_mfma_f32_16x16x32_bf16 a[60:63], v[196:199], a[252:255], a[60:63]
    v_cvt_pk_bf16_f32 v194, v180, v181
    v_add_f32 v255, v255, v182
    v_mfma_f32_16x16x32_bf16 a[60:63], v[200:203], a[220:223], a[60:63]
    v_add_f32 v255, v255, v183
    v_cvt_pk_bf16_f32 v195, v182, v183
    v_mfma_f32_16x16x32_bf16 v[176:179], a[160:163], v[96:99], v[236:239]
    s_barrier
    ds_read_b128 a[128:131], v240 offset:16384
    ds_read_b128 a[132:135], v241 offset:16384
    v_mfma_f32_16x16x32_bf16 v[176:179], a[164:167], v[100:103], v[176:179]
    v_exp_f32 v184, v184
    v_mfma_f32_16x16x32_bf16 v[176:179], a[168:171], v[104:107], v[176:179]
    ds_read_b128 a[136:139], v242 offset:16384
    ds_read_b128 a[140:143], v243 offset:16384
    v_mfma_f32_16x16x32_bf16 v[176:179], a[172:175], v[108:111], v[176:179]
    v_exp_f32 v185, v185
    v_mfma_f32_16x16x32_bf16 v[180:183], a[188:191], v[108:111], v[236:239]
    v_exp_f32 v186, v186
    v_mfma_f32_16x16x32_bf16 v[180:183], a[184:187], v[104:107], v[180:183]
    v_add_f32 v254, v254, v184
    v_add_f32 v254, v254, v185
    v_mfma_f32_16x16x32_bf16 v[180:183], a[180:183], v[100:103], v[180:183]
    v_exp_f32 v187, v187
    v_mfma_f32_16x16x32_bf16 v[180:183], a[176:179], v[96:99], v[180:183]
    v_cvt_pk_bf16_f32 v200, v184, v185
    v_add_f32 v254, v254, v186
    v_mfma_f32_16x16x32_bf16 a[96:99], v[204:207], a[192:195], a[96:99]
    v_exp_f32 v188, v188
    v_mfma_f32_16x16x32_bf16 a[96:99], v[192:195], a[224:227], a[96:99]
    v_add_f32 v254, v254, v187
    v_cvt_pk_bf16_f32 v201, v186, v187
    v_mfma_f32_16x16x32_bf16 a[100:103], v[192:195], a[228:231], a[100:103]
    v_exp_f32 v189, v189
    v_mfma_f32_16x16x32_bf16 a[100:103], v[204:207], a[196:199], a[100:103]
    v_exp_f32 v190, v190
    v_mfma_f32_16x16x32_bf16 a[104:107], v[204:207], a[200:203], a[104:107]
    v_add_f32 v254, v254, v188
    v_add_f32 v254, v254, v189
    v_mfma_f32_16x16x32_bf16 a[104:107], v[192:195], a[232:235], a[104:107]
    v_exp_f32 v191, v191
    v_mfma_f32_16x16x32_bf16 a[108:111], v[192:195], a[236:239], a[108:111]
    v_cvt_pk_bf16_f32 v202, v188, v189
    v_add_f32 v254, v254, v190
    v_mfma_f32_16x16x32_bf16 a[108:111], v[204:207], a[204:207], a[108:111]
    v_add_f32 v254, v254, v191
    v_cvt_pk_bf16_f32 v203, v190, v191
    v_mfma_f32_16x16x32_bf16 v[184:187], a[160:163], v[80:83], v[232:235]
    ds_read_b128 a[144:147], v240 offset:20480
    ds_read_b128 a[148:151], v241 offset:20480
    v_mfma_f32_16x16x32_bf16 v[184:187], a[164:167], v[84:87], v[184:187]
    v_exp_f32 v176, v176
    v_mfma_f32_16x16x32_bf16 v[184:187], a[168:171], v[88:91], v[184:187]
    ds_read_b128 a[152:155], v242 offset:20480
    ds_read_b128 a[156:159], v243 offset:20480
    v_mfma_f32_16x16x32_bf16 v[184:187], a[172:175], v[92:95], v[184:187]
    v_exp_f32 v177, v177
    v_mfma_f32_16x16x32_bf16 v[188:191], a[188:191], v[92:95], v[232:235]
    v_exp_f32 v178, v178
    v_mfma_f32_16x16x32_bf16 v[188:191], a[184:187], v[88:91], v[188:191]
    v_add_f32 v1, v1, v176
    v_add_f32 v1, v1, v177
    v_mfma_f32_16x16x32_bf16 v[188:191], a[180:183], v[84:87], v[188:191]
    v_exp_f32 v179, v179
    v_mfma_f32_16x16x32_bf16 v[188:191], a[176:179], v[80:83], v[188:191]
    v_cvt_pk_bf16_f32 v196, v176, v177
    v_add_f32 v1, v1, v178
    v_mfma_f32_16x16x32_bf16 a[112:115], v[204:207], a[208:211], a[112:115]
    v_exp_f32 v180, v180
    v_mfma_f32_16x16x32_bf16 a[112:115], v[192:195], a[240:243], a[112:115]
    v_add_f32 v1, v1, v179
    v_cvt_pk_bf16_f32 v197, v178, v179
    v_mfma_f32_16x16x32_bf16 a[116:119], v[192:195], a[244:247], a[116:119]
    v_exp_f32 v181, v181
    v_mfma_f32_16x16x32_bf16 a[116:119], v[204:207], a[212:215], a[116:119]
    v_exp_f32 v182, v182
    v_mfma_f32_16x16x32_bf16 a[120:123], v[204:207], a[216:219], a[120:123]
    v_add_f32 v1, v1, v180
    v_add_f32 v1, v1, v181
    v_mfma_f32_16x16x32_bf16 a[120:123], v[192:195], a[248:251], a[120:123]
    v_exp_f32 v183, v183
    v_mfma_f32_16x16x32_bf16 a[124:127], v[192:195], a[252:255], a[124:127]
    v_cvt_pk_bf16_f32 v198, v180, v181
    v_add_f32 v1, v1, v182
    v_mfma_f32_16x16x32_bf16 a[124:127], v[204:207], a[220:223], a[124:127]
    s_waitcnt lgkmcnt(0)
    v_add_f32 v1, v1, v183
    v_cvt_pk_bf16_f32 v199, v182, v183
    v_mfma_f32_16x16x32_bf16 v[176:179], a[128:131], v[16:19], v[216:219]
    v_exp_f32 v184, v184
    v_mfma_f32_16x16x32_bf16 v[176:179], a[132:135], v[20:23], v[176:179]
    v_exp_f32 v185, v185
    v_mfma_f32_16x16x32_bf16 v[176:179], a[136:139], v[24:27], v[176:179]
    v_exp_f32 v186, v186
    v_mfma_f32_16x16x32_bf16 v[176:179], a[140:143], v[28:31], v[176:179]
    v_add_f32 v0, v0, v184
    v_add_f32 v0, v0, v185
    v_mfma_f32_16x16x32_bf16 v[180:183], a[156:159], v[28:31], v[216:219]
    v_exp_f32 v187, v187
    v_mfma_f32_16x16x32_bf16 v[180:183], a[152:155], v[24:27], v[180:183]
    v_cvt_pk_bf16_f32 v204, v184, v185
    v_add_f32 v0, v0, v186
    v_mfma_f32_16x16x32_bf16 v[180:183], a[148:151], v[20:23], v[180:183]
    v_exp_f32 v188, v188
    v_mfma_f32_16x16x32_bf16 v[180:183], a[144:147], v[16:19], v[180:183]
    v_add_f32 v0, v0, v187
    v_cvt_pk_bf16_f32 v205, v186, v187
    v_mfma_f32_16x16x32_bf16 v[144:147], v[208:211], a[192:195], v[144:147]
    v_exp_f32 v189, v189
    v_mfma_f32_16x16x32_bf16 v[144:147], v[196:199], a[224:227], v[144:147]
    v_exp_f32 v190, v190
    v_mfma_f32_16x16x32_bf16 v[148:151], v[196:199], a[228:231], v[148:151]
    v_add_f32 v0, v0, v188
    v_add_f32 v0, v0, v189
    v_mfma_f32_16x16x32_bf16 v[148:151], v[208:211], a[196:199], v[148:151]
    v_exp_f32 v191, v191
    v_mfma_f32_16x16x32_bf16 v[152:155], v[208:211], a[200:203], v[152:155]
    ds_read_b64_tr_b16 a[192:193], v244 offset:16384
    ds_read_b64_tr_b16 a[194:195], v244 offset:20480
    v_mfma_f32_16x16x32_bf16 v[152:155], v[196:199], a[232:235], v[152:155]
    v_cvt_pk_bf16_f32 v206, v188, v189
    v_add_f32 v0, v0, v190
    v_mfma_f32_16x16x32_bf16 v[156:159], v[196:199], a[236:239], v[156:159]
    ds_read_b64_tr_b16 a[196:197], v245 offset:16384
    ds_read_b64_tr_b16 a[198:199], v245 offset:20480
    v_mfma_f32_16x16x32_bf16 v[156:159], v[208:211], a[204:207], v[156:159]
    v_add_f32 v0, v0, v191
    v_cvt_pk_bf16_f32 v207, v190, v191
    v_mfma_f32_16x16x32_bf16 v[184:187], a[128:131], v[32:35], v[220:223]
    ds_read_b64_tr_b16 a[200:201], v246 offset:16384
    ds_read_b64_tr_b16 a[202:203], v246 offset:20480
    v_mfma_f32_16x16x32_bf16 v[184:187], a[132:135], v[36:39], v[184:187]
    v_exp_f32 v176, v176
    v_mfma_f32_16x16x32_bf16 v[184:187], a[136:139], v[40:43], v[184:187]
    ds_read_b64_tr_b16 a[204:205], v247 offset:16384
    ds_read_b64_tr_b16 a[206:207], v247 offset:20480
    v_mfma_f32_16x16x32_bf16 v[184:187], a[140:143], v[44:47], v[184:187]
    v_exp_f32 v177, v177
    v_mfma_f32_16x16x32_bf16 v[188:191], a[156:159], v[44:47], v[220:223]
    v_exp_f32 v178, v178
    v_mfma_f32_16x16x32_bf16 v[188:191], a[152:155], v[40:43], v[188:191]
    v_add_f32 v252, v252, v176
    v_add_f32 v252, v252, v177
    v_mfma_f32_16x16x32_bf16 v[188:191], a[148:151], v[36:39], v[188:191]
    v_exp_f32 v179, v179
    v_mfma_f32_16x16x32_bf16 v[188:191], a[144:147], v[32:35], v[188:191]
    v_cvt_pk_bf16_f32 v192, v176, v177
    v_add_f32 v252, v252, v178
    v_mfma_f32_16x16x32_bf16 v[160:163], v[208:211], a[208:211], v[160:163]
    v_exp_f32 v180, v180
    v_mfma_f32_16x16x32_bf16 v[160:163], v[196:199], a[240:243], v[160:163]
    v_add_f32 v252, v252, v179
    v_cvt_pk_bf16_f32 v193, v178, v179
    v_mfma_f32_16x16x32_bf16 v[164:167], v[196:199], a[244:247], v[164:167]
    v_exp_f32 v181, v181
    v_mfma_f32_16x16x32_bf16 v[164:167], v[208:211], a[212:215], v[164:167]
    v_exp_f32 v182, v182
    v_mfma_f32_16x16x32_bf16 v[168:171], v[208:211], a[216:219], v[168:171]
    v_add_f32 v252, v252, v180
    v_add_f32 v252, v252, v181
    v_mfma_f32_16x16x32_bf16 v[168:171], v[196:199], a[248:251], v[168:171]
    s_add_u32 s28, s28, 1
    v_exp_f32 v183, v183
    v_mfma_f32_16x16x32_bf16 v[172:175], v[196:199], a[252:255], v[172:175]
    v_cvt_pk_bf16_f32 v194, v180, v181
    v_add_f32 v252, v252, v182
    v_mfma_f32_16x16x32_bf16 v[172:175], v[208:211], a[220:223], v[172:175]
    s_cmp_lg_u32 s28, 5
    v_add_f32 v252, v252, v183
    v_cvt_pk_bf16_f32 v195, v182, v183
    v_mfma_f32_16x16x32_bf16 v[176:179], a[128:131], v[48:51], v[224:227]
    s_cbranch_scc1 L_loop_w0
L_trans_w0:
    ds_read_b64_tr_b16 a[208:209], v248 offset:16384
    ds_read_b64_tr_b16 a[210:211], v248 offset:20480
    v_mov_b32 v216, v252
    v_mfma_f32_16x16x32_bf16 v[176:179], a[132:135], v[52:55], v[176:179]
    v_exp_f32 v184, v184
    v_mfma_f32_16x16x32_bf16 v[176:179], a[136:139], v[56:59], v[176:179]
    ds_read_b64_tr_b16 a[212:213], v249 offset:16384
    ds_read_b64_tr_b16 a[214:215], v249 offset:20480
    v_permlane16_swap_b32 v252, v216
    v_exp_f32 v185, v185
    v_mfma_f32_16x16x32_bf16 v[176:179], a[140:143], v[60:63], v[176:179]
    v_add_f32 v252, v252, v216
    v_mov_b32 v216, v252
    v_mfma_f32_16x16x32_bf16 v[180:183], a[156:159], v[60:63], v[224:227]
    v_exp_f32 v186, v186
    v_add_f32 v253, v253, v184
    v_add_f32 v253, v253, v185
    v_mfma_f32_16x16x32_bf16 v[180:183], a[152:155], v[56:59], v[180:183]
    v_permlane32_swap_b32 v252, v216
    v_exp_f32 v187, v187
    v_cvt_pk_bf16_f32 v208, v184, v185
    v_mfma_f32_16x16x32_bf16 v[180:183], a[148:151], v[52:55], v[180:183]
    v_add_f32 v252, v252, v216
    v_subrev_u32 v216, s57, v252
    v_add_f32 v253, v253, v186
    v_mfma_f32_16x16x32_bf16 v[180:183], a[144:147], v[48:51], v[180:183]
    s_waitcnt lgkmcnt(4)
    v_cmp_le_u32 vcc, s36, v216
    v_rcp_f32 v252, v252
    v_mfma_f32_16x16x32_bf16 a[0:3], v[212:215], a[224:227], a[0:3]
    ds_read_b128 v[16:19], v8 offset:0
    ds_read_b128 v[20:23], v9 offset:0
    ds_bpermute_b32 v216, v4, v252 offset:0
    v_mfma_f32_16x16x32_bf16 a[0:3], v[192:195], a[192:195], a[0:3]
    s_cmp_lg_u64 vcc, 0
    ds_bpermute_b32 v217, v4, v252 offset:4
    v_mfma_f32_16x16x32_bf16 a[4:7], v[192:195], a[196:199], a[4:7]
    s_cselect_b32 s56, 1, 0
    ds_read_b128 v[24:27], v10 offset:0
    ds_read_b128 v[28:31], v11 offset:0
    ds_bpermute_b32 v218, v4, v252 offset:8
    v_mfma_f32_16x16x32_bf16 a[4:7], v[212:215], a[228:231], a[4:7]
    s_or_b32 s27, s27, s56
    ds_bpermute_b32 v219, v4, v252 offset:12
    v_exp_f32 v188, v188
    v_mfma_f32_16x16x32_bf16 a[8:11], v[212:215], a[232:235], a[8:11]
    v_add_f32 v253, v253, v187
    v_cvt_pk_bf16_f32 v209, v186, v187
    v_mfma_f32_16x16x32_bf16 a[8:11], v[192:195], a[200:203], a[8:11]
    v_exp_f32 v189, v189
    v_exp_f32 v190, v190
    v_add_f32 v253, v253, v188
    v_mfma_f32_16x16x32_bf16 a[12:15], v[192:195], a[204:207], a[12:15]
    v_add_f32 v253, v253, v189
    v_exp_f32 v191, v191
    v_mfma_f32_16x16x32_bf16 a[12:15], v[212:215], a[236:239], a[12:15]
    v_cvt_pk_bf16_f32 v210, v188, v189
    v_add_f32 v253, v253, v190
    v_add_f32 v253, v253, v191
    v_cvt_pk_bf16_f32 v211, v190, v191
    v_mfma_f32_16x16x32_bf16 v[184:187], a[128:131], v[64:67], v[228:231]
    ds_read_b64_tr_b16 a[216:217], v250 offset:16384
    ds_read_b64_tr_b16 a[218:219], v250 offset:20480
    v_mov_b32 v220, v253
    v_mfma_f32_16x16x32_bf16 v[184:187], a[132:135], v[68:71], v[184:187]
    v_exp_f32 v176, v176
    v_mfma_f32_16x16x32_bf16 v[184:187], a[136:139], v[72:75], v[184:187]
    ds_read_b64_tr_b16 a[220:221], v251 offset:16384
    ds_read_b64_tr_b16 a[222:223], v251 offset:20480
    v_permlane16_swap_b32 v253, v220
    v_mfma_f32_16x16x32_bf16 v[184:187], a[140:143], v[76:79], v[184:187]
    v_add_f32 v253, v253, v220
    v_mov_b32 v220, v253
    v_mfma_f32_16x16x32_bf16 v[188:191], a[156:159], v[76:79], v[228:231]
    v_exp_f32 v177, v177
    v_mfma_f32_16x16x32_bf16 v[188:191], a[152:155], v[72:75], v[188:191]
    v_permlane32_swap_b32 v253, v220
    v_mfma_f32_16x16x32_bf16 v[188:191], a[148:151], v[68:71], v[188:191]
    v_add_f32 v253, v253, v220
    v_subrev_u32 v220, s57, v253
    v_mfma_f32_16x16x32_bf16 v[188:191], a[144:147], v[64:67], v[188:191]
    s_waitcnt lgkmcnt(4)
    v_cmp_le_u32 vcc, s36, v220
    v_rcp_f32 v253, v253
    v_mfma_f32_16x16x32_bf16 a[16:19], v[212:215], a[240:243], a[16:19]
    ds_bpermute_b32 v220, v4, v253 offset:0
    v_mfma_f32_16x16x32_bf16 a[16:19], v[192:195], a[208:211], a[16:19]
    s_cmp_lg_u64 vcc, 0
    ds_bpermute_b32 v221, v4, v253 offset:4
    v_mfma_f32_16x16x32_bf16 a[20:23], v[192:195], a[212:215], a[20:23]
    s_cselect_b32 s56, 2, 0
    ds_bpermute_b32 v222, v4, v253 offset:8
    v_mfma_f32_16x16x32_bf16 a[20:23], v[212:215], a[244:247], a[20:23]
    s_or_b32 s27, s27, s56
    ds_bpermute_b32 v223, v4, v253 offset:12
    v_mfma_f32_16x16x32_bf16 a[24:27], v[212:215], a[248:251], a[24:27]
    s_waitcnt lgkmcnt(4)
    v_exp_f32 v178, v178
    v_add_f32 v254, v254, v176
    v_mfma_f32_16x16x32_bf16 a[24:27], v[192:195], a[216:219], a[24:27]
    v_add_f32 v254, v254, v177
    v_mfma_f32_16x16x32_bf16 a[28:31], v[192:195], a[220:223], a[28:31]
    s_barrier
    v_exp_f32 v179, v179
    v_cvt_pk_bf16_f32 v196, v176, v177
    v_mfma_f32_16x16x32_bf16 a[28:31], v[212:215], a[252:255], a[28:31]
    v_add_f32 v254, v254, v178
    v_exp_f32 v180, v180
    v_mfma_f32_16x16x32_bf16 a[32:35], v[208:211], a[192:195], a[32:35]
    v_add_f32 v254, v254, v179
    v_cvt_pk_bf16_f32 v197, v178, v179
    v_mfma_f32_16x16x32_bf16 a[36:39], v[208:211], a[196:199], a[36:39]
    ds_read_b128 v[32:35], v8 offset:4096
    ds_read_b128 v[36:39], v9 offset:4096
    v_mfma_f32_16x16x32_bf16 a[40:43], v[208:211], a[200:203], a[40:43]
    v_exp_f32 v181, v181
    v_mfma_f32_16x16x32_bf16 a[44:47], v[208:211], a[204:207], a[44:47]
    ds_read_b128 v[40:43], v10 offset:4096
    ds_read_b128 v[44:47], v11 offset:4096
    v_mfma_f32_16x16x32_bf16 a[48:51], v[208:211], a[208:211], a[48:51]
    v_exp_f32 v182, v182
    v_add_f32 v254, v254, v180
    v_mfma_f32_16x16x32_bf16 a[52:55], v[208:211], a[212:215], a[52:55]
    v_add_f32 v254, v254, v181
    v_mfma_f32_16x16x32_bf16 a[56:59], v[208:211], a[216:219], a[56:59]
    v_exp_f32 v183, v183
    v_cvt_pk_bf16_f32 v198, v180, v181
    v_mfma_f32_16x16x32_bf16 a[60:63], v[208:211], a[220:223], a[60:63]
    v_add_f32 v254, v254, v182
    v_add_f32 v254, v254, v183
    v_cvt_pk_bf16_f32 v199, v182, v183
    s_waitcnt lgkmcnt(14)
.p2align 3
    v_mfma_f32_4x4x4_16b_bf16 v[212:215], v[12:13], v[16:17], 0
    v_accvgpr_read_b32 v176, a0
    v_mfma_f32_4x4x4_16b_bf16 v[208:211], v[12:13], v[18:19], 0
    v_accvgpr_read_b32 v177, a4
    v_mfma_f32_4x4x4_16b_bf16 v[212:215], v[14:15], v[16:17], v[212:215]
    v_accvgpr_read_b32 v178, a8
    v_mfma_f32_4x4x4_16b_bf16 v[208:211], v[14:15], v[18:19], v[208:211]
    v_accvgpr_read_b32 v179, a12
    v_accvgpr_read_b32 v180, a16
    v_accvgpr_read_b32 v181, a20
    v_accvgpr_read_b32 v182, a24
    v_accvgpr_read_b32 v183, a28
    s_waitcnt lgkmcnt(12)
.p2align 3
    v_pk_mul_f32 v[176:177], v[176:177], v[216:217] op_sel:[0,0] op_sel_hi:[1,0]
    v_pk_mul_f32 v[178:179], v[178:179], v[216:217] op_sel:[0,0] op_sel_hi:[1,0]
    v_pk_mul_f32 v[180:181], v[180:181], v[216:217] op_sel:[0,0] op_sel_hi:[1,0]
    v_pk_mul_f32 v[182:183], v[182:183], v[216:217] op_sel:[0,0] op_sel_hi:[1,0]
    v_cvt_pk_bf16_f32 v192, v176, v177
    v_cvt_pk_bf16_f32 v193, v178, v179
    v_cvt_pk_bf16_f32 v194, v180, v181
    v_cvt_pk_bf16_f32 v195, v182, v183
    v_cvt_pk_bf16_f32 v16, v212, v213
    v_cvt_pk_bf16_f32 v17, v214, v215
    v_cvt_pk_bf16_f32 v18, v208, v209
    v_cvt_pk_bf16_f32 v19, v210, v211
    v_mfma_f32_4x4x4_16b_bf16 v[212:215], v[12:13], v[20:21], 0
    ds_write_b128 v2, v[192:195] offset:0
    v_accvgpr_read_b32 v176, a1
    v_mfma_f32_4x4x4_16b_bf16 v[208:211], v[12:13], v[22:23], 0
    v_accvgpr_read_b32 v177, a5
    v_mfma_f32_4x4x4_16b_bf16 v[212:215], v[14:15], v[20:21], v[212:215]
    v_accvgpr_read_b32 v178, a9
    v_mfma_f32_4x4x4_16b_bf16 v[208:211], v[14:15], v[22:23], v[208:211]
    v_accvgpr_read_b32 v179, a13
    v_accvgpr_read_b32 v180, a17
    v_accvgpr_read_b32 v181, a21
    v_accvgpr_read_b32 v182, a25
    v_accvgpr_read_b32 v183, a29
    v_pk_mul_f32 v[176:177], v[176:177], v[216:217] op_sel:[0,1] op_sel_hi:[1,1]
    v_pk_mul_f32 v[178:179], v[178:179], v[216:217] op_sel:[0,1] op_sel_hi:[1,1]
    v_pk_mul_f32 v[180:181], v[180:181], v[216:217] op_sel:[0,1] op_sel_hi:[1,1]
    v_pk_mul_f32 v[182:183], v[182:183], v[216:217] op_sel:[0,1] op_sel_hi:[1,1]
    v_cvt_pk_bf16_f32 v192, v176, v177
    v_cvt_pk_bf16_f32 v193, v178, v179
    v_cvt_pk_bf16_f32 v194, v180, v181
    v_cvt_pk_bf16_f32 v195, v182, v183
    v_cvt_pk_bf16_f32 v20, v212, v213
    v_cvt_pk_bf16_f32 v21, v214, v215
    v_cvt_pk_bf16_f32 v22, v208, v209
    v_cvt_pk_bf16_f32 v23, v210, v211
    v_mfma_f32_4x4x4_16b_bf16 v[212:215], v[12:13], v[24:25], 0
    ds_write_b128 v3, v[192:195] offset:256
    v_accvgpr_read_b32 v176, a2
    v_mfma_f32_4x4x4_16b_bf16 v[208:211], v[12:13], v[26:27], 0
    v_accvgpr_read_b32 v177, a6
    v_mfma_f32_4x4x4_16b_bf16 v[212:215], v[14:15], v[24:25], v[212:215]
    v_accvgpr_read_b32 v178, a10
    v_mfma_f32_4x4x4_16b_bf16 v[208:211], v[14:15], v[26:27], v[208:211]
    v_accvgpr_read_b32 v179, a14
    v_accvgpr_read_b32 v180, a18
    v_accvgpr_read_b32 v181, a22
    v_accvgpr_read_b32 v182, a26
    v_accvgpr_read_b32 v183, a30
    v_pk_mul_f32 v[176:177], v[176:177], v[218:219] op_sel:[0,0] op_sel_hi:[1,0]
    v_pk_mul_f32 v[178:179], v[178:179], v[218:219] op_sel:[0,0] op_sel_hi:[1,0]
    v_pk_mul_f32 v[180:181], v[180:181], v[218:219] op_sel:[0,0] op_sel_hi:[1,0]
    v_pk_mul_f32 v[182:183], v[182:183], v[218:219] op_sel:[0,0] op_sel_hi:[1,0]
    v_cvt_pk_bf16_f32 v192, v176, v177
    v_cvt_pk_bf16_f32 v193, v178, v179
    v_cvt_pk_bf16_f32 v194, v180, v181
    v_cvt_pk_bf16_f32 v195, v182, v183
    v_cvt_pk_bf16_f32 v24, v212, v213
    v_cvt_pk_bf16_f32 v25, v214, v215
    v_cvt_pk_bf16_f32 v26, v208, v209
    v_cvt_pk_bf16_f32 v27, v210, v211
    v_mfma_f32_4x4x4_16b_bf16 v[212:215], v[12:13], v[28:29], 0
    ds_write_b128 v2, v[192:195] offset:512
    v_accvgpr_read_b32 v176, a3
    v_mfma_f32_4x4x4_16b_bf16 v[208:211], v[12:13], v[30:31], 0
    v_accvgpr_read_b32 v177, a7
    v_mfma_f32_4x4x4_16b_bf16 v[212:215], v[14:15], v[28:29], v[212:215]
    v_accvgpr_read_b32 v178, a11
    v_mfma_f32_4x4x4_16b_bf16 v[208:211], v[14:15], v[30:31], v[208:211]
    v_accvgpr_read_b32 v179, a15
    v_accvgpr_read_b32 v180, a19
    v_accvgpr_read_b32 v181, a23
    v_accvgpr_read_b32 v182, a27
    v_accvgpr_read_b32 v183, a31
    v_pk_mul_f32 v[176:177], v[176:177], v[218:219] op_sel:[0,1] op_sel_hi:[1,1]
    v_pk_mul_f32 v[178:179], v[178:179], v[218:219] op_sel:[0,1] op_sel_hi:[1,1]
    v_pk_mul_f32 v[180:181], v[180:181], v[218:219] op_sel:[0,1] op_sel_hi:[1,1]
    v_pk_mul_f32 v[182:183], v[182:183], v[218:219] op_sel:[0,1] op_sel_hi:[1,1]
    v_cvt_pk_bf16_f32 v192, v176, v177
    v_cvt_pk_bf16_f32 v193, v178, v179
    v_cvt_pk_bf16_f32 v194, v180, v181
    v_cvt_pk_bf16_f32 v195, v182, v183
    ds_write_b128 v3, v[192:195] offset:768
    v_cvt_pk_bf16_f32 v28, v212, v213
    v_cvt_pk_bf16_f32 v29, v214, v215
    v_cvt_pk_bf16_f32 v30, v208, v209
    v_cvt_pk_bf16_f32 v31, v210, v211
    s_waitcnt lgkmcnt(4)
.p2align 3
    v_mfma_f32_4x4x4_16b_bf16 v[212:215], v[12:13], v[32:33], 0
    v_accvgpr_read_b32 v176, a32
    v_mfma_f32_4x4x4_16b_bf16 v[208:211], v[12:13], v[34:35], 0
    ds_read_b128 a[16:19], v4 offset:24576
    ds_read_b128 a[20:23], v4 offset:24640
    v_accvgpr_read_b32 v177, a36
    v_mfma_f32_4x4x4_16b_bf16 v[212:215], v[14:15], v[32:33], v[212:215]
    ds_read_b128 a[24:27], v4 offset:24704
    ds_read_b128 a[28:31], v4 offset:24768
    v_accvgpr_read_b32 v178, a40
    v_mfma_f32_4x4x4_16b_bf16 v[208:211], v[14:15], v[34:35], v[208:211]
    v_accvgpr_read_b32 v179, a44
    v_accvgpr_read_b32 v180, a48
    v_accvgpr_read_b32 v181, a52
    v_accvgpr_read_b32 v182, a56
    v_accvgpr_read_b32 v183, a60
    s_waitcnt lgkmcnt(12)
.p2align 3
    v_pk_mul_f32 v[176:177], v[176:177], v[220:221] op_sel:[0,0] op_sel_hi:[1,0]
    v_pk_mul_f32 v[178:179], v[178:179], v[220:221] op_sel:[0,0] op_sel_hi:[1,0]
    v_pk_mul_f32 v[180:181], v[180:181], v[220:221] op_sel:[0,0] op_sel_hi:[1,0]
    v_pk_mul_f32 v[182:183], v[182:183], v[220:221] op_sel:[0,0] op_sel_hi:[1,0]
    v_cvt_pk_bf16_f32 v192, v176, v177
    v_cvt_pk_bf16_f32 v193, v178, v179
    v_cvt_pk_bf16_f32 v194, v180, v181
    v_cvt_pk_bf16_f32 v195, v182, v183
    v_cvt_pk_bf16_f32 v32, v212, v213
    v_cvt_pk_bf16_f32 v33, v214, v215
    v_cvt_pk_bf16_f32 v34, v208, v209
    v_cvt_pk_bf16_f32 v35, v210, v211
    v_mfma_f32_4x4x4_16b_bf16 v[212:215], v[12:13], v[36:37], 0
    ds_write_b128 v2, v[192:195] offset:4096
    v_accvgpr_read_b32 v176, a33
    v_mfma_f32_4x4x4_16b_bf16 v[208:211], v[12:13], v[38:39], 0
    v_accvgpr_read_b32 v177, a37
    v_mfma_f32_4x4x4_16b_bf16 v[212:215], v[14:15], v[36:37], v[212:215]
    v_accvgpr_read_b32 v178, a41
    v_mfma_f32_4x4x4_16b_bf16 v[208:211], v[14:15], v[38:39], v[208:211]
    v_accvgpr_read_b32 v179, a45
    v_accvgpr_read_b32 v180, a49
    v_accvgpr_read_b32 v181, a53
    v_accvgpr_read_b32 v182, a57
    v_accvgpr_read_b32 v183, a61
    v_pk_mul_f32 v[176:177], v[176:177], v[220:221] op_sel:[0,1] op_sel_hi:[1,1]
    v_pk_mul_f32 v[178:179], v[178:179], v[220:221] op_sel:[0,1] op_sel_hi:[1,1]
    v_pk_mul_f32 v[180:181], v[180:181], v[220:221] op_sel:[0,1] op_sel_hi:[1,1]
    v_pk_mul_f32 v[182:183], v[182:183], v[220:221] op_sel:[0,1] op_sel_hi:[1,1]
    v_cvt_pk_bf16_f32 v192, v176, v177
    v_cvt_pk_bf16_f32 v193, v178, v179
    v_cvt_pk_bf16_f32 v194, v180, v181
    v_cvt_pk_bf16_f32 v195, v182, v183
    v_cvt_pk_bf16_f32 v36, v212, v213
    v_cvt_pk_bf16_f32 v37, v214, v215
    v_cvt_pk_bf16_f32 v38, v208, v209
    v_cvt_pk_bf16_f32 v39, v210, v211
    v_mfma_f32_4x4x4_16b_bf16 v[212:215], v[12:13], v[40:41], 0
    ds_write_b128 v3, v[192:195] offset:4352
    v_accvgpr_read_b32 v176, a34
    v_mfma_f32_4x4x4_16b_bf16 v[208:211], v[12:13], v[42:43], 0
    v_accvgpr_read_b32 v177, a38
    v_mfma_f32_4x4x4_16b_bf16 v[212:215], v[14:15], v[40:41], v[212:215]
    v_accvgpr_read_b32 v178, a42
    v_mfma_f32_4x4x4_16b_bf16 v[208:211], v[14:15], v[42:43], v[208:211]
    v_accvgpr_read_b32 v179, a46
    v_accvgpr_read_b32 v180, a50
    v_accvgpr_read_b32 v181, a54
    v_accvgpr_read_b32 v182, a58
    v_accvgpr_read_b32 v183, a62
    v_pk_mul_f32 v[176:177], v[176:177], v[222:223] op_sel:[0,0] op_sel_hi:[1,0]
    v_pk_mul_f32 v[178:179], v[178:179], v[222:223] op_sel:[0,0] op_sel_hi:[1,0]
    v_pk_mul_f32 v[180:181], v[180:181], v[222:223] op_sel:[0,0] op_sel_hi:[1,0]
    v_pk_mul_f32 v[182:183], v[182:183], v[222:223] op_sel:[0,0] op_sel_hi:[1,0]
    v_cvt_pk_bf16_f32 v192, v176, v177
    v_cvt_pk_bf16_f32 v193, v178, v179
    v_cvt_pk_bf16_f32 v194, v180, v181
    v_cvt_pk_bf16_f32 v195, v182, v183
    v_cvt_pk_bf16_f32 v40, v212, v213
    v_cvt_pk_bf16_f32 v41, v214, v215
    v_cvt_pk_bf16_f32 v42, v208, v209
    v_cvt_pk_bf16_f32 v43, v210, v211
    v_mfma_f32_4x4x4_16b_bf16 v[212:215], v[12:13], v[44:45], 0
    ds_write_b128 v2, v[192:195] offset:4608
    v_accvgpr_read_b32 v176, a35
    v_mfma_f32_4x4x4_16b_bf16 v[208:211], v[12:13], v[46:47], 0
    v_accvgpr_read_b32 v177, a39
    v_mfma_f32_4x4x4_16b_bf16 v[212:215], v[14:15], v[44:45], v[212:215]
    v_accvgpr_read_b32 v178, a43
    v_mfma_f32_4x4x4_16b_bf16 v[208:211], v[14:15], v[46:47], v[208:211]
    v_accvgpr_read_b32 v179, a47
    v_accvgpr_read_b32 v180, a51
    v_accvgpr_read_b32 v181, a55
    v_accvgpr_read_b32 v182, a59
    v_accvgpr_read_b32 v183, a63
    v_pk_mul_f32 v[176:177], v[176:177], v[222:223] op_sel:[0,1] op_sel_hi:[1,1]
    v_pk_mul_f32 v[178:179], v[178:179], v[222:223] op_sel:[0,1] op_sel_hi:[1,1]
    v_pk_mul_f32 v[180:181], v[180:181], v[222:223] op_sel:[0,1] op_sel_hi:[1,1]
    v_pk_mul_f32 v[182:183], v[182:183], v[222:223] op_sel:[0,1] op_sel_hi:[1,1]
    v_cvt_pk_bf16_f32 v192, v176, v177
    v_cvt_pk_bf16_f32 v193, v178, v179
    v_cvt_pk_bf16_f32 v194, v180, v181
    v_cvt_pk_bf16_f32 v195, v182, v183
    ds_write_b128 v3, v[192:195] offset:4864
    v_cvt_pk_bf16_f32 v44, v212, v213
    v_cvt_pk_bf16_f32 v45, v214, v215
    v_cvt_pk_bf16_f32 v46, v208, v209
    v_cvt_pk_bf16_f32 v47, v210, v211
    s_waitcnt lgkmcnt(4)
    v_mfma_f32_16x16x32_bf16 v[220:223], a[16:19], v[32:35], 0
    v_mov_b32 v224, v254
    v_mfma_f32_16x16x32_bf16 v[220:223], a[20:23], v[36:39], v[220:223]
    ds_read_b128 v[48:51], v8 offset:8192
    ds_read_b128 v[52:55], v9 offset:8192
    v_exp_f32 v184, v184
    v_mfma_f32_16x16x32_bf16 v[220:223], a[24:27], v[40:43], v[220:223]
    v_permlane16_swap_b32 v254, v224
    v_mfma_f32_16x16x32_bf16 v[220:223], a[28:31], v[44:47], v[220:223]
    ds_read_b128 v[56:59], v10 offset:8192
    ds_read_b128 v[60:63], v11 offset:8192
    v_add_f32 v254, v254, v224
    v_mov_b32 v224, v254
    v_mfma_f32_16x16x32_bf16 v[216:219], a[16:19], v[16:19], 0
    v_exp_f32 v185, v185
    v_mfma_f32_16x16x32_bf16 v[216:219], a[20:23], v[20:23], v[216:219]
    v_permlane32_swap_b32 v254, v224
    v_exp_f32 v186, v186
    v_mfma_f32_16x16x32_bf16 v[216:219], a[24:27], v[24:27], v[216:219]
    v_add_f32 v254, v254, v224
    v_subrev_u32 v224, s57, v254
    v_add_f32 v255, v255, v184
    v_mfma_f32_16x16x32_bf16 v[216:219], a[28:31], v[28:31], v[216:219]
    v_cmp_le_u32 vcc, s36, v224
    v_rcp_f32 v254, v254
    v_mfma_f32_16x16x32_bf16 v[176:179], a[128:131], v[80:83], v[232:235]
    ds_read_b128 a[160:163], v240 offset:24576
    ds_read_b128 a[164:167], v241 offset:24576
    ds_bpermute_b32 v224, v4, v254 offset:0
    v_mfma_f32_16x16x32_bf16 v[176:179], a[132:135], v[84:87], v[176:179]
    s_cmp_lg_u64 vcc, 0
    ds_bpermute_b32 v225, v4, v254 offset:4
    v_mfma_f32_16x16x32_bf16 v[176:179], a[136:139], v[88:91], v[176:179]
    s_cselect_b32 s56, 4, 0
    ds_read_b128 a[168:171], v242 offset:24576
    ds_read_b128 a[172:175], v243 offset:24576
    ds_bpermute_b32 v226, v4, v254 offset:8
    v_mfma_f32_16x16x32_bf16 v[176:179], a[140:143], v[92:95], v[176:179]
    s_or_b32 s27, s27, s56
    ds_bpermute_b32 v227, v4, v254 offset:12
    v_mfma_f32_16x16x32_bf16 v[180:183], a[156:159], v[92:95], v[232:235]
    v_add_f32 v255, v255, v185
    v_sub_f32 v220, s61, v220
    v_mfma_f32_16x16x32_bf16 v[180:183], a[152:155], v[88:91], v[180:183]
    v_exp_f32 v187, v187
    v_mfma_f32_16x16x32_bf16 v[180:183], a[148:151], v[84:87], v[180:183]
    v_cvt_pk_bf16_f32 v212, v184, v185
    v_add_f32 v255, v255, v186
    v_mfma_f32_16x16x32_bf16 v[180:183], a[144:147], v[80:83], v[180:183]
    v_exp_f32 v188, v188
    v_mfma_f32_16x16x32_bf16 a[64:67], v[200:203], a[224:227], a[64:67]
    v_add_f32 v255, v255, v187
    v_cvt_pk_bf16_f32 v213, v186, v187
    v_mfma_f32_16x16x32_bf16 a[64:67], v[196:199], a[192:195], a[64:67]
    v_exp_f32 v189, v189
    v_sub_f32 v221, s61, v221
    v_mfma_f32_16x16x32_bf16 a[68:71], v[196:199], a[196:199], a[68:71]
    v_exp_f32 v190, v190
    v_add_f32 v255, v255, v188
    v_mfma_f32_16x16x32_bf16 a[68:71], v[200:203], a[228:231], a[68:71]
    v_add_f32 v255, v255, v189
    v_sub_f32 v222, s61, v222
    v_mfma_f32_16x16x32_bf16 a[72:75], v[200:203], a[232:235], a[72:75]
    v_exp_f32 v191, v191
    v_cvt_pk_bf16_f32 v214, v188, v189
    v_mfma_f32_16x16x32_bf16 a[72:75], v[196:199], a[200:203], a[72:75]
    v_add_f32 v255, v255, v190
    v_add_f32 v255, v255, v191
    v_mfma_f32_16x16x32_bf16 a[76:79], v[196:199], a[204:207], a[76:79]
    v_cvt_pk_bf16_f32 v215, v190, v191
    v_sub_f32 v223, s61, v223
    v_sub_f32 v216, s61, v216
    v_sub_f32 v217, s61, v217
    v_sub_f32 v218, s61, v218
    v_sub_f32 v219, s61, v219
    v_mfma_f32_16x16x32_bf16 a[76:79], v[200:203], a[236:239], a[76:79]
    v_mfma_f32_16x16x32_bf16 v[184:187], a[128:131], v[96:99], v[236:239]
    ds_read_b128 a[176:179], v240 offset:28672
    ds_read_b128 a[180:183], v241 offset:28672
    v_mov_b32 v228, v255
    v_mfma_f32_16x16x32_bf16 v[184:187], a[132:135], v[100:103], v[184:187]
    v_exp_f32 v176, v176
    v_mfma_f32_16x16x32_bf16 v[184:187], a[136:139], v[104:107], v[184:187]
    ds_read_b128 a[184:187], v242 offset:28672
    ds_read_b128 a[188:191], v243 offset:28672
    v_permlane16_swap_b32 v255, v228
    v_mfma_f32_16x16x32_bf16 v[184:187], a[140:143], v[108:111], v[184:187]
    v_add_f32 v255, v255, v228
    v_mov_b32 v228, v255
    v_mfma_f32_16x16x32_bf16 v[188:191], a[156:159], v[108:111], v[236:239]
    v_exp_f32 v177, v177
    v_mfma_f32_16x16x32_bf16 v[188:191], a[152:155], v[104:107], v[188:191]
    v_permlane32_swap_b32 v255, v228
    v_mfma_f32_16x16x32_bf16 v[188:191], a[148:151], v[100:103], v[188:191]
    v_add_f32 v255, v255, v228
    v_subrev_u32 v228, s57, v255
    v_mfma_f32_16x16x32_bf16 v[188:191], a[144:147], v[96:99], v[188:191]
    v_cmp_le_u32 vcc, s36, v228
    v_rcp_f32 v255, v255
    v_mfma_f32_16x16x32_bf16 a[80:83], v[200:203], a[240:243], a[80:83]
    ds_bpermute_b32 v228, v4, v255 offset:0
    v_mfma_f32_16x16x32_bf16 a[80:83], v[196:199], a[208:211], a[80:83]
    s_cmp_lg_u64 vcc, 0
    ds_bpermute_b32 v229, v4, v255 offset:4
    v_mfma_f32_16x16x32_bf16 a[84:87], v[196:199], a[212:215], a[84:87]
    s_cselect_b32 s56, 8, 0
    ds_bpermute_b32 v230, v4, v255 offset:8
    v_mfma_f32_16x16x32_bf16 a[84:87], v[200:203], a[244:247], a[84:87]
    s_or_b32 s27, s27, s56
    ds_bpermute_b32 v231, v4, v255 offset:12
    v_mfma_f32_16x16x32_bf16 a[88:91], v[200:203], a[248:251], a[88:91]
    v_exp_f32 v178, v178
    v_add_f32 v0, v0, v176
    v_mfma_f32_16x16x32_bf16 a[88:91], v[196:199], a[216:219], a[88:91]
    v_add_f32 v0, v0, v177
    v_mfma_f32_16x16x32_bf16 a[92:95], v[196:199], a[220:223], a[92:95]
    v_exp_f32 v179, v179
    v_cvt_pk_bf16_f32 v192, v176, v177
    v_mfma_f32_16x16x32_bf16 a[92:95], v[200:203], a[252:255], a[92:95]
    s_waitcnt lgkmcnt(0)
    v_add_f32 v0, v0, v178
    v_exp_f32 v180, v180
    v_mfma_f32_16x16x32_bf16 a[96:99], v[212:215], a[192:195], a[96:99]
    v_add_f32 v0, v0, v179
    v_cvt_pk_bf16_f32 v193, v178, v179
    v_mfma_f32_16x16x32_bf16 a[100:103], v[212:215], a[196:199], a[100:103]
    ds_read_b128 v[64:67], v8 offset:12288
    ds_read_b128 v[68:71], v9 offset:12288
    v_mfma_f32_16x16x32_bf16 a[104:107], v[212:215], a[200:203], a[104:107]
    v_exp_f32 v181, v181
    v_mfma_f32_16x16x32_bf16 a[108:111], v[212:215], a[204:207], a[108:111]
    ds_read_b128 v[72:75], v10 offset:12288
    ds_read_b128 v[76:79], v11 offset:12288
    v_mfma_f32_16x16x32_bf16 a[112:115], v[212:215], a[208:211], a[112:115]
    v_exp_f32 v182, v182
    v_add_f32 v0, v0, v180
    v_mfma_f32_16x16x32_bf16 a[116:119], v[212:215], a[212:215], a[116:119]
    v_add_f32 v0, v0, v181
    v_mfma_f32_16x16x32_bf16 a[120:123], v[212:215], a[216:219], a[120:123]
    v_exp_f32 v183, v183
    v_cvt_pk_bf16_f32 v194, v180, v181
    v_mfma_f32_16x16x32_bf16 a[124:127], v[212:215], a[220:223], a[124:127]
    v_add_f32 v0, v0, v182
    v_add_f32 v0, v0, v183
    v_cvt_pk_bf16_f32 v195, v182, v183
    s_waitcnt lgkmcnt(15)
.p2align 3
    v_mfma_f32_4x4x4_16b_bf16 v[200:203], v[12:13], v[48:49], 0
    v_accvgpr_read_b32 v176, a64
    v_mfma_f32_4x4x4_16b_bf16 v[212:215], v[12:13], v[50:51], 0
    v_accvgpr_read_b32 v177, a68
    v_mfma_f32_4x4x4_16b_bf16 v[200:203], v[14:15], v[48:49], v[200:203]
    v_accvgpr_read_b32 v178, a72
    v_mfma_f32_4x4x4_16b_bf16 v[212:215], v[14:15], v[50:51], v[212:215]
    v_accvgpr_read_b32 v179, a76
    v_accvgpr_read_b32 v180, a80
    v_accvgpr_read_b32 v181, a84
    v_accvgpr_read_b32 v182, a88
    v_accvgpr_read_b32 v183, a92
    s_waitcnt lgkmcnt(12)
.p2align 3
    v_pk_mul_f32 v[176:177], v[176:177], v[224:225] op_sel:[0,0] op_sel_hi:[1,0]
    v_pk_mul_f32 v[178:179], v[178:179], v[224:225] op_sel:[0,0] op_sel_hi:[1,0]
    v_pk_mul_f32 v[180:181], v[180:181], v[224:225] op_sel:[0,0] op_sel_hi:[1,0]
    v_pk_mul_f32 v[182:183], v[182:183], v[224:225] op_sel:[0,0] op_sel_hi:[1,0]
    v_cvt_pk_bf16_f32 v196, v176, v177
    v_cvt_pk_bf16_f32 v197, v178, v179
    v_cvt_pk_bf16_f32 v198, v180, v181
    v_cvt_pk_bf16_f32 v199, v182, v183
    v_cvt_pk_bf16_f32 v48, v200, v201
    v_cvt_pk_bf16_f32 v49, v202, v203
    v_cvt_pk_bf16_f32 v50, v212, v213
    v_cvt_pk_bf16_f32 v51, v214, v215
    v_mfma_f32_4x4x4_16b_bf16 v[200:203], v[12:13], v[52:53], 0
    ds_write_b128 v2, v[196:199] offset:8192
    v_accvgpr_read_b32 v176, a65
    v_mfma_f32_4x4x4_16b_bf16 v[212:215], v[12:13], v[54:55], 0
    v_accvgpr_read_b32 v177, a69
    v_mfma_f32_4x4x4_16b_bf16 v[200:203], v[14:15], v[52:53], v[200:203]
    v_accvgpr_read_b32 v178, a73
    v_mfma_f32_4x4x4_16b_bf16 v[212:215], v[14:15], v[54:55], v[212:215]
    v_accvgpr_read_b32 v179, a77
    v_accvgpr_read_b32 v180, a81
    v_accvgpr_read_b32 v181, a85
    v_accvgpr_read_b32 v182, a89
    v_accvgpr_read_b32 v183, a93
    v_pk_mul_f32 v[176:177], v[176:177], v[224:225] op_sel:[0,1] op_sel_hi:[1,1]
    v_pk_mul_f32 v[178:179], v[178:179], v[224:225] op_sel:[0,1] op_sel_hi:[1,1]
    v_pk_mul_f32 v[180:181], v[180:181], v[224:225] op_sel:[0,1] op_sel_hi:[1,1]
    v_pk_mul_f32 v[182:183], v[182:183], v[224:225] op_sel:[0,1] op_sel_hi:[1,1]
    v_cvt_pk_bf16_f32 v196, v176, v177
    v_cvt_pk_bf16_f32 v197, v178, v179
    v_cvt_pk_bf16_f32 v198, v180, v181
    v_cvt_pk_bf16_f32 v199, v182, v183
    v_cvt_pk_bf16_f32 v52, v200, v201
    v_cvt_pk_bf16_f32 v53, v202, v203
    v_cvt_pk_bf16_f32 v54, v212, v213
    v_cvt_pk_bf16_f32 v55, v214, v215
    v_mfma_f32_4x4x4_16b_bf16 v[200:203], v[12:13], v[56:57], 0
    ds_write_b128 v3, v[196:199] offset:8448
    v_accvgpr_read_b32 v176, a66
    v_mfma_f32_4x4x4_16b_bf16 v[212:215], v[12:13], v[58:59], 0
    v_accvgpr_read_b32 v177, a70
    v_mfma_f32_4x4x4_16b_bf16 v[200:203], v[14:15], v[56:57], v[200:203]
    v_accvgpr_read_b32 v178, a74
    v_mfma_f32_4x4x4_16b_bf16 v[212:215], v[14:15], v[58:59], v[212:215]
    v_accvgpr_read_b32 v179, a78
    v_accvgpr_read_b32 v180, a82
    v_accvgpr_read_b32 v181, a86
    v_accvgpr_read_b32 v182, a90
    v_accvgpr_read_b32 v183, a94
    v_pk_mul_f32 v[176:177], v[176:177], v[226:227] op_sel:[0,0] op_sel_hi:[1,0]
    v_pk_mul_f32 v[178:179], v[178:179], v[226:227] op_sel:[0,0] op_sel_hi:[1,0]
    v_pk_mul_f32 v[180:181], v[180:181], v[226:227] op_sel:[0,0] op_sel_hi:[1,0]
    v_pk_mul_f32 v[182:183], v[182:183], v[226:227] op_sel:[0,0] op_sel_hi:[1,0]
    v_cvt_pk_bf16_f32 v196, v176, v177
    v_cvt_pk_bf16_f32 v197, v178, v179
    v_cvt_pk_bf16_f32 v198, v180, v181
    v_cvt_pk_bf16_f32 v199, v182, v183
    v_cvt_pk_bf16_f32 v56, v200, v201
    v_cvt_pk_bf16_f32 v57, v202, v203
    v_cvt_pk_bf16_f32 v58, v212, v213
    v_cvt_pk_bf16_f32 v59, v214, v215
    v_mfma_f32_4x4x4_16b_bf16 v[200:203], v[12:13], v[60:61], 0
    ds_write_b128 v2, v[196:199] offset:8704
    v_accvgpr_read_b32 v176, a67
    v_mfma_f32_4x4x4_16b_bf16 v[212:215], v[12:13], v[62:63], 0
    v_accvgpr_read_b32 v177, a71
    v_mfma_f32_4x4x4_16b_bf16 v[200:203], v[14:15], v[60:61], v[200:203]
    v_accvgpr_read_b32 v178, a75
    v_mfma_f32_4x4x4_16b_bf16 v[212:215], v[14:15], v[62:63], v[212:215]
    v_accvgpr_read_b32 v179, a79
    v_accvgpr_read_b32 v180, a83
    v_accvgpr_read_b32 v181, a87
    v_accvgpr_read_b32 v182, a91
    v_accvgpr_read_b32 v183, a95
    v_pk_mul_f32 v[176:177], v[176:177], v[226:227] op_sel:[0,1] op_sel_hi:[1,1]
    v_pk_mul_f32 v[178:179], v[178:179], v[226:227] op_sel:[0,1] op_sel_hi:[1,1]
    v_pk_mul_f32 v[180:181], v[180:181], v[226:227] op_sel:[0,1] op_sel_hi:[1,1]
    v_pk_mul_f32 v[182:183], v[182:183], v[226:227] op_sel:[0,1] op_sel_hi:[1,1]
    v_cvt_pk_bf16_f32 v196, v176, v177
    v_cvt_pk_bf16_f32 v197, v178, v179
    v_cvt_pk_bf16_f32 v198, v180, v181
    v_cvt_pk_bf16_f32 v199, v182, v183
    ds_write_b128 v3, v[196:199] offset:8960
    v_cvt_pk_bf16_f32 v60, v200, v201
    v_cvt_pk_bf16_f32 v61, v202, v203
    v_cvt_pk_bf16_f32 v62, v212, v213
    v_cvt_pk_bf16_f32 v63, v214, v215
    s_waitcnt lgkmcnt(4)
.p2align 3
    v_mfma_f32_4x4x4_16b_bf16 v[200:203], v[12:13], v[64:65], 0
    v_accvgpr_read_b32 v176, a96
    v_mfma_f32_4x4x4_16b_bf16 v[212:215], v[12:13], v[66:67], 0
    v_accvgpr_read_b32 v177, a100
    v_mfma_f32_4x4x4_16b_bf16 v[200:203], v[14:15], v[64:65], v[200:203]
    v_accvgpr_read_b32 v178, a104
    v_mfma_f32_4x4x4_16b_bf16 v[212:215], v[14:15], v[66:67], v[212:215]
    v_accvgpr_read_b32 v179, a108
    v_accvgpr_read_b32 v180, a112
    v_accvgpr_read_b32 v181, a116
    v_accvgpr_read_b32 v182, a120
    v_accvgpr_read_b32 v183, a124
    s_waitcnt lgkmcnt(8)
.p2align 3
    v_pk_mul_f32 v[176:177], v[176:177], v[228:229] op_sel:[0,0] op_sel_hi:[1,0]
    v_pk_mul_f32 v[178:179], v[178:179], v[228:229] op_sel:[0,0] op_sel_hi:[1,0]
    v_pk_mul_f32 v[180:181], v[180:181], v[228:229] op_sel:[0,0] op_sel_hi:[1,0]
    v_pk_mul_f32 v[182:183], v[182:183], v[228:229] op_sel:[0,0] op_sel_hi:[1,0]
    v_cvt_pk_bf16_f32 v196, v176, v177
    v_cvt_pk_bf16_f32 v197, v178, v179
    v_cvt_pk_bf16_f32 v198, v180, v181
    v_cvt_pk_bf16_f32 v199, v182, v183
    v_cvt_pk_bf16_f32 v64, v200, v201
    v_cvt_pk_bf16_f32 v65, v202, v203
    v_cvt_pk_bf16_f32 v66, v212, v213
    v_cvt_pk_bf16_f32 v67, v214, v215
    v_mfma_f32_4x4x4_16b_bf16 v[200:203], v[12:13], v[68:69], 0
    ds_write_b128 v2, v[196:199] offset:12288
    v_accvgpr_read_b32 v176, a97
    v_mfma_f32_4x4x4_16b_bf16 v[212:215], v[12:13], v[70:71], 0
    v_accvgpr_read_b32 v177, a101
    v_mfma_f32_4x4x4_16b_bf16 v[200:203], v[14:15], v[68:69], v[200:203]
    v_accvgpr_read_b32 v178, a105
    v_mfma_f32_4x4x4_16b_bf16 v[212:215], v[14:15], v[70:71], v[212:215]
    v_accvgpr_read_b32 v179, a109
    v_accvgpr_read_b32 v180, a113
    v_accvgpr_read_b32 v181, a117
    v_accvgpr_read_b32 v182, a121
    v_accvgpr_read_b32 v183, a125
    v_pk_mul_f32 v[176:177], v[176:177], v[228:229] op_sel:[0,1] op_sel_hi:[1,1]
    v_pk_mul_f32 v[178:179], v[178:179], v[228:229] op_sel:[0,1] op_sel_hi:[1,1]
    v_pk_mul_f32 v[180:181], v[180:181], v[228:229] op_sel:[0,1] op_sel_hi:[1,1]
    v_pk_mul_f32 v[182:183], v[182:183], v[228:229] op_sel:[0,1] op_sel_hi:[1,1]
    v_cvt_pk_bf16_f32 v196, v176, v177
    v_cvt_pk_bf16_f32 v197, v178, v179
    v_cvt_pk_bf16_f32 v198, v180, v181
    v_cvt_pk_bf16_f32 v199, v182, v183
    v_cvt_pk_bf16_f32 v68, v200, v201
    v_cvt_pk_bf16_f32 v69, v202, v203
    v_cvt_pk_bf16_f32 v70, v212, v213
    v_cvt_pk_bf16_f32 v71, v214, v215
    v_mfma_f32_4x4x4_16b_bf16 v[200:203], v[12:13], v[72:73], 0
    ds_write_b128 v3, v[196:199] offset:12544
    v_accvgpr_read_b32 v176, a98
    v_mfma_f32_4x4x4_16b_bf16 v[212:215], v[12:13], v[74:75], 0
    v_accvgpr_read_b32 v177, a102
    v_mfma_f32_4x4x4_16b_bf16 v[200:203], v[14:15], v[72:73], v[200:203]
    v_accvgpr_read_b32 v178, a106
    v_mfma_f32_4x4x4_16b_bf16 v[212:215], v[14:15], v[74:75], v[212:215]
    v_accvgpr_read_b32 v179, a110
    v_accvgpr_read_b32 v180, a114
    v_accvgpr_read_b32 v181, a118
    v_accvgpr_read_b32 v182, a122
    v_accvgpr_read_b32 v183, a126
    v_pk_mul_f32 v[176:177], v[176:177], v[230:231] op_sel:[0,0] op_sel_hi:[1,0]
    v_pk_mul_f32 v[178:179], v[178:179], v[230:231] op_sel:[0,0] op_sel_hi:[1,0]
    v_pk_mul_f32 v[180:181], v[180:181], v[230:231] op_sel:[0,0] op_sel_hi:[1,0]
    v_pk_mul_f32 v[182:183], v[182:183], v[230:231] op_sel:[0,0] op_sel_hi:[1,0]
    v_cvt_pk_bf16_f32 v196, v176, v177
    v_cvt_pk_bf16_f32 v197, v178, v179
    v_cvt_pk_bf16_f32 v198, v180, v181
    v_cvt_pk_bf16_f32 v199, v182, v183
    v_cvt_pk_bf16_f32 v72, v200, v201
    v_cvt_pk_bf16_f32 v73, v202, v203
    v_cvt_pk_bf16_f32 v74, v212, v213
    v_cvt_pk_bf16_f32 v75, v214, v215
    v_mfma_f32_4x4x4_16b_bf16 v[200:203], v[12:13], v[76:77], 0
    ds_write_b128 v2, v[196:199] offset:12800
    v_accvgpr_read_b32 v176, a99
    v_mfma_f32_4x4x4_16b_bf16 v[212:215], v[12:13], v[78:79], 0
    v_accvgpr_read_b32 v177, a103
    v_mfma_f32_4x4x4_16b_bf16 v[200:203], v[14:15], v[76:77], v[200:203]
    v_accvgpr_read_b32 v178, a107
    v_mfma_f32_4x4x4_16b_bf16 v[212:215], v[14:15], v[78:79], v[212:215]
    v_accvgpr_read_b32 v179, a111
    v_accvgpr_read_b32 v180, a115
    v_accvgpr_read_b32 v181, a119
    v_accvgpr_read_b32 v182, a123
    v_accvgpr_read_b32 v183, a127
    v_pk_mul_f32 v[176:177], v[176:177], v[230:231] op_sel:[0,1] op_sel_hi:[1,1]
    v_pk_mul_f32 v[178:179], v[178:179], v[230:231] op_sel:[0,1] op_sel_hi:[1,1]
    v_pk_mul_f32 v[180:181], v[180:181], v[230:231] op_sel:[0,1] op_sel_hi:[1,1]
    v_pk_mul_f32 v[182:183], v[182:183], v[230:231] op_sel:[0,1] op_sel_hi:[1,1]
    v_cvt_pk_bf16_f32 v196, v176, v177
    v_cvt_pk_bf16_f32 v197, v178, v179
    v_cvt_pk_bf16_f32 v198, v180, v181
    v_cvt_pk_bf16_f32 v199, v182, v183
    ds_write_b128 v3, v[196:199] offset:13056
    v_cvt_pk_bf16_f32 v76, v200, v201
    v_cvt_pk_bf16_f32 v77, v202, v203
    v_cvt_pk_bf16_f32 v78, v212, v213
    v_cvt_pk_bf16_f32 v79, v214, v215
    v_mfma_f32_16x16x32_bf16 v[228:231], a[16:19], v[64:67], 0
    v_mov_b32 v232, v0
    v_mfma_f32_16x16x32_bf16 v[228:231], a[20:23], v[68:71], v[228:231]
    ds_read_b128 v[80:83], v8 offset:16384
    ds_read_b128 v[84:87], v9 offset:16384
    v_exp_f32 v184, v184
    v_mfma_f32_16x16x32_bf16 v[228:231], a[24:27], v[72:75], v[228:231]
    v_permlane16_swap_b32 v0, v232
    v_mfma_f32_16x16x32_bf16 v[228:231], a[28:31], v[76:79], v[228:231]
    ds_read_b128 v[88:91], v10 offset:16384
    ds_read_b128 v[92:95], v11 offset:16384
    v_add_f32 v0, v0, v232
    v_mov_b32 v232, v0
    v_mfma_f32_16x16x32_bf16 v[224:227], a[16:19], v[48:51], 0
    v_exp_f32 v185, v185
    v_mfma_f32_16x16x32_bf16 v[224:227], a[20:23], v[52:55], v[224:227]
    v_permlane32_swap_b32 v0, v232
    v_exp_f32 v186, v186
    v_mfma_f32_16x16x32_bf16 v[224:227], a[24:27], v[56:59], v[224:227]
    v_add_f32 v0, v0, v232
    v_subrev_u32 v232, s57, v0
    v_add_f32 v1, v1, v184
    v_mfma_f32_16x16x32_bf16 v[224:227], a[28:31], v[60:63], v[224:227]
    v_cmp_le_u32 vcc, s36, v232
    v_rcp_f32 v0, v0
    v_mfma_f32_16x16x32_bf16 v[176:179], a[160:163], v[32:35], v[220:223]
    ds_bpermute_b32 v232, v4, v0 offset:0
    v_mfma_f32_16x16x32_bf16 v[176:179], a[164:167], v[36:39], v[176:179]
    s_cmp_lg_u64 vcc, 0
    ds_bpermute_b32 v233, v4, v0 offset:4
    v_mfma_f32_16x16x32_bf16 v[176:179], a[168:171], v[40:43], v[176:179]
    s_cselect_b32 s56, 16, 0
    ds_bpermute_b32 v234, v4, v0 offset:8
    v_add_f32 v1, v1, v185
    v_mfma_f32_16x16x32_bf16 v[176:179], a[172:175], v[44:47], v[176:179]
    s_or_b32 s27, s27, s56
    ds_bpermute_b32 v235, v4, v0 offset:12
    v_sub_f32 v228, s61, v228
    v_mfma_f32_16x16x32_bf16 v[180:183], a[188:191], v[44:47], v[220:223]
    v_exp_f32 v187, v187
    v_mfma_f32_16x16x32_bf16 v[180:183], a[184:187], v[40:43], v[180:183]
    v_cvt_pk_bf16_f32 v200, v184, v185
    v_add_f32 v1, v1, v186
    v_sub_f32 v229, s61, v229
    v_mfma_f32_16x16x32_bf16 v[180:183], a[180:183], v[36:39], v[180:183]
    v_exp_f32 v188, v188
    v_mfma_f32_16x16x32_bf16 v[180:183], a[176:179], v[32:35], v[180:183]
    v_add_f32 v1, v1, v187
    v_cvt_pk_bf16_f32 v201, v186, v187
    v_sub_f32 v230, s61, v230
    v_mfma_f32_16x16x32_bf16 v[112:115], v[204:207], a[224:227], v[112:115]
    v_exp_f32 v189, v189
    v_mfma_f32_16x16x32_bf16 v[112:115], v[192:195], a[192:195], v[112:115]
    v_exp_f32 v190, v190
    v_add_f32 v1, v1, v188
    v_mfma_f32_16x16x32_bf16 v[116:119], v[192:195], a[196:199], v[116:119]
    v_add_f32 v1, v1, v189
    v_exp_f32 v191, v191
    v_mfma_f32_16x16x32_bf16 v[116:119], v[204:207], a[228:231], v[116:119]
    v_cvt_pk_bf16_f32 v202, v188, v189
    v_add_f32 v1, v1, v190
    v_mfma_f32_16x16x32_bf16 v[120:123], v[204:207], a[232:235], v[120:123]
    ds_read_b64_tr_b16 a[224:225], v244 offset:24576
    ds_read_b64_tr_b16 a[226:227], v244 offset:28672
    v_add_f32 v1, v1, v191
    v_mfma_f32_16x16x32_bf16 v[120:123], v[192:195], a[200:203], v[120:123]
    v_cvt_pk_bf16_f32 v203, v190, v191
    v_sub_f32 v231, s61, v231
    v_mfma_f32_16x16x32_bf16 v[124:127], v[192:195], a[204:207], v[124:127]
    ds_read_b64_tr_b16 a[228:229], v245 offset:24576
    ds_read_b64_tr_b16 a[230:231], v245 offset:28672
    v_sub_f32 v224, s61, v224
    v_sub_f32 v225, s61, v225
    v_sub_f32 v226, s61, v226
    v_sub_f32 v227, s61, v227
    v_mfma_f32_16x16x32_bf16 v[124:127], v[204:207], a[236:239], v[124:127]
    v_mfma_f32_16x16x32_bf16 v[184:187], a[160:163], v[16:19], v[216:219]
    ds_read_b64_tr_b16 a[232:233], v246 offset:24576
    ds_read_b64_tr_b16 a[234:235], v246 offset:28672
    v_mov_b32 v236, v1
    v_mfma_f32_16x16x32_bf16 v[184:187], a[164:167], v[20:23], v[184:187]
    v_exp_f32 v176, v176
    v_mfma_f32_16x16x32_bf16 v[184:187], a[168:171], v[24:27], v[184:187]
    ds_read_b64_tr_b16 a[236:237], v247 offset:24576
    ds_read_b64_tr_b16 a[238:239], v247 offset:28672
    v_permlane16_swap_b32 v1, v236
    v_mfma_f32_16x16x32_bf16 v[184:187], a[172:175], v[28:31], v[184:187]
    v_add_f32 v1, v1, v236
    v_mov_b32 v236, v1
    v_mfma_f32_16x16x32_bf16 v[188:191], a[188:191], v[28:31], v[216:219]
    v_exp_f32 v177, v177
    v_mfma_f32_16x16x32_bf16 v[188:191], a[184:187], v[24:27], v[188:191]
    v_permlane32_swap_b32 v1, v236
    v_mfma_f32_16x16x32_bf16 v[188:191], a[180:183], v[20:23], v[188:191]
    v_add_f32 v1, v1, v236
    v_subrev_u32 v236, s57, v1
    v_mfma_f32_16x16x32_bf16 v[188:191], a[176:179], v[16:19], v[188:191]
    v_cmp_le_u32 vcc, s36, v236
    v_rcp_f32 v1, v1
    v_mfma_f32_16x16x32_bf16 v[128:131], v[204:207], a[240:243], v[128:131]
    ds_bpermute_b32 v236, v4, v1 offset:0
    v_mfma_f32_16x16x32_bf16 v[128:131], v[192:195], a[208:211], v[128:131]
    s_cmp_lg_u64 vcc, 0
    ds_bpermute_b32 v237, v4, v1 offset:4
    v_mfma_f32_16x16x32_bf16 v[132:135], v[192:195], a[212:215], v[132:135]
    s_cselect_b32 s56, 32, 0
    ds_bpermute_b32 v238, v4, v1 offset:8
    v_mfma_f32_16x16x32_bf16 v[132:135], v[204:207], a[244:247], v[132:135]
    s_or_b32 s27, s27, s56
    ds_bpermute_b32 v239, v4, v1 offset:12
    v_mfma_f32_16x16x32_bf16 v[136:139], v[204:207], a[248:251], v[136:139]
    v_exp_f32 v178, v178
    v_mov_b32 v253, v176
    v_mfma_f32_16x16x32_bf16 v[136:139], v[192:195], a[216:219], v[136:139]
    v_add_f32 v253, v253, v177
    v_mfma_f32_16x16x32_bf16 v[140:143], v[192:195], a[220:223], v[140:143]
    v_exp_f32 v179, v179
    v_cvt_pk_bf16_f32 v196, v176, v177
    v_mfma_f32_16x16x32_bf16 v[140:143], v[204:207], a[252:255], v[140:143]
    v_add_f32 v253, v253, v178
    v_exp_f32 v180, v180
    v_mfma_f32_16x16x32_bf16 v[144:147], v[200:203], a[192:195], v[144:147]
    v_add_f32 v253, v253, v179
    v_cvt_pk_bf16_f32 v197, v178, v179
    v_mfma_f32_16x16x32_bf16 v[148:151], v[200:203], a[196:199], v[148:151]
    ds_read_b128 v[96:99], v8 offset:20480
    ds_read_b128 v[100:103], v9 offset:20480
    v_mfma_f32_16x16x32_bf16 v[152:155], v[200:203], a[200:203], v[152:155]
    v_exp_f32 v181, v181
    v_mfma_f32_16x16x32_bf16 v[156:159], v[200:203], a[204:207], v[156:159]
    ds_read_b128 v[104:107], v10 offset:20480
    ds_read_b128 v[108:111], v11 offset:20480
    v_mfma_f32_16x16x32_bf16 v[160:163], v[200:203], a[208:211], v[160:163]
    v_exp_f32 v182, v182
    v_add_f32 v253, v253, v180
    v_mfma_f32_16x16x32_bf16 v[164:167], v[200:203], a[212:215], v[164:167]
    v_add_f32 v253, v253, v181
    v_mfma_f32_16x16x32_bf16 v[168:171], v[200:203], a[216:219], v[168:171]
    v_exp_f32 v183, v183
    v_cvt_pk_bf16_f32 v198, v180, v181
    v_mfma_f32_16x16x32_bf16 v[172:175], v[200:203], a[220:223], v[172:175]
    v_add_f32 v253, v253, v182
    v_add_f32 v253, v253, v183
    v_cvt_pk_bf16_f32 v199, v182, v183
    s_waitcnt lgkmcnt(15)
    s_waitcnt lgkmcnt(15)
.p2align 3
    v_pk_mul_f32 v[112:113], v[112:113], v[232:233]
    v_pk_mul_f32 v[116:117], v[116:117], v[232:233]
    v_pk_mul_f32 v[120:121], v[120:121], v[232:233]
    v_pk_mul_f32 v[124:125], v[124:125], v[232:233]
    v_pk_mul_f32 v[128:129], v[128:129], v[232:233]
    v_pk_mul_f32 v[132:133], v[132:133], v[232:233]
    v_pk_mul_f32 v[136:137], v[136:137], v[232:233]
    v_pk_mul_f32 v[140:141], v[140:141], v[232:233]
    v_pk_mul_f32 v[114:115], v[114:115], v[234:235]
    v_pk_mul_f32 v[118:119], v[118:119], v[234:235]
    v_pk_mul_f32 v[122:123], v[122:123], v[234:235]
    v_pk_mul_f32 v[126:127], v[126:127], v[234:235]
    v_pk_mul_f32 v[130:131], v[130:131], v[234:235]
    v_pk_mul_f32 v[134:135], v[134:135], v[234:235]
    v_pk_mul_f32 v[138:139], v[138:139], v[234:235]
    v_pk_mul_f32 v[142:143], v[142:143], v[234:235]
    v_mfma_f32_4x4x4_16b_bf16 v[176:179], v[12:13], v[80:81], 0
    v_cvt_pk_bf16_f32 v192, v112, v116
    v_mfma_f32_4x4x4_16b_bf16 v[180:183], v[12:13], v[82:83], 0
    v_cvt_pk_bf16_f32 v193, v120, v124
    v_cvt_pk_bf16_f32 v194, v128, v132
    v_mfma_f32_4x4x4_16b_bf16 v[176:179], v[14:15], v[80:81], v[176:179]
    v_cvt_pk_bf16_f32 v195, v136, v140
    v_mfma_f32_4x4x4_16b_bf16 v[180:183], v[14:15], v[82:83], v[180:183]
    ds_write_b128 v2, v[192:195] offset:16384
    v_mfma_f32_4x4x4_16b_bf16 v[204:207], v[12:13], v[84:85], 0
    v_cvt_pk_bf16_f32 v192, v113, v117
    v_mfma_f32_4x4x4_16b_bf16 v[200:203], v[12:13], v[86:87], 0
    v_cvt_pk_bf16_f32 v193, v121, v125
    v_cvt_pk_bf16_f32 v194, v129, v133
    v_mfma_f32_4x4x4_16b_bf16 v[204:207], v[14:15], v[84:85], v[204:207]
    v_cvt_pk_bf16_f32 v195, v137, v141
    v_mfma_f32_4x4x4_16b_bf16 v[200:203], v[14:15], v[86:87], v[200:203]
    ds_write_b128 v3, v[192:195] offset:16640
    v_cvt_pk_bf16_f32 v80, v176, v177
    v_cvt_pk_bf16_f32 v81, v178, v179
    v_cvt_pk_bf16_f32 v82, v180, v181
    v_cvt_pk_bf16_f32 v83, v182, v183
    v_mfma_f32_4x4x4_16b_bf16 v[176:179], v[12:13], v[88:89], 0
    v_cvt_pk_bf16_f32 v192, v114, v118
    v_mfma_f32_4x4x4_16b_bf16 v[180:183], v[12:13], v[90:91], 0
    v_cvt_pk_bf16_f32 v193, v122, v126
    v_cvt_pk_bf16_f32 v194, v130, v134
    v_mfma_f32_4x4x4_16b_bf16 v[176:179], v[14:15], v[88:89], v[176:179]
    v_cvt_pk_bf16_f32 v195, v138, v142
    v_mfma_f32_4x4x4_16b_bf16 v[180:183], v[14:15], v[90:91], v[180:183]
    ds_write_b128 v2, v[192:195] offset:16896
    v_cvt_pk_bf16_f32 v84, v204, v205
    v_cvt_pk_bf16_f32 v85, v206, v207
    v_cvt_pk_bf16_f32 v86, v200, v201
    v_cvt_pk_bf16_f32 v87, v202, v203
    v_mfma_f32_4x4x4_16b_bf16 v[204:207], v[12:13], v[92:93], 0
    v_cvt_pk_bf16_f32 v192, v115, v119
    v_mfma_f32_4x4x4_16b_bf16 v[200:203], v[12:13], v[94:95], 0
    v_cvt_pk_bf16_f32 v193, v123, v127
    v_cvt_pk_bf16_f32 v194, v131, v135
    v_mfma_f32_4x4x4_16b_bf16 v[204:207], v[14:15], v[92:93], v[204:207]
    v_cvt_pk_bf16_f32 v195, v139, v143
    v_mfma_f32_4x4x4_16b_bf16 v[200:203], v[14:15], v[94:95], v[200:203]
    ds_write_b128 v3, v[192:195] offset:17152
    v_cvt_pk_bf16_f32 v88, v176, v177
    v_cvt_pk_bf16_f32 v89, v178, v179
    v_cvt_pk_bf16_f32 v90, v180, v181
    v_cvt_pk_bf16_f32 v91, v182, v183
    v_cvt_pk_bf16_f32 v92, v204, v205
    v_cvt_pk_bf16_f32 v93, v206, v207
    v_cvt_pk_bf16_f32 v94, v200, v201
    v_cvt_pk_bf16_f32 v95, v202, v203
    s_waitcnt lgkmcnt(4)
    s_waitcnt lgkmcnt(8)
.p2align 3
    v_pk_mul_f32 v[144:145], v[144:145], v[236:237]
    v_pk_mul_f32 v[148:149], v[148:149], v[236:237]
    v_pk_mul_f32 v[152:153], v[152:153], v[236:237]
    v_pk_mul_f32 v[156:157], v[156:157], v[236:237]
    v_pk_mul_f32 v[160:161], v[160:161], v[236:237]
    v_pk_mul_f32 v[164:165], v[164:165], v[236:237]
    v_pk_mul_f32 v[168:169], v[168:169], v[236:237]
    v_pk_mul_f32 v[172:173], v[172:173], v[236:237]
    v_pk_mul_f32 v[146:147], v[146:147], v[238:239]
    v_pk_mul_f32 v[150:151], v[150:151], v[238:239]
    v_pk_mul_f32 v[154:155], v[154:155], v[238:239]
    v_pk_mul_f32 v[158:159], v[158:159], v[238:239]
    v_pk_mul_f32 v[162:163], v[162:163], v[238:239]
    v_pk_mul_f32 v[166:167], v[166:167], v[238:239]
    v_pk_mul_f32 v[170:171], v[170:171], v[238:239]
    v_pk_mul_f32 v[174:175], v[174:175], v[238:239]
    v_mfma_f32_4x4x4_16b_bf16 v[176:179], v[12:13], v[96:97], 0
    v_cvt_pk_bf16_f32 v192, v144, v148
    v_mfma_f32_4x4x4_16b_bf16 v[180:183], v[12:13], v[98:99], 0
    v_cvt_pk_bf16_f32 v193, v152, v156
    v_cvt_pk_bf16_f32 v194, v160, v164
    v_mfma_f32_4x4x4_16b_bf16 v[176:179], v[14:15], v[96:97], v[176:179]
    v_cvt_pk_bf16_f32 v195, v168, v172
    v_mfma_f32_4x4x4_16b_bf16 v[180:183], v[14:15], v[98:99], v[180:183]
    ds_write_b128 v2, v[192:195] offset:20480
    v_mfma_f32_4x4x4_16b_bf16 v[204:207], v[12:13], v[100:101], 0
    v_cvt_pk_bf16_f32 v192, v145, v149
    v_mfma_f32_4x4x4_16b_bf16 v[200:203], v[12:13], v[102:103], 0
    v_cvt_pk_bf16_f32 v193, v153, v157
    v_cvt_pk_bf16_f32 v194, v161, v165
    v_mfma_f32_4x4x4_16b_bf16 v[204:207], v[14:15], v[100:101], v[204:207]
    v_cvt_pk_bf16_f32 v195, v169, v173
    v_mfma_f32_4x4x4_16b_bf16 v[200:203], v[14:15], v[102:103], v[200:203]
    ds_write_b128 v3, v[192:195] offset:20736
    v_cvt_pk_bf16_f32 v96, v176, v177
    v_cvt_pk_bf16_f32 v97, v178, v179
    v_cvt_pk_bf16_f32 v98, v180, v181
    v_cvt_pk_bf16_f32 v99, v182, v183
    v_mfma_f32_4x4x4_16b_bf16 v[176:179], v[12:13], v[104:105], 0
    v_cvt_pk_bf16_f32 v192, v146, v150
    v_mfma_f32_4x4x4_16b_bf16 v[180:183], v[12:13], v[106:107], 0
    v_cvt_pk_bf16_f32 v193, v154, v158
    v_cvt_pk_bf16_f32 v194, v162, v166
    v_mfma_f32_4x4x4_16b_bf16 v[176:179], v[14:15], v[104:105], v[176:179]
    v_cvt_pk_bf16_f32 v195, v170, v174
    v_mfma_f32_4x4x4_16b_bf16 v[180:183], v[14:15], v[106:107], v[180:183]
    ds_write_b128 v2, v[192:195] offset:20992
    v_cvt_pk_bf16_f32 v100, v204, v205
    v_cvt_pk_bf16_f32 v101, v206, v207
    v_cvt_pk_bf16_f32 v102, v200, v201
    v_cvt_pk_bf16_f32 v103, v202, v203
    v_mfma_f32_4x4x4_16b_bf16 v[204:207], v[12:13], v[108:109], 0
    v_cvt_pk_bf16_f32 v192, v147, v151
    v_mfma_f32_4x4x4_16b_bf16 v[200:203], v[12:13], v[110:111], 0
    v_cvt_pk_bf16_f32 v193, v155, v159
    v_cvt_pk_bf16_f32 v194, v163, v167
    v_mfma_f32_4x4x4_16b_bf16 v[204:207], v[14:15], v[108:109], v[204:207]
    v_cvt_pk_bf16_f32 v195, v171, v175
    v_mfma_f32_4x4x4_16b_bf16 v[200:203], v[14:15], v[110:111], v[200:203]
    ds_write_b128 v3, v[192:195] offset:21248
    v_cvt_pk_bf16_f32 v104, v176, v177
    v_cvt_pk_bf16_f32 v105, v178, v179
    v_cvt_pk_bf16_f32 v106, v180, v181
    v_cvt_pk_bf16_f32 v107, v182, v183
    v_cvt_pk_bf16_f32 v108, v204, v205
    v_cvt_pk_bf16_f32 v109, v206, v207
    v_cvt_pk_bf16_f32 v110, v200, v201
    v_cvt_pk_bf16_f32 v111, v202, v203
    v_mfma_f32_16x16x32_bf16 v[236:239], a[16:19], v[96:99], 0
    v_exp_f32 v184, v184
    v_mfma_f32_16x16x32_bf16 v[236:239], a[20:23], v[100:103], v[236:239]
    v_exp_f32 v185, v185
    v_mfma_f32_16x16x32_bf16 v[236:239], a[24:27], v[104:107], v[236:239]
    v_exp_f32 v186, v186
    v_mfma_f32_16x16x32_bf16 v[236:239], a[28:31], v[108:111], v[236:239]
    v_mov_b32 v252, v184
    v_add_f32 v252, v252, v185
    v_mfma_f32_16x16x32_bf16 v[232:235], a[16:19], v[80:83], 0
    v_exp_f32 v187, v187
    v_mfma_f32_16x16x32_bf16 v[232:235], a[20:23], v[84:87], v[232:235]
    v_cvt_pk_bf16_f32 v204, v184, v185
    v_add_f32 v252, v252, v186
    v_mfma_f32_16x16x32_bf16 v[232:235], a[24:27], v[88:91], v[232:235]
    v_exp_f32 v188, v188
    v_mfma_f32_16x16x32_bf16 v[232:235], a[28:31], v[92:95], v[232:235]
    v_add_f32 v252, v252, v187
    v_cvt_pk_bf16_f32 v205, v186, v187
    v_mfma_f32_16x16x32_bf16 v[176:179], a[160:163], v[64:67], v[228:231]
    ds_read_b64_tr_b16 a[240:241], v248 offset:24576
    ds_read_b64_tr_b16 a[242:243], v248 offset:28672
    v_mfma_f32_16x16x32_bf16 v[176:179], a[164:167], v[68:71], v[176:179]
    v_exp_f32 v189, v189
    v_mfma_f32_16x16x32_bf16 v[176:179], a[168:171], v[72:75], v[176:179]
    ds_read_b64_tr_b16 a[244:245], v249 offset:24576
    ds_read_b64_tr_b16 a[246:247], v249 offset:28672
    v_mfma_f32_16x16x32_bf16 v[176:179], a[172:175], v[76:79], v[176:179]
    v_exp_f32 v190, v190
    v_mfma_f32_16x16x32_bf16 v[180:183], a[188:191], v[76:79], v[228:231]
    v_add_f32 v252, v252, v188
    v_add_f32 v252, v252, v189
    v_mfma_f32_16x16x32_bf16 v[180:183], a[184:187], v[72:75], v[180:183]
    v_exp_f32 v191, v191
    v_mfma_f32_16x16x32_bf16 v[180:183], a[180:183], v[68:71], v[180:183]
    v_cvt_pk_bf16_f32 v206, v188, v189
    v_add_f32 v252, v252, v190
    v_mfma_f32_16x16x32_bf16 v[180:183], a[176:179], v[64:67], v[180:183]
    s_waitcnt lgkmcnt(4)
    v_add_f32 v252, v252, v191
    v_cvt_pk_bf16_f32 v207, v190, v191
    v_mfma_f32_16x16x32_bf16 a[32:35], v[196:199], a[224:227], 0
    v_sub_f32 v236, s61, v236
    v_sub_f32 v237, s61, v237
    v_mfma_f32_16x16x32_bf16 a[36:39], v[196:199], a[228:231], 0
    v_sub_f32 v238, s61, v238
    v_sub_f32 v239, s61, v239
    v_mfma_f32_16x16x32_bf16 a[40:43], v[196:199], a[232:235], 0
    v_sub_f32 v232, s61, v232
    v_sub_f32 v233, s61, v233
    v_sub_f32 v234, s61, v234
    v_sub_f32 v235, s61, v235
    v_mfma_f32_16x16x32_bf16 a[44:47], v[196:199], a[236:239], 0
    v_mfma_f32_16x16x32_bf16 v[184:187], a[160:163], v[48:51], v[224:227]
    ds_read_b64_tr_b16 a[248:249], v250 offset:24576
    ds_read_b64_tr_b16 a[250:251], v250 offset:28672
    v_mfma_f32_16x16x32_bf16 v[184:187], a[164:167], v[52:55], v[184:187]
    ds_read_b64_tr_b16 a[252:253], v251 offset:24576
    ds_read_b64_tr_b16 a[254:255], v251 offset:28672
    v_exp_f32 v176, v176
    v_mfma_f32_16x16x32_bf16 v[184:187], a[168:171], v[56:59], v[184:187]
    v_exp_f32 v177, v177
    v_mfma_f32_16x16x32_bf16 v[184:187], a[172:175], v[60:63], v[184:187]
    v_exp_f32 v178, v178
    v_mov_b32 v255, v176
    v_add_f32 v255, v255, v177
    v_mfma_f32_16x16x32_bf16 v[188:191], a[188:191], v[60:63], v[224:227]
    v_exp_f32 v179, v179
    v_mfma_f32_16x16x32_bf16 v[188:191], a[184:187], v[56:59], v[188:191]
    v_cvt_pk_bf16_f32 v192, v176, v177
    v_add_f32 v255, v255, v178
    v_mfma_f32_16x16x32_bf16 v[188:191], a[180:183], v[52:55], v[188:191]
    v_exp_f32 v180, v180
    v_add_f32 v255, v255, v179
    v_cvt_pk_bf16_f32 v193, v178, v179
    v_mfma_f32_16x16x32_bf16 v[188:191], a[176:179], v[48:51], v[188:191]
    s_waitcnt lgkmcnt(4)
    v_exp_f32 v181, v181
    v_mfma_f32_16x16x32_bf16 a[48:51], v[196:199], a[240:243], 0
    v_exp_f32 v182, v182
    v_mfma_f32_16x16x32_bf16 a[52:55], v[196:199], a[244:247], 0
    s_waitcnt lgkmcnt(0)
    v_add_f32 v255, v255, v180
    v_add_f32 v255, v255, v181
    v_exp_f32 v183, v183
    v_mfma_f32_16x16x32_bf16 a[56:59], v[196:199], a[248:251], 0
    v_cvt_pk_bf16_f32 v194, v180, v181
    v_add_f32 v255, v255, v182
    v_mfma_f32_16x16x32_bf16 a[60:63], v[196:199], a[252:255], 0
    v_add_f32 v255, v255, v183
    v_cvt_pk_bf16_f32 v195, v182, v183
    v_mfma_f32_16x16x32_bf16 v[176:179], a[160:163], v[96:99], v[236:239]
    s_barrier
    ds_read_b128 a[128:131], v240 offset:0
    ds_read_b128 a[132:135], v241 offset:0
    v_mfma_f32_16x16x32_bf16 v[176:179], a[164:167], v[100:103], v[176:179]
    v_exp_f32 v184, v184
    v_mfma_f32_16x16x32_bf16 v[176:179], a[168:171], v[104:107], v[176:179]
    ds_read_b128 a[136:139], v242 offset:0
    ds_read_b128 a[140:143], v243 offset:0
    v_exp_f32 v185, v185
    v_mfma_f32_16x16x32_bf16 v[176:179], a[172:175], v[108:111], v[176:179]
    v_exp_f32 v186, v186
    v_mov_b32 v254, v184
    v_add_f32 v254, v254, v185
    v_mfma_f32_16x16x32_bf16 v[180:183], a[188:191], v[108:111], v[236:239]
    v_exp_f32 v187, v187
    v_mfma_f32_16x16x32_bf16 v[180:183], a[184:187], v[104:107], v[180:183]
    v_cvt_pk_bf16_f32 v208, v184, v185
    v_add_f32 v254, v254, v186
    v_mfma_f32_16x16x32_bf16 v[180:183], a[180:183], v[100:103], v[180:183]
    v_exp_f32 v188, v188
    v_add_f32 v254, v254, v187
    v_cvt_pk_bf16_f32 v209, v186, v187
    v_mfma_f32_16x16x32_bf16 v[180:183], a[176:179], v[96:99], v[180:183]
    v_exp_f32 v189, v189
    v_mfma_f32_16x16x32_bf16 a[96:99], v[192:195], a[224:227], 0
    v_exp_f32 v190, v190
    v_mfma_f32_16x16x32_bf16 a[100:103], v[192:195], a[228:231], 0
    v_add_f32 v254, v254, v188
    v_add_f32 v254, v254, v189
    v_exp_f32 v191, v191
    v_mfma_f32_16x16x32_bf16 a[104:107], v[192:195], a[232:235], 0
    v_cvt_pk_bf16_f32 v210, v188, v189
    v_add_f32 v254, v254, v190
    v_mfma_f32_16x16x32_bf16 a[108:111], v[192:195], a[236:239], 0
    v_add_f32 v254, v254, v191
    v_cvt_pk_bf16_f32 v211, v190, v191
    v_mfma_f32_16x16x32_bf16 v[184:187], a[160:163], v[80:83], v[232:235]
    ds_read_b128 a[144:147], v240 offset:4096
    ds_read_b128 a[148:151], v241 offset:4096
    v_mfma_f32_16x16x32_bf16 v[184:187], a[164:167], v[84:87], v[184:187]
    v_exp_f32 v176, v176
    v_mfma_f32_16x16x32_bf16 v[184:187], a[168:171], v[88:91], v[184:187]
    ds_read_b128 a[152:155], v242 offset:4096
    ds_read_b128 a[156:159], v243 offset:4096
    v_exp_f32 v177, v177
    v_mfma_f32_16x16x32_bf16 v[184:187], a[172:175], v[92:95], v[184:187]
    v_exp_f32 v178, v178
    v_mov_b32 v1, v176
    v_add_f32 v1, v1, v177
    v_mfma_f32_16x16x32_bf16 v[188:191], a[188:191], v[92:95], v[232:235]
    v_exp_f32 v179, v179
    v_mfma_f32_16x16x32_bf16 v[188:191], a[184:187], v[88:91], v[188:191]
    v_cvt_pk_bf16_f32 v196, v176, v177
    v_add_f32 v1, v1, v178
    v_mfma_f32_16x16x32_bf16 v[188:191], a[180:183], v[84:87], v[188:191]
    v_exp_f32 v180, v180
    v_add_f32 v1, v1, v179
    v_cvt_pk_bf16_f32 v197, v178, v179
    v_mfma_f32_16x16x32_bf16 v[188:191], a[176:179], v[80:83], v[188:191]
    v_exp_f32 v181, v181
    v_mfma_f32_16x16x32_bf16 a[112:115], v[192:195], a[240:243], 0
    v_exp_f32 v182, v182
    v_mfma_f32_16x16x32_bf16 a[116:119], v[192:195], a[244:247], 0
    v_add_f32 v1, v1, v180
    v_add_f32 v1, v1, v181
    v_exp_f32 v183, v183
    v_mfma_f32_16x16x32_bf16 a[120:123], v[192:195], a[248:251], 0
    v_cvt_pk_bf16_f32 v198, v180, v181
    v_add_f32 v1, v1, v182
    v_mfma_f32_16x16x32_bf16 a[124:127], v[192:195], a[252:255], 0
    s_waitcnt lgkmcnt(0)
    v_add_f32 v1, v1, v183
    v_cvt_pk_bf16_f32 v199, v182, v183
    v_mfma_f32_16x16x32_bf16 v[176:179], a[128:131], v[16:19], v[216:219]
    ds_read_b64_tr_b16 a[192:193], v244 offset:0
    ds_read_b64_tr_b16 a[194:195], v244 offset:4096
    v_mfma_f32_16x16x32_bf16 v[176:179], a[132:135], v[20:23], v[176:179]
    v_exp_f32 v184, v184
    v_mfma_f32_16x16x32_bf16 v[176:179], a[136:139], v[24:27], v[176:179]
    ds_read_b64_tr_b16 a[196:197], v245 offset:0
    ds_read_b64_tr_b16 a[198:199], v245 offset:4096
    v_exp_f32 v185, v185
    v_mfma_f32_16x16x32_bf16 v[176:179], a[140:143], v[28:31], v[176:179]
    v_exp_f32 v186, v186
    v_mov_b32 v0, v184
    v_add_f32 v0, v0, v185
    v_mfma_f32_16x16x32_bf16 v[180:183], a[156:159], v[28:31], v[216:219]
    v_exp_f32 v187, v187
    v_mfma_f32_16x16x32_bf16 v[180:183], a[152:155], v[24:27], v[180:183]
    v_cvt_pk_bf16_f32 v212, v184, v185
    v_add_f32 v0, v0, v186
    v_mfma_f32_16x16x32_bf16 v[180:183], a[148:151], v[20:23], v[180:183]
    v_exp_f32 v188, v188
    v_add_f32 v0, v0, v187
    v_cvt_pk_bf16_f32 v213, v186, v187
    v_mfma_f32_16x16x32_bf16 v[180:183], a[144:147], v[16:19], v[180:183]
    v_exp_f32 v189, v189
    v_mfma_f32_16x16x32_bf16 v[144:147], v[196:199], a[224:227], 0
    v_exp_f32 v190, v190
    v_mfma_f32_16x16x32_bf16 v[148:151], v[196:199], a[228:231], 0
    v_add_f32 v0, v0, v188
    v_add_f32 v0, v0, v189
    v_exp_f32 v191, v191
    v_mfma_f32_16x16x32_bf16 v[152:155], v[196:199], a[232:235], 0
    v_cvt_pk_bf16_f32 v214, v188, v189
    v_add_f32 v0, v0, v190
    v_mfma_f32_16x16x32_bf16 v[156:159], v[196:199], a[236:239], 0
    v_add_f32 v0, v0, v191
    v_cvt_pk_bf16_f32 v215, v190, v191
    v_mfma_f32_16x16x32_bf16 v[184:187], a[128:131], v[32:35], v[220:223]
    ds_read_b64_tr_b16 a[200:201], v246 offset:0
    ds_read_b64_tr_b16 a[202:203], v246 offset:4096
    v_mfma_f32_16x16x32_bf16 v[184:187], a[132:135], v[36:39], v[184:187]
    v_exp_f32 v176, v176
    v_mfma_f32_16x16x32_bf16 v[184:187], a[136:139], v[40:43], v[184:187]
    ds_read_b64_tr_b16 a[204:205], v247 offset:0
    ds_read_b64_tr_b16 a[206:207], v247 offset:4096
    v_exp_f32 v177, v177
    v_mfma_f32_16x16x32_bf16 v[184:187], a[140:143], v[44:47], v[184:187]
    v_exp_f32 v178, v178
    v_add_f32 v252, v252, v176
    v_add_f32 v252, v252, v177
    v_mfma_f32_16x16x32_bf16 v[188:191], a[156:159], v[44:47], v[220:223]
    v_exp_f32 v179, v179
    v_mfma_f32_16x16x32_bf16 v[188:191], a[152:155], v[40:43], v[188:191]
    v_cvt_pk_bf16_f32 v192, v176, v177
    v_add_f32 v252, v252, v178
    v_mfma_f32_16x16x32_bf16 v[188:191], a[148:151], v[36:39], v[188:191]
    v_exp_f32 v180, v180
    v_add_f32 v252, v252, v179
    v_cvt_pk_bf16_f32 v193, v178, v179
    v_mfma_f32_16x16x32_bf16 v[188:191], a[144:147], v[32:35], v[188:191]
    v_exp_f32 v181, v181
    v_mfma_f32_16x16x32_bf16 v[160:163], v[196:199], a[240:243], 0
    v_exp_f32 v182, v182
    v_mfma_f32_16x16x32_bf16 v[164:167], v[196:199], a[244:247], 0
    v_add_f32 v252, v252, v180
    v_add_f32 v252, v252, v181
    v_exp_f32 v183, v183
    v_mfma_f32_16x16x32_bf16 v[168:171], v[196:199], a[248:251], 0
    v_cvt_pk_bf16_f32 v194, v180, v181
    v_add_f32 v252, v252, v182
    v_mfma_f32_16x16x32_bf16 v[172:175], v[196:199], a[252:255], 0
    v_add_f32 v252, v252, v183
    v_cvt_pk_bf16_f32 v195, v182, v183
    v_mfma_f32_16x16x32_bf16 v[176:179], a[128:131], v[48:51], v[224:227]
    ds_read_b64_tr_b16 a[208:209], v248 offset:0
    ds_read_b64_tr_b16 a[210:211], v248 offset:4096
    v_mfma_f32_16x16x32_bf16 v[176:179], a[132:135], v[52:55], v[176:179]
    v_exp_f32 v184, v184
    v_mfma_f32_16x16x32_bf16 v[176:179], a[136:139], v[56:59], v[176:179]
    ds_read_b64_tr_b16 a[212:213], v249 offset:0
    ds_read_b64_tr_b16 a[214:215], v249 offset:4096
    v_mfma_f32_16x16x32_bf16 v[176:179], a[140:143], v[60:63], v[176:179]
    v_exp_f32 v185, v185
    v_mfma_f32_16x16x32_bf16 v[180:183], a[156:159], v[60:63], v[224:227]
    v_exp_f32 v186, v186
    v_mfma_f32_16x16x32_bf16 v[180:183], a[152:155], v[56:59], v[180:183]
    v_add_f32 v253, v253, v184
    v_add_f32 v253, v253, v185
    v_mfma_f32_16x16x32_bf16 v[180:183], a[148:151], v[52:55], v[180:183]
    v_exp_f32 v187, v187
    v_mfma_f32_16x16x32_bf16 v[180:183], a[144:147], v[48:51], v[180:183]
    s_waitcnt lgkmcnt(4)
    v_cvt_pk_bf16_f32 v200, v184, v185
    v_add_f32 v253, v253, v186
    v_mfma_f32_16x16x32_bf16 a[0:3], v[204:207], a[224:227], 0
    v_exp_f32 v188, v188
    v_mfma_f32_16x16x32_bf16 a[0:3], v[192:195], a[192:195], a[0:3]
    v_add_f32 v253, v253, v187
    v_cvt_pk_bf16_f32 v201, v186, v187
    v_mfma_f32_16x16x32_bf16 a[4:7], v[192:195], a[196:199], 0
    v_exp_f32 v189, v189
    v_mfma_f32_16x16x32_bf16 a[4:7], v[204:207], a[228:231], a[4:7]
    v_exp_f32 v190, v190
    v_mfma_f32_16x16x32_bf16 a[8:11], v[204:207], a[232:235], 0
    v_add_f32 v253, v253, v188
    v_add_f32 v253, v253, v189
    v_mfma_f32_16x16x32_bf16 a[8:11], v[192:195], a[200:203], a[8:11]
    v_exp_f32 v191, v191
    v_mfma_f32_16x16x32_bf16 a[12:15], v[192:195], a[204:207], 0
    v_cvt_pk_bf16_f32 v202, v188, v189
    v_add_f32 v253, v253, v190
    v_mfma_f32_16x16x32_bf16 a[12:15], v[204:207], a[236:239], a[12:15]
    v_add_f32 v253, v253, v191
    v_cvt_pk_bf16_f32 v203, v190, v191
    v_mfma_f32_16x16x32_bf16 v[184:187], a[128:131], v[64:67], v[228:231]
    ds_read_b64_tr_b16 a[216:217], v250 offset:0
    ds_read_b64_tr_b16 a[218:219], v250 offset:4096
    v_mfma_f32_16x16x32_bf16 v[184:187], a[132:135], v[68:71], v[184:187]
    v_exp_f32 v176, v176
    v_mfma_f32_16x16x32_bf16 v[184:187], a[136:139], v[72:75], v[184:187]
    ds_read_b64_tr_b16 a[220:221], v251 offset:0
    ds_read_b64_tr_b16 a[222:223], v251 offset:4096
    v_mfma_f32_16x16x32_bf16 v[184:187], a[140:143], v[76:79], v[184:187]
    v_exp_f32 v177, v177
    v_mfma_f32_16x16x32_bf16 v[188:191], a[156:159], v[76:79], v[228:231]
    v_exp_f32 v178, v178
    v_mfma_f32_16x16x32_bf16 v[188:191], a[152:155], v[72:75], v[188:191]
    v_add_f32 v254, v254, v176
    v_add_f32 v254, v254, v177
    v_mfma_f32_16x16x32_bf16 v[188:191], a[148:151], v[68:71], v[188:191]
    v_exp_f32 v179, v179
    v_mfma_f32_16x16x32_bf16 v[188:191], a[144:147], v[64:67], v[188:191]
    s_waitcnt lgkmcnt(4)
    v_cvt_pk_bf16_f32 v196, v176, v177
    v_add_f32 v254, v254, v178
    v_mfma_f32_16x16x32_bf16 a[16:19], v[204:207], a[240:243], 0
    v_exp_f32 v180, v180
    v_mfma_f32_16x16x32_bf16 a[16:19], v[192:195], a[208:211], a[16:19]
    v_add_f32 v254, v254, v179
    v_cvt_pk_bf16_f32 v197, v178, v179
    v_mfma_f32_16x16x32_bf16 a[20:23], v[192:195], a[212:215], 0
    v_exp_f32 v181, v181
    v_mfma_f32_16x16x32_bf16 a[20:23], v[204:207], a[244:247], a[20:23]
    v_exp_f32 v182, v182
    v_mfma_f32_16x16x32_bf16 a[24:27], v[204:207], a[248:251], 0
    s_waitcnt lgkmcnt(2)
    v_add_f32 v254, v254, v180
    v_add_f32 v254, v254, v181
    v_mfma_f32_16x16x32_bf16 a[24:27], v[192:195], a[216:219], a[24:27]
    s_waitcnt lgkmcnt(0)
    v_exp_f32 v183, v183
    v_mfma_f32_16x16x32_bf16 a[28:31], v[192:195], a[220:223], 0
    v_cvt_pk_bf16_f32 v198, v180, v181
    v_add_f32 v254, v254, v182
    v_mfma_f32_16x16x32_bf16 a[28:31], v[204:207], a[252:255], a[28:31]
    v_add_f32 v254, v254, v183
    v_cvt_pk_bf16_f32 v199, v182, v183
    v_mfma_f32_16x16x32_bf16 v[176:179], a[128:131], v[80:83], v[232:235]
    s_barrier
    ds_read_b128 a[160:163], v240 offset:8192
    ds_read_b128 a[164:167], v241 offset:8192
    v_mfma_f32_16x16x32_bf16 v[176:179], a[132:135], v[84:87], v[176:179]
    v_exp_f32 v184, v184
    v_mfma_f32_16x16x32_bf16 v[176:179], a[136:139], v[88:91], v[176:179]
    ds_read_b128 a[168:171], v242 offset:8192
    ds_read_b128 a[172:175], v243 offset:8192
    v_mfma_f32_16x16x32_bf16 v[176:179], a[140:143], v[92:95], v[176:179]
    v_exp_f32 v185, v185
    v_mfma_f32_16x16x32_bf16 v[180:183], a[156:159], v[92:95], v[232:235]
    v_exp_f32 v186, v186
    v_mfma_f32_16x16x32_bf16 v[180:183], a[152:155], v[88:91], v[180:183]
    v_add_f32 v255, v255, v184
    v_add_f32 v255, v255, v185
    v_mfma_f32_16x16x32_bf16 v[180:183], a[148:151], v[84:87], v[180:183]
    v_exp_f32 v187, v187
    v_mfma_f32_16x16x32_bf16 v[180:183], a[144:147], v[80:83], v[180:183]
    v_cvt_pk_bf16_f32 v204, v184, v185
    v_add_f32 v255, v255, v186
    v_mfma_f32_16x16x32_bf16 a[64:67], v[208:211], a[224:227], 0
    v_exp_f32 v188, v188
    v_mfma_f32_16x16x32_bf16 a[64:67], v[196:199], a[192:195], a[64:67]
    v_add_f32 v255, v255, v187
    v_cvt_pk_bf16_f32 v205, v186, v187
    v_mfma_f32_16x16x32_bf16 a[68:71], v[196:199], a[196:199], 0
    v_exp_f32 v189, v189
    v_mfma_f32_16x16x32_bf16 a[68:71], v[208:211], a[228:231], a[68:71]
    v_exp_f32 v190, v190
    v_mfma_f32_16x16x32_bf16 a[72:75], v[208:211], a[232:235], 0
    v_add_f32 v255, v255, v188
    v_add_f32 v255, v255, v189
    v_mfma_f32_16x16x32_bf16 a[72:75], v[196:199], a[200:203], a[72:75]
    v_exp_f32 v191, v191
    v_mfma_f32_16x16x32_bf16 a[76:79], v[196:199], a[204:207], 0
    v_cvt_pk_bf16_f32 v206, v188, v189
    v_add_f32 v255, v255, v190
    v_mfma_f32_16x16x32_bf16 a[76:79], v[208:211], a[236:239], a[76:79]
    v_add_f32 v255, v255, v191
    v_cvt_pk_bf16_f32 v207, v190, v191
    v_mfma_f32_16x16x32_bf16 v[184:187], a[128:131], v[96:99], v[236:239]
    ds_read_b128 a[176:179], v240 offset:12288
    ds_read_b128 a[180:183], v241 offset:12288
    v_mfma_f32_16x16x32_bf16 v[184:187], a[132:135], v[100:103], v[184:187]
    v_exp_f32 v176, v176
    v_mfma_f32_16x16x32_bf16 v[184:187], a[136:139], v[104:107], v[184:187]
    ds_read_b128 a[184:187], v242 offset:12288
    ds_read_b128 a[188:191], v243 offset:12288
    v_mfma_f32_16x16x32_bf16 v[184:187], a[140:143], v[108:111], v[184:187]
    v_exp_f32 v177, v177
    v_mfma_f32_16x16x32_bf16 v[188:191], a[156:159], v[108:111], v[236:239]
    v_exp_f32 v178, v178
    v_mfma_f32_16x16x32_bf16 v[188:191], a[152:155], v[104:107], v[188:191]
    v_add_f32 v0, v0, v176
    v_add_f32 v0, v0, v177
    v_mfma_f32_16x16x32_bf16 v[188:191], a[148:151], v[100:103], v[188:191]
    v_exp_f32 v179, v179
    v_mfma_f32_16x16x32_bf16 v[188:191], a[144:147], v[96:99], v[188:191]
    v_cvt_pk_bf16_f32 v192, v176, v177
    v_add_f32 v0, v0, v178
    v_mfma_f32_16x16x32_bf16 a[80:83], v[208:211], a[240:243], 0
    v_exp_f32 v180, v180
    v_mfma_f32_16x16x32_bf16 a[80:83], v[196:199], a[208:211], a[80:83]
    v_add_f32 v0, v0, v179
    v_cvt_pk_bf16_f32 v193, v178, v179
    v_mfma_f32_16x16x32_bf16 a[84:87], v[196:199], a[212:215], 0
    v_exp_f32 v181, v181
    v_mfma_f32_16x16x32_bf16 a[84:87], v[208:211], a[244:247], a[84:87]
    v_exp_f32 v182, v182
    v_mfma_f32_16x16x32_bf16 a[88:91], v[208:211], a[248:251], 0
    v_add_f32 v0, v0, v180
    v_add_f32 v0, v0, v181
    v_mfma_f32_16x16x32_bf16 a[88:91], v[196:199], a[216:219], a[88:91]
    v_exp_f32 v183, v183
    v_mfma_f32_16x16x32_bf16 a[92:95], v[196:199], a[220:223], 0
    v_cvt_pk_bf16_f32 v194, v180, v181
    v_add_f32 v0, v0, v182
    v_mfma_f32_16x16x32_bf16 a[92:95], v[208:211], a[252:255], a[92:95]
    s_waitcnt lgkmcnt(0)
    v_add_f32 v0, v0, v183
    v_cvt_pk_bf16_f32 v195, v182, v183
    v_mfma_f32_16x16x32_bf16 v[176:179], a[160:163], v[32:35], v[220:223]
    v_exp_f32 v184, v184
    v_mfma_f32_16x16x32_bf16 v[176:179], a[164:167], v[36:39], v[176:179]
    v_exp_f32 v185, v185
    v_mfma_f32_16x16x32_bf16 v[176:179], a[168:171], v[40:43], v[176:179]
    v_exp_f32 v186, v186
    v_mfma_f32_16x16x32_bf16 v[176:179], a[172:175], v[44:47], v[176:179]
    v_add_f32 v1, v1, v184
    v_add_f32 v1, v1, v185
    v_mfma_f32_16x16x32_bf16 v[180:183], a[188:191], v[44:47], v[220:223]
    v_exp_f32 v187, v187
    v_mfma_f32_16x16x32_bf16 v[180:183], a[184:187], v[40:43], v[180:183]
    v_cvt_pk_bf16_f32 v208, v184, v185
    v_add_f32 v1, v1, v186
    v_mfma_f32_16x16x32_bf16 v[180:183], a[180:183], v[36:39], v[180:183]
    v_exp_f32 v188, v188
    v_mfma_f32_16x16x32_bf16 v[180:183], a[176:179], v[32:35], v[180:183]
    v_add_f32 v1, v1, v187
    v_cvt_pk_bf16_f32 v209, v186, v187
    v_mfma_f32_16x16x32_bf16 v[112:115], v[212:215], a[224:227], 0
    v_exp_f32 v189, v189
    v_mfma_f32_16x16x32_bf16 v[112:115], v[192:195], a[192:195], v[112:115]
    v_exp_f32 v190, v190
    v_mfma_f32_16x16x32_bf16 v[116:119], v[192:195], a[196:199], 0
    v_add_f32 v1, v1, v188
    v_add_f32 v1, v1, v189
    v_mfma_f32_16x16x32_bf16 v[116:119], v[212:215], a[228:231], v[116:119]
    v_exp_f32 v191, v191
    v_mfma_f32_16x16x32_bf16 v[120:123], v[212:215], a[232:235], 0
    ds_read_b64_tr_b16 a[224:225], v244 offset:8192
    ds_read_b64_tr_b16 a[226:227], v244 offset:12288
    v_mfma_f32_16x16x32_bf16 v[120:123], v[192:195], a[200:203], v[120:123]
    v_cvt_pk_bf16_f32 v210, v188, v189
    v_add_f32 v1, v1, v190
    v_mfma_f32_16x16x32_bf16 v[124:127], v[192:195], a[204:207], 0
    ds_read_b64_tr_b16 a[228:229], v245 offset:8192
    ds_read_b64_tr_b16 a[230:231], v245 offset:12288
    v_mfma_f32_16x16x32_bf16 v[124:127], v[212:215], a[236:239], v[124:127]
    v_add_f32 v1, v1, v191
    v_cvt_pk_bf16_f32 v211, v190, v191
    v_mfma_f32_16x16x32_bf16 v[184:187], a[160:163], v[16:19], v[216:219]
    ds_read_b64_tr_b16 a[232:233], v246 offset:8192
    ds_read_b64_tr_b16 a[234:235], v246 offset:12288
    v_mfma_f32_16x16x32_bf16 v[184:187], a[164:167], v[20:23], v[184:187]
    v_exp_f32 v176, v176
    v_mfma_f32_16x16x32_bf16 v[184:187], a[168:171], v[24:27], v[184:187]
    ds_read_b64_tr_b16 a[236:237], v247 offset:8192
    ds_read_b64_tr_b16 a[238:239], v247 offset:12288
    v_mfma_f32_16x16x32_bf16 v[184:187], a[172:175], v[28:31], v[184:187]
    v_exp_f32 v177, v177
    v_mfma_f32_16x16x32_bf16 v[188:191], a[188:191], v[28:31], v[216:219]
    v_exp_f32 v178, v178
    v_mfma_f32_16x16x32_bf16 v[188:191], a[184:187], v[24:27], v[188:191]
    v_add_f32 v253, v253, v176
    v_add_f32 v253, v253, v177
    v_mfma_f32_16x16x32_bf16 v[188:191], a[180:183], v[20:23], v[188:191]
    v_exp_f32 v179, v179
    v_mfma_f32_16x16x32_bf16 v[188:191], a[176:179], v[16:19], v[188:191]
    v_cvt_pk_bf16_f32 v196, v176, v177
    v_add_f32 v253, v253, v178
    v_mfma_f32_16x16x32_bf16 v[128:131], v[212:215], a[240:243], 0
    v_exp_f32 v180, v180
    v_mfma_f32_16x16x32_bf16 v[128:131], v[192:195], a[208:211], v[128:131]
    v_add_f32 v253, v253, v179
    v_cvt_pk_bf16_f32 v197, v178, v179
    v_mfma_f32_16x16x32_bf16 v[132:135], v[192:195], a[212:215], 0
    v_exp_f32 v181, v181
    v_mfma_f32_16x16x32_bf16 v[132:135], v[212:215], a[244:247], v[132:135]
    v_exp_f32 v182, v182
    v_mfma_f32_16x16x32_bf16 v[136:139], v[212:215], a[248:251], 0
    v_add_f32 v253, v253, v180
    v_add_f32 v253, v253, v181
    v_mfma_f32_16x16x32_bf16 v[136:139], v[192:195], a[216:219], v[136:139]
    v_exp_f32 v183, v183
    v_mfma_f32_16x16x32_bf16 v[140:143], v[192:195], a[220:223], 0
    v_cvt_pk_bf16_f32 v198, v180, v181
    v_add_f32 v253, v253, v182
    v_mfma_f32_16x16x32_bf16 v[140:143], v[212:215], a[252:255], v[140:143]
    v_add_f32 v253, v253, v183
    v_cvt_pk_bf16_f32 v199, v182, v183
    s_branch L_loop1_w0
L_final_w0:
    v_mfma_f32_16x16x32_bf16 v[176:179], a[128:131], v[80:83], v[232:235]
    s_barrier
    ds_read_b128 a[160:163], v240 offset:8192
    ds_read_b128 a[164:167], v241 offset:8192
    v_mfma_f32_16x16x32_bf16 v[176:179], a[132:135], v[84:87], v[176:179]
    v_exp_f32 v184, v184
    v_mfma_f32_16x16x32_bf16 v[176:179], a[136:139], v[88:91], v[176:179]
    s_add_u32 s92, s55, 16384
    ds_read_b128 a[168:171], v242 offset:8192
    ds_read_b128 a[172:175], v243 offset:8192
    v_mfma_f32_16x16x32_bf16 v[176:179], a[140:143], v[92:95], v[176:179]
    s_add_u32 s93, s55, 20480
    v_exp_f32 v185, v185
    v_mfma_f32_16x16x32_bf16 v[180:183], a[156:159], v[92:95], v[232:235]
    s_add_u32 s88, s55, 0
    v_exp_f32 v186, v186
    v_mfma_f32_16x16x32_bf16 v[180:183], a[152:155], v[88:91], v[180:183]
    s_add_u32 s89, s55, 4096
    v_add_f32 v0, v0, v184
    v_add_f32 v0, v0, v185
    v_mfma_f32_16x16x32_bf16 v[180:183], a[148:151], v[84:87], v[180:183]
    s_add_u32 s90, s55, 8192
    v_exp_f32 v187, v187
    v_mfma_f32_16x16x32_bf16 v[180:183], a[144:147], v[80:83], v[180:183]
    s_add_u32 s91, s55, 12288
    v_cvt_pk_bf16_f32 v212, v184, v185
    v_add_f32 v0, v0, v186
    v_mfma_f32_16x16x32_bf16 v[144:147], v[200:203], a[192:195], v[144:147]
    v_exp_f32 v188, v188
    v_mfma_f32_16x16x32_bf16 v[144:147], v[196:199], a[224:227], v[144:147]
    v_add_f32 v0, v0, v187
    v_cvt_pk_bf16_f32 v213, v186, v187
    v_mfma_f32_16x16x32_bf16 v[148:151], v[196:199], a[228:231], v[148:151]
    v_exp_f32 v189, v189
    v_mfma_f32_16x16x32_bf16 v[148:151], v[200:203], a[196:199], v[148:151]
    v_exp_f32 v190, v190
    v_mfma_f32_16x16x32_bf16 v[152:155], v[200:203], a[200:203], v[152:155]
    v_add_f32 v0, v0, v188
    v_add_f32 v0, v0, v189
    v_mfma_f32_16x16x32_bf16 v[152:155], v[196:199], a[232:235], v[152:155]
    v_exp_f32 v191, v191
    v_mfma_f32_16x16x32_bf16 v[156:159], v[196:199], a[236:239], v[156:159]
    v_cvt_pk_bf16_f32 v214, v188, v189
    v_add_f32 v0, v0, v190
    v_mfma_f32_16x16x32_bf16 v[156:159], v[200:203], a[204:207], v[156:159]
    v_add_f32 v0, v0, v191
    v_cvt_pk_bf16_f32 v215, v190, v191
    v_mfma_f32_16x16x32_bf16 a[0:3], v[204:207], a[224:227], a[0:3]
    ds_read_b128 a[176:179], v240 offset:12288
    ds_read_b128 a[180:183], v241 offset:12288
    v_mfma_f32_16x16x32_bf16 a[4:7], v[204:207], a[228:231], a[4:7]
    ds_read_b128 a[184:187], v242 offset:12288
    ds_read_b128 a[188:191], v243 offset:12288
    v_mfma_f32_16x16x32_bf16 a[8:11], v[204:207], a[232:235], a[8:11]
    ds_read_b64_tr_b16 a[192:193], v244 offset:0
    ds_read_b64_tr_b16 a[194:195], v244 offset:4096
    v_mfma_f32_16x16x32_bf16 a[12:15], v[204:207], a[236:239], a[12:15]
    ds_read_b64_tr_b16 a[196:197], v245 offset:0
    ds_read_b64_tr_b16 a[198:199], v245 offset:4096
    v_mfma_f32_16x16x32_bf16 a[16:19], v[204:207], a[240:243], a[16:19]
    ds_read_b64_tr_b16 a[200:201], v246 offset:0
    ds_read_b64_tr_b16 a[202:203], v246 offset:4096
    v_mfma_f32_16x16x32_bf16 a[20:23], v[204:207], a[244:247], a[20:23]
    ds_read_b64_tr_b16 a[204:205], v247 offset:0
    ds_read_b64_tr_b16 a[206:207], v247 offset:4096
    v_mfma_f32_16x16x32_bf16 a[24:27], v[204:207], a[248:251], a[24:27]
    v_mfma_f32_16x16x32_bf16 a[28:31], v[204:207], a[252:255], a[28:31]
    v_mfma_f32_16x16x32_bf16 a[64:67], v[208:211], a[224:227], a[64:67]
    v_mfma_f32_16x16x32_bf16 a[68:71], v[208:211], a[228:231], a[68:71]
    v_mfma_f32_16x16x32_bf16 a[72:75], v[208:211], a[232:235], a[72:75]
    v_mfma_f32_16x16x32_bf16 a[76:79], v[208:211], a[236:239], a[76:79]
    v_mfma_f32_16x16x32_bf16 a[80:83], v[208:211], a[240:243], a[80:83]
    v_mfma_f32_16x16x32_bf16 a[84:87], v[208:211], a[244:247], a[84:87]
    v_mfma_f32_16x16x32_bf16 a[88:91], v[208:211], a[248:251], a[88:91]
    v_mfma_f32_16x16x32_bf16 a[92:95], v[208:211], a[252:255], a[92:95]
    s_waitcnt lgkmcnt(8)
    v_mfma_f32_16x16x32_bf16 v[184:187], a[160:163], v[80:83], v[232:235]
    v_exp_f32 v176, v176
    v_mfma_f32_16x16x32_bf16 v[184:187], a[164:167], v[84:87], v[184:187]
    v_exp_f32 v177, v177
    v_mfma_f32_16x16x32_bf16 v[184:187], a[168:171], v[88:91], v[184:187]
    v_exp_f32 v178, v178
    v_mfma_f32_16x16x32_bf16 v[184:187], a[172:175], v[92:95], v[184:187]
    v_add_f32 v0, v0, v176
    v_add_f32 v0, v0, v177
    v_mfma_f32_16x16x32_bf16 v[188:191], a[188:191], v[92:95], v[232:235]
    v_exp_f32 v179, v179
    v_mfma_f32_16x16x32_bf16 v[188:191], a[184:187], v[88:91], v[188:191]
    v_cvt_pk_bf16_f32 v192, v176, v177
    v_add_f32 v0, v0, v178
    v_mfma_f32_16x16x32_bf16 v[188:191], a[180:183], v[84:87], v[188:191]
    v_exp_f32 v180, v180
    v_mfma_f32_16x16x32_bf16 v[188:191], a[176:179], v[80:83], v[188:191]
    v_add_f32 v0, v0, v179
    v_cvt_pk_bf16_f32 v193, v178, v179
    v_mfma_f32_16x16x32_bf16 v[160:163], v[200:203], a[208:211], v[160:163]
    v_exp_f32 v181, v181
    v_mfma_f32_16x16x32_bf16 v[160:163], v[196:199], a[240:243], v[160:163]
    v_exp_f32 v182, v182
    v_mfma_f32_16x16x32_bf16 v[164:167], v[196:199], a[244:247], v[164:167]
    v_add_f32 v0, v0, v180
    v_add_f32 v0, v0, v181
    v_mfma_f32_16x16x32_bf16 v[164:167], v[200:203], a[212:215], v[164:167]
    v_exp_f32 v183, v183
    v_mfma_f32_16x16x32_bf16 v[168:171], v[200:203], a[216:219], v[168:171]
    v_cvt_pk_bf16_f32 v194, v180, v181
    v_add_f32 v0, v0, v182
    v_mfma_f32_16x16x32_bf16 v[168:171], v[196:199], a[248:251], v[168:171]
    v_add_f32 v0, v0, v183
    v_cvt_pk_bf16_f32 v195, v182, v183
    v_mfma_f32_16x16x32_bf16 v[172:175], v[196:199], a[252:255], v[172:175]
    v_mfma_f32_16x16x32_bf16 v[172:175], v[200:203], a[220:223], v[172:175]
    v_mfma_f32_16x16x32_bf16 v[112:115], v[212:215], a[224:227], v[112:115]
    ds_read_b64_tr_b16 a[208:209], v248 offset:0
    ds_read_b64_tr_b16 a[210:211], v248 offset:4096
    v_mfma_f32_16x16x32_bf16 v[116:119], v[212:215], a[228:231], v[116:119]
    ds_read_b64_tr_b16 a[212:213], v249 offset:0
    ds_read_b64_tr_b16 a[214:215], v249 offset:4096
    v_mfma_f32_16x16x32_bf16 v[120:123], v[212:215], a[232:235], v[120:123]
    ds_read_b64_tr_b16 a[216:217], v250 offset:0
    ds_read_b64_tr_b16 a[218:219], v250 offset:4096
    v_mfma_f32_16x16x32_bf16 v[124:127], v[212:215], a[236:239], v[124:127]
    ds_read_b64_tr_b16 a[220:221], v251 offset:0
    ds_read_b64_tr_b16 a[222:223], v251 offset:4096
    v_mfma_f32_16x16x32_bf16 v[128:131], v[212:215], a[240:243], v[128:131]
    ds_read_b64_tr_b16 a[224:225], v244 offset:8192
    v_mfma_f32_16x16x32_bf16 v[132:135], v[212:215], a[244:247], v[132:135]
    ds_read_b64_tr_b16 a[226:227], v244 offset:12288
    v_mfma_f32_16x16x32_bf16 v[136:139], v[212:215], a[248:251], v[136:139]
    ds_read_b64_tr_b16 a[228:229], v245 offset:8192
    ds_read_b64_tr_b16 a[230:231], v245 offset:12288
    v_mfma_f32_16x16x32_bf16 v[140:143], v[212:215], a[252:255], v[140:143]
    ds_read_b64_tr_b16 a[232:233], v246 offset:8192
    ds_read_b64_tr_b16 a[234:235], v246 offset:12288
    v_mfma_f32_16x16x32_bf16 v[176:179], a[128:131], v[96:99], v[236:239]
    ds_read_b64_tr_b16 a[236:237], v247 offset:8192
    ds_read_b64_tr_b16 a[238:239], v247 offset:12288
    v_mfma_f32_16x16x32_bf16 v[176:179], a[132:135], v[100:103], v[176:179]
    ds_read_b64_tr_b16 a[240:241], v248 offset:8192
    v_exp_f32 v184, v184
    v_mfma_f32_16x16x32_bf16 v[176:179], a[136:139], v[104:107], v[176:179]
    ds_read_b64_tr_b16 a[242:243], v248 offset:12288
    ds_read_b64_tr_b16 a[244:245], v249 offset:8192
    v_mfma_f32_16x16x32_bf16 v[176:179], a[140:143], v[108:111], v[176:179]
    ds_read_b64_tr_b16 a[246:247], v249 offset:12288
    v_exp_f32 v185, v185
    v_mfma_f32_16x16x32_bf16 v[180:183], a[156:159], v[108:111], v[236:239]
    ds_read_b64_tr_b16 a[248:249], v250 offset:8192
    v_exp_f32 v186, v186
    v_mfma_f32_16x16x32_bf16 v[180:183], a[152:155], v[104:107], v[180:183]
    v_add_f32 v0, v0, v184
    v_add_f32 v0, v0, v185
    v_mfma_f32_16x16x32_bf16 v[180:183], a[148:151], v[100:103], v[180:183]
    ds_read_b64_tr_b16 a[250:251], v250 offset:12288
    v_exp_f32 v187, v187
    v_mfma_f32_16x16x32_bf16 v[180:183], a[144:147], v[96:99], v[180:183]
    s_waitcnt lgkmcnt(14)
    v_cvt_pk_bf16_f32 v196, v184, v185
    v_add_f32 v0, v0, v186
    v_mfma_f32_16x16x32_bf16 v[112:115], v[192:195], a[192:195], v[112:115]
    ds_read_b64_tr_b16 a[252:253], v251 offset:8192
    v_exp_f32 v188, v188
    v_mfma_f32_16x16x32_bf16 v[116:119], v[192:195], a[196:199], v[116:119]
    v_add_f32 v0, v0, v187
    v_cvt_pk_bf16_f32 v197, v186, v187
    v_mfma_f32_16x16x32_bf16 v[120:123], v[192:195], a[200:203], v[120:123]
    ds_read_b64_tr_b16 a[254:255], v251 offset:12288
    v_exp_f32 v189, v189
    v_mfma_f32_16x16x32_bf16 v[124:127], v[192:195], a[204:207], v[124:127]
    v_exp_f32 v190, v190
    v_mbcnt_lo_u32_b32 v200, -1, 0
    v_mfma_f32_16x16x32_bf16 v[128:131], v[192:195], a[208:211], v[128:131]
    v_add_f32 v0, v0, v188
    v_add_f32 v0, v0, v189
    v_mbcnt_hi_u32_b32 v200, -1, v200
    v_mfma_f32_16x16x32_bf16 v[132:135], v[192:195], a[212:215], v[132:135]
    v_exp_f32 v191, v191
    v_lshlrev_b32 v200, 4, v200
    v_mfma_f32_16x16x32_bf16 v[136:139], v[192:195], a[216:219], v[136:139]
    v_cvt_pk_bf16_f32 v198, v188, v189
    v_add_f32 v0, v0, v190
    v_mfma_f32_16x16x32_bf16 v[140:143], v[192:195], a[220:223], v[140:143]
    v_add_f32 v0, v0, v191
    v_cvt_pk_bf16_f32 v199, v190, v191
    v_mfma_f32_16x16x32_bf16 v[184:187], a[160:163], v[96:99], v[236:239]
    v_mov_b32 v232, v0
    v_mfma_f32_16x16x32_bf16 v[184:187], a[164:167], v[100:103], v[184:187]
    v_exp_f32 v176, v176
    v_exp_f32 v177, v177
    v_mfma_f32_16x16x32_bf16 v[184:187], a[168:171], v[104:107], v[184:187]
    v_permlane16_swap_b32 v0, v232
    v_exp_f32 v178, v178
    v_mfma_f32_16x16x32_bf16 v[184:187], a[172:175], v[108:111], v[184:187]
    v_add_f32 v0, v0, v232
    v_mov_b32 v232, v0
    v_add_f32 v1, v1, v176
    v_mfma_f32_16x16x32_bf16 v[188:191], a[188:191], v[108:111], v[236:239]
    v_add_f32 v1, v1, v177
    v_exp_f32 v179, v179
    v_mfma_f32_16x16x32_bf16 v[188:191], a[184:187], v[104:107], v[188:191]
    v_permlane32_swap_b32 v0, v232
    v_cvt_pk_bf16_f32 v192, v176, v177
    v_add_f32 v1, v1, v178
    v_mfma_f32_16x16x32_bf16 v[188:191], a[180:183], v[100:103], v[188:191]
    v_add_f32 v0, v0, v232
    v_subrev_u32 v232, s57, v0
    v_mfma_f32_16x16x32_bf16 v[188:191], a[176:179], v[96:99], v[188:191]
    s_waitcnt lgkmcnt(0)
    v_cmp_le_u32 vcc, s36, v232
    v_rcp_f32 v0, v0
    v_mfma_f32_16x16x32_bf16 v[112:115], v[196:199], a[224:227], v[112:115]
    ds_bpermute_b32 v232, v4, v0 offset:0
    v_mfma_f32_16x16x32_bf16 v[116:119], v[196:199], a[228:231], v[116:119]
    s_cmp_lg_u64 vcc, 0
    ds_bpermute_b32 v233, v4, v0 offset:4
    v_exp_f32 v180, v180
    v_mfma_f32_16x16x32_bf16 v[120:123], v[196:199], a[232:235], v[120:123]
    s_cselect_b32 s56, 1024, 0
    ds_bpermute_b32 v234, v4, v0 offset:8
    v_add_f32 v1, v1, v179
    v_mfma_f32_16x16x32_bf16 v[124:127], v[196:199], a[236:239], v[124:127]
    s_or_b32 s27, s27, s56
    ds_bpermute_b32 v235, v4, v0 offset:12
    v_cvt_pk_bf16_f32 v193, v178, v179
    v_mfma_f32_16x16x32_bf16 v[128:131], v[196:199], a[240:243], v[128:131]
    v_exp_f32 v181, v181
    v_mfma_f32_16x16x32_bf16 v[132:135], v[196:199], a[244:247], v[132:135]
    v_exp_f32 v182, v182
    v_add_f32 v1, v1, v180
    v_add_f32 v1, v1, v181
    v_mfma_f32_16x16x32_bf16 v[136:139], v[196:199], a[248:251], v[136:139]
    v_exp_f32 v183, v183
    v_cvt_pk_bf16_f32 v194, v180, v181
    v_mfma_f32_16x16x32_bf16 v[140:143], v[196:199], a[252:255], v[140:143]
    v_add_f32 v1, v1, v182
    v_add_f32 v1, v1, v183
    v_cvt_pk_bf16_f32 v195, v182, v183
    s_waitcnt lgkmcnt(0)
.p2align 3
    v_pk_mul_f32 v[112:113], v[112:113], v[232:233]
    v_pk_mul_f32 v[116:117], v[116:117], v[232:233]
    v_pk_mul_f32 v[120:121], v[120:121], v[232:233]
    v_pk_mul_f32 v[124:125], v[124:125], v[232:233]
    v_pk_mul_f32 v[128:129], v[128:129], v[232:233]
    v_pk_mul_f32 v[132:133], v[132:133], v[232:233]
    v_pk_mul_f32 v[136:137], v[136:137], v[232:233]
    v_pk_mul_f32 v[140:141], v[140:141], v[232:233]
    v_pk_mul_f32 v[114:115], v[114:115], v[234:235]
    v_pk_mul_f32 v[118:119], v[118:119], v[234:235]
    v_pk_mul_f32 v[122:123], v[122:123], v[234:235]
    v_pk_mul_f32 v[126:127], v[126:127], v[234:235]
    v_pk_mul_f32 v[130:131], v[130:131], v[234:235]
    v_pk_mul_f32 v[134:135], v[134:135], v[234:235]
    v_pk_mul_f32 v[138:139], v[138:139], v[234:235]
    v_pk_mul_f32 v[142:143], v[142:143], v[234:235]
    v_cvt_pk_bf16_f32 v80, v112, v116
    v_cvt_pk_bf16_f32 v81, v120, v124
    v_cvt_pk_bf16_f32 v82, v128, v132
    v_cvt_pk_bf16_f32 v83, v136, v140
    v_cvt_pk_bf16_f32 v84, v113, v117
    v_cvt_pk_bf16_f32 v85, v121, v125
    v_cvt_pk_bf16_f32 v86, v129, v133
    v_cvt_pk_bf16_f32 v87, v137, v141
    v_cvt_pk_bf16_f32 v88, v114, v118
    v_cvt_pk_bf16_f32 v89, v122, v126
    v_cvt_pk_bf16_f32 v90, v130, v134
    v_cvt_pk_bf16_f32 v91, v138, v142
    v_cvt_pk_bf16_f32 v92, v115, v119
    v_cvt_pk_bf16_f32 v93, v123, v127
    v_cvt_pk_bf16_f32 v94, v131, v135
    v_cvt_pk_bf16_f32 v95, v139, v143
    v_mfma_f32_16x16x32_bf16 v[176:179], a[128:131], v[16:19], v[216:219]
    ds_write_b128 v2, v[80:83] offset:16384
    v_mfma_f32_16x16x32_bf16 v[176:179], a[132:135], v[20:23], v[176:179]
    v_exp_f32 v184, v184
    v_mfma_f32_16x16x32_bf16 v[176:179], a[136:139], v[24:27], v[176:179]
    ds_write_b128 v3, v[84:87] offset:16640
    v_mfma_f32_16x16x32_bf16 v[176:179], a[140:143], v[28:31], v[176:179]
    v_exp_f32 v185, v185
    v_mfma_f32_16x16x32_bf16 v[180:183], a[156:159], v[28:31], v[216:219]
    ds_write_b128 v2, v[88:91] offset:16896
    v_exp_f32 v186, v186
    v_mfma_f32_16x16x32_bf16 v[180:183], a[152:155], v[24:27], v[180:183]
    v_add_f32 v1, v1, v184
    v_add_f32 v1, v1, v185
    v_mfma_f32_16x16x32_bf16 v[180:183], a[148:151], v[20:23], v[180:183]
    ds_write_b128 v3, v[92:95] offset:17152
    v_exp_f32 v187, v187
    v_mfma_f32_16x16x32_bf16 v[180:183], a[144:147], v[16:19], v[180:183]
    v_cvt_pk_bf16_f32 v196, v184, v185
    v_add_f32 v1, v1, v186
    v_mfma_f32_16x16x32_bf16 v[144:147], v[192:195], a[192:195], v[144:147]
    v_exp_f32 v188, v188
    v_mfma_f32_16x16x32_bf16 v[148:151], v[192:195], a[196:199], v[148:151]
    ds_read_b64_tr_b16 v[128:129], v6 offset:16384
    ds_read_b64_tr_b16 v[130:131], v7 offset:16384
    v_add_f32 v1, v1, v187
    v_cvt_pk_bf16_f32 v197, v186, v187
    v_mfma_f32_16x16x32_bf16 v[152:155], v[192:195], a[200:203], v[152:155]
    ds_read_b64_tr_b16 v[132:133], v6 offset:17408
    v_exp_f32 v189, v189
    v_mfma_f32_16x16x32_bf16 v[156:159], v[192:195], a[204:207], v[156:159]
    ds_read_b64_tr_b16 v[134:135], v7 offset:17408
    ds_read_b64_tr_b16 v[136:137], v6 offset:18432
    v_exp_f32 v190, v190
    v_mfma_f32_16x16x32_bf16 v[160:163], v[192:195], a[208:211], v[160:163]
    ds_read_b64_tr_b16 v[138:139], v7 offset:18432
    v_add_f32 v1, v1, v188
    v_add_f32 v1, v1, v189
    v_mfma_f32_16x16x32_bf16 v[164:167], v[192:195], a[212:215], v[164:167]
    ds_read_b64_tr_b16 v[140:141], v6 offset:19456
    ds_read_b64_tr_b16 v[142:143], v7 offset:19456
    v_exp_f32 v191, v191
    v_mfma_f32_16x16x32_bf16 v[168:171], v[192:195], a[216:219], v[168:171]
    v_cvt_pk_bf16_f32 v198, v188, v189
    v_add_f32 v1, v1, v190
    v_mfma_f32_16x16x32_bf16 v[172:175], v[192:195], a[220:223], v[172:175]
    v_add_f32 v1, v1, v191
    v_cvt_pk_bf16_f32 v199, v190, v191
    v_mfma_f32_16x16x32_bf16 v[184:187], a[160:163], v[16:19], v[216:219]
    v_mov_b32 v236, v1
    v_exp_f32 v176, v176
    v_mfma_f32_16x16x32_bf16 v[184:187], a[164:167], v[20:23], v[184:187]
    s_waitcnt lgkmcnt(0)
    buffer_store_dwordx4 v[128:131], v200, s[20:23], s92 offen offset:0 sc1
    v_mfma_f32_16x16x32_bf16 v[184:187], a[168:171], v[24:27], v[184:187]
    v_permlane16_swap_b32 v1, v236
    v_exp_f32 v177, v177
    v_mfma_f32_16x16x32_bf16 v[184:187], a[172:175], v[28:31], v[184:187]
    v_add_f32 v1, v1, v236
    v_mov_b32 v236, v1
    v_exp_f32 v178, v178
    v_add_f32 v252, v252, v176
    v_mfma_f32_16x16x32_bf16 v[188:191], a[188:191], v[28:31], v[216:219]
    v_add_f32 v252, v252, v177
    v_exp_f32 v179, v179
    v_cvt_pk_bf16_f32 v192, v176, v177
    v_mfma_f32_16x16x32_bf16 v[188:191], a[184:187], v[24:27], v[188:191]
    buffer_store_dwordx4 v[132:135], v200, s[20:23], s92 offen offset:1024 sc1
    v_permlane32_swap_b32 v1, v236
    v_mfma_f32_16x16x32_bf16 v[188:191], a[180:183], v[20:23], v[188:191]
    v_add_f32 v1, v1, v236
    v_subrev_u32 v236, s57, v1
    v_add_f32 v252, v252, v178
    v_mfma_f32_16x16x32_bf16 v[188:191], a[176:179], v[16:19], v[188:191]
    v_cmp_le_u32 vcc, s36, v236
    v_rcp_f32 v1, v1
    v_mfma_f32_16x16x32_bf16 v[144:147], v[196:199], a[224:227], v[144:147]
    ds_bpermute_b32 v236, v4, v1 offset:0
    v_exp_f32 v180, v180
    v_mfma_f32_16x16x32_bf16 v[148:151], v[196:199], a[228:231], v[148:151]
    s_cmp_lg_u64 vcc, 0
    buffer_store_dwordx4 v[136:139], v200, s[20:23], s92 offen offset:2048 sc1
    ds_bpermute_b32 v237, v4, v1 offset:4
    v_mfma_f32_16x16x32_bf16 v[152:155], v[196:199], a[232:235], v[152:155]
    s_cselect_b32 s56, 2048, 0
    ds_bpermute_b32 v238, v4, v1 offset:8
    v_mfma_f32_16x16x32_bf16 v[156:159], v[196:199], a[236:239], v[156:159]
    s_or_b32 s27, s27, s56
    ds_bpermute_b32 v239, v4, v1 offset:12
    v_add_f32 v252, v252, v179
    v_cvt_pk_bf16_f32 v193, v178, v179
    v_mfma_f32_16x16x32_bf16 v[160:163], v[196:199], a[240:243], v[160:163]
    v_exp_f32 v181, v181
    v_exp_f32 v182, v182
    v_mfma_f32_16x16x32_bf16 v[164:167], v[196:199], a[244:247], v[164:167]
    v_add_f32 v252, v252, v180
    v_add_f32 v252, v252, v181
    v_mfma_f32_16x16x32_bf16 v[168:171], v[196:199], a[248:251], v[168:171]
    v_exp_f32 v183, v183
    v_cvt_pk_bf16_f32 v194, v180, v181
    v_add_f32 v252, v252, v182
    v_add_f32 v252, v252, v183
    v_mfma_f32_16x16x32_bf16 v[172:175], v[196:199], a[252:255], v[172:175]
    buffer_store_dwordx4 v[140:143], v200, s[20:23], s92 offen offset:3072 sc1
    v_cvt_pk_bf16_f32 v195, v182, v183
    s_waitcnt lgkmcnt(0)
.p2align 3
    v_pk_mul_f32 v[144:145], v[144:145], v[236:237]
    v_pk_mul_f32 v[148:149], v[148:149], v[236:237]
    v_pk_mul_f32 v[152:153], v[152:153], v[236:237]
    v_pk_mul_f32 v[156:157], v[156:157], v[236:237]
    v_pk_mul_f32 v[160:161], v[160:161], v[236:237]
    v_pk_mul_f32 v[164:165], v[164:165], v[236:237]
    v_pk_mul_f32 v[168:169], v[168:169], v[236:237]
    v_pk_mul_f32 v[172:173], v[172:173], v[236:237]
    v_pk_mul_f32 v[146:147], v[146:147], v[238:239]
    v_pk_mul_f32 v[150:151], v[150:151], v[238:239]
    v_pk_mul_f32 v[154:155], v[154:155], v[238:239]
    v_pk_mul_f32 v[158:159], v[158:159], v[238:239]
    v_pk_mul_f32 v[162:163], v[162:163], v[238:239]
    v_pk_mul_f32 v[166:167], v[166:167], v[238:239]
    v_pk_mul_f32 v[170:171], v[170:171], v[238:239]
    v_pk_mul_f32 v[174:175], v[174:175], v[238:239]
    v_cvt_pk_bf16_f32 v96, v144, v148
    v_cvt_pk_bf16_f32 v97, v152, v156
    v_cvt_pk_bf16_f32 v98, v160, v164
    v_cvt_pk_bf16_f32 v99, v168, v172
    v_cvt_pk_bf16_f32 v100, v145, v149
    v_cvt_pk_bf16_f32 v101, v153, v157
    v_cvt_pk_bf16_f32 v102, v161, v165
    v_cvt_pk_bf16_f32 v103, v169, v173
    v_cvt_pk_bf16_f32 v104, v146, v150
    v_cvt_pk_bf16_f32 v105, v154, v158
    v_cvt_pk_bf16_f32 v106, v162, v166
    v_cvt_pk_bf16_f32 v107, v170, v174
    v_cvt_pk_bf16_f32 v108, v147, v151
    v_cvt_pk_bf16_f32 v109, v155, v159
    v_cvt_pk_bf16_f32 v110, v163, v167
    v_cvt_pk_bf16_f32 v111, v171, v175
    v_mfma_f32_16x16x32_bf16 v[176:179], a[128:131], v[32:35], v[220:223]
    ds_write_b128 v2, v[96:99] offset:20480
    v_mfma_f32_16x16x32_bf16 v[176:179], a[132:135], v[36:39], v[176:179]
    v_exp_f32 v184, v184
    v_mfma_f32_16x16x32_bf16 v[176:179], a[136:139], v[40:43], v[176:179]
    ds_write_b128 v3, v[100:103] offset:20736
    v_mfma_f32_16x16x32_bf16 v[176:179], a[140:143], v[44:47], v[176:179]
    v_exp_f32 v185, v185
    v_mfma_f32_16x16x32_bf16 v[180:183], a[156:159], v[44:47], v[220:223]
    ds_write_b128 v2, v[104:107] offset:20992
    v_exp_f32 v186, v186
    v_mfma_f32_16x16x32_bf16 v[180:183], a[152:155], v[40:43], v[180:183]
    v_add_f32 v252, v252, v184
    v_add_f32 v252, v252, v185
    v_mfma_f32_16x16x32_bf16 v[180:183], a[148:151], v[36:39], v[180:183]
    ds_write_b128 v3, v[108:111] offset:21248
    v_exp_f32 v187, v187
    v_mfma_f32_16x16x32_bf16 v[180:183], a[144:147], v[32:35], v[180:183]
    v_cvt_pk_bf16_f32 v196, v184, v185
    v_add_f32 v252, v252, v186
    v_mfma_f32_16x16x32_bf16 a[0:3], v[192:195], a[192:195], a[0:3]
    v_exp_f32 v188, v188
    v_mfma_f32_16x16x32_bf16 a[4:7], v[192:195], a[196:199], a[4:7]
    ds_read_b64_tr_b16 v[160:161], v6 offset:20480
    ds_read_b64_tr_b16 v[162:163], v7 offset:20480
    v_add_f32 v252, v252, v187
    v_cvt_pk_bf16_f32 v197, v186, v187
    v_mfma_f32_16x16x32_bf16 a[8:11], v[192:195], a[200:203], a[8:11]
    ds_read_b64_tr_b16 v[164:165], v6 offset:21504
    v_exp_f32 v189, v189
    v_mfma_f32_16x16x32_bf16 a[12:15], v[192:195], a[204:207], a[12:15]
    ds_read_b64_tr_b16 v[166:167], v7 offset:21504
    ds_read_b64_tr_b16 v[168:169], v6 offset:22528
    v_exp_f32 v190, v190
    v_mfma_f32_16x16x32_bf16 a[16:19], v[192:195], a[208:211], a[16:19]
    ds_read_b64_tr_b16 v[170:171], v7 offset:22528
    v_add_f32 v252, v252, v188
    v_add_f32 v252, v252, v189
    v_mfma_f32_16x16x32_bf16 a[20:23], v[192:195], a[212:215], a[20:23]
    ds_read_b64_tr_b16 v[172:173], v6 offset:23552
    ds_read_b64_tr_b16 v[174:175], v7 offset:23552
    v_exp_f32 v191, v191
    v_mfma_f32_16x16x32_bf16 a[24:27], v[192:195], a[216:219], a[24:27]
    v_cvt_pk_bf16_f32 v198, v188, v189
    v_add_f32 v252, v252, v190
    v_mfma_f32_16x16x32_bf16 a[28:31], v[192:195], a[220:223], a[28:31]
    v_add_f32 v252, v252, v191
    v_cvt_pk_bf16_f32 v199, v190, v191
    v_mfma_f32_16x16x32_bf16 v[184:187], a[160:163], v[32:35], v[220:223]
    v_mov_b32 v216, v252
    v_exp_f32 v176, v176
    v_mfma_f32_16x16x32_bf16 v[184:187], a[164:167], v[36:39], v[184:187]
    s_waitcnt lgkmcnt(0)
    buffer_store_dwordx4 v[160:163], v200, s[20:23], s93 offen offset:0 sc1
    v_mfma_f32_16x16x32_bf16 v[184:187], a[168:171], v[40:43], v[184:187]
    v_permlane16_swap_b32 v252, v216
    v_exp_f32 v177, v177
    v_mfma_f32_16x16x32_bf16 v[184:187], a[172:175], v[44:47], v[184:187]
    v_add_f32 v252, v252, v216
    v_mov_b32 v216, v252
    v_exp_f32 v178, v178
    v_add_f32 v253, v253, v176
    v_mfma_f32_16x16x32_bf16 v[188:191], a[188:191], v[44:47], v[220:223]
    v_add_f32 v253, v253, v177
    v_exp_f32 v179, v179
    v_cvt_pk_bf16_f32 v192, v176, v177
    v_mfma_f32_16x16x32_bf16 v[188:191], a[184:187], v[40:43], v[188:191]
    buffer_store_dwordx4 v[164:167], v200, s[20:23], s93 offen offset:1024 sc1
    v_permlane32_swap_b32 v252, v216
    v_mfma_f32_16x16x32_bf16 v[188:191], a[180:183], v[36:39], v[188:191]
    v_add_f32 v252, v252, v216
    v_subrev_u32 v216, s57, v252
    v_add_f32 v253, v253, v178
    v_mfma_f32_16x16x32_bf16 v[188:191], a[176:179], v[32:35], v[188:191]
    v_cmp_le_u32 vcc, s36, v216
    v_rcp_f32 v252, v252
    v_mfma_f32_16x16x32_bf16 a[0:3], v[196:199], a[224:227], a[0:3]
    ds_bpermute_b32 v216, v4, v252 offset:0
    v_exp_f32 v180, v180
    v_mfma_f32_16x16x32_bf16 a[4:7], v[196:199], a[228:231], a[4:7]
    s_cmp_lg_u64 vcc, 0
    buffer_store_dwordx4 v[168:171], v200, s[20:23], s93 offen offset:2048 sc1
    ds_bpermute_b32 v217, v4, v252 offset:4
    v_mfma_f32_16x16x32_bf16 a[8:11], v[196:199], a[232:235], a[8:11]
    s_cselect_b32 s56, 64, 0
    ds_bpermute_b32 v218, v4, v252 offset:8
    v_mfma_f32_16x16x32_bf16 a[12:15], v[196:199], a[236:239], a[12:15]
    s_or_b32 s27, s27, s56
    ds_bpermute_b32 v219, v4, v252 offset:12
    v_add_f32 v253, v253, v179
    v_cvt_pk_bf16_f32 v193, v178, v179
    v_mfma_f32_16x16x32_bf16 a[16:19], v[196:199], a[240:243], a[16:19]
    v_exp_f32 v181, v181
    v_exp_f32 v182, v182
    v_mfma_f32_16x16x32_bf16 a[20:23], v[196:199], a[244:247], a[20:23]
    v_add_f32 v253, v253, v180
    v_add_f32 v253, v253, v181
    v_mfma_f32_16x16x32_bf16 a[24:27], v[196:199], a[248:251], a[24:27]
    v_exp_f32 v183, v183
    v_cvt_pk_bf16_f32 v194, v180, v181
    v_add_f32 v253, v253, v182
    v_add_f32 v253, v253, v183
    v_mfma_f32_16x16x32_bf16 a[28:31], v[196:199], a[252:255], a[28:31]
    buffer_store_dwordx4 v[172:175], v200, s[20:23], s93 offen offset:3072 sc1
    v_cvt_pk_bf16_f32 v195, v182, v183
    s_nop 3
.p2align 3
    v_accvgpr_read_b32 v176, a0
    v_accvgpr_read_b32 v177, a4
    v_accvgpr_read_b32 v178, a8
    v_accvgpr_read_b32 v179, a12
    v_accvgpr_read_b32 v180, a16
    v_accvgpr_read_b32 v181, a20
    v_accvgpr_read_b32 v182, a24
    v_accvgpr_read_b32 v183, a28
    s_waitcnt lgkmcnt(0)
.p2align 3
    v_pk_mul_f32 v[176:177], v[176:177], v[216:217] op_sel:[0,0] op_sel_hi:[1,0]
    v_pk_mul_f32 v[178:179], v[178:179], v[216:217] op_sel:[0,0] op_sel_hi:[1,0]
    v_pk_mul_f32 v[180:181], v[180:181], v[216:217] op_sel:[0,0] op_sel_hi:[1,0]
    v_pk_mul_f32 v[182:183], v[182:183], v[216:217] op_sel:[0,0] op_sel_hi:[1,0]
    v_cvt_pk_bf16_f32 v16, v176, v177
    v_cvt_pk_bf16_f32 v17, v178, v179
    v_cvt_pk_bf16_f32 v18, v180, v181
    v_cvt_pk_bf16_f32 v19, v182, v183
    v_accvgpr_read_b32 v176, a1
    v_accvgpr_read_b32 v177, a5
    v_accvgpr_read_b32 v178, a9
    v_accvgpr_read_b32 v179, a13
    v_accvgpr_read_b32 v180, a17
    v_accvgpr_read_b32 v181, a21
    v_accvgpr_read_b32 v182, a25
    v_accvgpr_read_b32 v183, a29
    v_pk_mul_f32 v[176:177], v[176:177], v[216:217] op_sel:[0,1] op_sel_hi:[1,1]
    v_pk_mul_f32 v[178:179], v[178:179], v[216:217] op_sel:[0,1] op_sel_hi:[1,1]
    v_pk_mul_f32 v[180:181], v[180:181], v[216:217] op_sel:[0,1] op_sel_hi:[1,1]
    v_pk_mul_f32 v[182:183], v[182:183], v[216:217] op_sel:[0,1] op_sel_hi:[1,1]
    v_cvt_pk_bf16_f32 v20, v176, v177
    v_cvt_pk_bf16_f32 v21, v178, v179
    v_cvt_pk_bf16_f32 v22, v180, v181
    v_cvt_pk_bf16_f32 v23, v182, v183
    v_accvgpr_read_b32 v176, a2
    v_accvgpr_read_b32 v177, a6
    v_accvgpr_read_b32 v178, a10
    v_accvgpr_read_b32 v179, a14
    v_accvgpr_read_b32 v180, a18
    v_accvgpr_read_b32 v181, a22
    v_accvgpr_read_b32 v182, a26
    v_accvgpr_read_b32 v183, a30
    v_pk_mul_f32 v[176:177], v[176:177], v[218:219] op_sel:[0,0] op_sel_hi:[1,0]
    v_pk_mul_f32 v[178:179], v[178:179], v[218:219] op_sel:[0,0] op_sel_hi:[1,0]
    v_pk_mul_f32 v[180:181], v[180:181], v[218:219] op_sel:[0,0] op_sel_hi:[1,0]
    v_pk_mul_f32 v[182:183], v[182:183], v[218:219] op_sel:[0,0] op_sel_hi:[1,0]
    v_cvt_pk_bf16_f32 v24, v176, v177
    v_cvt_pk_bf16_f32 v25, v178, v179
    v_cvt_pk_bf16_f32 v26, v180, v181
    v_cvt_pk_bf16_f32 v27, v182, v183
    v_accvgpr_read_b32 v176, a3
    v_accvgpr_read_b32 v177, a7
    v_accvgpr_read_b32 v178, a11
    v_accvgpr_read_b32 v179, a15
    v_accvgpr_read_b32 v180, a19
    v_accvgpr_read_b32 v181, a23
    v_accvgpr_read_b32 v182, a27
    v_accvgpr_read_b32 v183, a31
    v_pk_mul_f32 v[176:177], v[176:177], v[218:219] op_sel:[0,1] op_sel_hi:[1,1]
    v_pk_mul_f32 v[178:179], v[178:179], v[218:219] op_sel:[0,1] op_sel_hi:[1,1]
    v_pk_mul_f32 v[180:181], v[180:181], v[218:219] op_sel:[0,1] op_sel_hi:[1,1]
    v_pk_mul_f32 v[182:183], v[182:183], v[218:219] op_sel:[0,1] op_sel_hi:[1,1]
    v_cvt_pk_bf16_f32 v28, v176, v177
    v_cvt_pk_bf16_f32 v29, v178, v179
    v_cvt_pk_bf16_f32 v30, v180, v181
    v_cvt_pk_bf16_f32 v31, v182, v183
    v_mfma_f32_16x16x32_bf16 v[176:179], a[128:131], v[48:51], v[224:227]
    ds_write_b128 v2, v[16:19] offset:0
    v_mfma_f32_16x16x32_bf16 v[176:179], a[132:135], v[52:55], v[176:179]
    v_exp_f32 v184, v184
    v_mfma_f32_16x16x32_bf16 v[176:179], a[136:139], v[56:59], v[176:179]
    ds_write_b128 v3, v[20:23] offset:256
    v_mfma_f32_16x16x32_bf16 v[176:179], a[140:143], v[60:63], v[176:179]
    v_exp_f32 v185, v185
    v_mfma_f32_16x16x32_bf16 v[180:183], a[156:159], v[60:63], v[224:227]
    ds_write_b128 v2, v[24:27] offset:512
    v_exp_f32 v186, v186
    v_mfma_f32_16x16x32_bf16 v[180:183], a[152:155], v[56:59], v[180:183]
    v_add_f32 v253, v253, v184
    v_add_f32 v253, v253, v185
    v_mfma_f32_16x16x32_bf16 v[180:183], a[148:151], v[52:55], v[180:183]
    ds_write_b128 v3, v[28:31] offset:768
    v_exp_f32 v187, v187
    v_mfma_f32_16x16x32_bf16 v[180:183], a[144:147], v[48:51], v[180:183]
    v_cvt_pk_bf16_f32 v196, v184, v185
    v_add_f32 v253, v253, v186
    v_mfma_f32_16x16x32_bf16 a[32:35], v[192:195], a[192:195], a[32:35]
    v_exp_f32 v188, v188
    v_mfma_f32_16x16x32_bf16 a[36:39], v[192:195], a[196:199], a[36:39]
    ds_read_b64_tr_b16 a[0:1], v6 offset:0
    ds_read_b64_tr_b16 a[2:3], v7 offset:0
    v_add_f32 v253, v253, v187
    v_cvt_pk_bf16_f32 v197, v186, v187
    v_mfma_f32_16x16x32_bf16 a[40:43], v[192:195], a[200:203], a[40:43]
    ds_read_b64_tr_b16 a[4:5], v6 offset:1024
    v_exp_f32 v189, v189
    v_mfma_f32_16x16x32_bf16 a[44:47], v[192:195], a[204:207], a[44:47]
    ds_read_b64_tr_b16 a[6:7], v7 offset:1024
    ds_read_b64_tr_b16 a[8:9], v6 offset:2048
    v_exp_f32 v190, v190
    v_mfma_f32_16x16x32_bf16 a[48:51], v[192:195], a[208:211], a[48:51]
    ds_read_b64_tr_b16 a[10:11], v7 offset:2048
    v_add_f32 v253, v253, v188
    v_add_f32 v253, v253, v189
    v_mfma_f32_16x16x32_bf16 a[52:55], v[192:195], a[212:215], a[52:55]
    ds_read_b64_tr_b16 a[12:13], v6 offset:3072
    ds_read_b64_tr_b16 a[14:15], v7 offset:3072
    v_exp_f32 v191, v191
    v_mfma_f32_16x16x32_bf16 a[56:59], v[192:195], a[216:219], a[56:59]
    v_cvt_pk_bf16_f32 v198, v188, v189
    v_add_f32 v253, v253, v190
    v_mfma_f32_16x16x32_bf16 a[60:63], v[192:195], a[220:223], a[60:63]
    v_add_f32 v253, v253, v191
    v_cvt_pk_bf16_f32 v199, v190, v191
    v_mfma_f32_16x16x32_bf16 v[184:187], a[160:163], v[48:51], v[224:227]
    v_mov_b32 v220, v253
    v_exp_f32 v176, v176
    v_mfma_f32_16x16x32_bf16 v[184:187], a[164:167], v[52:55], v[184:187]
    s_waitcnt lgkmcnt(0)
    buffer_store_dwordx4 a[0:3], v200, s[20:23], s88 offen offset:0 sc1
    v_mfma_f32_16x16x32_bf16 v[184:187], a[168:171], v[56:59], v[184:187]
    v_permlane16_swap_b32 v253, v220
    v_exp_f32 v177, v177
    v_mfma_f32_16x16x32_bf16 v[184:187], a[172:175], v[60:63], v[184:187]
    v_add_f32 v253, v253, v220
    v_mov_b32 v220, v253
    v_exp_f32 v178, v178
    v_add_f32 v254, v254, v176
    v_mfma_f32_16x16x32_bf16 v[188:191], a[188:191], v[60:63], v[224:227]
    v_add_f32 v254, v254, v177
    v_exp_f32 v179, v179
    v_cvt_pk_bf16_f32 v192, v176, v177
    v_mfma_f32_16x16x32_bf16 v[188:191], a[184:187], v[56:59], v[188:191]
    buffer_store_dwordx4 a[4:7], v200, s[20:23], s88 offen offset:1024 sc1
    v_permlane32_swap_b32 v253, v220
    v_mfma_f32_16x16x32_bf16 v[188:191], a[180:183], v[52:55], v[188:191]
    v_add_f32 v253, v253, v220
    v_subrev_u32 v220, s57, v253
    v_add_f32 v254, v254, v178
    v_mfma_f32_16x16x32_bf16 v[188:191], a[176:179], v[48:51], v[188:191]
    v_cmp_le_u32 vcc, s36, v220
    v_rcp_f32 v253, v253
    v_mfma_f32_16x16x32_bf16 a[32:35], v[196:199], a[224:227], a[32:35]
    ds_bpermute_b32 v220, v4, v253 offset:0
    v_exp_f32 v180, v180
    v_mfma_f32_16x16x32_bf16 a[36:39], v[196:199], a[228:231], a[36:39]
    s_cmp_lg_u64 vcc, 0
    buffer_store_dwordx4 a[8:11], v200, s[20:23], s88 offen offset:2048 sc1
    ds_bpermute_b32 v221, v4, v253 offset:4
    v_mfma_f32_16x16x32_bf16 a[40:43], v[196:199], a[232:235], a[40:43]
    s_cselect_b32 s56, 128, 0
    ds_bpermute_b32 v222, v4, v253 offset:8
    v_mfma_f32_16x16x32_bf16 a[44:47], v[196:199], a[236:239], a[44:47]
    s_or_b32 s27, s27, s56
    ds_bpermute_b32 v223, v4, v253 offset:12
    v_add_f32 v254, v254, v179
    v_cvt_pk_bf16_f32 v193, v178, v179
    v_mfma_f32_16x16x32_bf16 a[48:51], v[196:199], a[240:243], a[48:51]
    v_exp_f32 v181, v181
    v_exp_f32 v182, v182
    v_mfma_f32_16x16x32_bf16 a[52:55], v[196:199], a[244:247], a[52:55]
    v_add_f32 v254, v254, v180
    v_add_f32 v254, v254, v181
    v_mfma_f32_16x16x32_bf16 a[56:59], v[196:199], a[248:251], a[56:59]
    v_exp_f32 v183, v183
    v_cvt_pk_bf16_f32 v194, v180, v181
    v_add_f32 v254, v254, v182
    v_add_f32 v254, v254, v183
    v_mfma_f32_16x16x32_bf16 a[60:63], v[196:199], a[252:255], a[60:63]
    buffer_store_dwordx4 a[12:15], v200, s[20:23], s88 offen offset:3072 sc1
    v_cvt_pk_bf16_f32 v195, v182, v183
    s_nop 3
.p2align 3
    v_accvgpr_read_b32 v176, a32
    v_accvgpr_read_b32 v177, a36
    v_accvgpr_read_b32 v178, a40
    v_accvgpr_read_b32 v179, a44
    v_accvgpr_read_b32 v180, a48
    v_accvgpr_read_b32 v181, a52
    v_accvgpr_read_b32 v182, a56
    v_accvgpr_read_b32 v183, a60
    s_waitcnt lgkmcnt(0)
.p2align 3
    v_pk_mul_f32 v[176:177], v[176:177], v[220:221] op_sel:[0,0] op_sel_hi:[1,0]
    v_pk_mul_f32 v[178:179], v[178:179], v[220:221] op_sel:[0,0] op_sel_hi:[1,0]
    v_pk_mul_f32 v[180:181], v[180:181], v[220:221] op_sel:[0,0] op_sel_hi:[1,0]
    v_pk_mul_f32 v[182:183], v[182:183], v[220:221] op_sel:[0,0] op_sel_hi:[1,0]
    v_cvt_pk_bf16_f32 v32, v176, v177
    v_cvt_pk_bf16_f32 v33, v178, v179
    v_cvt_pk_bf16_f32 v34, v180, v181
    v_cvt_pk_bf16_f32 v35, v182, v183
    v_accvgpr_read_b32 v176, a33
    v_accvgpr_read_b32 v177, a37
    v_accvgpr_read_b32 v178, a41
    v_accvgpr_read_b32 v179, a45
    v_accvgpr_read_b32 v180, a49
    v_accvgpr_read_b32 v181, a53
    v_accvgpr_read_b32 v182, a57
    v_accvgpr_read_b32 v183, a61
    v_pk_mul_f32 v[176:177], v[176:177], v[220:221] op_sel:[0,1] op_sel_hi:[1,1]
    v_pk_mul_f32 v[178:179], v[178:179], v[220:221] op_sel:[0,1] op_sel_hi:[1,1]
    v_pk_mul_f32 v[180:181], v[180:181], v[220:221] op_sel:[0,1] op_sel_hi:[1,1]
    v_pk_mul_f32 v[182:183], v[182:183], v[220:221] op_sel:[0,1] op_sel_hi:[1,1]
    v_cvt_pk_bf16_f32 v36, v176, v177
    v_cvt_pk_bf16_f32 v37, v178, v179
    v_cvt_pk_bf16_f32 v38, v180, v181
    v_cvt_pk_bf16_f32 v39, v182, v183
    v_accvgpr_read_b32 v176, a34
    v_accvgpr_read_b32 v177, a38
    v_accvgpr_read_b32 v178, a42
    v_accvgpr_read_b32 v179, a46
    v_accvgpr_read_b32 v180, a50
    v_accvgpr_read_b32 v181, a54
    v_accvgpr_read_b32 v182, a58
    v_accvgpr_read_b32 v183, a62
    v_pk_mul_f32 v[176:177], v[176:177], v[222:223] op_sel:[0,0] op_sel_hi:[1,0]
    v_pk_mul_f32 v[178:179], v[178:179], v[222:223] op_sel:[0,0] op_sel_hi:[1,0]
    v_pk_mul_f32 v[180:181], v[180:181], v[222:223] op_sel:[0,0] op_sel_hi:[1,0]
    v_pk_mul_f32 v[182:183], v[182:183], v[222:223] op_sel:[0,0] op_sel_hi:[1,0]
    v_cvt_pk_bf16_f32 v40, v176, v177
    v_cvt_pk_bf16_f32 v41, v178, v179
    v_cvt_pk_bf16_f32 v42, v180, v181
    v_cvt_pk_bf16_f32 v43, v182, v183
    v_accvgpr_read_b32 v176, a35
    v_accvgpr_read_b32 v177, a39
    v_accvgpr_read_b32 v178, a43
    v_accvgpr_read_b32 v179, a47
    v_accvgpr_read_b32 v180, a51
    v_accvgpr_read_b32 v181, a55
    v_accvgpr_read_b32 v182, a59
    v_accvgpr_read_b32 v183, a63
    v_pk_mul_f32 v[176:177], v[176:177], v[222:223] op_sel:[0,1] op_sel_hi:[1,1]
    v_pk_mul_f32 v[178:179], v[178:179], v[222:223] op_sel:[0,1] op_sel_hi:[1,1]
    v_pk_mul_f32 v[180:181], v[180:181], v[222:223] op_sel:[0,1] op_sel_hi:[1,1]
    v_pk_mul_f32 v[182:183], v[182:183], v[222:223] op_sel:[0,1] op_sel_hi:[1,1]
    v_cvt_pk_bf16_f32 v44, v176, v177
    v_cvt_pk_bf16_f32 v45, v178, v179
    v_cvt_pk_bf16_f32 v46, v180, v181
    v_cvt_pk_bf16_f32 v47, v182, v183
    v_mfma_f32_16x16x32_bf16 v[176:179], a[128:131], v[64:67], v[228:231]
    ds_write_b128 v2, v[32:35] offset:4096
    v_mfma_f32_16x16x32_bf16 v[176:179], a[132:135], v[68:71], v[176:179]
    v_exp_f32 v184, v184
    v_mfma_f32_16x16x32_bf16 v[176:179], a[136:139], v[72:75], v[176:179]
    ds_write_b128 v3, v[36:39] offset:4352
    v_mfma_f32_16x16x32_bf16 v[176:179], a[140:143], v[76:79], v[176:179]
    v_exp_f32 v185, v185
    v_mfma_f32_16x16x32_bf16 v[180:183], a[156:159], v[76:79], v[228:231]
    ds_write_b128 v2, v[40:43] offset:4608
    v_exp_f32 v186, v186
    v_mfma_f32_16x16x32_bf16 v[180:183], a[152:155], v[72:75], v[180:183]
    v_add_f32 v254, v254, v184
    v_add_f32 v254, v254, v185
    v_mfma_f32_16x16x32_bf16 v[180:183], a[148:151], v[68:71], v[180:183]
    ds_write_b128 v3, v[44:47] offset:4864
    v_exp_f32 v187, v187
    v_mfma_f32_16x16x32_bf16 v[180:183], a[144:147], v[64:67], v[180:183]
    v_cvt_pk_bf16_f32 v196, v184, v185
    v_add_f32 v254, v254, v186
    v_mfma_f32_16x16x32_bf16 a[64:67], v[192:195], a[192:195], a[64:67]
    v_exp_f32 v188, v188
    v_mfma_f32_16x16x32_bf16 a[68:71], v[192:195], a[196:199], a[68:71]
    ds_read_b64_tr_b16 a[32:33], v6 offset:4096
    ds_read_b64_tr_b16 a[34:35], v7 offset:4096
    v_add_f32 v254, v254, v187
    v_cvt_pk_bf16_f32 v197, v186, v187
    v_mfma_f32_16x16x32_bf16 a[72:75], v[192:195], a[200:203], a[72:75]
    ds_read_b64_tr_b16 a[36:37], v6 offset:5120
    v_exp_f32 v189, v189
    v_mfma_f32_16x16x32_bf16 a[76:79], v[192:195], a[204:207], a[76:79]
    ds_read_b64_tr_b16 a[38:39], v7 offset:5120
    ds_read_b64_tr_b16 a[40:41], v6 offset:6144
    v_exp_f32 v190, v190
    v_mfma_f32_16x16x32_bf16 a[80:83], v[192:195], a[208:211], a[80:83]
    ds_read_b64_tr_b16 a[42:43], v7 offset:6144
    v_add_f32 v254, v254, v188
    v_add_f32 v254, v254, v189
    v_mfma_f32_16x16x32_bf16 a[84:87], v[192:195], a[212:215], a[84:87]
    ds_read_b64_tr_b16 a[44:45], v6 offset:7168
    ds_read_b64_tr_b16 a[46:47], v7 offset:7168
    v_exp_f32 v191, v191
    v_mfma_f32_16x16x32_bf16 a[88:91], v[192:195], a[216:219], a[88:91]
    v_cvt_pk_bf16_f32 v198, v188, v189
    v_add_f32 v254, v254, v190
    v_mfma_f32_16x16x32_bf16 a[92:95], v[192:195], a[220:223], a[92:95]
    v_add_f32 v254, v254, v191
    v_cvt_pk_bf16_f32 v199, v190, v191
    v_mfma_f32_16x16x32_bf16 v[184:187], a[160:163], v[64:67], v[228:231]
    v_mov_b32 v224, v254
    v_exp_f32 v176, v176
    v_mfma_f32_16x16x32_bf16 v[184:187], a[164:167], v[68:71], v[184:187]
    s_waitcnt lgkmcnt(0)
    buffer_store_dwordx4 a[32:35], v200, s[20:23], s89 offen offset:0 sc1
    v_mfma_f32_16x16x32_bf16 v[184:187], a[168:171], v[72:75], v[184:187]
    v_permlane16_swap_b32 v254, v224
    v_exp_f32 v177, v177
    v_mfma_f32_16x16x32_bf16 v[184:187], a[172:175], v[76:79], v[184:187]
    v_add_f32 v254, v254, v224
    v_mov_b32 v224, v254
    v_exp_f32 v178, v178
    v_add_f32 v255, v255, v176
    v_mfma_f32_16x16x32_bf16 v[188:191], a[188:191], v[76:79], v[228:231]
    v_add_f32 v255, v255, v177
    v_exp_f32 v179, v179
    v_cvt_pk_bf16_f32 v192, v176, v177
    v_mfma_f32_16x16x32_bf16 v[188:191], a[184:187], v[72:75], v[188:191]
    buffer_store_dwordx4 a[36:39], v200, s[20:23], s89 offen offset:1024 sc1
    v_permlane32_swap_b32 v254, v224
    v_mfma_f32_16x16x32_bf16 v[188:191], a[180:183], v[68:71], v[188:191]
    v_add_f32 v254, v254, v224
    v_subrev_u32 v224, s57, v254
    v_add_f32 v255, v255, v178
    v_mfma_f32_16x16x32_bf16 v[188:191], a[176:179], v[64:67], v[188:191]
    v_cmp_le_u32 vcc, s36, v224
    v_rcp_f32 v254, v254
    v_mfma_f32_16x16x32_bf16 a[64:67], v[196:199], a[224:227], a[64:67]
    ds_bpermute_b32 v224, v4, v254 offset:0
    v_exp_f32 v180, v180
    v_mfma_f32_16x16x32_bf16 a[68:71], v[196:199], a[228:231], a[68:71]
    s_cmp_lg_u64 vcc, 0
    buffer_store_dwordx4 a[40:43], v200, s[20:23], s89 offen offset:2048 sc1
    ds_bpermute_b32 v225, v4, v254 offset:4
    v_mfma_f32_16x16x32_bf16 a[72:75], v[196:199], a[232:235], a[72:75]
    s_cselect_b32 s56, 256, 0
    ds_bpermute_b32 v226, v4, v254 offset:8
    v_mfma_f32_16x16x32_bf16 a[76:79], v[196:199], a[236:239], a[76:79]
    s_or_b32 s27, s27, s56
    ds_bpermute_b32 v227, v4, v254 offset:12
    v_add_f32 v255, v255, v179
    v_cvt_pk_bf16_f32 v193, v178, v179
    v_mfma_f32_16x16x32_bf16 a[80:83], v[196:199], a[240:243], a[80:83]
    v_exp_f32 v181, v181
    v_exp_f32 v182, v182
    v_mfma_f32_16x16x32_bf16 a[84:87], v[196:199], a[244:247], a[84:87]
    v_add_f32 v255, v255, v180
    v_add_f32 v255, v255, v181
    v_mfma_f32_16x16x32_bf16 a[88:91], v[196:199], a[248:251], a[88:91]
    v_exp_f32 v183, v183
    v_cvt_pk_bf16_f32 v194, v180, v181
    v_add_f32 v255, v255, v182
    v_add_f32 v255, v255, v183
    v_mfma_f32_16x16x32_bf16 a[92:95], v[196:199], a[252:255], a[92:95]
    buffer_store_dwordx4 a[44:47], v200, s[20:23], s89 offen offset:3072 sc1
    v_cvt_pk_bf16_f32 v195, v182, v183
    s_nop 3
.p2align 3
    v_accvgpr_read_b32 v176, a64
    v_accvgpr_read_b32 v177, a68
    v_accvgpr_read_b32 v178, a72
    v_accvgpr_read_b32 v179, a76
    v_accvgpr_read_b32 v180, a80
    v_accvgpr_read_b32 v181, a84
    v_accvgpr_read_b32 v182, a88
    v_accvgpr_read_b32 v183, a92
    s_waitcnt lgkmcnt(0)
.p2align 3
    v_pk_mul_f32 v[176:177], v[176:177], v[224:225] op_sel:[0,0] op_sel_hi:[1,0]
    v_pk_mul_f32 v[178:179], v[178:179], v[224:225] op_sel:[0,0] op_sel_hi:[1,0]
    v_pk_mul_f32 v[180:181], v[180:181], v[224:225] op_sel:[0,0] op_sel_hi:[1,0]
    v_pk_mul_f32 v[182:183], v[182:183], v[224:225] op_sel:[0,0] op_sel_hi:[1,0]
    v_cvt_pk_bf16_f32 v48, v176, v177
    v_cvt_pk_bf16_f32 v49, v178, v179
    v_cvt_pk_bf16_f32 v50, v180, v181
    v_cvt_pk_bf16_f32 v51, v182, v183
    v_accvgpr_read_b32 v176, a65
    v_accvgpr_read_b32 v177, a69
    v_accvgpr_read_b32 v178, a73
    v_accvgpr_read_b32 v179, a77
    v_accvgpr_read_b32 v180, a81
    v_accvgpr_read_b32 v181, a85
    v_accvgpr_read_b32 v182, a89
    v_accvgpr_read_b32 v183, a93
    v_pk_mul_f32 v[176:177], v[176:177], v[224:225] op_sel:[0,1] op_sel_hi:[1,1]
    v_pk_mul_f32 v[178:179], v[178:179], v[224:225] op_sel:[0,1] op_sel_hi:[1,1]
    v_pk_mul_f32 v[180:181], v[180:181], v[224:225] op_sel:[0,1] op_sel_hi:[1,1]
    v_pk_mul_f32 v[182:183], v[182:183], v[224:225] op_sel:[0,1] op_sel_hi:[1,1]
    v_cvt_pk_bf16_f32 v52, v176, v177
    v_cvt_pk_bf16_f32 v53, v178, v179
    v_cvt_pk_bf16_f32 v54, v180, v181
    v_cvt_pk_bf16_f32 v55, v182, v183
    v_accvgpr_read_b32 v176, a66
    v_accvgpr_read_b32 v177, a70
    v_accvgpr_read_b32 v178, a74
    v_accvgpr_read_b32 v179, a78
    v_accvgpr_read_b32 v180, a82
    v_accvgpr_read_b32 v181, a86
    v_accvgpr_read_b32 v182, a90
    v_accvgpr_read_b32 v183, a94
    v_pk_mul_f32 v[176:177], v[176:177], v[226:227] op_sel:[0,0] op_sel_hi:[1,0]
    v_pk_mul_f32 v[178:179], v[178:179], v[226:227] op_sel:[0,0] op_sel_hi:[1,0]
    v_pk_mul_f32 v[180:181], v[180:181], v[226:227] op_sel:[0,0] op_sel_hi:[1,0]
    v_pk_mul_f32 v[182:183], v[182:183], v[226:227] op_sel:[0,0] op_sel_hi:[1,0]
    v_cvt_pk_bf16_f32 v56, v176, v177
    v_cvt_pk_bf16_f32 v57, v178, v179
    v_cvt_pk_bf16_f32 v58, v180, v181
    v_cvt_pk_bf16_f32 v59, v182, v183
    v_accvgpr_read_b32 v176, a67
    v_accvgpr_read_b32 v177, a71
    v_accvgpr_read_b32 v178, a75
    v_accvgpr_read_b32 v179, a79
    v_accvgpr_read_b32 v180, a83
    v_accvgpr_read_b32 v181, a87
    v_accvgpr_read_b32 v182, a91
    v_accvgpr_read_b32 v183, a95
    v_pk_mul_f32 v[176:177], v[176:177], v[226:227] op_sel:[0,1] op_sel_hi:[1,1]
    v_pk_mul_f32 v[178:179], v[178:179], v[226:227] op_sel:[0,1] op_sel_hi:[1,1]
    v_pk_mul_f32 v[180:181], v[180:181], v[226:227] op_sel:[0,1] op_sel_hi:[1,1]
    v_pk_mul_f32 v[182:183], v[182:183], v[226:227] op_sel:[0,1] op_sel_hi:[1,1]
    v_cvt_pk_bf16_f32 v60, v176, v177
    v_cvt_pk_bf16_f32 v61, v178, v179
    v_cvt_pk_bf16_f32 v62, v180, v181
    v_cvt_pk_bf16_f32 v63, v182, v183
    ds_write_b128 v2, v[48:51] offset:8192
    ds_write_b128 v3, v[52:55] offset:8448
    ds_write_b128 v2, v[56:59] offset:8704
    ds_write_b128 v3, v[60:63] offset:8960
    ds_read_b64_tr_b16 a[64:65], v6 offset:8192
    ds_read_b64_tr_b16 a[66:67], v7 offset:8192
    ds_read_b64_tr_b16 a[68:69], v6 offset:9216
    ds_read_b64_tr_b16 a[70:71], v7 offset:9216
    ds_read_b64_tr_b16 a[72:73], v6 offset:10240
    ds_read_b64_tr_b16 a[74:75], v7 offset:10240
    ds_read_b64_tr_b16 a[76:77], v6 offset:11264
    ds_read_b64_tr_b16 a[78:79], v7 offset:11264
    s_nop 1
    v_mfma_f32_16x16x32_bf16 a[96:99], v[192:195], a[192:195], a[96:99]
    v_mfma_f32_16x16x32_bf16 a[100:103], v[192:195], a[196:199], a[100:103]
    v_exp_f32 v184, v184
    v_exp_f32 v185, v185
    v_mfma_f32_16x16x32_bf16 a[104:107], v[192:195], a[200:203], a[104:107]
    v_exp_f32 v186, v186
    v_add_f32 v255, v255, v184
    v_add_f32 v255, v255, v185
    v_mfma_f32_16x16x32_bf16 a[108:111], v[192:195], a[204:207], a[108:111]
    s_waitcnt lgkmcnt(0)
    buffer_store_dwordx4 a[64:67], v200, s[20:23], s90 offen offset:0 sc1
    v_exp_f32 v187, v187
    v_cvt_pk_bf16_f32 v196, v184, v185
    v_add_f32 v255, v255, v186
    v_mfma_f32_16x16x32_bf16 a[112:115], v[192:195], a[208:211], a[112:115]
    buffer_store_dwordx4 a[68:71], v200, s[20:23], s90 offen offset:1024 sc1
    v_exp_f32 v188, v188
    v_add_f32 v255, v255, v187
    v_cvt_pk_bf16_f32 v197, v186, v187
    v_mfma_f32_16x16x32_bf16 a[116:119], v[192:195], a[212:215], a[116:119]
    buffer_store_dwordx4 a[72:75], v200, s[20:23], s90 offen offset:2048 sc1
    v_exp_f32 v189, v189
    v_exp_f32 v190, v190
    v_mfma_f32_16x16x32_bf16 a[120:123], v[192:195], a[216:219], a[120:123]
    buffer_store_dwordx4 a[76:79], v200, s[20:23], s90 offen offset:3072 sc1
    v_add_f32 v255, v255, v188
    v_add_f32 v255, v255, v189
    v_exp_f32 v191, v191
    v_mfma_f32_16x16x32_bf16 a[124:127], v[192:195], a[220:223], a[124:127]
    v_cvt_pk_bf16_f32 v198, v188, v189
    v_add_f32 v255, v255, v190
    v_add_f32 v255, v255, v191
    v_cvt_pk_bf16_f32 v199, v190, v191
    s_nop 1
    v_mfma_f32_16x16x32_bf16 a[96:99], v[196:199], a[224:227], a[96:99]
    v_mov_b32 v228, v255
    v_mfma_f32_16x16x32_bf16 a[100:103], v[196:199], a[228:231], a[100:103]
    s_nop 1
    v_permlane16_swap_b32 v255, v228
    v_mfma_f32_16x16x32_bf16 a[104:107], v[196:199], a[232:235], a[104:107]
    v_add_f32 v255, v255, v228
    v_mov_b32 v228, v255
    v_mfma_f32_16x16x32_bf16 a[108:111], v[196:199], a[236:239], a[108:111]
    s_nop 1
    v_permlane32_swap_b32 v255, v228
    v_mfma_f32_16x16x32_bf16 a[112:115], v[196:199], a[240:243], a[112:115]
    v_add_f32 v255, v255, v228
    v_subrev_u32 v228, s57, v255
    v_mfma_f32_16x16x32_bf16 a[116:119], v[196:199], a[244:247], a[116:119]
    v_cmp_le_u32 vcc, s36, v228
    v_rcp_f32 v255, v255
    v_mfma_f32_16x16x32_bf16 a[120:123], v[196:199], a[248:251], a[120:123]
    ds_bpermute_b32 v228, v4, v255 offset:0
    ds_bpermute_b32 v229, v4, v255 offset:4
    v_mfma_f32_16x16x32_bf16 a[124:127], v[196:199], a[252:255], a[124:127]
    ds_bpermute_b32 v230, v4, v255 offset:8
    ds_bpermute_b32 v231, v4, v255 offset:12
    s_cmp_lg_u64 vcc, 0
    s_cselect_b32 s56, 512, 0
    s_or_b32 s27, s27, s56
    s_nop 3
.p2align 3
    v_accvgpr_read_b32 v176, a96
    v_accvgpr_read_b32 v177, a100
    v_accvgpr_read_b32 v178, a104
    v_accvgpr_read_b32 v179, a108
    v_accvgpr_read_b32 v180, a112
    v_accvgpr_read_b32 v181, a116
    v_accvgpr_read_b32 v182, a120
    v_accvgpr_read_b32 v183, a124
    s_waitcnt lgkmcnt(0)
.p2align 3
    v_pk_mul_f32 v[176:177], v[176:177], v[228:229] op_sel:[0,0] op_sel_hi:[1,0]
    v_pk_mul_f32 v[178:179], v[178:179], v[228:229] op_sel:[0,0] op_sel_hi:[1,0]
    v_pk_mul_f32 v[180:181], v[180:181], v[228:229] op_sel:[0,0] op_sel_hi:[1,0]
    v_pk_mul_f32 v[182:183], v[182:183], v[228:229] op_sel:[0,0] op_sel_hi:[1,0]
    v_cvt_pk_bf16_f32 v64, v176, v177
    v_cvt_pk_bf16_f32 v65, v178, v179
    v_cvt_pk_bf16_f32 v66, v180, v181
    v_cvt_pk_bf16_f32 v67, v182, v183
    v_accvgpr_read_b32 v176, a97
    v_accvgpr_read_b32 v177, a101
    v_accvgpr_read_b32 v178, a105
    v_accvgpr_read_b32 v179, a109
    v_accvgpr_read_b32 v180, a113
    v_accvgpr_read_b32 v181, a117
    v_accvgpr_read_b32 v182, a121
    v_accvgpr_read_b32 v183, a125
    v_pk_mul_f32 v[176:177], v[176:177], v[228:229] op_sel:[0,1] op_sel_hi:[1,1]
    v_pk_mul_f32 v[178:179], v[178:179], v[228:229] op_sel:[0,1] op_sel_hi:[1,1]
    v_pk_mul_f32 v[180:181], v[180:181], v[228:229] op_sel:[0,1] op_sel_hi:[1,1]
    v_pk_mul_f32 v[182:183], v[182:183], v[228:229] op_sel:[0,1] op_sel_hi:[1,1]
    v_cvt_pk_bf16_f32 v68, v176, v177
    v_cvt_pk_bf16_f32 v69, v178, v179
    v_cvt_pk_bf16_f32 v70, v180, v181
    v_cvt_pk_bf16_f32 v71, v182, v183
    v_accvgpr_read_b32 v176, a98
    v_accvgpr_read_b32 v177, a102
    v_accvgpr_read_b32 v178, a106
    v_accvgpr_read_b32 v179, a110
    v_accvgpr_read_b32 v180, a114
    v_accvgpr_read_b32 v181, a118
    v_accvgpr_read_b32 v182, a122
    v_accvgpr_read_b32 v183, a126
    v_pk_mul_f32 v[176:177], v[176:177], v[230:231] op_sel:[0,0] op_sel_hi:[1,0]
    v_pk_mul_f32 v[178:179], v[178:179], v[230:231] op_sel:[0,0] op_sel_hi:[1,0]
    v_pk_mul_f32 v[180:181], v[180:181], v[230:231] op_sel:[0,0] op_sel_hi:[1,0]
    v_pk_mul_f32 v[182:183], v[182:183], v[230:231] op_sel:[0,0] op_sel_hi:[1,0]
    v_cvt_pk_bf16_f32 v72, v176, v177
    v_cvt_pk_bf16_f32 v73, v178, v179
    v_cvt_pk_bf16_f32 v74, v180, v181
    v_cvt_pk_bf16_f32 v75, v182, v183
    v_accvgpr_read_b32 v176, a99
    v_accvgpr_read_b32 v177, a103
    v_accvgpr_read_b32 v178, a107
    v_accvgpr_read_b32 v179, a111
    v_accvgpr_read_b32 v180, a115
    v_accvgpr_read_b32 v181, a119
    v_accvgpr_read_b32 v182, a123
    v_accvgpr_read_b32 v183, a127
    v_pk_mul_f32 v[176:177], v[176:177], v[230:231] op_sel:[0,1] op_sel_hi:[1,1]
    v_pk_mul_f32 v[178:179], v[178:179], v[230:231] op_sel:[0,1] op_sel_hi:[1,1]
    v_pk_mul_f32 v[180:181], v[180:181], v[230:231] op_sel:[0,1] op_sel_hi:[1,1]
    v_pk_mul_f32 v[182:183], v[182:183], v[230:231] op_sel:[0,1] op_sel_hi:[1,1]
    v_cvt_pk_bf16_f32 v76, v176, v177
    v_cvt_pk_bf16_f32 v77, v178, v179
    v_cvt_pk_bf16_f32 v78, v180, v181
    v_cvt_pk_bf16_f32 v79, v182, v183
    ds_write_b128 v2, v[64:67] offset:12288
    ds_write_b128 v3, v[68:71] offset:12544
    ds_write_b128 v2, v[72:75] offset:12800
    ds_write_b128 v3, v[76:79] offset:13056
    ds_read_b64_tr_b16 a[96:97], v6 offset:12288
    ds_read_b64_tr_b16 a[98:99], v7 offset:12288
    ds_read_b64_tr_b16 a[100:101], v6 offset:13312
    ds_read_b64_tr_b16 a[102:103], v7 offset:13312
    ds_read_b64_tr_b16 a[104:105], v6 offset:14336
    ds_read_b64_tr_b16 a[106:107], v7 offset:14336
    ds_read_b64_tr_b16 a[108:109], v6 offset:15360
    ds_read_b64_tr_b16 a[110:111], v7 offset:15360
    s_waitcnt lgkmcnt(0)
    buffer_store_dwordx4 a[96:99], v200, s[20:23], s91 offen offset:0 sc1
    buffer_store_dwordx4 a[100:103], v200, s[20:23], s91 offen offset:1024 sc1
    buffer_store_dwordx4 a[104:107], v200, s[20:23], s91 offen offset:2048 sc1
    buffer_store_dwordx4 a[108:111], v200, s[20:23], s91 offen offset:3072 sc1
    s_cmp_lg_u32 s27, 0
    s_cbranch_scc1 L_slow
    s_endpgm
L_start_w3:
    s_add_u32 s32, s25, 32768
    s_add_u32 s35, s32, 4096
    s_mov_b32 s33, 4
    s_mov_b32 s34, 0
    s_mov_b32 s37, 0x10000000
    s_waitcnt vmcnt(12)
    ds_read_b128 v[16:19], v8 offset:0
    ds_read_b128 v[20:23], v9 offset:0
    ds_read_b128 v[24:27], v10 offset:0
    ds_read_b128 v[28:31], v11 offset:0
    s_mov_b32 m0, s54
    s_add_u32 s54, s54, 4096
    buffer_load_dwordx4 v96, s[8:11], s53 offen offset:0 nt lds
    buffer_load_dwordx4 v97, s[8:11], s53 offen offset:1024 nt lds
    buffer_load_dwordx4 v98, s[8:11], s53 offen offset:2048 nt lds
    buffer_load_dwordx4 v99, s[8:11], s53 offen offset:3072 nt lds
    s_add_u32 s53, s53, 4096
    s_waitcnt lgkmcnt(0)
.p2align 3
    v_mfma_f32_4x4x4_16b_bf16 v[184:187], v[12:13], v[16:17], 0
    v_mfma_f32_4x4x4_16b_bf16 v[188:191], v[12:13], v[18:19], 0
    s_nop 0
.p2align 3
    v_mfma_f32_4x4x4_16b_bf16 v[184:187], v[14:15], v[16:17], v[184:187]
    v_mfma_f32_4x4x4_16b_bf16 v[192:195], v[12:13], v[20:21], 0
    v_mfma_f32_4x4x4_16b_bf16 v[188:191], v[14:15], v[18:19], v[188:191]
    v_mfma_f32_4x4x4_16b_bf16 v[216:219], v[12:13], v[22:23], 0
    s_nop 1
.p2align 3
    v_cvt_pk_bf16_f32 v16, v184, v185
    v_mfma_f32_4x4x4_16b_bf16 v[192:195], v[14:15], v[20:21], v[192:195]
    v_cvt_pk_bf16_f32 v17, v186, v187
    v_mfma_f32_4x4x4_16b_bf16 v[184:187], v[12:13], v[24:25], 0
    v_cvt_pk_bf16_f32 v18, v188, v189
    v_mfma_f32_4x4x4_16b_bf16 v[216:219], v[14:15], v[22:23], v[216:219]
    v_cvt_pk_bf16_f32 v19, v190, v191
    v_mfma_f32_4x4x4_16b_bf16 v[188:191], v[12:13], v[26:27], 0
    v_cvt_pk_bf16_f32 v20, v192, v193
    v_mfma_f32_4x4x4_16b_bf16 v[184:187], v[14:15], v[24:25], v[184:187]
    v_cvt_pk_bf16_f32 v21, v194, v195
    v_mfma_f32_4x4x4_16b_bf16 v[192:195], v[12:13], v[28:29], 0
    v_cvt_pk_bf16_f32 v22, v216, v217
    v_mfma_f32_4x4x4_16b_bf16 v[188:191], v[14:15], v[26:27], v[188:191]
    v_cvt_pk_bf16_f32 v23, v218, v219
    v_mfma_f32_4x4x4_16b_bf16 v[216:219], v[12:13], v[30:31], 0
    v_cvt_pk_bf16_f32 v24, v184, v185
    v_mfma_f32_4x4x4_16b_bf16 v[192:195], v[14:15], v[28:29], v[192:195]
    v_cvt_pk_bf16_f32 v25, v186, v187
    v_cvt_pk_bf16_f32 v26, v188, v189
    v_mfma_f32_4x4x4_16b_bf16 v[216:219], v[14:15], v[30:31], v[216:219]
    v_cvt_pk_bf16_f32 v27, v190, v191
    s_nop 0
.p2align 3
    v_cvt_pk_bf16_f32 v28, v192, v193
    v_cvt_pk_bf16_f32 v29, v194, v195
    s_nop 0
.p2align 3
    v_cvt_pk_bf16_f32 v30, v216, v217
    v_cvt_pk_bf16_f32 v31, v218, v219
    s_waitcnt vmcnt(12)
    s_barrier
    ds_read_b128 v[160:163], v4 offset:0
    ds_read_b128 v[164:167], v4 offset:64
    ds_read_b128 v[168:171], v4 offset:128
    ds_read_b128 v[172:175], v4 offset:192
    ds_read_b128 a[128:131], v240 offset:0
    ds_read_b128 a[132:135], v241 offset:0
    ds_read_b128 a[136:139], v242 offset:0
    ds_read_b128 a[140:143], v243 offset:0
    ds_read_b128 a[144:147], v240 offset:4096
    ds_read_b128 a[148:151], v241 offset:4096
    ds_read_b128 a[152:155], v242 offset:4096
    ds_read_b128 a[156:159], v243 offset:4096
    s_mov_b32 m0, s54
    s_add_u32 s54, s54, 4096
    buffer_load_dwordx4 v96, s[8:11], s53 offen offset:0 nt lds
    buffer_load_dwordx4 v97, s[8:11], s53 offen offset:1024 nt lds
    buffer_load_dwordx4 v98, s[8:11], s53 offen offset:2048 nt lds
    buffer_load_dwordx4 v99, s[8:11], s53 offen offset:3072 nt lds
    s_add_u32 s53, s53, 4096
    s_waitcnt lgkmcnt(8)
    v_mfma_f32_16x16x32_bf16 v[216:219], v[160:163], v[16:19], 0
    ds_read_b128 a[160:163], v240 offset:8192
    ds_read_b128 a[164:167], v241 offset:8192
    v_mfma_f32_16x16x32_bf16 v[216:219], v[164:167], v[20:23], v[216:219]
    ds_read_b128 a[168:171], v242 offset:8192
    ds_read_b128 a[172:175], v243 offset:8192
    v_mfma_f32_16x16x32_bf16 v[216:219], v[168:171], v[24:27], v[216:219]
    ds_read_b128 a[176:179], v240 offset:12288
    ds_read_b128 a[180:183], v241 offset:12288
    v_mfma_f32_16x16x32_bf16 v[216:219], v[172:175], v[28:31], v[216:219]
    ds_read_b128 a[184:187], v242 offset:12288
    ds_read_b128 a[188:191], v243 offset:12288
    s_nop 5
    v_sub_f32 v216, s61, v216
    v_sub_f32 v217, s61, v217
    v_sub_f32 v218, s61, v218
    v_sub_f32 v219, s61, v219
    s_waitcnt lgkmcnt(8)
    s_nop 0
    v_mfma_f32_16x16x32_bf16 v[176:179], a[128:131], v[16:19], v[216:219]
    v_mfma_f32_16x16x32_bf16 v[176:179], a[132:135], v[20:23], v[176:179]
    v_mfma_f32_16x16x32_bf16 v[176:179], a[136:139], v[24:27], v[176:179]
    v_mfma_f32_16x16x32_bf16 v[176:179], a[140:143], v[28:31], v[176:179]
    s_waitcnt vmcnt(12)
    ds_read_b128 v[32:35], v8 offset:4096
    ds_read_b128 v[36:39], v9 offset:4096
    v_mfma_f32_16x16x32_bf16 v[180:183], a[156:159], v[28:31], v[216:219]
    v_mfma_f32_16x16x32_bf16 v[180:183], a[152:155], v[24:27], v[180:183]
    ds_read_b128 v[40:43], v10 offset:4096
    ds_read_b128 v[44:47], v11 offset:4096
    v_mfma_f32_16x16x32_bf16 v[180:183], a[148:151], v[20:23], v[180:183]
    v_mfma_f32_16x16x32_bf16 v[180:183], a[144:147], v[16:19], v[180:183]
    s_waitcnt lgkmcnt(0)
.p2align 3
    v_mfma_f32_4x4x4_16b_bf16 v[184:187], v[12:13], v[32:33], 0
    v_mfma_f32_4x4x4_16b_bf16 v[188:191], v[12:13], v[34:35], 0
    s_nop 0
.p2align 3
    v_mfma_f32_4x4x4_16b_bf16 v[184:187], v[14:15], v[32:33], v[184:187]
    v_mfma_f32_4x4x4_16b_bf16 v[192:195], v[12:13], v[36:37], 0
    v_mfma_f32_4x4x4_16b_bf16 v[188:191], v[14:15], v[34:35], v[188:191]
    v_mfma_f32_4x4x4_16b_bf16 v[220:223], v[12:13], v[38:39], 0
    s_nop 1
.p2align 3
    v_cvt_pk_bf16_f32 v32, v184, v185
    v_mfma_f32_4x4x4_16b_bf16 v[192:195], v[14:15], v[36:37], v[192:195]
    v_cvt_pk_bf16_f32 v33, v186, v187
    v_mfma_f32_4x4x4_16b_bf16 v[184:187], v[12:13], v[40:41], 0
    v_cvt_pk_bf16_f32 v34, v188, v189
    v_mfma_f32_4x4x4_16b_bf16 v[220:223], v[14:15], v[38:39], v[220:223]
    v_cvt_pk_bf16_f32 v35, v190, v191
    v_mfma_f32_4x4x4_16b_bf16 v[188:191], v[12:13], v[42:43], 0
    v_cvt_pk_bf16_f32 v36, v192, v193
    v_mfma_f32_4x4x4_16b_bf16 v[184:187], v[14:15], v[40:41], v[184:187]
    v_cvt_pk_bf16_f32 v37, v194, v195
    v_mfma_f32_4x4x4_16b_bf16 v[192:195], v[12:13], v[44:45], 0
    v_cvt_pk_bf16_f32 v38, v220, v221
    v_mfma_f32_4x4x4_16b_bf16 v[188:191], v[14:15], v[42:43], v[188:191]
    v_cvt_pk_bf16_f32 v39, v222, v223
    v_mfma_f32_4x4x4_16b_bf16 v[220:223], v[12:13], v[46:47], 0
    v_cvt_pk_bf16_f32 v40, v184, v185
    v_mfma_f32_4x4x4_16b_bf16 v[192:195], v[14:15], v[44:45], v[192:195]
    v_cvt_pk_bf16_f32 v41, v186, v187
    v_cvt_pk_bf16_f32 v42, v188, v189
    v_mfma_f32_4x4x4_16b_bf16 v[220:223], v[14:15], v[46:47], v[220:223]
    v_cvt_pk_bf16_f32 v43, v190, v191
    s_nop 0
.p2align 3
    v_cvt_pk_bf16_f32 v44, v192, v193
    v_cvt_pk_bf16_f32 v45, v194, v195
    s_nop 0
.p2align 3
    v_cvt_pk_bf16_f32 v46, v220, v221
    v_cvt_pk_bf16_f32 v47, v222, v223
    s_waitcnt vmcnt(8)
    s_barrier
    v_mfma_f32_16x16x32_bf16 v[220:223], v[160:163], v[32:35], 0
    s_mov_b32 m0, s54
    s_add_u32 s54, s54, 4096
    buffer_load_dwordx4 v96, s[8:11], s53 offen offset:0 nt lds
    ds_read_b64_tr_b16 a[192:193], v244 offset:0
    ds_read_b64_tr_b16 a[194:195], v244 offset:4096
    ds_read_b64_tr_b16 a[196:197], v245 offset:0
    v_mfma_f32_16x16x32_bf16 v[220:223], v[164:167], v[36:39], v[220:223]
    buffer_load_dwordx4 v97, s[8:11], s53 offen offset:1024 nt lds
    ds_read_b64_tr_b16 a[198:199], v245 offset:4096
    ds_read_b64_tr_b16 a[200:201], v246 offset:0
    ds_read_b64_tr_b16 a[202:203], v246 offset:4096
    v_mfma_f32_16x16x32_bf16 v[220:223], v[168:171], v[40:43], v[220:223]
    buffer_load_dwordx4 v98, s[8:11], s53 offen offset:2048 nt lds
    ds_read_b64_tr_b16 a[204:205], v247 offset:0
    ds_read_b64_tr_b16 a[206:207], v247 offset:4096
    v_mfma_f32_16x16x32_bf16 v[220:223], v[172:175], v[44:47], v[220:223]
    buffer_load_dwordx4 v99, s[8:11], s53 offen offset:3072 nt lds
    s_add_u32 s53, s53, 4096
    ds_read_b64_tr_b16 a[208:209], v248 offset:0
    ds_read_b64_tr_b16 a[210:211], v248 offset:4096
    ds_read_b64_tr_b16 a[212:213], v249 offset:0
    v_mfma_f32_16x16x32_bf16 v[184:187], a[160:163], v[16:19], v[216:219]
    ds_read_b64_tr_b16 a[214:215], v249 offset:4096
    ds_read_b64_tr_b16 a[216:217], v250 offset:0
    ds_read_b64_tr_b16 a[218:219], v250 offset:4096
    v_mfma_f32_16x16x32_bf16 v[184:187], a[164:167], v[20:23], v[184:187]
    ds_read_b64_tr_b16 a[220:221], v251 offset:0
    ds_read_b64_tr_b16 a[222:223], v251 offset:4096
    v_exp_f32 v176, v176
    v_exp_f32 v177, v177
    v_mfma_f32_16x16x32_bf16 v[184:187], a[168:171], v[24:27], v[184:187]
    ds_read_b64_tr_b16 a[224:225], v244 offset:8192
    ds_read_b64_tr_b16 a[226:227], v244 offset:12288
    ds_read_b64_tr_b16 a[228:229], v245 offset:8192
    v_exp_f32 v178, v178
    v_mov_b32 v252, v176
    v_add_f32 v252, v252, v177
    v_mfma_f32_16x16x32_bf16 v[184:187], a[172:175], v[28:31], v[184:187]
    ds_read_b64_tr_b16 a[230:231], v245 offset:12288
    ds_read_b64_tr_b16 a[232:233], v246 offset:8192
    ds_read_b64_tr_b16 a[234:235], v246 offset:12288
    v_exp_f32 v179, v179
    v_cvt_pk_bf16_f32 v192, v176, v177
    v_add_f32 v252, v252, v178
    v_sub_f32 v220, s61, v220
    v_mfma_f32_16x16x32_bf16 v[188:191], a[188:191], v[28:31], v[216:219]
    ds_read_b64_tr_b16 a[236:237], v247 offset:8192
    ds_read_b64_tr_b16 a[238:239], v247 offset:12288
    v_exp_f32 v180, v180
    v_add_f32 v252, v252, v179
    v_cvt_pk_bf16_f32 v193, v178, v179
    v_sub_f32 v221, s61, v221
    v_mfma_f32_16x16x32_bf16 v[188:191], a[184:187], v[24:27], v[188:191]
    ds_read_b64_tr_b16 a[240:241], v248 offset:8192
    ds_read_b64_tr_b16 a[242:243], v248 offset:12288
    ds_read_b64_tr_b16 a[244:245], v249 offset:8192
    v_exp_f32 v181, v181
    v_exp_f32 v182, v182
    v_sub_f32 v222, s61, v222
    v_mfma_f32_16x16x32_bf16 v[188:191], a[180:183], v[20:23], v[188:191]
    ds_read_b64_tr_b16 a[246:247], v249 offset:12288
    ds_read_b64_tr_b16 a[248:249], v250 offset:8192
    ds_read_b64_tr_b16 a[250:251], v250 offset:12288
    v_add_f32 v252, v252, v180
    v_add_f32 v252, v252, v181
    v_exp_f32 v183, v183
    v_sub_f32 v223, s61, v223
    v_mfma_f32_16x16x32_bf16 v[188:191], a[176:179], v[16:19], v[188:191]
    ds_read_b64_tr_b16 a[252:253], v251 offset:8192
    ds_read_b64_tr_b16 a[254:255], v251 offset:12288
    v_cvt_pk_bf16_f32 v194, v180, v181
    v_add_f32 v252, v252, v182
    v_add_f32 v252, v252, v183
    v_cvt_pk_bf16_f32 v195, v182, v183
    s_nop 7
    v_mfma_f32_16x16x32_bf16 v[176:179], a[128:131], v[32:35], v[220:223]
    v_mfma_f32_16x16x32_bf16 v[176:179], a[132:135], v[36:39], v[176:179]
    v_exp_f32 v184, v184
    v_mfma_f32_16x16x32_bf16 v[176:179], a[136:139], v[40:43], v[176:179]
    v_mfma_f32_16x16x32_bf16 v[176:179], a[140:143], v[44:47], v[176:179]
    v_exp_f32 v185, v185
    v_mfma_f32_16x16x32_bf16 v[180:183], a[156:159], v[44:47], v[220:223]
    v_exp_f32 v186, v186
    v_mfma_f32_16x16x32_bf16 v[180:183], a[152:155], v[40:43], v[180:183]
    v_add_f32 v252, v252, v184
    v_add_f32 v252, v252, v185
    v_mfma_f32_16x16x32_bf16 v[180:183], a[148:151], v[36:39], v[180:183]
    v_exp_f32 v187, v187
    v_mfma_f32_16x16x32_bf16 v[180:183], a[144:147], v[32:35], v[180:183]
    s_waitcnt lgkmcnt(0)
    v_cvt_pk_bf16_f32 v208, v184, v185
    v_add_f32 v252, v252, v186
    v_mfma_f32_16x16x32_bf16 a[0:3], v[192:195], a[192:195], 0
    v_exp_f32 v188, v188
    v_mfma_f32_16x16x32_bf16 a[4:7], v[192:195], a[196:199], 0
    v_add_f32 v252, v252, v187
    v_cvt_pk_bf16_f32 v209, v186, v187
    v_mfma_f32_16x16x32_bf16 a[8:11], v[192:195], a[200:203], 0
    v_exp_f32 v189, v189
    v_mfma_f32_16x16x32_bf16 a[12:15], v[192:195], a[204:207], 0
    s_waitcnt vmcnt(8)
    ds_read_b128 v[48:51], v8 offset:8192
    ds_read_b128 v[52:55], v9 offset:8192
    v_exp_f32 v190, v190
    v_mfma_f32_16x16x32_bf16 a[16:19], v[192:195], a[208:211], 0
    v_add_f32 v252, v252, v188
    v_add_f32 v252, v252, v189
    v_mfma_f32_16x16x32_bf16 a[20:23], v[192:195], a[212:215], 0
    ds_read_b128 v[56:59], v10 offset:8192
    ds_read_b128 v[60:63], v11 offset:8192
    v_exp_f32 v191, v191
    v_mfma_f32_16x16x32_bf16 a[24:27], v[192:195], a[216:219], 0
    v_cvt_pk_bf16_f32 v210, v188, v189
    v_add_f32 v252, v252, v190
    v_mfma_f32_16x16x32_bf16 a[28:31], v[192:195], a[220:223], 0
    v_add_f32 v252, v252, v191
    v_cvt_pk_bf16_f32 v211, v190, v191
    s_barrier
    s_waitcnt lgkmcnt(0)
.p2align 3
    v_mfma_f32_4x4x4_16b_bf16 v[184:187], v[12:13], v[48:49], 0
    v_mfma_f32_4x4x4_16b_bf16 v[188:191], v[12:13], v[50:51], 0
    s_nop 0
.p2align 3
    v_mfma_f32_4x4x4_16b_bf16 v[184:187], v[14:15], v[48:49], v[184:187]
    v_mfma_f32_4x4x4_16b_bf16 v[192:195], v[12:13], v[52:53], 0
    v_mfma_f32_4x4x4_16b_bf16 v[188:191], v[14:15], v[50:51], v[188:191]
    v_mfma_f32_4x4x4_16b_bf16 v[224:227], v[12:13], v[54:55], 0
    s_nop 1
.p2align 3
    v_cvt_pk_bf16_f32 v48, v184, v185
    v_mfma_f32_4x4x4_16b_bf16 v[192:195], v[14:15], v[52:53], v[192:195]
    v_cvt_pk_bf16_f32 v49, v186, v187
    v_mfma_f32_4x4x4_16b_bf16 v[184:187], v[12:13], v[56:57], 0
    v_cvt_pk_bf16_f32 v50, v188, v189
    v_mfma_f32_4x4x4_16b_bf16 v[224:227], v[14:15], v[54:55], v[224:227]
    v_cvt_pk_bf16_f32 v51, v190, v191
    v_mfma_f32_4x4x4_16b_bf16 v[188:191], v[12:13], v[58:59], 0
    v_cvt_pk_bf16_f32 v52, v192, v193
    v_mfma_f32_4x4x4_16b_bf16 v[184:187], v[14:15], v[56:57], v[184:187]
    v_cvt_pk_bf16_f32 v53, v194, v195
    v_mfma_f32_4x4x4_16b_bf16 v[192:195], v[12:13], v[60:61], 0
    v_cvt_pk_bf16_f32 v54, v224, v225
    v_mfma_f32_4x4x4_16b_bf16 v[188:191], v[14:15], v[58:59], v[188:191]
    v_cvt_pk_bf16_f32 v55, v226, v227
    v_mfma_f32_4x4x4_16b_bf16 v[224:227], v[12:13], v[62:63], 0
    v_cvt_pk_bf16_f32 v56, v184, v185
    v_mfma_f32_4x4x4_16b_bf16 v[192:195], v[14:15], v[60:61], v[192:195]
    v_cvt_pk_bf16_f32 v57, v186, v187
    v_cvt_pk_bf16_f32 v58, v188, v189
    v_mfma_f32_4x4x4_16b_bf16 v[224:227], v[14:15], v[62:63], v[224:227]
    v_cvt_pk_bf16_f32 v59, v190, v191
    s_nop 0
.p2align 3
    v_cvt_pk_bf16_f32 v60, v192, v193
    v_cvt_pk_bf16_f32 v61, v194, v195
    s_nop 0
.p2align 3
    v_cvt_pk_bf16_f32 v62, v224, v225
    v_cvt_pk_bf16_f32 v63, v226, v227
    v_mfma_f32_16x16x32_bf16 v[224:227], v[160:163], v[48:51], 0
    v_mfma_f32_16x16x32_bf16 v[224:227], v[164:167], v[52:55], v[224:227]
    v_mfma_f32_16x16x32_bf16 v[224:227], v[168:171], v[56:59], v[224:227]
    v_mfma_f32_16x16x32_bf16 v[224:227], v[172:175], v[60:63], v[224:227]
    v_mfma_f32_16x16x32_bf16 v[184:187], a[160:163], v[32:35], v[220:223]
    v_mfma_f32_16x16x32_bf16 v[184:187], a[164:167], v[36:39], v[184:187]
    v_exp_f32 v176, v176
    v_exp_f32 v177, v177
    v_mfma_f32_16x16x32_bf16 v[184:187], a[168:171], v[40:43], v[184:187]
    v_exp_f32 v178, v178
    v_mov_b32 v253, v176
    v_add_f32 v253, v253, v177
    v_mfma_f32_16x16x32_bf16 v[184:187], a[172:175], v[44:47], v[184:187]
    v_exp_f32 v179, v179
    v_cvt_pk_bf16_f32 v192, v176, v177
    v_add_f32 v253, v253, v178
    v_sub_f32 v224, s61, v224
    v_mfma_f32_16x16x32_bf16 v[188:191], a[188:191], v[44:47], v[220:223]
    v_exp_f32 v180, v180
    v_add_f32 v253, v253, v179
    v_cvt_pk_bf16_f32 v193, v178, v179
    v_sub_f32 v225, s61, v225
    v_mfma_f32_16x16x32_bf16 v[188:191], a[184:187], v[40:43], v[188:191]
    v_exp_f32 v181, v181
    v_exp_f32 v182, v182
    v_sub_f32 v226, s61, v226
    v_mfma_f32_16x16x32_bf16 v[188:191], a[180:183], v[36:39], v[188:191]
    v_add_f32 v253, v253, v180
    v_add_f32 v253, v253, v181
    v_exp_f32 v183, v183
    v_sub_f32 v227, s61, v227
    v_mfma_f32_16x16x32_bf16 v[188:191], a[176:179], v[32:35], v[188:191]
    v_cvt_pk_bf16_f32 v194, v180, v181
    v_add_f32 v253, v253, v182
    v_add_f32 v253, v253, v183
    v_cvt_pk_bf16_f32 v195, v182, v183
    s_nop 7
    v_mfma_f32_16x16x32_bf16 v[176:179], a[128:131], v[48:51], v[224:227]
    v_mfma_f32_16x16x32_bf16 v[176:179], a[132:135], v[52:55], v[176:179]
    v_exp_f32 v184, v184
    v_mfma_f32_16x16x32_bf16 v[176:179], a[136:139], v[56:59], v[176:179]
    v_mfma_f32_16x16x32_bf16 v[176:179], a[140:143], v[60:63], v[176:179]
    v_exp_f32 v185, v185
    v_mfma_f32_16x16x32_bf16 v[180:183], a[156:159], v[60:63], v[224:227]
    v_exp_f32 v186, v186
    v_mfma_f32_16x16x32_bf16 v[180:183], a[152:155], v[56:59], v[180:183]
    v_add_f32 v253, v253, v184
    v_add_f32 v253, v253, v185
    v_mfma_f32_16x16x32_bf16 v[180:183], a[148:151], v[52:55], v[180:183]
    v_exp_f32 v187, v187
    v_mfma_f32_16x16x32_bf16 v[180:183], a[144:147], v[48:51], v[180:183]
    v_cvt_pk_bf16_f32 v196, v184, v185
    v_add_f32 v253, v253, v186
    v_mfma_f32_16x16x32_bf16 a[32:35], v[192:195], a[192:195], 0
    v_exp_f32 v188, v188
    v_mfma_f32_16x16x32_bf16 a[36:39], v[192:195], a[196:199], 0
    v_add_f32 v253, v253, v187
    v_cvt_pk_bf16_f32 v197, v186, v187
    v_mfma_f32_16x16x32_bf16 a[40:43], v[192:195], a[200:203], 0
    v_exp_f32 v189, v189
    v_mfma_f32_16x16x32_bf16 a[44:47], v[192:195], a[204:207], 0
    s_waitcnt vmcnt(4)
    ds_read_b128 v[64:67], v8 offset:12288
    ds_read_b128 v[68:71], v9 offset:12288
    v_exp_f32 v190, v190
    v_mfma_f32_16x16x32_bf16 a[48:51], v[192:195], a[208:211], 0
    v_add_f32 v253, v253, v188
    v_add_f32 v253, v253, v189
    v_mfma_f32_16x16x32_bf16 a[52:55], v[192:195], a[212:215], 0
    ds_read_b128 v[72:75], v10 offset:12288
    ds_read_b128 v[76:79], v11 offset:12288
    v_exp_f32 v191, v191
    v_mfma_f32_16x16x32_bf16 a[56:59], v[192:195], a[216:219], 0
    v_cvt_pk_bf16_f32 v198, v188, v189
    v_add_f32 v253, v253, v190
    v_mfma_f32_16x16x32_bf16 a[60:63], v[192:195], a[220:223], 0
    v_add_f32 v253, v253, v191
    v_cvt_pk_bf16_f32 v199, v190, v191
    s_waitcnt lgkmcnt(0)
.p2align 3
    v_mfma_f32_4x4x4_16b_bf16 v[184:187], v[12:13], v[64:65], 0
    v_mfma_f32_4x4x4_16b_bf16 v[188:191], v[12:13], v[66:67], 0
    s_nop 0
.p2align 3
    v_mfma_f32_4x4x4_16b_bf16 v[184:187], v[14:15], v[64:65], v[184:187]
    v_mfma_f32_4x4x4_16b_bf16 v[192:195], v[12:13], v[68:69], 0
    v_mfma_f32_4x4x4_16b_bf16 v[188:191], v[14:15], v[66:67], v[188:191]
    v_mfma_f32_4x4x4_16b_bf16 v[228:231], v[12:13], v[70:71], 0
    s_nop 1
.p2align 3
    v_cvt_pk_bf16_f32 v64, v184, v185
    v_mfma_f32_4x4x4_16b_bf16 v[192:195], v[14:15], v[68:69], v[192:195]
    v_cvt_pk_bf16_f32 v65, v186, v187
    v_mfma_f32_4x4x4_16b_bf16 v[184:187], v[12:13], v[72:73], 0
    v_cvt_pk_bf16_f32 v66, v188, v189
    v_mfma_f32_4x4x4_16b_bf16 v[228:231], v[14:15], v[70:71], v[228:231]
    v_cvt_pk_bf16_f32 v67, v190, v191
    v_mfma_f32_4x4x4_16b_bf16 v[188:191], v[12:13], v[74:75], 0
    v_cvt_pk_bf16_f32 v68, v192, v193
    v_mfma_f32_4x4x4_16b_bf16 v[184:187], v[14:15], v[72:73], v[184:187]
    v_cvt_pk_bf16_f32 v69, v194, v195
    v_mfma_f32_4x4x4_16b_bf16 v[192:195], v[12:13], v[76:77], 0
    v_cvt_pk_bf16_f32 v70, v228, v229
    v_mfma_f32_4x4x4_16b_bf16 v[188:191], v[14:15], v[74:75], v[188:191]
    v_cvt_pk_bf16_f32 v71, v230, v231
    v_mfma_f32_4x4x4_16b_bf16 v[228:231], v[12:13], v[78:79], 0
    v_cvt_pk_bf16_f32 v72, v184, v185
    v_mfma_f32_4x4x4_16b_bf16 v[192:195], v[14:15], v[76:77], v[192:195]
    v_cvt_pk_bf16_f32 v73, v186, v187
    v_cvt_pk_bf16_f32 v74, v188, v189
    v_mfma_f32_4x4x4_16b_bf16 v[228:231], v[14:15], v[78:79], v[228:231]
    v_cvt_pk_bf16_f32 v75, v190, v191
    s_nop 0
.p2align 3
    v_cvt_pk_bf16_f32 v76, v192, v193
    v_cvt_pk_bf16_f32 v77, v194, v195
    s_nop 0
.p2align 3
    v_cvt_pk_bf16_f32 v78, v228, v229
    v_cvt_pk_bf16_f32 v79, v230, v231
    v_mfma_f32_16x16x32_bf16 v[228:231], v[160:163], v[64:67], 0
    s_add_u32 m0, s6, 16384
    s_add_u32 s29, s7, 16384
    buffer_load_dwordx4 v103, s[12:15], s29 offen nt lds
    v_mfma_f32_16x16x32_bf16 v[228:231], v[164:167], v[68:71], v[228:231]
    s_add_u32 m0, s6, 20480
    s_add_u32 s29, s7, 20480
    buffer_load_dwordx4 v103, s[12:15], s29 offen nt lds
    v_mfma_f32_16x16x32_bf16 v[228:231], v[168:171], v[72:75], v[228:231]
    s_add_u32 m0, s6, 24576
    s_add_u32 s29, s7, 24576
    buffer_load_dwordx4 v103, s[12:15], s29 offen nt lds
    v_mfma_f32_16x16x32_bf16 v[228:231], v[172:175], v[76:79], v[228:231]
    s_add_u32 m0, s6, 28672
    s_add_u32 s29, s7, 28672
    buffer_load_dwordx4 v103, s[12:15], s29 offen nt lds
    v_mfma_f32_16x16x32_bf16 v[184:187], a[160:163], v[48:51], v[224:227]
    v_mfma_f32_16x16x32_bf16 v[184:187], a[164:167], v[52:55], v[184:187]
    v_exp_f32 v176, v176
    v_mfma_f32_16x16x32_bf16 v[184:187], a[168:171], v[56:59], v[184:187]
    v_mfma_f32_16x16x32_bf16 v[184:187], a[172:175], v[60:63], v[184:187]
    v_exp_f32 v177, v177
    v_mfma_f32_16x16x32_bf16 v[188:191], a[188:191], v[60:63], v[224:227]
    v_exp_f32 v178, v178
    v_mfma_f32_16x16x32_bf16 v[188:191], a[184:187], v[56:59], v[188:191]
    v_mov_b32 v254, v176
    v_add_f32 v254, v254, v177
    v_mfma_f32_16x16x32_bf16 v[188:191], a[180:183], v[52:55], v[188:191]
    v_exp_f32 v179, v179
    v_mfma_f32_16x16x32_bf16 v[188:191], a[176:179], v[48:51], v[188:191]
    v_cvt_pk_bf16_f32 v192, v176, v177
    v_add_f32 v254, v254, v178
    v_mfma_f32_16x16x32_bf16 a[32:35], v[196:199], a[224:227], a[32:35]
    v_exp_f32 v180, v180
    v_mfma_f32_16x16x32_bf16 a[36:39], v[196:199], a[228:231], a[36:39]
    v_add_f32 v254, v254, v179
    v_cvt_pk_bf16_f32 v193, v178, v179
    v_mfma_f32_16x16x32_bf16 a[40:43], v[196:199], a[232:235], a[40:43]
    v_exp_f32 v181, v181
    v_mfma_f32_16x16x32_bf16 a[44:47], v[196:199], a[236:239], a[44:47]
    v_exp_f32 v182, v182
    v_sub_f32 v228, s61, v228
    v_mfma_f32_16x16x32_bf16 a[48:51], v[196:199], a[240:243], a[48:51]
    v_add_f32 v254, v254, v180
    v_add_f32 v254, v254, v181
    v_sub_f32 v229, s61, v229
    v_mfma_f32_16x16x32_bf16 a[52:55], v[196:199], a[244:247], a[52:55]
    v_exp_f32 v183, v183
    v_sub_f32 v230, s61, v230
    v_mfma_f32_16x16x32_bf16 a[56:59], v[196:199], a[248:251], a[56:59]
    v_cvt_pk_bf16_f32 v194, v180, v181
    v_add_f32 v254, v254, v182
    v_sub_f32 v231, s61, v231
    v_mfma_f32_16x16x32_bf16 a[60:63], v[196:199], a[252:255], a[60:63]
    v_add_f32 v254, v254, v183
    v_cvt_pk_bf16_f32 v195, v182, v183
    v_mfma_f32_16x16x32_bf16 v[176:179], a[128:131], v[64:67], v[228:231]
    v_mfma_f32_16x16x32_bf16 v[176:179], a[132:135], v[68:71], v[176:179]
    v_exp_f32 v184, v184
    v_mfma_f32_16x16x32_bf16 v[176:179], a[136:139], v[72:75], v[176:179]
    v_mfma_f32_16x16x32_bf16 v[176:179], a[140:143], v[76:79], v[176:179]
    v_exp_f32 v185, v185
    v_mfma_f32_16x16x32_bf16 v[180:183], a[156:159], v[76:79], v[228:231]
    v_exp_f32 v186, v186
    v_mfma_f32_16x16x32_bf16 v[180:183], a[152:155], v[72:75], v[180:183]
    v_add_f32 v254, v254, v184
    v_add_f32 v254, v254, v185
    v_mfma_f32_16x16x32_bf16 v[180:183], a[148:151], v[68:71], v[180:183]
    v_exp_f32 v187, v187
    v_mfma_f32_16x16x32_bf16 v[180:183], a[144:147], v[64:67], v[180:183]
    v_cvt_pk_bf16_f32 v212, v184, v185
    v_add_f32 v254, v254, v186
    v_mfma_f32_16x16x32_bf16 a[64:67], v[192:195], a[192:195], 0
    v_exp_f32 v188, v188
    v_mfma_f32_16x16x32_bf16 a[68:71], v[192:195], a[196:199], 0
    v_add_f32 v254, v254, v187
    v_cvt_pk_bf16_f32 v213, v186, v187
    v_mfma_f32_16x16x32_bf16 a[72:75], v[192:195], a[200:203], 0
    v_exp_f32 v189, v189
    v_mfma_f32_16x16x32_bf16 a[76:79], v[192:195], a[204:207], 0
    s_waitcnt vmcnt(4)
    ds_read_b128 v[80:83], v8 offset:16384
    ds_read_b128 v[84:87], v9 offset:16384
    v_exp_f32 v190, v190
    v_mfma_f32_16x16x32_bf16 a[80:83], v[192:195], a[208:211], 0
    v_add_f32 v254, v254, v188
    v_add_f32 v254, v254, v189
    v_mfma_f32_16x16x32_bf16 a[84:87], v[192:195], a[212:215], 0
    ds_read_b128 v[88:91], v10 offset:16384
    ds_read_b128 v[92:95], v11 offset:16384
    v_exp_f32 v191, v191
    v_mfma_f32_16x16x32_bf16 a[88:91], v[192:195], a[216:219], 0
    v_cvt_pk_bf16_f32 v214, v188, v189
    v_add_f32 v254, v254, v190
    v_mfma_f32_16x16x32_bf16 a[92:95], v[192:195], a[220:223], 0
    v_add_f32 v254, v254, v191
    v_cvt_pk_bf16_f32 v215, v190, v191
    s_waitcnt lgkmcnt(0)
.p2align 3
    v_mfma_f32_4x4x4_16b_bf16 v[184:187], v[12:13], v[80:81], 0
    v_mfma_f32_4x4x4_16b_bf16 v[188:191], v[12:13], v[82:83], 0
    s_nop 0
.p2align 3
    v_mfma_f32_4x4x4_16b_bf16 v[184:187], v[14:15], v[80:81], v[184:187]
    v_mfma_f32_4x4x4_16b_bf16 v[192:195], v[12:13], v[84:85], 0
    v_mfma_f32_4x4x4_16b_bf16 v[188:191], v[14:15], v[82:83], v[188:191]
    v_mfma_f32_4x4x4_16b_bf16 v[232:235], v[12:13], v[86:87], 0
    s_nop 1
.p2align 3
    v_cvt_pk_bf16_f32 v80, v184, v185
    v_mfma_f32_4x4x4_16b_bf16 v[192:195], v[14:15], v[84:85], v[192:195]
    v_cvt_pk_bf16_f32 v81, v186, v187
    v_mfma_f32_4x4x4_16b_bf16 v[184:187], v[12:13], v[88:89], 0
    v_cvt_pk_bf16_f32 v82, v188, v189
    v_mfma_f32_4x4x4_16b_bf16 v[232:235], v[14:15], v[86:87], v[232:235]
    v_cvt_pk_bf16_f32 v83, v190, v191
    v_mfma_f32_4x4x4_16b_bf16 v[188:191], v[12:13], v[90:91], 0
    v_cvt_pk_bf16_f32 v84, v192, v193
    v_mfma_f32_4x4x4_16b_bf16 v[184:187], v[14:15], v[88:89], v[184:187]
    v_cvt_pk_bf16_f32 v85, v194, v195
    v_mfma_f32_4x4x4_16b_bf16 v[192:195], v[12:13], v[92:93], 0
    v_cvt_pk_bf16_f32 v86, v232, v233
    v_mfma_f32_4x4x4_16b_bf16 v[188:191], v[14:15], v[90:91], v[188:191]
    v_cvt_pk_bf16_f32 v87, v234, v235
    v_mfma_f32_4x4x4_16b_bf16 v[232:235], v[12:13], v[94:95], 0
    v_cvt_pk_bf16_f32 v88, v184, v185
    v_mfma_f32_4x4x4_16b_bf16 v[192:195], v[14:15], v[92:93], v[192:195]
    v_cvt_pk_bf16_f32 v89, v186, v187
    v_cvt_pk_bf16_f32 v90, v188, v189
    v_mfma_f32_4x4x4_16b_bf16 v[232:235], v[14:15], v[94:95], v[232:235]
    v_cvt_pk_bf16_f32 v91, v190, v191
    s_nop 0
.p2align 3
    v_cvt_pk_bf16_f32 v92, v192, v193
    v_cvt_pk_bf16_f32 v93, v194, v195
    s_nop 0
.p2align 3
    v_cvt_pk_bf16_f32 v94, v232, v233
    v_cvt_pk_bf16_f32 v95, v234, v235
    v_mfma_f32_16x16x32_bf16 v[232:235], v[160:163], v[80:83], 0
    s_add_u32 m0, s6, 49152
    s_add_u32 s29, s7, 16384
    buffer_load_dwordx4 v104, s[16:19], s29 offen nt lds
    v_mfma_f32_16x16x32_bf16 v[232:235], v[164:167], v[84:87], v[232:235]
    s_add_u32 m0, s6, 53248
    s_add_u32 s29, s7, 20480
    buffer_load_dwordx4 v104, s[16:19], s29 offen nt lds
    v_mfma_f32_16x16x32_bf16 v[232:235], v[168:171], v[88:91], v[232:235]
    s_add_u32 m0, s6, 57344
    s_add_u32 s29, s7, 24576
    buffer_load_dwordx4 v104, s[16:19], s29 offen nt lds
    v_mfma_f32_16x16x32_bf16 v[232:235], v[172:175], v[92:95], v[232:235]
    s_add_u32 m0, s6, 61440
    s_add_u32 s29, s7, 28672
    buffer_load_dwordx4 v104, s[16:19], s29 offen nt lds
    v_mfma_f32_16x16x32_bf16 v[184:187], a[160:163], v[64:67], v[228:231]
    v_mfma_f32_16x16x32_bf16 v[184:187], a[164:167], v[68:71], v[184:187]
    v_exp_f32 v176, v176
    v_exp_f32 v177, v177
    v_mfma_f32_16x16x32_bf16 v[184:187], a[168:171], v[72:75], v[184:187]
    v_exp_f32 v178, v178
    v_mov_b32 v255, v176
    v_add_f32 v255, v255, v177
    v_mfma_f32_16x16x32_bf16 v[184:187], a[172:175], v[76:79], v[184:187]
    v_exp_f32 v179, v179
    v_cvt_pk_bf16_f32 v192, v176, v177
    v_add_f32 v255, v255, v178
    v_sub_f32 v232, s61, v232
    v_mfma_f32_16x16x32_bf16 v[188:191], a[188:191], v[76:79], v[228:231]
    v_exp_f32 v180, v180
    v_add_f32 v255, v255, v179
    v_cvt_pk_bf16_f32 v193, v178, v179
    v_sub_f32 v233, s61, v233
    v_mfma_f32_16x16x32_bf16 v[188:191], a[184:187], v[72:75], v[188:191]
    v_exp_f32 v181, v181
    v_exp_f32 v182, v182
    v_sub_f32 v234, s61, v234
    v_mfma_f32_16x16x32_bf16 v[188:191], a[180:183], v[68:71], v[188:191]
    v_add_f32 v255, v255, v180
    v_add_f32 v255, v255, v181
    v_exp_f32 v183, v183
    v_sub_f32 v235, s61, v235
    v_mfma_f32_16x16x32_bf16 v[188:191], a[176:179], v[64:67], v[188:191]
    v_cvt_pk_bf16_f32 v194, v180, v181
    v_add_f32 v255, v255, v182
    v_add_f32 v255, v255, v183
    v_cvt_pk_bf16_f32 v195, v182, v183
    s_nop 7
    s_add_u32 m0, s34, 0
    s_nop 0
    buffer_load_dwordx4 v96, s[12:15], s32 offen offset:0 nt lds
    buffer_load_dwordx4 v97, s[12:15], s32 offen offset:1024 nt lds
    buffer_load_dwordx4 v98, s[12:15], s32 offen offset:2048 nt lds
    buffer_load_dwordx4 v99, s[12:15], s32 offen offset:3072 nt lds
    s_add_u32 m0, s34, 4096
    s_nop 0
    buffer_load_dwordx4 v96, s[12:15], s35 offen offset:0 nt lds
    buffer_load_dwordx4 v97, s[12:15], s35 offen offset:1024 nt lds
    buffer_load_dwordx4 v98, s[12:15], s35 offen offset:2048 nt lds
    buffer_load_dwordx4 v99, s[12:15], s35 offen offset:3072 nt lds
    s_add_u32 m0, s34, 32768
    s_nop 0
    buffer_load_dwordx4 v96, s[16:19], s32 offen offset:0 nt lds
    buffer_load_dwordx4 v97, s[16:19], s32 offen offset:1024 nt lds
    buffer_load_dwordx4 v96, s[16:19], s32 offen offset:2048 nt lds
    buffer_load_dwordx4 v97, s[16:19], s32 offen offset:3072 nt lds
    s_add_u32 m0, s34, 36864
    s_nop 0
    buffer_load_dwordx4 v96, s[16:19], s35 offen offset:0 nt lds
    buffer_load_dwordx4 v97, s[16:19], s35 offen offset:1024 nt lds
    buffer_load_dwordx4 v96, s[16:19], s35 offen offset:2048 nt lds
    buffer_load_dwordx4 v97, s[16:19], s35 offen offset:3072 nt lds
    s_add_u32 s33, s33, 1
    s_add_u32 s32, s32, 8192
    s_cmp_eq_u32 s33, 23
    s_cselect_b32 s32, s26, s32
    s_cmp_eq_u32 s33, 46
    s_cselect_b32 s32, s37, s32
    s_add_u32 s35, s32, 4096
    s_add_u32 s34, s34, 8192
    s_and_b32 s34, s34, 32767
    v_mfma_f32_16x16x32_bf16 v[176:179], a[128:131], v[80:83], v[232:235]
    v_mfma_f32_16x16x32_bf16 v[176:179], a[132:135], v[84:87], v[176:179]
    v_exp_f32 v184, v184
    v_mfma_f32_16x16x32_bf16 v[176:179], a[136:139], v[88:91], v[176:179]
    v_mfma_f32_16x16x32_bf16 v[176:179], a[140:143], v[92:95], v[176:179]
    v_exp_f32 v185, v185
    v_mfma_f32_16x16x32_bf16 v[180:183], a[156:159], v[92:95], v[232:235]
    v_exp_f32 v186, v186
    v_mfma_f32_16x16x32_bf16 v[180:183], a[152:155], v[88:91], v[180:183]
    v_add_f32 v255, v255, v184
    v_add_f32 v255, v255, v185
    v_mfma_f32_16x16x32_bf16 v[180:183], a[148:151], v[84:87], v[180:183]
    v_exp_f32 v187, v187
    v_mfma_f32_16x16x32_bf16 v[180:183], a[144:147], v[80:83], v[180:183]
    s_waitcnt vmcnt(20)
    v_cvt_pk_bf16_f32 v196, v184, v185
    v_add_f32 v255, v255, v186
    v_mfma_f32_16x16x32_bf16 v[112:115], v[192:195], a[192:195], 0
    s_barrier
    ds_read_b128 a[128:131], v240 offset:16384
    v_exp_f32 v188, v188
    v_mfma_f32_16x16x32_bf16 v[116:119], v[192:195], a[196:199], 0
    v_add_f32 v255, v255, v187
    v_cvt_pk_bf16_f32 v197, v186, v187
    v_mfma_f32_16x16x32_bf16 v[120:123], v[192:195], a[200:203], 0
    ds_read_b128 a[132:135], v241 offset:16384
    v_exp_f32 v189, v189
    v_mfma_f32_16x16x32_bf16 v[124:127], v[192:195], a[204:207], 0
    ds_read_b128 a[136:139], v242 offset:16384
    v_exp_f32 v190, v190
    v_mfma_f32_16x16x32_bf16 v[128:131], v[192:195], a[208:211], 0
    v_add_f32 v255, v255, v188
    v_add_f32 v255, v255, v189
    v_mfma_f32_16x16x32_bf16 v[132:135], v[192:195], a[212:215], 0
    ds_read_b128 a[140:143], v243 offset:16384
    v_exp_f32 v191, v191
    v_mfma_f32_16x16x32_bf16 v[136:139], v[192:195], a[216:219], 0
    v_cvt_pk_bf16_f32 v198, v188, v189
    v_add_f32 v255, v255, v190
    v_mfma_f32_16x16x32_bf16 v[140:143], v[192:195], a[220:223], 0
    v_add_f32 v255, v255, v191
    v_cvt_pk_bf16_f32 v199, v190, v191
    v_mfma_f32_16x16x32_bf16 v[184:187], a[160:163], v[80:83], v[232:235]
    ds_read_b128 a[144:147], v240 offset:20480
    ds_read_b128 a[148:151], v241 offset:20480
    v_mfma_f32_16x16x32_bf16 v[184:187], a[164:167], v[84:87], v[184:187]
    ds_read_b128 a[152:155], v242 offset:20480
    ds_read_b128 a[156:159], v243 offset:20480
    v_exp_f32 v176, v176
    v_mfma_f32_16x16x32_bf16 v[184:187], a[168:171], v[88:91], v[184:187]
    v_mfma_f32_16x16x32_bf16 v[184:187], a[172:175], v[92:95], v[184:187]
    v_exp_f32 v177, v177
    v_mfma_f32_16x16x32_bf16 v[188:191], a[188:191], v[92:95], v[232:235]
    v_exp_f32 v178, v178
    v_mfma_f32_16x16x32_bf16 v[188:191], a[184:187], v[88:91], v[188:191]
    v_mov_b32 v0, v176
    v_add_f32 v0, v0, v177
    v_mfma_f32_16x16x32_bf16 v[188:191], a[180:183], v[84:87], v[188:191]
    v_exp_f32 v179, v179
    v_mfma_f32_16x16x32_bf16 v[188:191], a[176:179], v[80:83], v[188:191]
    v_cvt_pk_bf16_f32 v192, v176, v177
    v_add_f32 v0, v0, v178
    v_mfma_f32_16x16x32_bf16 v[112:115], v[196:199], a[224:227], v[112:115]
    v_exp_f32 v180, v180
    v_mfma_f32_16x16x32_bf16 v[116:119], v[196:199], a[228:231], v[116:119]
    v_add_f32 v0, v0, v179
    v_cvt_pk_bf16_f32 v193, v178, v179
    v_mfma_f32_16x16x32_bf16 v[120:123], v[196:199], a[232:235], v[120:123]
    v_exp_f32 v181, v181
    v_mfma_f32_16x16x32_bf16 v[124:127], v[196:199], a[236:239], v[124:127]
    v_exp_f32 v182, v182
    v_mfma_f32_16x16x32_bf16 v[128:131], v[196:199], a[240:243], v[128:131]
    v_add_f32 v0, v0, v180
    v_add_f32 v0, v0, v181
    v_mfma_f32_16x16x32_bf16 v[132:135], v[196:199], a[244:247], v[132:135]
    v_exp_f32 v183, v183
    v_mfma_f32_16x16x32_bf16 v[136:139], v[196:199], a[248:251], v[136:139]
    v_cvt_pk_bf16_f32 v194, v180, v181
    v_add_f32 v0, v0, v182
    v_mfma_f32_16x16x32_bf16 v[140:143], v[196:199], a[252:255], v[140:143]
    v_add_f32 v0, v0, v183
    v_cvt_pk_bf16_f32 v195, v182, v183
    s_waitcnt lgkmcnt(0)
    v_mfma_f32_16x16x32_bf16 v[176:179], a[128:131], v[16:19], v[216:219]
    v_mfma_f32_16x16x32_bf16 v[176:179], a[132:135], v[20:23], v[176:179]
    v_exp_f32 v184, v184
    v_mfma_f32_16x16x32_bf16 v[176:179], a[136:139], v[24:27], v[176:179]
    v_mfma_f32_16x16x32_bf16 v[176:179], a[140:143], v[28:31], v[176:179]
    v_exp_f32 v185, v185
    v_mfma_f32_16x16x32_bf16 v[180:183], a[156:159], v[28:31], v[216:219]
    v_exp_f32 v186, v186
    v_mfma_f32_16x16x32_bf16 v[180:183], a[152:155], v[24:27], v[180:183]
    v_add_f32 v0, v0, v184
    v_add_f32 v0, v0, v185
    v_mfma_f32_16x16x32_bf16 v[180:183], a[148:151], v[20:23], v[180:183]
    v_exp_f32 v187, v187
    v_mfma_f32_16x16x32_bf16 v[180:183], a[144:147], v[16:19], v[180:183]
    v_cvt_pk_bf16_f32 v196, v184, v185
    v_add_f32 v0, v0, v186
    v_mfma_f32_16x16x32_bf16 v[144:147], v[192:195], a[192:195], 0
    v_exp_f32 v188, v188
    v_mfma_f32_16x16x32_bf16 v[148:151], v[192:195], a[196:199], 0
    v_add_f32 v0, v0, v187
    v_cvt_pk_bf16_f32 v197, v186, v187
    v_mfma_f32_16x16x32_bf16 v[152:155], v[192:195], a[200:203], 0
    v_exp_f32 v189, v189
    v_mfma_f32_16x16x32_bf16 v[156:159], v[192:195], a[204:207], 0
    v_exp_f32 v190, v190
    v_mfma_f32_16x16x32_bf16 v[160:163], v[192:195], a[208:211], 0
    v_add_f32 v0, v0, v188
    v_add_f32 v0, v0, v189
    v_mfma_f32_16x16x32_bf16 v[164:167], v[192:195], a[212:215], 0
    v_exp_f32 v191, v191
    v_mfma_f32_16x16x32_bf16 v[168:171], v[192:195], a[216:219], 0
    v_cvt_pk_bf16_f32 v198, v188, v189
    v_add_f32 v0, v0, v190
    v_mfma_f32_16x16x32_bf16 v[172:175], v[192:195], a[220:223], 0
    s_waitcnt vmcnt(16)
    v_add_f32 v0, v0, v191
    v_cvt_pk_bf16_f32 v199, v190, v191
    v_mfma_f32_16x16x32_bf16 v[184:187], a[128:131], v[32:35], v[220:223]
    s_barrier
    ds_read_b64_tr_b16 a[192:193], v244 offset:16384
    ds_read_b64_tr_b16 a[194:195], v244 offset:20480
    v_mfma_f32_16x16x32_bf16 v[184:187], a[132:135], v[36:39], v[184:187]
    v_exp_f32 v176, v176
    v_mfma_f32_16x16x32_bf16 v[184:187], a[136:139], v[40:43], v[184:187]
    ds_read_b64_tr_b16 a[196:197], v245 offset:16384
    ds_read_b64_tr_b16 a[198:199], v245 offset:20480
    v_mfma_f32_16x16x32_bf16 v[184:187], a[140:143], v[44:47], v[184:187]
    v_exp_f32 v177, v177
    v_mfma_f32_16x16x32_bf16 v[188:191], a[156:159], v[44:47], v[220:223]
    ds_read_b64_tr_b16 a[200:201], v246 offset:16384
    v_exp_f32 v178, v178
    v_mfma_f32_16x16x32_bf16 v[188:191], a[152:155], v[40:43], v[188:191]
    v_add_f32 v252, v252, v176
    v_add_f32 v252, v252, v177
    v_mfma_f32_16x16x32_bf16 v[188:191], a[148:151], v[36:39], v[188:191]
    ds_read_b64_tr_b16 a[202:203], v246 offset:20480
    v_exp_f32 v179, v179
    v_mfma_f32_16x16x32_bf16 v[188:191], a[144:147], v[32:35], v[188:191]
    v_cvt_pk_bf16_f32 v192, v176, v177
    v_add_f32 v252, v252, v178
    v_mfma_f32_16x16x32_bf16 v[144:147], v[196:199], a[224:227], v[144:147]
    ds_read_b64_tr_b16 a[204:205], v247 offset:16384
    v_exp_f32 v180, v180
    v_mfma_f32_16x16x32_bf16 v[148:151], v[196:199], a[228:231], v[148:151]
    v_add_f32 v252, v252, v179
    v_cvt_pk_bf16_f32 v193, v178, v179
    v_mfma_f32_16x16x32_bf16 v[152:155], v[196:199], a[232:235], v[152:155]
    ds_read_b64_tr_b16 a[206:207], v247 offset:20480
    v_exp_f32 v181, v181
    v_mfma_f32_16x16x32_bf16 v[156:159], v[196:199], a[236:239], v[156:159]
    ds_read_b64_tr_b16 a[208:209], v248 offset:16384
    v_exp_f32 v182, v182
    v_mfma_f32_16x16x32_bf16 v[160:163], v[196:199], a[240:243], v[160:163]
    ds_read_b64_tr_b16 a[210:211], v248 offset:20480
    v_add_f32 v252, v252, v180
    v_add_f32 v252, v252, v181
    v_mfma_f32_16x16x32_bf16 v[164:167], v[196:199], a[244:247], v[164:167]
    ds_read_b64_tr_b16 a[212:213], v249 offset:16384
    v_exp_f32 v183, v183
    v_mfma_f32_16x16x32_bf16 v[168:171], v[196:199], a[248:251], v[168:171]
    ds_read_b64_tr_b16 a[214:215], v249 offset:20480
    v_cvt_pk_bf16_f32 v194, v180, v181
    v_add_f32 v252, v252, v182
    v_mfma_f32_16x16x32_bf16 v[172:175], v[196:199], a[252:255], v[172:175]
    v_add_f32 v252, v252, v183
    v_cvt_pk_bf16_f32 v195, v182, v183
    s_add_u32 m0, s34, 0
    s_nop 0
    buffer_load_dwordx4 v96, s[12:15], s32 offen offset:0 nt lds
    buffer_load_dwordx4 v97, s[12:15], s32 offen offset:1024 nt lds
    buffer_load_dwordx4 v98, s[12:15], s32 offen offset:2048 nt lds
    buffer_load_dwordx4 v99, s[12:15], s32 offen offset:3072 nt lds
    s_add_u32 m0, s34, 4096
    s_nop 0
    buffer_load_dwordx4 v96, s[12:15], s35 offen offset:0 nt lds
    buffer_load_dwordx4 v97, s[12:15], s35 offen offset:1024 nt lds
    buffer_load_dwordx4 v98, s[12:15], s35 offen offset:2048 nt lds
    buffer_load_dwordx4 v99, s[12:15], s35 offen offset:3072 nt lds
    s_add_u32 m0, s34, 32768
    s_nop 0
    buffer_load_dwordx4 v96, s[16:19], s32 offen offset:0 nt lds
    buffer_load_dwordx4 v97, s[16:19], s32 offen offset:1024 nt lds
    buffer_load_dwordx4 v96, s[16:19], s32 offen offset:2048 nt lds
    buffer_load_dwordx4 v97, s[16:19], s32 offen offset:3072 nt lds
    s_add_u32 m0, s34, 36864
    s_nop 0
    buffer_load_dwordx4 v96, s[16:19], s35 offen offset:0 nt lds
    buffer_load_dwordx4 v97, s[16:19], s35 offen offset:1024 nt lds
    buffer_load_dwordx4 v96, s[16:19], s35 offen offset:2048 nt lds
    buffer_load_dwordx4 v97, s[16:19], s35 offen offset:3072 nt lds
    s_add_u32 s33, s33, 1
    s_add_u32 s32, s32, 8192
    s_cmp_eq_u32 s33, 23
    s_cselect_b32 s32, s26, s32
    s_cmp_eq_u32 s33, 46
    s_cselect_b32 s32, s37, s32
    s_add_u32 s35, s32, 4096
    s_add_u32 s34, s34, 8192
    s_and_b32 s34, s34, 32767
    s_add_u32 s53, s26, s63
    s_sub_u32 s53, s53, 16384
    s_mov_b32 s54, 49152
    s_cmp_lt_u32 s54, 65536
    s_cselect_b32 s52, s37, s53
    s_cselect_b32 m0, 159744, s54
    s_nop 0
    buffer_load_dwordx4 v96, s[8:11], s52 offen offset:0 nt lds
    buffer_load_dwordx4 v97, s[8:11], s52 offen offset:1024 nt lds
    buffer_load_dwordx4 v98, s[8:11], s52 offen offset:2048 nt lds
    buffer_load_dwordx4 v99, s[8:11], s52 offen offset:3072 nt lds
    s_add_u32 s53, s53, 4096
    s_add_u32 s54, s54, 4096
    s_cmp_lt_u32 s54, 65536
    s_cselect_b32 s52, s37, s53
    s_cselect_b32 m0, 159744, s54
    s_nop 0
    buffer_load_dwordx4 v96, s[8:11], s52 offen offset:0 nt lds
    buffer_load_dwordx4 v97, s[8:11], s52 offen offset:1024 nt lds
    buffer_load_dwordx4 v98, s[8:11], s52 offen offset:2048 nt lds
    buffer_load_dwordx4 v99, s[8:11], s52 offen offset:3072 nt lds
    s_add_u32 s53, s53, 4096
    s_add_u32 s54, s54, 4096
    s_mov_b32 s28, 0
.p2align 6
L_loop_w3:
    v_mfma_f32_16x16x32_bf16 v[176:179], a[128:131], v[48:51], v[224:227]
    ds_read_b64_tr_b16 a[216:217], v250 offset:16384
    ds_read_b64_tr_b16 a[218:219], v250 offset:20480
    v_mfma_f32_16x16x32_bf16 v[176:179], a[132:135], v[52:55], v[176:179]
    v_exp_f32 v184, v184
    v_mfma_f32_16x16x32_bf16 v[176:179], a[136:139], v[56:59], v[176:179]
    ds_read_b64_tr_b16 a[220:221], v251 offset:16384
    ds_read_b64_tr_b16 a[222:223], v251 offset:20480
    v_mfma_f32_16x16x32_bf16 v[176:179], a[140:143], v[60:63], v[176:179]
    v_exp_f32 v185, v185
    v_mfma_f32_16x16x32_bf16 v[180:183], a[156:159], v[60:63], v[224:227]
    v_exp_f32 v186, v186
    v_mfma_f32_16x16x32_bf16 v[180:183], a[152:155], v[56:59], v[180:183]
    v_add_f32 v253, v253, v184
    v_add_f32 v253, v253, v185
    v_mfma_f32_16x16x32_bf16 v[180:183], a[148:151], v[52:55], v[180:183]
    v_exp_f32 v187, v187
    v_mfma_f32_16x16x32_bf16 v[180:183], a[144:147], v[48:51], v[180:183]
    s_waitcnt lgkmcnt(4)
    v_cvt_pk_bf16_f32 v200, v184, v185
    v_add_f32 v253, v253, v186
    v_mfma_f32_16x16x32_bf16 a[0:3], v[208:211], a[224:227], a[0:3]
    v_exp_f32 v188, v188
    v_mfma_f32_16x16x32_bf16 a[0:3], v[192:195], a[192:195], a[0:3]
    v_add_f32 v253, v253, v187
    v_cvt_pk_bf16_f32 v201, v186, v187
    v_mfma_f32_16x16x32_bf16 a[4:7], v[192:195], a[196:199], a[4:7]
    v_exp_f32 v189, v189
    v_mfma_f32_16x16x32_bf16 a[4:7], v[208:211], a[228:231], a[4:7]
    v_exp_f32 v190, v190
    v_mfma_f32_16x16x32_bf16 a[8:11], v[208:211], a[232:235], a[8:11]
    v_add_f32 v253, v253, v188
    v_add_f32 v253, v253, v189
    v_mfma_f32_16x16x32_bf16 a[8:11], v[192:195], a[200:203], a[8:11]
    v_exp_f32 v191, v191
    v_mfma_f32_16x16x32_bf16 a[12:15], v[192:195], a[204:207], a[12:15]
    v_cvt_pk_bf16_f32 v202, v188, v189
    v_add_f32 v253, v253, v190
    v_mfma_f32_16x16x32_bf16 a[12:15], v[208:211], a[236:239], a[12:15]
    s_waitcnt vmcnt(44) lgkmcnt(0)
    v_add_f32 v253, v253, v191
    v_cvt_pk_bf16_f32 v203, v190, v191
    v_mfma_f32_16x16x32_bf16 v[184:187], a[128:131], v[64:67], v[228:231]
    s_barrier
    ds_read_b128 a[160:163], v240 offset:24576
    ds_read_b128 a[164:167], v241 offset:24576
    v_mfma_f32_16x16x32_bf16 v[184:187], a[132:135], v[68:71], v[184:187]
    v_exp_f32 v176, v176
    v_mfma_f32_16x16x32_bf16 v[184:187], a[136:139], v[72:75], v[184:187]
    s_add_u32 m0, s34, 0
    ds_read_b128 a[168:171], v242 offset:24576
    ds_read_b128 a[172:175], v243 offset:24576
    v_mfma_f32_16x16x32_bf16 v[184:187], a[140:143], v[76:79], v[184:187]
    buffer_load_dwordx4 v96, s[12:15], s32 offen offset:0 nt lds
    v_exp_f32 v177, v177
    v_mfma_f32_16x16x32_bf16 v[188:191], a[156:159], v[76:79], v[228:231]
    buffer_load_dwordx4 v97, s[12:15], s32 offen offset:1024 nt lds
    v_exp_f32 v178, v178
    v_mfma_f32_16x16x32_bf16 v[188:191], a[152:155], v[72:75], v[188:191]
    v_add_f32 v254, v254, v176
    v_add_f32 v254, v254, v177
    v_mfma_f32_16x16x32_bf16 v[188:191], a[148:151], v[68:71], v[188:191]
    buffer_load_dwordx4 v98, s[12:15], s32 offen offset:2048 nt lds
    v_exp_f32 v179, v179
    v_mfma_f32_16x16x32_bf16 v[188:191], a[144:147], v[64:67], v[188:191]
    buffer_load_dwordx4 v99, s[12:15], s32 offen offset:3072 nt lds
    v_cvt_pk_bf16_f32 v196, v176, v177
    v_add_f32 v254, v254, v178
    v_mfma_f32_16x16x32_bf16 a[16:19], v[208:211], a[240:243], a[16:19]
    s_add_u32 m0, s34, 4096
    v_exp_f32 v180, v180
    v_mfma_f32_16x16x32_bf16 a[16:19], v[192:195], a[208:211], a[16:19]
    buffer_load_dwordx4 v96, s[12:15], s35 offen offset:0 nt lds
    v_add_f32 v254, v254, v179
    v_cvt_pk_bf16_f32 v197, v178, v179
    v_mfma_f32_16x16x32_bf16 a[20:23], v[192:195], a[212:215], a[20:23]
    buffer_load_dwordx4 v97, s[12:15], s35 offen offset:1024 nt lds
    v_exp_f32 v181, v181
    v_mfma_f32_16x16x32_bf16 a[20:23], v[208:211], a[244:247], a[20:23]
    v_exp_f32 v182, v182
    v_mfma_f32_16x16x32_bf16 a[24:27], v[208:211], a[248:251], a[24:27]
    buffer_load_dwordx4 v98, s[12:15], s35 offen offset:2048 nt lds
    v_add_f32 v254, v254, v180
    v_add_f32 v254, v254, v181
    v_mfma_f32_16x16x32_bf16 a[24:27], v[192:195], a[216:219], a[24:27]
    buffer_load_dwordx4 v99, s[12:15], s35 offen offset:3072 nt lds
    v_exp_f32 v183, v183
    v_mfma_f32_16x16x32_bf16 a[28:31], v[192:195], a[220:223], a[28:31]
    s_add_u32 m0, s34, 32768
    v_cvt_pk_bf16_f32 v198, v180, v181
    v_add_f32 v254, v254, v182
    v_mfma_f32_16x16x32_bf16 a[28:31], v[208:211], a[252:255], a[28:31]
    buffer_load_dwordx4 v96, s[16:19], s32 offen offset:0 nt lds
    v_add_f32 v254, v254, v183
    v_cvt_pk_bf16_f32 v199, v182, v183
    v_mfma_f32_16x16x32_bf16 v[176:179], a[128:131], v[80:83], v[232:235]
    ds_read_b128 a[176:179], v240 offset:28672
    ds_read_b128 a[180:183], v241 offset:28672
    v_mfma_f32_16x16x32_bf16 v[176:179], a[132:135], v[84:87], v[176:179]
    v_exp_f32 v184, v184
    v_mfma_f32_16x16x32_bf16 v[176:179], a[136:139], v[88:91], v[176:179]
    ds_read_b128 a[184:187], v242 offset:28672
    ds_read_b128 a[188:191], v243 offset:28672
    v_mfma_f32_16x16x32_bf16 v[176:179], a[140:143], v[92:95], v[176:179]
    buffer_load_dwordx4 v97, s[16:19], s32 offen offset:1024 nt lds
    v_exp_f32 v185, v185
    v_mfma_f32_16x16x32_bf16 v[180:183], a[156:159], v[92:95], v[232:235]
    buffer_load_dwordx4 v96, s[16:19], s32 offen offset:2048 nt lds
    v_exp_f32 v186, v186
    v_mfma_f32_16x16x32_bf16 v[180:183], a[152:155], v[88:91], v[180:183]
    v_add_f32 v255, v255, v184
    v_add_f32 v255, v255, v185
    v_mfma_f32_16x16x32_bf16 v[180:183], a[148:151], v[84:87], v[180:183]
    buffer_load_dwordx4 v97, s[16:19], s32 offen offset:3072 nt lds
    v_exp_f32 v187, v187
    v_mfma_f32_16x16x32_bf16 v[180:183], a[144:147], v[80:83], v[180:183]
    s_add_u32 m0, s34, 36864
    v_cvt_pk_bf16_f32 v204, v184, v185
    v_add_f32 v255, v255, v186
    v_mfma_f32_16x16x32_bf16 a[64:67], v[212:215], a[224:227], a[64:67]
    buffer_load_dwordx4 v96, s[16:19], s35 offen offset:0 nt lds
    v_exp_f32 v188, v188
    v_mfma_f32_16x16x32_bf16 a[64:67], v[196:199], a[192:195], a[64:67]
    buffer_load_dwordx4 v97, s[16:19], s35 offen offset:1024 nt lds
    v_add_f32 v255, v255, v187
    v_cvt_pk_bf16_f32 v205, v186, v187
    v_mfma_f32_16x16x32_bf16 a[68:71], v[196:199], a[196:199], a[68:71]
    buffer_load_dwordx4 v96, s[16:19], s35 offen offset:2048 nt lds
    v_exp_f32 v189, v189
    v_mfma_f32_16x16x32_bf16 a[68:71], v[212:215], a[228:231], a[68:71]
    v_exp_f32 v190, v190
    v_mfma_f32_16x16x32_bf16 a[72:75], v[212:215], a[232:235], a[72:75]
    buffer_load_dwordx4 v97, s[16:19], s35 offen offset:3072 nt lds
    v_add_f32 v255, v255, v188
    v_add_f32 v255, v255, v189
    v_mfma_f32_16x16x32_bf16 a[72:75], v[196:199], a[200:203], a[72:75]
    v_exp_f32 v191, v191
    v_mfma_f32_16x16x32_bf16 a[76:79], v[196:199], a[204:207], a[76:79]
    v_cvt_pk_bf16_f32 v206, v188, v189
    v_add_f32 v255, v255, v190
    v_mfma_f32_16x16x32_bf16 a[76:79], v[212:215], a[236:239], a[76:79]
    s_waitcnt lgkmcnt(0)
    v_add_f32 v255, v255, v191
    v_cvt_pk_bf16_f32 v207, v190, v191
    v_mfma_f32_16x16x32_bf16 v[184:187], a[160:163], v[32:35], v[220:223]
    ds_read_b64_tr_b16 a[224:225], v244 offset:24576
    ds_read_b64_tr_b16 a[226:227], v244 offset:28672
    v_mfma_f32_16x16x32_bf16 v[184:187], a[164:167], v[36:39], v[184:187]
    s_add_u32 s33, s33, 1
    v_exp_f32 v176, v176
    v_mfma_f32_16x16x32_bf16 v[184:187], a[168:171], v[40:43], v[184:187]
    s_add_u32 s32, s32, 8192
    ds_read_b64_tr_b16 a[228:229], v245 offset:24576
    ds_read_b64_tr_b16 a[230:231], v245 offset:28672
    v_mfma_f32_16x16x32_bf16 v[184:187], a[172:175], v[44:47], v[184:187]
    s_cmp_eq_u32 s33, 23
    v_exp_f32 v177, v177
    v_mfma_f32_16x16x32_bf16 v[188:191], a[188:191], v[44:47], v[220:223]
    s_cselect_b32 s32, s26, s32
    v_exp_f32 v178, v178
    v_mfma_f32_16x16x32_bf16 v[188:191], a[184:187], v[40:43], v[188:191]
    s_cmp_eq_u32 s33, 46
    ds_read_b64_tr_b16 a[232:233], v246 offset:24576
    v_add_f32 v0, v0, v176
    v_add_f32 v0, v0, v177
    v_mfma_f32_16x16x32_bf16 v[188:191], a[180:183], v[36:39], v[188:191]
    s_cselect_b32 s32, s37, s32
    v_exp_f32 v179, v179
    v_mfma_f32_16x16x32_bf16 v[188:191], a[176:179], v[32:35], v[188:191]
    s_add_u32 s35, s32, 4096
    v_cvt_pk_bf16_f32 v192, v176, v177
    v_add_f32 v0, v0, v178
    v_mfma_f32_16x16x32_bf16 a[80:83], v[212:215], a[240:243], a[80:83]
    s_add_u32 s34, s34, 8192
    v_exp_f32 v180, v180
    v_mfma_f32_16x16x32_bf16 a[80:83], v[196:199], a[208:211], a[80:83]
    s_and_b32 s34, s34, 32767
    ds_read_b64_tr_b16 a[234:235], v246 offset:28672
    v_add_f32 v0, v0, v179
    v_cvt_pk_bf16_f32 v193, v178, v179
    v_mfma_f32_16x16x32_bf16 a[84:87], v[196:199], a[212:215], a[84:87]
    v_exp_f32 v181, v181
    v_mfma_f32_16x16x32_bf16 a[84:87], v[212:215], a[244:247], a[84:87]
    v_exp_f32 v182, v182
    v_mfma_f32_16x16x32_bf16 a[88:91], v[212:215], a[248:251], a[88:91]
    v_add_f32 v0, v0, v180
    v_add_f32 v0, v0, v181
    v_mfma_f32_16x16x32_bf16 a[88:91], v[196:199], a[216:219], a[88:91]
    v_exp_f32 v183, v183
    v_mfma_f32_16x16x32_bf16 a[92:95], v[196:199], a[220:223], a[92:95]
    v_cvt_pk_bf16_f32 v194, v180, v181
    v_add_f32 v0, v0, v182
    v_mfma_f32_16x16x32_bf16 a[92:95], v[212:215], a[252:255], a[92:95]
    v_add_f32 v0, v0, v183
    v_cvt_pk_bf16_f32 v195, v182, v183
    v_mfma_f32_16x16x32_bf16 v[176:179], a[160:163], v[16:19], v[216:219]
    s_cmp_lt_u32 s54, 65536
    ds_read_b64_tr_b16 a[236:237], v247 offset:24576
    ds_read_b64_tr_b16 a[238:239], v247 offset:28672
    v_mfma_f32_16x16x32_bf16 v[176:179], a[164:167], v[20:23], v[176:179]
    s_cselect_b32 s52, s37, s53
    v_exp_f32 v184, v184
    v_mfma_f32_16x16x32_bf16 v[176:179], a[168:171], v[24:27], v[176:179]
    s_cselect_b32 m0, 159744, s54
    ds_read_b64_tr_b16 a[240:241], v248 offset:24576
    ds_read_b64_tr_b16 a[242:243], v248 offset:28672
    v_mfma_f32_16x16x32_bf16 v[176:179], a[172:175], v[28:31], v[176:179]
    s_add_u32 s53, s53, 4096
    buffer_load_dwordx4 v96, s[8:11], s52 offen offset:0 nt lds
    v_exp_f32 v185, v185
    v_mfma_f32_16x16x32_bf16 v[180:183], a[188:191], v[28:31], v[216:219]
    s_add_u32 s54, s54, 4096
    buffer_load_dwordx4 v97, s[8:11], s52 offen offset:1024 nt lds
    v_exp_f32 v186, v186
    v_mfma_f32_16x16x32_bf16 v[180:183], a[184:187], v[24:27], v[180:183]
    ds_read_b64_tr_b16 a[244:245], v249 offset:24576
    v_add_f32 v253, v253, v184
    v_add_f32 v253, v253, v185
    v_mfma_f32_16x16x32_bf16 v[180:183], a[180:183], v[20:23], v[180:183]
    buffer_load_dwordx4 v98, s[8:11], s52 offen offset:2048 nt lds
    v_exp_f32 v187, v187
    v_mfma_f32_16x16x32_bf16 v[180:183], a[176:179], v[16:19], v[180:183]
    buffer_load_dwordx4 v99, s[8:11], s52 offen offset:3072 nt lds
    v_cvt_pk_bf16_f32 v196, v184, v185
    v_add_f32 v253, v253, v186
    v_mfma_f32_16x16x32_bf16 v[144:147], v[192:195], a[192:195], v[144:147]
    s_cmp_lt_u32 s54, 65536
    v_exp_f32 v188, v188
    v_mfma_f32_16x16x32_bf16 v[148:151], v[192:195], a[196:199], v[148:151]
    s_cselect_b32 s52, s37, s53
    ds_read_b64_tr_b16 a[246:247], v249 offset:28672
    v_add_f32 v253, v253, v187
    v_cvt_pk_bf16_f32 v197, v186, v187
    v_mfma_f32_16x16x32_bf16 v[152:155], v[192:195], a[200:203], v[152:155]
    s_cselect_b32 m0, 159744, s54
    v_exp_f32 v189, v189
    v_mfma_f32_16x16x32_bf16 v[156:159], v[192:195], a[204:207], v[156:159]
    s_add_u32 s53, s53, 4096
    buffer_load_dwordx4 v96, s[8:11], s52 offen offset:0 nt lds
    v_exp_f32 v190, v190
    v_mfma_f32_16x16x32_bf16 v[160:163], v[192:195], a[208:211], v[160:163]
    s_add_u32 s54, s54, 4096
    buffer_load_dwordx4 v97, s[8:11], s52 offen offset:1024 nt lds
    v_add_f32 v253, v253, v188
    v_add_f32 v253, v253, v189
    v_mfma_f32_16x16x32_bf16 v[164:167], v[192:195], a[212:215], v[164:167]
    buffer_load_dwordx4 v98, s[8:11], s52 offen offset:2048 nt lds
    v_exp_f32 v191, v191
    v_mfma_f32_16x16x32_bf16 v[168:171], v[192:195], a[216:219], v[168:171]
    buffer_load_dwordx4 v99, s[8:11], s52 offen offset:3072 nt lds
    v_cvt_pk_bf16_f32 v198, v188, v189
    v_add_f32 v253, v253, v190
    v_mfma_f32_16x16x32_bf16 v[172:175], v[192:195], a[220:223], v[172:175]
    v_add_f32 v253, v253, v191
    v_cvt_pk_bf16_f32 v199, v190, v191
    v_mfma_f32_16x16x32_bf16 v[184:187], a[160:163], v[64:67], v[228:231]
    ds_read_b64_tr_b16 a[248:249], v250 offset:24576
    ds_read_b64_tr_b16 a[250:251], v250 offset:28672
    v_mfma_f32_16x16x32_bf16 v[184:187], a[164:167], v[68:71], v[184:187]
    v_exp_f32 v176, v176
    v_mfma_f32_16x16x32_bf16 v[184:187], a[168:171], v[72:75], v[184:187]
    ds_read_b64_tr_b16 a[252:253], v251 offset:24576
    ds_read_b64_tr_b16 a[254:255], v251 offset:28672
    v_mfma_f32_16x16x32_bf16 v[184:187], a[172:175], v[76:79], v[184:187]
    v_exp_f32 v177, v177
    v_mfma_f32_16x16x32_bf16 v[188:191], a[188:191], v[76:79], v[228:231]
    v_exp_f32 v178, v178
    v_mfma_f32_16x16x32_bf16 v[188:191], a[184:187], v[72:75], v[188:191]
    v_add_f32 v252, v252, v176
    v_add_f32 v252, v252, v177
    v_mfma_f32_16x16x32_bf16 v[188:191], a[180:183], v[68:71], v[188:191]
    v_exp_f32 v179, v179
    v_mfma_f32_16x16x32_bf16 v[188:191], a[176:179], v[64:67], v[188:191]
    s_waitcnt lgkmcnt(4)
    v_cvt_pk_bf16_f32 v208, v176, v177
    v_add_f32 v252, v252, v178
    v_mfma_f32_16x16x32_bf16 a[32:35], v[200:203], a[192:195], a[32:35]
    v_exp_f32 v180, v180
    v_mfma_f32_16x16x32_bf16 a[32:35], v[196:199], a[224:227], a[32:35]
    v_add_f32 v252, v252, v179
    v_cvt_pk_bf16_f32 v209, v178, v179
    v_mfma_f32_16x16x32_bf16 a[36:39], v[196:199], a[228:231], a[36:39]
    v_exp_f32 v181, v181
    v_mfma_f32_16x16x32_bf16 a[36:39], v[200:203], a[196:199], a[36:39]
    v_exp_f32 v182, v182
    v_mfma_f32_16x16x32_bf16 a[40:43], v[200:203], a[200:203], a[40:43]
    v_add_f32 v252, v252, v180
    v_add_f32 v252, v252, v181
    v_mfma_f32_16x16x32_bf16 a[40:43], v[196:199], a[232:235], a[40:43]
    v_exp_f32 v183, v183
    v_mfma_f32_16x16x32_bf16 a[44:47], v[196:199], a[236:239], a[44:47]
    v_cvt_pk_bf16_f32 v210, v180, v181
    v_add_f32 v252, v252, v182
    v_mfma_f32_16x16x32_bf16 a[44:47], v[200:203], a[204:207], a[44:47]
    s_waitcnt vmcnt(48) lgkmcnt(0)
    v_add_f32 v252, v252, v183
    v_cvt_pk_bf16_f32 v211, v182, v183
    v_mfma_f32_16x16x32_bf16 v[176:179], a[160:163], v[48:51], v[224:227]
    s_barrier
    ds_read_b128 a[128:131], v240 offset:0
    ds_read_b128 a[132:135], v241 offset:0
    v_mfma_f32_16x16x32_bf16 v[176:179], a[164:167], v[52:55], v[176:179]
    v_exp_f32 v184, v184
    v_mfma_f32_16x16x32_bf16 v[176:179], a[168:171], v[56:59], v[176:179]
    s_add_u32 m0, s34, 0
    ds_read_b128 a[136:139], v242 offset:0
    ds_read_b128 a[140:143], v243 offset:0
    v_mfma_f32_16x16x32_bf16 v[176:179], a[172:175], v[60:63], v[176:179]
    buffer_load_dwordx4 v96, s[12:15], s32 offen offset:0 nt lds
    v_exp_f32 v185, v185
    v_mfma_f32_16x16x32_bf16 v[180:183], a[188:191], v[60:63], v[224:227]
    buffer_load_dwordx4 v97, s[12:15], s32 offen offset:1024 nt lds
    v_exp_f32 v186, v186
    v_mfma_f32_16x16x32_bf16 v[180:183], a[184:187], v[56:59], v[180:183]
    v_add_f32 v255, v255, v184
    v_add_f32 v255, v255, v185
    v_mfma_f32_16x16x32_bf16 v[180:183], a[180:183], v[52:55], v[180:183]
    buffer_load_dwordx4 v98, s[12:15], s32 offen offset:2048 nt lds
    v_exp_f32 v187, v187
    v_mfma_f32_16x16x32_bf16 v[180:183], a[176:179], v[48:51], v[180:183]
    buffer_load_dwordx4 v99, s[12:15], s32 offen offset:3072 nt lds
    v_cvt_pk_bf16_f32 v192, v184, v185
    v_add_f32 v255, v255, v186
    v_mfma_f32_16x16x32_bf16 a[48:51], v[200:203], a[208:211], a[48:51]
    s_add_u32 m0, s34, 4096
    v_exp_f32 v188, v188
    v_mfma_f32_16x16x32_bf16 a[48:51], v[196:199], a[240:243], a[48:51]
    buffer_load_dwordx4 v96, s[12:15], s35 offen offset:0 nt lds
    v_add_f32 v255, v255, v187
    v_cvt_pk_bf16_f32 v193, v186, v187
    v_mfma_f32_16x16x32_bf16 a[52:55], v[196:199], a[244:247], a[52:55]
    buffer_load_dwordx4 v97, s[12:15], s35 offen offset:1024 nt lds
    v_exp_f32 v189, v189
    v_mfma_f32_16x16x32_bf16 a[52:55], v[200:203], a[212:215], a[52:55]
    v_exp_f32 v190, v190
    v_mfma_f32_16x16x32_bf16 a[56:59], v[200:203], a[216:219], a[56:59]
    buffer_load_dwordx4 v98, s[12:15], s35 offen offset:2048 nt lds
    v_add_f32 v255, v255, v188
    v_add_f32 v255, v255, v189
    v_mfma_f32_16x16x32_bf16 a[56:59], v[196:199], a[248:251], a[56:59]
    buffer_load_dwordx4 v99, s[12:15], s35 offen offset:3072 nt lds
    v_exp_f32 v191, v191
    v_mfma_f32_16x16x32_bf16 a[60:63], v[196:199], a[252:255], a[60:63]
    s_add_u32 m0, s34, 32768
    v_cvt_pk_bf16_f32 v194, v188, v189
    v_add_f32 v255, v255, v190
    v_mfma_f32_16x16x32_bf16 a[60:63], v[200:203], a[220:223], a[60:63]
    buffer_load_dwordx4 v96, s[16:19], s32 offen offset:0 nt lds
    v_add_f32 v255, v255, v191
    v_cvt_pk_bf16_f32 v195, v190, v191
    v_mfma_f32_16x16x32_bf16 v[184:187], a[160:163], v[80:83], v[232:235]
    ds_read_b128 a[144:147], v240 offset:4096
    ds_read_b128 a[148:151], v241 offset:4096
    v_mfma_f32_16x16x32_bf16 v[184:187], a[164:167], v[84:87], v[184:187]
    v_exp_f32 v176, v176
    v_mfma_f32_16x16x32_bf16 v[184:187], a[168:171], v[88:91], v[184:187]
    ds_read_b128 a[152:155], v242 offset:4096
    ds_read_b128 a[156:159], v243 offset:4096
    v_mfma_f32_16x16x32_bf16 v[184:187], a[172:175], v[92:95], v[184:187]
    buffer_load_dwordx4 v97, s[16:19], s32 offen offset:1024 nt lds
    v_exp_f32 v177, v177
    v_mfma_f32_16x16x32_bf16 v[188:191], a[188:191], v[92:95], v[232:235]
    buffer_load_dwordx4 v96, s[16:19], s32 offen offset:2048 nt lds
    v_exp_f32 v178, v178
    v_mfma_f32_16x16x32_bf16 v[188:191], a[184:187], v[88:91], v[188:191]
    v_add_f32 v254, v254, v176
    v_add_f32 v254, v254, v177
    v_mfma_f32_16x16x32_bf16 v[188:191], a[180:183], v[84:87], v[188:191]
    buffer_load_dwordx4 v97, s[16:19], s32 offen offset:3072 nt lds
    v_exp_f32 v179, v179
    v_mfma_f32_16x16x32_bf16 v[188:191], a[176:179], v[80:83], v[188:191]
    s_add_u32 m0, s34, 36864
    v_cvt_pk_bf16_f32 v212, v176, v177
    v_add_f32 v254, v254, v178
    v_mfma_f32_16x16x32_bf16 v[112:115], v[204:207], a[192:195], v[112:115]
    buffer_load_dwordx4 v96, s[16:19], s35 offen offset:0 nt lds
    v_exp_f32 v180, v180
    v_mfma_f32_16x16x32_bf16 v[112:115], v[192:195], a[224:227], v[112:115]
    buffer_load_dwordx4 v97, s[16:19], s35 offen offset:1024 nt lds
    v_add_f32 v254, v254, v179
    v_cvt_pk_bf16_f32 v213, v178, v179
    v_mfma_f32_16x16x32_bf16 v[116:119], v[192:195], a[228:231], v[116:119]
    buffer_load_dwordx4 v96, s[16:19], s35 offen offset:2048 nt lds
    v_exp_f32 v181, v181
    v_mfma_f32_16x16x32_bf16 v[116:119], v[204:207], a[196:199], v[116:119]
    v_exp_f32 v182, v182
    v_mfma_f32_16x16x32_bf16 v[120:123], v[204:207], a[200:203], v[120:123]
    buffer_load_dwordx4 v97, s[16:19], s35 offen offset:3072 nt lds
    v_add_f32 v254, v254, v180
    v_add_f32 v254, v254, v181
    v_mfma_f32_16x16x32_bf16 v[120:123], v[192:195], a[232:235], v[120:123]
    v_exp_f32 v183, v183
    v_mfma_f32_16x16x32_bf16 v[124:127], v[192:195], a[236:239], v[124:127]
    v_cvt_pk_bf16_f32 v214, v180, v181
    v_add_f32 v254, v254, v182
    v_mfma_f32_16x16x32_bf16 v[124:127], v[204:207], a[204:207], v[124:127]
    s_waitcnt lgkmcnt(0)
    v_add_f32 v254, v254, v183
    v_cvt_pk_bf16_f32 v215, v182, v183
    v_mfma_f32_16x16x32_bf16 v[176:179], a[128:131], v[16:19], v[216:219]
    ds_read_b64_tr_b16 a[192:193], v244 offset:0
    ds_read_b64_tr_b16 a[194:195], v244 offset:4096
    v_mfma_f32_16x16x32_bf16 v[176:179], a[132:135], v[20:23], v[176:179]
    s_add_u32 s33, s33, 1
    v_exp_f32 v184, v184
    v_mfma_f32_16x16x32_bf16 v[176:179], a[136:139], v[24:27], v[176:179]
    s_add_u32 s32, s32, 8192
    ds_read_b64_tr_b16 a[196:197], v245 offset:0
    ds_read_b64_tr_b16 a[198:199], v245 offset:4096
    v_mfma_f32_16x16x32_bf16 v[176:179], a[140:143], v[28:31], v[176:179]
    s_cmp_eq_u32 s33, 23
    v_exp_f32 v185, v185
    v_mfma_f32_16x16x32_bf16 v[180:183], a[156:159], v[28:31], v[216:219]
    s_cselect_b32 s32, s26, s32
    v_exp_f32 v186, v186
    v_mfma_f32_16x16x32_bf16 v[180:183], a[152:155], v[24:27], v[180:183]
    s_cmp_eq_u32 s33, 46
    ds_read_b64_tr_b16 a[200:201], v246 offset:0
    v_add_f32 v0, v0, v184
    v_add_f32 v0, v0, v185
    v_mfma_f32_16x16x32_bf16 v[180:183], a[148:151], v[20:23], v[180:183]
    s_cselect_b32 s32, s37, s32
    v_exp_f32 v187, v187
    v_mfma_f32_16x16x32_bf16 v[180:183], a[144:147], v[16:19], v[180:183]
    s_add_u32 s35, s32, 4096
    v_cvt_pk_bf16_f32 v196, v184, v185
    v_add_f32 v0, v0, v186
    v_mfma_f32_16x16x32_bf16 v[128:131], v[204:207], a[208:211], v[128:131]
    s_add_u32 s34, s34, 8192
    v_exp_f32 v188, v188
    v_mfma_f32_16x16x32_bf16 v[128:131], v[192:195], a[240:243], v[128:131]
    s_and_b32 s34, s34, 32767
    ds_read_b64_tr_b16 a[202:203], v246 offset:4096
    v_add_f32 v0, v0, v187
    v_cvt_pk_bf16_f32 v197, v186, v187
    v_mfma_f32_16x16x32_bf16 v[132:135], v[192:195], a[244:247], v[132:135]
    v_exp_f32 v189, v189
    v_mfma_f32_16x16x32_bf16 v[132:135], v[204:207], a[212:215], v[132:135]
    v_exp_f32 v190, v190
    v_mfma_f32_16x16x32_bf16 v[136:139], v[204:207], a[216:219], v[136:139]
    v_add_f32 v0, v0, v188
    v_add_f32 v0, v0, v189
    v_mfma_f32_16x16x32_bf16 v[136:139], v[192:195], a[248:251], v[136:139]
    v_exp_f32 v191, v191
    v_mfma_f32_16x16x32_bf16 v[140:143], v[192:195], a[252:255], v[140:143]
    v_cvt_pk_bf16_f32 v198, v188, v189
    v_add_f32 v0, v0, v190
    v_mfma_f32_16x16x32_bf16 v[140:143], v[204:207], a[220:223], v[140:143]
    v_add_f32 v0, v0, v191
    v_cvt_pk_bf16_f32 v199, v190, v191
    v_mfma_f32_16x16x32_bf16 v[184:187], a[128:131], v[32:35], v[220:223]
    s_cmp_lt_u32 s54, 65536
    ds_read_b64_tr_b16 a[204:205], v247 offset:0
    ds_read_b64_tr_b16 a[206:207], v247 offset:4096
    v_mfma_f32_16x16x32_bf16 v[184:187], a[132:135], v[36:39], v[184:187]
    s_cselect_b32 s52, s37, s53
    v_exp_f32 v176, v176
    v_mfma_f32_16x16x32_bf16 v[184:187], a[136:139], v[40:43], v[184:187]
    s_cselect_b32 m0, 159744, s54
    ds_read_b64_tr_b16 a[208:209], v248 offset:0
    ds_read_b64_tr_b16 a[210:211], v248 offset:4096
    v_mfma_f32_16x16x32_bf16 v[184:187], a[140:143], v[44:47], v[184:187]
    s_add_u32 s53, s53, 4096
    buffer_load_dwordx4 v96, s[8:11], s52 offen offset:0 nt lds
    v_exp_f32 v177, v177
    v_mfma_f32_16x16x32_bf16 v[188:191], a[156:159], v[44:47], v[220:223]
    s_add_u32 s54, s54, 4096
    buffer_load_dwordx4 v97, s[8:11], s52 offen offset:1024 nt lds
    v_exp_f32 v178, v178
    v_mfma_f32_16x16x32_bf16 v[188:191], a[152:155], v[40:43], v[188:191]
    ds_read_b64_tr_b16 a[212:213], v249 offset:0
    v_add_f32 v252, v252, v176
    v_add_f32 v252, v252, v177
    v_mfma_f32_16x16x32_bf16 v[188:191], a[148:151], v[36:39], v[188:191]
    buffer_load_dwordx4 v98, s[8:11], s52 offen offset:2048 nt lds
    v_exp_f32 v179, v179
    v_mfma_f32_16x16x32_bf16 v[188:191], a[144:147], v[32:35], v[188:191]
    buffer_load_dwordx4 v99, s[8:11], s52 offen offset:3072 nt lds
    v_cvt_pk_bf16_f32 v192, v176, v177
    v_add_f32 v252, v252, v178
    v_mfma_f32_16x16x32_bf16 v[144:147], v[196:199], a[224:227], v[144:147]
    v_exp_f32 v180, v180
    v_mfma_f32_16x16x32_bf16 v[148:151], v[196:199], a[228:231], v[148:151]
    ds_read_b64_tr_b16 a[214:215], v249 offset:4096
    v_add_f32 v252, v252, v179
    v_cvt_pk_bf16_f32 v193, v178, v179
    v_mfma_f32_16x16x32_bf16 v[152:155], v[196:199], a[232:235], v[152:155]
    v_exp_f32 v181, v181
    v_mfma_f32_16x16x32_bf16 v[156:159], v[196:199], a[236:239], v[156:159]
    v_exp_f32 v182, v182
    v_mfma_f32_16x16x32_bf16 v[160:163], v[196:199], a[240:243], v[160:163]
    v_add_f32 v252, v252, v180
    v_add_f32 v252, v252, v181
    v_mfma_f32_16x16x32_bf16 v[164:167], v[196:199], a[244:247], v[164:167]
    v_exp_f32 v183, v183
    v_mfma_f32_16x16x32_bf16 v[168:171], v[196:199], a[248:251], v[168:171]
    v_cvt_pk_bf16_f32 v194, v180, v181
    v_add_f32 v252, v252, v182
    v_mfma_f32_16x16x32_bf16 v[172:175], v[196:199], a[252:255], v[172:175]
    v_add_f32 v252, v252, v183
    v_cvt_pk_bf16_f32 v195, v182, v183
    v_mfma_f32_16x16x32_bf16 v[176:179], a[128:131], v[48:51], v[224:227]
    ds_read_b64_tr_b16 a[216:217], v250 offset:0
    ds_read_b64_tr_b16 a[218:219], v250 offset:4096
    v_mfma_f32_16x16x32_bf16 v[176:179], a[132:135], v[52:55], v[176:179]
    v_exp_f32 v184, v184
    v_mfma_f32_16x16x32_bf16 v[176:179], a[136:139], v[56:59], v[176:179]
    ds_read_b64_tr_b16 a[220:221], v251 offset:0
    ds_read_b64_tr_b16 a[222:223], v251 offset:4096
    v_mfma_f32_16x16x32_bf16 v[176:179], a[140:143], v[60:63], v[176:179]
    v_exp_f32 v185, v185
    v_mfma_f32_16x16x32_bf16 v[180:183], a[156:159], v[60:63], v[224:227]
    v_exp_f32 v186, v186
    v_mfma_f32_16x16x32_bf16 v[180:183], a[152:155], v[56:59], v[180:183]
    v_add_f32 v253, v253, v184
    v_add_f32 v253, v253, v185
    v_mfma_f32_16x16x32_bf16 v[180:183], a[148:151], v[52:55], v[180:183]
    v_exp_f32 v187, v187
    v_mfma_f32_16x16x32_bf16 v[180:183], a[144:147], v[48:51], v[180:183]
    s_waitcnt lgkmcnt(4)
    v_cvt_pk_bf16_f32 v200, v184, v185
    v_add_f32 v253, v253, v186
    v_mfma_f32_16x16x32_bf16 a[0:3], v[208:211], a[224:227], a[0:3]
    v_exp_f32 v188, v188
    v_mfma_f32_16x16x32_bf16 a[0:3], v[192:195], a[192:195], a[0:3]
    v_add_f32 v253, v253, v187
    v_cvt_pk_bf16_f32 v201, v186, v187
    v_mfma_f32_16x16x32_bf16 a[4:7], v[192:195], a[196:199], a[4:7]
    v_exp_f32 v189, v189
    v_mfma_f32_16x16x32_bf16 a[4:7], v[208:211], a[228:231], a[4:7]
    v_exp_f32 v190, v190
    v_mfma_f32_16x16x32_bf16 a[8:11], v[208:211], a[232:235], a[8:11]
    v_add_f32 v253, v253, v188
    v_add_f32 v253, v253, v189
    v_mfma_f32_16x16x32_bf16 a[8:11], v[192:195], a[200:203], a[8:11]
    v_exp_f32 v191, v191
    v_mfma_f32_16x16x32_bf16 a[12:15], v[192:195], a[204:207], a[12:15]
    v_cvt_pk_bf16_f32 v202, v188, v189
    v_add_f32 v253, v253, v190
    v_mfma_f32_16x16x32_bf16 a[12:15], v[208:211], a[236:239], a[12:15]
    s_waitcnt vmcnt(48) lgkmcnt(0)
    v_add_f32 v253, v253, v191
    v_cvt_pk_bf16_f32 v203, v190, v191
    v_mfma_f32_16x16x32_bf16 v[184:187], a[128:131], v[64:67], v[228:231]
    s_barrier
    ds_read_b128 a[160:163], v240 offset:8192
    ds_read_b128 a[164:167], v241 offset:8192
    v_mfma_f32_16x16x32_bf16 v[184:187], a[132:135], v[68:71], v[184:187]
    v_exp_f32 v176, v176
    v_mfma_f32_16x16x32_bf16 v[184:187], a[136:139], v[72:75], v[184:187]
    s_add_u32 m0, s34, 0
    ds_read_b128 a[168:171], v242 offset:8192
    ds_read_b128 a[172:175], v243 offset:8192
    v_mfma_f32_16x16x32_bf16 v[184:187], a[140:143], v[76:79], v[184:187]
    buffer_load_dwordx4 v96, s[12:15], s32 offen offset:0 nt lds
    v_exp_f32 v177, v177
    v_mfma_f32_16x16x32_bf16 v[188:191], a[156:159], v[76:79], v[228:231]
    buffer_load_dwordx4 v97, s[12:15], s32 offen offset:1024 nt lds
    v_exp_f32 v178, v178
    v_mfma_f32_16x16x32_bf16 v[188:191], a[152:155], v[72:75], v[188:191]
    v_add_f32 v254, v254, v176
    v_add_f32 v254, v254, v177
    v_mfma_f32_16x16x32_bf16 v[188:191], a[148:151], v[68:71], v[188:191]
    buffer_load_dwordx4 v98, s[12:15], s32 offen offset:2048 nt lds
    v_exp_f32 v179, v179
    v_mfma_f32_16x16x32_bf16 v[188:191], a[144:147], v[64:67], v[188:191]
    buffer_load_dwordx4 v99, s[12:15], s32 offen offset:3072 nt lds
    v_cvt_pk_bf16_f32 v196, v176, v177
    v_add_f32 v254, v254, v178
    v_mfma_f32_16x16x32_bf16 a[16:19], v[208:211], a[240:243], a[16:19]
    s_add_u32 m0, s34, 4096
    v_exp_f32 v180, v180
    v_mfma_f32_16x16x32_bf16 a[16:19], v[192:195], a[208:211], a[16:19]
    buffer_load_dwordx4 v96, s[12:15], s35 offen offset:0 nt lds
    v_add_f32 v254, v254, v179
    v_cvt_pk_bf16_f32 v197, v178, v179
    v_mfma_f32_16x16x32_bf16 a[20:23], v[192:195], a[212:215], a[20:23]
    buffer_load_dwordx4 v97, s[12:15], s35 offen offset:1024 nt lds
    v_exp_f32 v181, v181
    v_mfma_f32_16x16x32_bf16 a[20:23], v[208:211], a[244:247], a[20:23]
    v_exp_f32 v182, v182
    v_mfma_f32_16x16x32_bf16 a[24:27], v[208:211], a[248:251], a[24:27]
    buffer_load_dwordx4 v98, s[12:15], s35 offen offset:2048 nt lds
    v_add_f32 v254, v254, v180
    v_add_f32 v254, v254, v181
    v_mfma_f32_16x16x32_bf16 a[24:27], v[192:195], a[216:219], a[24:27]
    buffer_load_dwordx4 v99, s[12:15], s35 offen offset:3072 nt lds
    v_exp_f32 v183, v183
    v_mfma_f32_16x16x32_bf16 a[28:31], v[192:195], a[220:223], a[28:31]
    s_add_u32 m0, s34, 32768
    v_cvt_pk_bf16_f32 v198, v180, v181
    v_add_f32 v254, v254, v182
    v_mfma_f32_16x16x32_bf16 a[28:31], v[208:211], a[252:255], a[28:31]
    buffer_load_dwordx4 v96, s[16:19], s32 offen offset:0 nt lds
    v_add_f32 v254, v254, v183
    v_cvt_pk_bf16_f32 v199, v182, v183
    v_mfma_f32_16x16x32_bf16 v[176:179], a[128:131], v[80:83], v[232:235]
    ds_read_b128 a[176:179], v240 offset:12288
    ds_read_b128 a[180:183], v241 offset:12288
    v_mfma_f32_16x16x32_bf16 v[176:179], a[132:135], v[84:87], v[176:179]
    v_exp_f32 v184, v184
    v_mfma_f32_16x16x32_bf16 v[176:179], a[136:139], v[88:91], v[176:179]
    ds_read_b128 a[184:187], v242 offset:12288
    ds_read_b128 a[188:191], v243 offset:12288
    v_mfma_f32_16x16x32_bf16 v[176:179], a[140:143], v[92:95], v[176:179]
    buffer_load_dwordx4 v97, s[16:19], s32 offen offset:1024 nt lds
    v_exp_f32 v185, v185
    v_mfma_f32_16x16x32_bf16 v[180:183], a[156:159], v[92:95], v[232:235]
    buffer_load_dwordx4 v96, s[16:19], s32 offen offset:2048 nt lds
    v_exp_f32 v186, v186
    v_mfma_f32_16x16x32_bf16 v[180:183], a[152:155], v[88:91], v[180:183]
    v_add_f32 v255, v255, v184
    v_add_f32 v255, v255, v185
    v_mfma_f32_16x16x32_bf16 v[180:183], a[148:151], v[84:87], v[180:183]
    buffer_load_dwordx4 v97, s[16:19], s32 offen offset:3072 nt lds
    v_exp_f32 v187, v187
    v_mfma_f32_16x16x32_bf16 v[180:183], a[144:147], v[80:83], v[180:183]
    s_add_u32 m0, s34, 36864
    v_cvt_pk_bf16_f32 v204, v184, v185
    v_add_f32 v255, v255, v186
    v_mfma_f32_16x16x32_bf16 a[64:67], v[212:215], a[224:227], a[64:67]
    buffer_load_dwordx4 v96, s[16:19], s35 offen offset:0 nt lds
    v_exp_f32 v188, v188
    v_mfma_f32_16x16x32_bf16 a[64:67], v[196:199], a[192:195], a[64:67]
    buffer_load_dwordx4 v97, s[16:19], s35 offen offset:1024 nt lds
    v_add_f32 v255, v255, v187
    v_cvt_pk_bf16_f32 v205, v186, v187
    v_mfma_f32_16x16x32_bf16 a[68:71], v[196:199], a[196:199], a[68:71]
    buffer_load_dwordx4 v96, s[16:19], s35 offen offset:2048 nt lds
    v_exp_f32 v189, v189
    v_mfma_f32_16x16x32_bf16 a[68:71], v[212:215], a[228:231], a[68:71]
    v_exp_f32 v190, v190
    v_mfma_f32_16x16x32_bf16 a[72:75], v[212:215], a[232:235], a[72:75]
    buffer_load_dwordx4 v97, s[16:19], s35 offen offset:3072 nt lds
    v_add_f32 v255, v255, v188
    v_add_f32 v255, v255, v189
    v_mfma_f32_16x16x32_bf16 a[72:75], v[196:199], a[200:203], a[72:75]
    v_exp_f32 v191, v191
    v_mfma_f32_16x16x32_bf16 a[76:79], v[196:199], a[204:207], a[76:79]
    v_cvt_pk_bf16_f32 v206, v188, v189
    v_add_f32 v255, v255, v190
    v_mfma_f32_16x16x32_bf16 a[76:79], v[212:215], a[236:239], a[76:79]
    s_waitcnt lgkmcnt(0)
    v_add_f32 v255, v255, v191
    v_cvt_pk_bf16_f32 v207, v190, v191
    v_mfma_f32_16x16x32_bf16 v[184:187], a[160:163], v[32:35], v[220:223]
    ds_read_b64_tr_b16 a[224:225], v244 offset:8192
    ds_read_b64_tr_b16 a[226:227], v244 offset:12288
    v_mfma_f32_16x16x32_bf16 v[184:187], a[164:167], v[36:39], v[184:187]
    s_add_u32 s33, s33, 1
    v_exp_f32 v176, v176
    v_mfma_f32_16x16x32_bf16 v[184:187], a[168:171], v[40:43], v[184:187]
    s_add_u32 s32, s32, 8192
    ds_read_b64_tr_b16 a[228:229], v245 offset:8192
    ds_read_b64_tr_b16 a[230:231], v245 offset:12288
    v_mfma_f32_16x16x32_bf16 v[184:187], a[172:175], v[44:47], v[184:187]
    s_cmp_eq_u32 s33, 23
    v_exp_f32 v177, v177
    v_mfma_f32_16x16x32_bf16 v[188:191], a[188:191], v[44:47], v[220:223]
    s_cselect_b32 s32, s26, s32
    v_exp_f32 v178, v178
    v_mfma_f32_16x16x32_bf16 v[188:191], a[184:187], v[40:43], v[188:191]
    s_cmp_eq_u32 s33, 46
    ds_read_b64_tr_b16 a[232:233], v246 offset:8192
    v_add_f32 v0, v0, v176
    v_add_f32 v0, v0, v177
    v_mfma_f32_16x16x32_bf16 v[188:191], a[180:183], v[36:39], v[188:191]
    s_cselect_b32 s32, s37, s32
    v_exp_f32 v179, v179
    v_mfma_f32_16x16x32_bf16 v[188:191], a[176:179], v[32:35], v[188:191]
    s_add_u32 s35, s32, 4096
    v_cvt_pk_bf16_f32 v192, v176, v177
    v_add_f32 v0, v0, v178
    v_mfma_f32_16x16x32_bf16 a[80:83], v[212:215], a[240:243], a[80:83]
    s_add_u32 s34, s34, 8192
    v_exp_f32 v180, v180
    v_mfma_f32_16x16x32_bf16 a[80:83], v[196:199], a[208:211], a[80:83]
    s_and_b32 s34, s34, 32767
    ds_read_b64_tr_b16 a[234:235], v246 offset:12288
    v_add_f32 v0, v0, v179
    v_cvt_pk_bf16_f32 v193, v178, v179
    v_mfma_f32_16x16x32_bf16 a[84:87], v[196:199], a[212:215], a[84:87]
    v_exp_f32 v181, v181
    v_mfma_f32_16x16x32_bf16 a[84:87], v[212:215], a[244:247], a[84:87]
    v_exp_f32 v182, v182
    v_mfma_f32_16x16x32_bf16 a[88:91], v[212:215], a[248:251], a[88:91]
    v_add_f32 v0, v0, v180
    v_add_f32 v0, v0, v181
    v_mfma_f32_16x16x32_bf16 a[88:91], v[196:199], a[216:219], a[88:91]
    v_exp_f32 v183, v183
    v_mfma_f32_16x16x32_bf16 a[92:95], v[196:199], a[220:223], a[92:95]
    v_cvt_pk_bf16_f32 v194, v180, v181
    v_add_f32 v0, v0, v182
    v_mfma_f32_16x16x32_bf16 a[92:95], v[212:215], a[252:255], a[92:95]
    v_add_f32 v0, v0, v183
    v_cvt_pk_bf16_f32 v195, v182, v183
    v_mfma_f32_16x16x32_bf16 v[176:179], a[160:163], v[16:19], v[216:219]
    s_cmp_lt_u32 s54, 65536
    ds_read_b64_tr_b16 a[236:237], v247 offset:8192
    ds_read_b64_tr_b16 a[238:239], v247 offset:12288
    v_mfma_f32_16x16x32_bf16 v[176:179], a[164:167], v[20:23], v[176:179]
    s_cselect_b32 s52, s37, s53
    v_exp_f32 v184, v184
    v_mfma_f32_16x16x32_bf16 v[176:179], a[168:171], v[24:27], v[176:179]
    s_cselect_b32 m0, 159744, s54
    ds_read_b64_tr_b16 a[240:241], v248 offset:8192
    ds_read_b64_tr_b16 a[242:243], v248 offset:12288
    v_mfma_f32_16x16x32_bf16 v[176:179], a[172:175], v[28:31], v[176:179]
    s_add_u32 s53, s53, 4096
    buffer_load_dwordx4 v96, s[8:11], s52 offen offset:0 nt lds
    v_exp_f32 v185, v185
    v_mfma_f32_16x16x32_bf16 v[180:183], a[188:191], v[28:31], v[216:219]
    s_add_u32 s54, s54, 4096
    buffer_load_dwordx4 v97, s[8:11], s52 offen offset:1024 nt lds
    v_exp_f32 v186, v186
    v_mfma_f32_16x16x32_bf16 v[180:183], a[184:187], v[24:27], v[180:183]
    ds_read_b64_tr_b16 a[244:245], v249 offset:8192
    v_add_f32 v253, v253, v184
    v_add_f32 v253, v253, v185
    v_mfma_f32_16x16x32_bf16 v[180:183], a[180:183], v[20:23], v[180:183]
    buffer_load_dwordx4 v98, s[8:11], s52 offen offset:2048 nt lds
    v_exp_f32 v187, v187
    v_mfma_f32_16x16x32_bf16 v[180:183], a[176:179], v[16:19], v[180:183]
    buffer_load_dwordx4 v99, s[8:11], s52 offen offset:3072 nt lds
    v_cvt_pk_bf16_f32 v196, v184, v185
    v_add_f32 v253, v253, v186
    v_mfma_f32_16x16x32_bf16 v[144:147], v[192:195], a[192:195], v[144:147]
    v_exp_f32 v188, v188
    v_mfma_f32_16x16x32_bf16 v[148:151], v[192:195], a[196:199], v[148:151]
    ds_read_b64_tr_b16 a[246:247], v249 offset:12288
    v_add_f32 v253, v253, v187
    v_cvt_pk_bf16_f32 v197, v186, v187
    v_mfma_f32_16x16x32_bf16 v[152:155], v[192:195], a[200:203], v[152:155]
    v_exp_f32 v189, v189
    v_mfma_f32_16x16x32_bf16 v[156:159], v[192:195], a[204:207], v[156:159]
    v_exp_f32 v190, v190
    v_mfma_f32_16x16x32_bf16 v[160:163], v[192:195], a[208:211], v[160:163]
    v_add_f32 v253, v253, v188
    v_add_f32 v253, v253, v189
    v_mfma_f32_16x16x32_bf16 v[164:167], v[192:195], a[212:215], v[164:167]
    v_exp_f32 v191, v191
    v_mfma_f32_16x16x32_bf16 v[168:171], v[192:195], a[216:219], v[168:171]
    v_cvt_pk_bf16_f32 v198, v188, v189
    v_add_f32 v253, v253, v190
    v_mfma_f32_16x16x32_bf16 v[172:175], v[192:195], a[220:223], v[172:175]
    v_add_f32 v253, v253, v191
    v_cvt_pk_bf16_f32 v199, v190, v191
L_loop1_w3:
    v_mfma_f32_16x16x32_bf16 v[184:187], a[160:163], v[64:67], v[228:231]
    ds_read_b64_tr_b16 a[248:249], v250 offset:8192
    ds_read_b64_tr_b16 a[250:251], v250 offset:12288
    v_mfma_f32_16x16x32_bf16 v[184:187], a[164:167], v[68:71], v[184:187]
    v_exp_f32 v176, v176
    v_mfma_f32_16x16x32_bf16 v[184:187], a[168:171], v[72:75], v[184:187]
    ds_read_b64_tr_b16 a[252:253], v251 offset:8192
    ds_read_b64_tr_b16 a[254:255], v251 offset:12288
    v_mfma_f32_16x16x32_bf16 v[184:187], a[172:175], v[76:79], v[184:187]
    v_exp_f32 v177, v177
    v_mfma_f32_16x16x32_bf16 v[188:191], a[188:191], v[76:79], v[228:231]
    v_exp_f32 v178, v178
    v_mfma_f32_16x16x32_bf16 v[188:191], a[184:187], v[72:75], v[188:191]
    v_add_f32 v252, v252, v176
    v_add_f32 v252, v252, v177
    v_mfma_f32_16x16x32_bf16 v[188:191], a[180:183], v[68:71], v[188:191]
    v_exp_f32 v179, v179
    v_mfma_f32_16x16x32_bf16 v[188:191], a[176:179], v[64:67], v[188:191]
    s_waitcnt lgkmcnt(4)
    v_cvt_pk_bf16_f32 v208, v176, v177
    v_add_f32 v252, v252, v178
    v_mfma_f32_16x16x32_bf16 a[32:35], v[200:203], a[192:195], a[32:35]
    v_exp_f32 v180, v180
    v_mfma_f32_16x16x32_bf16 a[32:35], v[196:199], a[224:227], a[32:35]
    v_add_f32 v252, v252, v179
    v_cvt_pk_bf16_f32 v209, v178, v179
    v_mfma_f32_16x16x32_bf16 a[36:39], v[196:199], a[228:231], a[36:39]
    v_exp_f32 v181, v181
    v_mfma_f32_16x16x32_bf16 a[36:39], v[200:203], a[196:199], a[36:39]
    v_exp_f32 v182, v182
    v_mfma_f32_16x16x32_bf16 a[40:43], v[200:203], a[200:203], a[40:43]
    v_add_f32 v252, v252, v180
    v_add_f32 v252, v252, v181
    v_mfma_f32_16x16x32_bf16 a[40:43], v[196:199], a[232:235], a[40:43]
    v_exp_f32 v183, v183
    v_mfma_f32_16x16x32_bf16 a[44:47], v[196:199], a[236:239], a[44:47]
    v_cvt_pk_bf16_f32 v210, v180, v181
    v_add_f32 v252, v252, v182
    v_mfma_f32_16x16x32_bf16 a[44:47], v[200:203], a[204:207], a[44:47]
    s_waitcnt vmcnt(48) lgkmcnt(0)
    v_add_f32 v252, v252, v183
    v_cvt_pk_bf16_f32 v211, v182, v183
    v_mfma_f32_16x16x32_bf16 v[176:179], a[160:163], v[48:51], v[224:227]
    s_barrier
    ds_read_b128 a[128:131], v240 offset:16384
    ds_read_b128 a[132:135], v241 offset:16384
    v_mfma_f32_16x16x32_bf16 v[176:179], a[164:167], v[52:55], v[176:179]
    v_exp_f32 v184, v184
    v_mfma_f32_16x16x32_bf16 v[176:179], a[168:171], v[56:59], v[176:179]
    s_add_u32 m0, s34, 0
    ds_read_b128 a[136:139], v242 offset:16384
    ds_read_b128 a[140:143], v243 offset:16384
    v_mfma_f32_16x16x32_bf16 v[176:179], a[172:175], v[60:63], v[176:179]
    buffer_load_dwordx4 v96, s[12:15], s32 offen offset:0 nt lds
    v_exp_f32 v185, v185
    v_mfma_f32_16x16x32_bf16 v[180:183], a[188:191], v[60:63], v[224:227]
    buffer_load_dwordx4 v97, s[12:15], s32 offen offset:1024 nt lds
    v_exp_f32 v186, v186
    v_mfma_f32_16x16x32_bf16 v[180:183], a[184:187], v[56:59], v[180:183]
    v_add_f32 v255, v255, v184
    v_add_f32 v255, v255, v185
    v_mfma_f32_16x16x32_bf16 v[180:183], a[180:183], v[52:55], v[180:183]
    buffer_load_dwordx4 v98, s[12:15], s32 offen offset:2048 nt lds
    v_exp_f32 v187, v187
    v_mfma_f32_16x16x32_bf16 v[180:183], a[176:179], v[48:51], v[180:183]
    buffer_load_dwordx4 v99, s[12:15], s32 offen offset:3072 nt lds
    v_cvt_pk_bf16_f32 v192, v184, v185
    v_add_f32 v255, v255, v186
    v_mfma_f32_16x16x32_bf16 a[48:51], v[200:203], a[208:211], a[48:51]
    s_add_u32 m0, s34, 4096
    v_exp_f32 v188, v188
    v_mfma_f32_16x16x32_bf16 a[48:51], v[196:199], a[240:243], a[48:51]
    buffer_load_dwordx4 v96, s[12:15], s35 offen offset:0 nt lds
    v_add_f32 v255, v255, v187
    v_cvt_pk_bf16_f32 v193, v186, v187
    v_mfma_f32_16x16x32_bf16 a[52:55], v[196:199], a[244:247], a[52:55]
    buffer_load_dwordx4 v97, s[12:15], s35 offen offset:1024 nt lds
    v_exp_f32 v189, v189
    v_mfma_f32_16x16x32_bf16 a[52:55], v[200:203], a[212:215], a[52:55]
    v_exp_f32 v190, v190
    v_mfma_f32_16x16x32_bf16 a[56:59], v[200:203], a[216:219], a[56:59]
    buffer_load_dwordx4 v98, s[12:15], s35 offen offset:2048 nt lds
    v_add_f32 v255, v255, v188
    v_add_f32 v255, v255, v189
    v_mfma_f32_16x16x32_bf16 a[56:59], v[196:199], a[248:251], a[56:59]
    buffer_load_dwordx4 v99, s[12:15], s35 offen offset:3072 nt lds
    v_exp_f32 v191, v191
    v_mfma_f32_16x16x32_bf16 a[60:63], v[196:199], a[252:255], a[60:63]
    s_add_u32 m0, s34, 32768
    v_cvt_pk_bf16_f32 v194, v188, v189
    v_add_f32 v255, v255, v190
    v_mfma_f32_16x16x32_bf16 a[60:63], v[200:203], a[220:223], a[60:63]
    buffer_load_dwordx4 v96, s[16:19], s32 offen offset:0 nt lds
    v_add_f32 v255, v255, v191
    v_cvt_pk_bf16_f32 v195, v190, v191
    v_mfma_f32_16x16x32_bf16 v[184:187], a[160:163], v[80:83], v[232:235]
    ds_read_b128 a[144:147], v240 offset:20480
    ds_read_b128 a[148:151], v241 offset:20480
    v_mfma_f32_16x16x32_bf16 v[184:187], a[164:167], v[84:87], v[184:187]
    v_exp_f32 v176, v176
    v_mfma_f32_16x16x32_bf16 v[184:187], a[168:171], v[88:91], v[184:187]
    ds_read_b128 a[152:155], v242 offset:20480
    ds_read_b128 a[156:159], v243 offset:20480
    v_mfma_f32_16x16x32_bf16 v[184:187], a[172:175], v[92:95], v[184:187]
    buffer_load_dwordx4 v97, s[16:19], s32 offen offset:1024 nt lds
    v_exp_f32 v177, v177
    v_mfma_f32_16x16x32_bf16 v[188:191], a[188:191], v[92:95], v[232:235]
    buffer_load_dwordx4 v96, s[16:19], s32 offen offset:2048 nt lds
    v_exp_f32 v178, v178
    v_mfma_f32_16x16x32_bf16 v[188:191], a[184:187], v[88:91], v[188:191]
    v_add_f32 v254, v254, v176
    v_add_f32 v254, v254, v177
    v_mfma_f32_16x16x32_bf16 v[188:191], a[180:183], v[84:87], v[188:191]
    buffer_load_dwordx4 v97, s[16:19], s32 offen offset:3072 nt lds
    v_exp_f32 v179, v179
    v_mfma_f32_16x16x32_bf16 v[188:191], a[176:179], v[80:83], v[188:191]
    s_add_u32 m0, s34, 36864
    v_cvt_pk_bf16_f32 v212, v176, v177
    v_add_f32 v254, v254, v178
    v_mfma_f32_16x16x32_bf16 v[112:115], v[204:207], a[192:195], v[112:115]
    buffer_load_dwordx4 v96, s[16:19], s35 offen offset:0 nt lds
    v_exp_f32 v180, v180
    v_mfma_f32_16x16x32_bf16 v[112:115], v[192:195], a[224:227], v[112:115]
    buffer_load_dwordx4 v97, s[16:19], s35 offen offset:1024 nt lds
    v_add_f32 v254, v254, v179
    v_cvt_pk_bf16_f32 v213, v178, v179
    v_mfma_f32_16x16x32_bf16 v[116:119], v[192:195], a[228:231], v[116:119]
    buffer_load_dwordx4 v96, s[16:19], s35 offen offset:2048 nt lds
    v_exp_f32 v181, v181
    v_mfma_f32_16x16x32_bf16 v[116:119], v[204:207], a[196:199], v[116:119]
    v_exp_f32 v182, v182
    v_mfma_f32_16x16x32_bf16 v[120:123], v[204:207], a[200:203], v[120:123]
    buffer_load_dwordx4 v97, s[16:19], s35 offen offset:3072 nt lds
    v_add_f32 v254, v254, v180
    v_add_f32 v254, v254, v181
    v_mfma_f32_16x16x32_bf16 v[120:123], v[192:195], a[232:235], v[120:123]
    v_exp_f32 v183, v183
    v_mfma_f32_16x16x32_bf16 v[124:127], v[192:195], a[236:239], v[124:127]
    v_cvt_pk_bf16_f32 v214, v180, v181
    v_add_f32 v254, v254, v182
    v_mfma_f32_16x16x32_bf16 v[124:127], v[204:207], a[204:207], v[124:127]
    s_waitcnt lgkmcnt(0)
    v_add_f32 v254, v254, v183
    v_cvt_pk_bf16_f32 v215, v182, v183
    v_mfma_f32_16x16x32_bf16 v[176:179], a[128:131], v[16:19], v[216:219]
    ds_read_b64_tr_b16 a[192:193], v244 offset:16384
    ds_read_b64_tr_b16 a[194:195], v244 offset:20480
    v_mfma_f32_16x16x32_bf16 v[176:179], a[132:135], v[20:23], v[176:179]
    s_add_u32 s33, s33, 1
    v_exp_f32 v184, v184
    v_mfma_f32_16x16x32_bf16 v[176:179], a[136:139], v[24:27], v[176:179]
    s_add_u32 s32, s32, 8192
    ds_read_b64_tr_b16 a[196:197], v245 offset:16384
    ds_read_b64_tr_b16 a[198:199], v245 offset:20480
    v_mfma_f32_16x16x32_bf16 v[176:179], a[140:143], v[28:31], v[176:179]
    s_cmp_eq_u32 s33, 23
    v_exp_f32 v185, v185
    v_mfma_f32_16x16x32_bf16 v[180:183], a[156:159], v[28:31], v[216:219]
    s_cselect_b32 s32, s26, s32
    v_exp_f32 v186, v186
    v_mfma_f32_16x16x32_bf16 v[180:183], a[152:155], v[24:27], v[180:183]
    s_cmp_eq_u32 s33, 46
    ds_read_b64_tr_b16 a[200:201], v246 offset:16384
    v_add_f32 v0, v0, v184
    v_add_f32 v0, v0, v185
    v_mfma_f32_16x16x32_bf16 v[180:183], a[148:151], v[20:23], v[180:183]
    s_cselect_b32 s32, s37, s32
    v_exp_f32 v187, v187
    v_mfma_f32_16x16x32_bf16 v[180:183], a[144:147], v[16:19], v[180:183]
    s_add_u32 s35, s32, 4096
    v_cvt_pk_bf16_f32 v196, v184, v185
    v_add_f32 v0, v0, v186
    v_mfma_f32_16x16x32_bf16 v[128:131], v[204:207], a[208:211], v[128:131]
    s_add_u32 s34, s34, 8192
    v_exp_f32 v188, v188
    v_mfma_f32_16x16x32_bf16 v[128:131], v[192:195], a[240:243], v[128:131]
    s_and_b32 s34, s34, 32767
    ds_read_b64_tr_b16 a[202:203], v246 offset:20480
    v_add_f32 v0, v0, v187
    v_cvt_pk_bf16_f32 v197, v186, v187
    v_mfma_f32_16x16x32_bf16 v[132:135], v[192:195], a[244:247], v[132:135]
    v_exp_f32 v189, v189
    v_mfma_f32_16x16x32_bf16 v[132:135], v[204:207], a[212:215], v[132:135]
    v_exp_f32 v190, v190
    v_mfma_f32_16x16x32_bf16 v[136:139], v[204:207], a[216:219], v[136:139]
    v_add_f32 v0, v0, v188
    v_add_f32 v0, v0, v189
    v_mfma_f32_16x16x32_bf16 v[136:139], v[192:195], a[248:251], v[136:139]
    v_exp_f32 v191, v191
    v_mfma_f32_16x16x32_bf16 v[140:143], v[192:195], a[252:255], v[140:143]
    v_cvt_pk_bf16_f32 v198, v188, v189
    v_add_f32 v0, v0, v190
    v_mfma_f32_16x16x32_bf16 v[140:143], v[204:207], a[220:223], v[140:143]
    v_add_f32 v0, v0, v191
    v_cvt_pk_bf16_f32 v199, v190, v191
    v_mfma_f32_16x16x32_bf16 v[184:187], a[128:131], v[32:35], v[220:223]
    s_cmp_lt_u32 s54, 65536
    ds_read_b64_tr_b16 a[204:205], v247 offset:16384
    ds_read_b64_tr_b16 a[206:207], v247 offset:20480
    v_mfma_f32_16x16x32_bf16 v[184:187], a[132:135], v[36:39], v[184:187]
    s_cselect_b32 s52, s37, s53
    v_exp_f32 v176, v176
    v_mfma_f32_16x16x32_bf16 v[184:187], a[136:139], v[40:43], v[184:187]
    s_cselect_b32 m0, 159744, s54
    ds_read_b64_tr_b16 a[208:209], v248 offset:16384
    ds_read_b64_tr_b16 a[210:211], v248 offset:20480
    v_mfma_f32_16x16x32_bf16 v[184:187], a[140:143], v[44:47], v[184:187]
    s_add_u32 s53, s53, 4096
    buffer_load_dwordx4 v96, s[8:11], s52 offen offset:0 nt lds
    v_exp_f32 v177, v177
    v_mfma_f32_16x16x32_bf16 v[188:191], a[156:159], v[44:47], v[220:223]
    s_add_u32 s54, s54, 4096
    buffer_load_dwordx4 v97, s[8:11], s52 offen offset:1024 nt lds
    v_exp_f32 v178, v178
    v_mfma_f32_16x16x32_bf16 v[188:191], a[152:155], v[40:43], v[188:191]
    ds_read_b64_tr_b16 a[212:213], v249 offset:16384
    v_add_f32 v252, v252, v176
    v_add_f32 v252, v252, v177
    v_mfma_f32_16x16x32_bf16 v[188:191], a[148:151], v[36:39], v[188:191]
    buffer_load_dwordx4 v98, s[8:11], s52 offen offset:2048 nt lds
    v_exp_f32 v179, v179
    v_mfma_f32_16x16x32_bf16 v[188:191], a[144:147], v[32:35], v[188:191]
    buffer_load_dwordx4 v99, s[8:11], s52 offen offset:3072 nt lds
    v_cvt_pk_bf16_f32 v192, v176, v177
    v_add_f32 v252, v252, v178
    v_mfma_f32_16x16x32_bf16 v[144:147], v[196:199], a[224:227], v[144:147]
    v_exp_f32 v180, v180
    v_mfma_f32_16x16x32_bf16 v[148:151], v[196:199], a[228:231], v[148:151]
    ds_read_b64_tr_b16 a[214:215], v249 offset:20480
    v_add_f32 v252, v252, v179
    v_cvt_pk_bf16_f32 v193, v178, v179
    v_mfma_f32_16x16x32_bf16 v[152:155], v[196:199], a[232:235], v[152:155]
    v_exp_f32 v181, v181
    v_mfma_f32_16x16x32_bf16 v[156:159], v[196:199], a[236:239], v[156:159]
    v_exp_f32 v182, v182
    v_mfma_f32_16x16x32_bf16 v[160:163], v[196:199], a[240:243], v[160:163]
    v_add_f32 v252, v252, v180
    v_add_f32 v252, v252, v181
    v_mfma_f32_16x16x32_bf16 v[164:167], v[196:199], a[244:247], v[164:167]
    s_add_u32 s28, s28, 1
    v_exp_f32 v183, v183
    v_mfma_f32_16x16x32_bf16 v[168:171], v[196:199], a[248:251], v[168:171]
    v_cvt_pk_bf16_f32 v194, v180, v181
    v_add_f32 v252, v252, v182
    v_mfma_f32_16x16x32_bf16 v[172:175], v[196:199], a[252:255], v[172:175]
    s_cmp_lt_u32 s28, 4
    v_add_f32 v252, v252, v183
    v_cvt_pk_bf16_f32 v195, v182, v183
    s_cbranch_scc1 L_loop_w3
    s_cmp_eq_u32 s28, 5
    s_cbranch_scc1 L_trans_w3
    v_lshlrev_b32 v103, 3, v102
    v_add_u32 v104, L_trans_w0-L_pc0, v103
    global_load_dword v108, v104, s[58:59]
    v_add_u32 v104, L_trans_w3-L_pc0, v103
    global_load_dword v108, v104, s[58:59]
    v_add_u32 v104, L_trans_w0+8192-L_pc0, v103
    global_load_dword v108, v104, s[58:59]
    v_add_u32 v104, L_trans_w3+8192-L_pc0, v103
    global_load_dword v108, v104, s[58:59]
    v_add_u32 v104, L_trans_w0+16384-L_pc0, v103
    global_load_dword v108, v104, s[58:59]
    v_add_u32 v104, L_trans_w3+16384-L_pc0, v103
    global_load_dword v108, v104, s[58:59]
    s_branch L_loop_w3
L_trans_w3:
    s_add_u32 s55, s25, s50
    s_waitcnt vmcnt(60)
    v_mfma_f32_16x16x32_bf16 v[176:179], a[128:131], v[48:51], v[224:227]
    ds_read_b64_tr_b16 a[216:217], v250 offset:16384
    ds_read_b64_tr_b16 a[218:219], v250 offset:20480
    v_mov_b32 v216, v252
    v_mfma_f32_16x16x32_bf16 v[176:179], a[132:135], v[52:55], v[176:179]
    v_exp_f32 v184, v184
    v_mfma_f32_16x16x32_bf16 v[176:179], a[136:139], v[56:59], v[176:179]
    ds_read_b64_tr_b16 a[220:221], v251 offset:16384
    ds_read_b64_tr_b16 a[222:223], v251 offset:20480
    v_permlane16_swap_b32 v252, v216
    v_exp_f32 v185, v185
    v_mfma_f32_16x16x32_bf16 v[176:179], a[140:143], v[60:63], v[176:179]
    v_add_f32 v252, v252, v216
    v_mov_b32 v216, v252
    v_mfma_f32_16x16x32_bf16 v[180:183], a[156:159], v[60:63], v[224:227]
    v_exp_f32 v186, v186
    v_add_f32 v253, v253, v184
    v_add_f32 v253, v253, v185
    v_mfma_f32_16x16x32_bf16 v[180:183], a[152:155], v[56:59], v[180:183]
    v_permlane32_swap_b32 v252, v216
    v_exp_f32 v187, v187
    v_cvt_pk_bf16_f32 v200, v184, v185
    v_mfma_f32_16x16x32_bf16 v[180:183], a[148:151], v[52:55], v[180:183]
    v_add_f32 v252, v252, v216
    v_subrev_u32 v216, s57, v252
    v_add_f32 v253, v253, v186
    v_mfma_f32_16x16x32_bf16 v[180:183], a[144:147], v[48:51], v[180:183]
    s_waitcnt lgkmcnt(4)
    v_cmp_le_u32 vcc, s36, v216
    v_rcp_f32 v252, v252
    v_mfma_f32_16x16x32_bf16 a[0:3], v[208:211], a[224:227], a[0:3]
    ds_read_b128 v[16:19], v8 offset:0
    ds_read_b128 v[20:23], v9 offset:0
    ds_bpermute_b32 v216, v4, v252 offset:0
    v_mfma_f32_16x16x32_bf16 a[0:3], v[192:195], a[192:195], a[0:3]
    s_cmp_lg_u64 vcc, 0
    ds_bpermute_b32 v217, v4, v252 offset:4
    v_mfma_f32_16x16x32_bf16 a[4:7], v[192:195], a[196:199], a[4:7]
    s_cselect_b32 s56, 1, 0
    ds_read_b128 v[24:27], v10 offset:0
    ds_read_b128 v[28:31], v11 offset:0
    ds_bpermute_b32 v218, v4, v252 offset:8
    v_mfma_f32_16x16x32_bf16 a[4:7], v[208:211], a[228:231], a[4:7]
    s_or_b32 s27, s27, s56
    ds_bpermute_b32 v219, v4, v252 offset:12
    v_exp_f32 v188, v188
    v_mfma_f32_16x16x32_bf16 a[8:11], v[208:211], a[232:235], a[8:11]
    v_add_f32 v253, v253, v187
    v_cvt_pk_bf16_f32 v201, v186, v187
    v_mfma_f32_16x16x32_bf16 a[8:11], v[192:195], a[200:203], a[8:11]
    v_exp_f32 v189, v189
    v_exp_f32 v190, v190
    v_add_f32 v253, v253, v188
    v_mfma_f32_16x16x32_bf16 a[12:15], v[192:195], a[204:207], a[12:15]
    v_add_f32 v253, v253, v189
    v_exp_f32 v191, v191
    v_mfma_f32_16x16x32_bf16 a[12:15], v[208:211], a[236:239], a[12:15]
    s_waitcnt vmcnt(32) lgkmcnt(0)
    v_cvt_pk_bf16_f32 v202, v188, v189
    v_add_f32 v253, v253, v190
    v_add_f32 v253, v253, v191
    v_cvt_pk_bf16_f32 v203, v190, v191
    v_mfma_f32_16x16x32_bf16 v[184:187], a[128:131], v[64:67], v[228:231]
    s_barrier
    ds_read_b128 a[160:163], v240 offset:24576
    ds_read_b128 a[164:167], v241 offset:24576
    v_mov_b32 v220, v253
    v_mfma_f32_16x16x32_bf16 v[184:187], a[132:135], v[68:71], v[184:187]
    v_exp_f32 v176, v176
    v_mfma_f32_16x16x32_bf16 v[184:187], a[136:139], v[72:75], v[184:187]
    s_add_u32 m0, s34, 0
    ds_read_b128 a[168:171], v242 offset:24576
    ds_read_b128 a[172:175], v243 offset:24576
    v_permlane16_swap_b32 v253, v220
    v_exp_f32 v177, v177
    v_mfma_f32_16x16x32_bf16 v[184:187], a[140:143], v[76:79], v[184:187]
    buffer_load_dwordx4 v96, s[12:15], s32 offen offset:0 nt lds
    v_add_f32 v253, v253, v220
    v_mov_b32 v220, v253
    v_mfma_f32_16x16x32_bf16 v[188:191], a[156:159], v[76:79], v[228:231]
    buffer_load_dwordx4 v97, s[12:15], s32 offen offset:1024 nt lds
    v_mfma_f32_16x16x32_bf16 v[188:191], a[152:155], v[72:75], v[188:191]
    v_permlane32_swap_b32 v253, v220
    v_mfma_f32_16x16x32_bf16 v[188:191], a[148:151], v[68:71], v[188:191]
    buffer_load_dwordx4 v98, s[12:15], s32 offen offset:2048 nt lds
    v_add_f32 v253, v253, v220
    v_subrev_u32 v220, s57, v253
    v_mfma_f32_16x16x32_bf16 v[188:191], a[144:147], v[64:67], v[188:191]
    buffer_load_dwordx4 v99, s[12:15], s32 offen offset:3072 nt lds
    v_cmp_le_u32 vcc, s36, v220
    v_rcp_f32 v253, v253
    v_mfma_f32_16x16x32_bf16 a[16:19], v[208:211], a[240:243], a[16:19]
    s_add_u32 m0, s34, 4096
    ds_bpermute_b32 v220, v4, v253 offset:0
    v_mfma_f32_16x16x32_bf16 a[16:19], v[192:195], a[208:211], a[16:19]
    s_cmp_lg_u64 vcc, 0
    buffer_load_dwordx4 v96, s[12:15], s35 offen offset:0 nt lds
    ds_bpermute_b32 v221, v4, v253 offset:4
    v_mfma_f32_16x16x32_bf16 a[20:23], v[192:195], a[212:215], a[20:23]
    s_cselect_b32 s56, 2, 0
    buffer_load_dwordx4 v97, s[12:15], s35 offen offset:1024 nt lds
    ds_bpermute_b32 v222, v4, v253 offset:8
    v_mfma_f32_16x16x32_bf16 a[20:23], v[208:211], a[244:247], a[20:23]
    s_or_b32 s27, s27, s56
    ds_bpermute_b32 v223, v4, v253 offset:12
    v_mfma_f32_16x16x32_bf16 a[24:27], v[208:211], a[248:251], a[24:27]
    buffer_load_dwordx4 v98, s[12:15], s35 offen offset:2048 nt lds
    v_mfma_f32_16x16x32_bf16 a[24:27], v[192:195], a[216:219], a[24:27]
    buffer_load_dwordx4 v99, s[12:15], s35 offen offset:3072 nt lds
    v_mfma_f32_16x16x32_bf16 a[28:31], v[192:195], a[220:223], a[28:31]
    s_add_u32 m0, s34, 32768
    v_exp_f32 v178, v178
    v_mfma_f32_16x16x32_bf16 a[28:31], v[208:211], a[252:255], a[28:31]
    buffer_load_dwordx4 v96, s[16:19], s32 offen offset:0 nt lds
    v_mfma_f32_16x16x32_bf16 a[32:35], v[200:203], a[192:195], a[32:35]
    v_add_f32 v254, v254, v176
    v_add_f32 v254, v254, v177
    v_mfma_f32_16x16x32_bf16 a[36:39], v[200:203], a[196:199], a[36:39]
    ds_read_b128 v[32:35], v8 offset:4096
    ds_read_b128 v[36:39], v9 offset:4096
    v_mfma_f32_16x16x32_bf16 a[40:43], v[200:203], a[200:203], a[40:43]
    v_exp_f32 v179, v179
    v_cvt_pk_bf16_f32 v196, v176, v177
    v_add_f32 v254, v254, v178
    v_mfma_f32_16x16x32_bf16 a[44:47], v[200:203], a[204:207], a[44:47]
    ds_read_b128 v[40:43], v10 offset:4096
    ds_read_b128 v[44:47], v11 offset:4096
    v_exp_f32 v180, v180
    v_mfma_f32_16x16x32_bf16 a[48:51], v[200:203], a[208:211], a[48:51]
    v_add_f32 v254, v254, v179
    v_cvt_pk_bf16_f32 v197, v178, v179
    v_mfma_f32_16x16x32_bf16 a[52:55], v[200:203], a[212:215], a[52:55]
    v_exp_f32 v181, v181
    v_exp_f32 v182, v182
    v_add_f32 v254, v254, v180
    v_mfma_f32_16x16x32_bf16 a[56:59], v[200:203], a[216:219], a[56:59]
    v_add_f32 v254, v254, v181
    v_exp_f32 v183, v183
    v_mfma_f32_16x16x32_bf16 a[60:63], v[200:203], a[220:223], a[60:63]
    v_cvt_pk_bf16_f32 v198, v180, v181
    v_add_f32 v254, v254, v182
    v_add_f32 v254, v254, v183
    v_cvt_pk_bf16_f32 v199, v182, v183
    s_waitcnt lgkmcnt(14)
.p2align 3
    v_mfma_f32_4x4x4_16b_bf16 v[208:211], v[12:13], v[16:17], 0
    v_accvgpr_read_b32 v176, a0
    v_mfma_f32_4x4x4_16b_bf16 v[200:203], v[12:13], v[18:19], 0
    v_accvgpr_read_b32 v177, a4
    v_mfma_f32_4x4x4_16b_bf16 v[208:211], v[14:15], v[16:17], v[208:211]
    v_accvgpr_read_b32 v178, a8
    v_mfma_f32_4x4x4_16b_bf16 v[200:203], v[14:15], v[18:19], v[200:203]
    v_accvgpr_read_b32 v179, a12
    v_accvgpr_read_b32 v180, a16
    v_accvgpr_read_b32 v181, a20
    v_accvgpr_read_b32 v182, a24
    v_accvgpr_read_b32 v183, a28
    s_waitcnt lgkmcnt(12)
.p2align 3
    v_pk_mul_f32 v[176:177], v[176:177], v[216:217] op_sel:[0,0] op_sel_hi:[1,0]
    v_pk_mul_f32 v[178:179], v[178:179], v[216:217] op_sel:[0,0] op_sel_hi:[1,0]
    v_pk_mul_f32 v[180:181], v[180:181], v[216:217] op_sel:[0,0] op_sel_hi:[1,0]
    v_pk_mul_f32 v[182:183], v[182:183], v[216:217] op_sel:[0,0] op_sel_hi:[1,0]
    v_cvt_pk_bf16_f32 v192, v176, v177
    v_cvt_pk_bf16_f32 v193, v178, v179
    v_cvt_pk_bf16_f32 v194, v180, v181
    v_cvt_pk_bf16_f32 v195, v182, v183
    v_cvt_pk_bf16_f32 v16, v208, v209
    v_cvt_pk_bf16_f32 v17, v210, v211
    v_cvt_pk_bf16_f32 v18, v200, v201
    v_cvt_pk_bf16_f32 v19, v202, v203
    v_mfma_f32_4x4x4_16b_bf16 v[208:211], v[12:13], v[20:21], 0
    ds_write_b128 v2, v[192:195] offset:0
    v_accvgpr_read_b32 v176, a1
    v_mfma_f32_4x4x4_16b_bf16 v[200:203], v[12:13], v[22:23], 0
    v_accvgpr_read_b32 v177, a5
    v_mfma_f32_4x4x4_16b_bf16 v[208:211], v[14:15], v[20:21], v[208:211]
    v_accvgpr_read_b32 v178, a9
    v_mfma_f32_4x4x4_16b_bf16 v[200:203], v[14:15], v[22:23], v[200:203]
    v_accvgpr_read_b32 v179, a13
    v_accvgpr_read_b32 v180, a17
    v_accvgpr_read_b32 v181, a21
    v_accvgpr_read_b32 v182, a25
    v_accvgpr_read_b32 v183, a29
    v_pk_mul_f32 v[176:177], v[176:177], v[216:217] op_sel:[0,1] op_sel_hi:[1,1]
    v_pk_mul_f32 v[178:179], v[178:179], v[216:217] op_sel:[0,1] op_sel_hi:[1,1]
    v_pk_mul_f32 v[180:181], v[180:181], v[216:217] op_sel:[0,1] op_sel_hi:[1,1]
    v_pk_mul_f32 v[182:183], v[182:183], v[216:217] op_sel:[0,1] op_sel_hi:[1,1]
    v_cvt_pk_bf16_f32 v192, v176, v177
    v_cvt_pk_bf16_f32 v193, v178, v179
    v_cvt_pk_bf16_f32 v194, v180, v181
    v_cvt_pk_bf16_f32 v195, v182, v183
    v_cvt_pk_bf16_f32 v20, v208, v209
    v_cvt_pk_bf16_f32 v21, v210, v211
    v_cvt_pk_bf16_f32 v22, v200, v201
    v_cvt_pk_bf16_f32 v23, v202, v203
    v_mfma_f32_4x4x4_16b_bf16 v[208:211], v[12:13], v[24:25], 0
    ds_write_b128 v3, v[192:195] offset:256
    v_accvgpr_read_b32 v176, a2
    v_mfma_f32_4x4x4_16b_bf16 v[200:203], v[12:13], v[26:27], 0
    v_accvgpr_read_b32 v177, a6
    v_mfma_f32_4x4x4_16b_bf16 v[208:211], v[14:15], v[24:25], v[208:211]
    v_accvgpr_read_b32 v178, a10
    v_mfma_f32_4x4x4_16b_bf16 v[200:203], v[14:15], v[26:27], v[200:203]
    v_accvgpr_read_b32 v179, a14
    v_accvgpr_read_b32 v180, a18
    v_accvgpr_read_b32 v181, a22
    v_accvgpr_read_b32 v182, a26
    v_accvgpr_read_b32 v183, a30
    v_pk_mul_f32 v[176:177], v[176:177], v[218:219] op_sel:[0,0] op_sel_hi:[1,0]
    v_pk_mul_f32 v[178:179], v[178:179], v[218:219] op_sel:[0,0] op_sel_hi:[1,0]
    v_pk_mul_f32 v[180:181], v[180:181], v[218:219] op_sel:[0,0] op_sel_hi:[1,0]
    v_pk_mul_f32 v[182:183], v[182:183], v[218:219] op_sel:[0,0] op_sel_hi:[1,0]
    v_cvt_pk_bf16_f32 v192, v176, v177
    v_cvt_pk_bf16_f32 v193, v178, v179
    v_cvt_pk_bf16_f32 v194, v180, v181
    v_cvt_pk_bf16_f32 v195, v182, v183
    v_cvt_pk_bf16_f32 v24, v208, v209
    v_cvt_pk_bf16_f32 v25, v210, v211
    v_cvt_pk_bf16_f32 v26, v200, v201
    v_cvt_pk_bf16_f32 v27, v202, v203
    v_mfma_f32_4x4x4_16b_bf16 v[208:211], v[12:13], v[28:29], 0
    ds_write_b128 v2, v[192:195] offset:512
    v_accvgpr_read_b32 v176, a3
    v_mfma_f32_4x4x4_16b_bf16 v[200:203], v[12:13], v[30:31], 0
    v_accvgpr_read_b32 v177, a7
    v_mfma_f32_4x4x4_16b_bf16 v[208:211], v[14:15], v[28:29], v[208:211]
    v_accvgpr_read_b32 v178, a11
    v_mfma_f32_4x4x4_16b_bf16 v[200:203], v[14:15], v[30:31], v[200:203]
    v_accvgpr_read_b32 v179, a15
    v_accvgpr_read_b32 v180, a19
    v_accvgpr_read_b32 v181, a23
    v_accvgpr_read_b32 v182, a27
    v_accvgpr_read_b32 v183, a31
    v_pk_mul_f32 v[176:177], v[176:177], v[218:219] op_sel:[0,1] op_sel_hi:[1,1]
    v_pk_mul_f32 v[178:179], v[178:179], v[218:219] op_sel:[0,1] op_sel_hi:[1,1]
    v_pk_mul_f32 v[180:181], v[180:181], v[218:219] op_sel:[0,1] op_sel_hi:[1,1]
    v_pk_mul_f32 v[182:183], v[182:183], v[218:219] op_sel:[0,1] op_sel_hi:[1,1]
    v_cvt_pk_bf16_f32 v192, v176, v177
    v_cvt_pk_bf16_f32 v193, v178, v179
    v_cvt_pk_bf16_f32 v194, v180, v181
    v_cvt_pk_bf16_f32 v195, v182, v183
    ds_write_b128 v3, v[192:195] offset:768
    v_cvt_pk_bf16_f32 v28, v208, v209
    v_cvt_pk_bf16_f32 v29, v210, v211
    v_cvt_pk_bf16_f32 v30, v200, v201
    v_cvt_pk_bf16_f32 v31, v202, v203
    ds_read_b64_tr_b16 a[0:1], v6 offset:0
    ds_read_b64_tr_b16 a[2:3], v7 offset:0
    ds_read_b64_tr_b16 a[4:5], v6 offset:1024
    ds_read_b64_tr_b16 a[6:7], v7 offset:1024
    ds_read_b64_tr_b16 a[8:9], v6 offset:2048
    ds_read_b64_tr_b16 a[10:11], v7 offset:2048
    ds_read_b64_tr_b16 a[12:13], v6 offset:3072
    ds_read_b64_tr_b16 a[14:15], v7 offset:3072
    s_add_u32 s88, s55, 0
    s_waitcnt lgkmcnt(12)
.p2align 3
    v_mfma_f32_4x4x4_16b_bf16 v[208:211], v[12:13], v[32:33], 0
    v_accvgpr_read_b32 v176, a32
    v_mfma_f32_4x4x4_16b_bf16 v[200:203], v[12:13], v[34:35], 0
    ds_read_b128 a[16:19], v4 offset:24576
    ds_read_b128 a[20:23], v4 offset:24640
    v_accvgpr_read_b32 v177, a36
    v_mfma_f32_4x4x4_16b_bf16 v[208:211], v[14:15], v[32:33], v[208:211]
    ds_read_b128 a[24:27], v4 offset:24704
    ds_read_b128 a[28:31], v4 offset:24768
    v_accvgpr_read_b32 v178, a40
    v_mfma_f32_4x4x4_16b_bf16 v[200:203], v[14:15], v[34:35], v[200:203]
    v_accvgpr_read_b32 v179, a44
    v_accvgpr_read_b32 v180, a48
    v_accvgpr_read_b32 v181, a52
    v_accvgpr_read_b32 v182, a56
    v_accvgpr_read_b32 v183, a60
    s_waitcnt lgkmcnt(15)
.p2align 3
    v_pk_mul_f32 v[176:177], v[176:177], v[220:221] op_sel:[0,0] op_sel_hi:[1,0]
    v_pk_mul_f32 v[178:179], v[178:179], v[220:221] op_sel:[0,0] op_sel_hi:[1,0]
    v_pk_mul_f32 v[180:181], v[180:181], v[220:221] op_sel:[0,0] op_sel_hi:[1,0]
    v_pk_mul_f32 v[182:183], v[182:183], v[220:221] op_sel:[0,0] op_sel_hi:[1,0]
    v_cvt_pk_bf16_f32 v192, v176, v177
    v_cvt_pk_bf16_f32 v193, v178, v179
    v_cvt_pk_bf16_f32 v194, v180, v181
    v_cvt_pk_bf16_f32 v195, v182, v183
    v_cvt_pk_bf16_f32 v32, v208, v209
    v_cvt_pk_bf16_f32 v33, v210, v211
    v_cvt_pk_bf16_f32 v34, v200, v201
    v_cvt_pk_bf16_f32 v35, v202, v203
    v_mfma_f32_4x4x4_16b_bf16 v[208:211], v[12:13], v[36:37], 0
    ds_write_b128 v2, v[192:195] offset:4096
    v_accvgpr_read_b32 v176, a33
    v_mfma_f32_4x4x4_16b_bf16 v[200:203], v[12:13], v[38:39], 0
    v_accvgpr_read_b32 v177, a37
    v_mfma_f32_4x4x4_16b_bf16 v[208:211], v[14:15], v[36:37], v[208:211]
    v_accvgpr_read_b32 v178, a41
    v_mfma_f32_4x4x4_16b_bf16 v[200:203], v[14:15], v[38:39], v[200:203]
    v_accvgpr_read_b32 v179, a45
    v_accvgpr_read_b32 v180, a49
    v_accvgpr_read_b32 v181, a53
    v_accvgpr_read_b32 v182, a57
    v_accvgpr_read_b32 v183, a61
    v_pk_mul_f32 v[176:177], v[176:177], v[220:221] op_sel:[0,1] op_sel_hi:[1,1]
    v_pk_mul_f32 v[178:179], v[178:179], v[220:221] op_sel:[0,1] op_sel_hi:[1,1]
    v_pk_mul_f32 v[180:181], v[180:181], v[220:221] op_sel:[0,1] op_sel_hi:[1,1]
    v_pk_mul_f32 v[182:183], v[182:183], v[220:221] op_sel:[0,1] op_sel_hi:[1,1]
    v_cvt_pk_bf16_f32 v192, v176, v177
    v_cvt_pk_bf16_f32 v193, v178, v179
    v_cvt_pk_bf16_f32 v194, v180, v181
    v_cvt_pk_bf16_f32 v195, v182, v183
    v_cvt_pk_bf16_f32 v36, v208, v209
    v_cvt_pk_bf16_f32 v37, v210, v211
    v_cvt_pk_bf16_f32 v38, v200, v201
    v_cvt_pk_bf16_f32 v39, v202, v203
    v_mfma_f32_4x4x4_16b_bf16 v[208:211], v[12:13], v[40:41], 0
    ds_write_b128 v3, v[192:195] offset:4352
    v_accvgpr_read_b32 v176, a34
    v_mfma_f32_4x4x4_16b_bf16 v[200:203], v[12:13], v[42:43], 0
    v_accvgpr_read_b32 v177, a38
    v_mfma_f32_4x4x4_16b_bf16 v[208:211], v[14:15], v[40:41], v[208:211]
    v_accvgpr_read_b32 v178, a42
    v_mfma_f32_4x4x4_16b_bf16 v[200:203], v[14:15], v[42:43], v[200:203]
    v_accvgpr_read_b32 v179, a46
    v_accvgpr_read_b32 v180, a50
    v_accvgpr_read_b32 v181, a54
    v_accvgpr_read_b32 v182, a58
    v_accvgpr_read_b32 v183, a62
    v_pk_mul_f32 v[176:177], v[176:177], v[222:223] op_sel:[0,0] op_sel_hi:[1,0]
    v_pk_mul_f32 v[178:179], v[178:179], v[222:223] op_sel:[0,0] op_sel_hi:[1,0]
    v_pk_mul_f32 v[180:181], v[180:181], v[222:223] op_sel:[0,0] op_sel_hi:[1,0]
    v_pk_mul_f32 v[182:183], v[182:183], v[222:223] op_sel:[0,0] op_sel_hi:[1,0]
    v_cvt_pk_bf16_f32 v192, v176, v177
    v_cvt_pk_bf16_f32 v193, v178, v179
    v_cvt_pk_bf16_f32 v194, v180, v181
    v_cvt_pk_bf16_f32 v195, v182, v183
    v_cvt_pk_bf16_f32 v40, v208, v209
    v_cvt_pk_bf16_f32 v41, v210, v211
    v_cvt_pk_bf16_f32 v42, v200, v201
    v_cvt_pk_bf16_f32 v43, v202, v203
    v_mfma_f32_4x4x4_16b_bf16 v[208:211], v[12:13], v[44:45], 0
    ds_write_b128 v2, v[192:195] offset:4608
    v_accvgpr_read_b32 v176, a35
    v_mfma_f32_4x4x4_16b_bf16 v[200:203], v[12:13], v[46:47], 0
    v_accvgpr_read_b32 v177, a39
    v_mfma_f32_4x4x4_16b_bf16 v[208:211], v[14:15], v[44:45], v[208:211]
    v_accvgpr_read_b32 v178, a43
    v_mfma_f32_4x4x4_16b_bf16 v[200:203], v[14:15], v[46:47], v[200:203]
    v_accvgpr_read_b32 v179, a47
    v_accvgpr_read_b32 v180, a51
    v_accvgpr_read_b32 v181, a55
    v_accvgpr_read_b32 v182, a59
    v_accvgpr_read_b32 v183, a63
    v_pk_mul_f32 v[176:177], v[176:177], v[222:223] op_sel:[0,1] op_sel_hi:[1,1]
    v_pk_mul_f32 v[178:179], v[178:179], v[222:223] op_sel:[0,1] op_sel_hi:[1,1]
    v_pk_mul_f32 v[180:181], v[180:181], v[222:223] op_sel:[0,1] op_sel_hi:[1,1]
    v_pk_mul_f32 v[182:183], v[182:183], v[222:223] op_sel:[0,1] op_sel_hi:[1,1]
    v_cvt_pk_bf16_f32 v192, v176, v177
    v_cvt_pk_bf16_f32 v193, v178, v179
    v_cvt_pk_bf16_f32 v194, v180, v181
    v_cvt_pk_bf16_f32 v195, v182, v183
    ds_write_b128 v3, v[192:195] offset:4864
    v_cvt_pk_bf16_f32 v44, v208, v209
    v_cvt_pk_bf16_f32 v45, v210, v211
    v_cvt_pk_bf16_f32 v46, v200, v201
    v_cvt_pk_bf16_f32 v47, v202, v203
    ds_read_b64_tr_b16 a[32:33], v6 offset:4096
    ds_read_b64_tr_b16 a[34:35], v7 offset:4096
    ds_read_b64_tr_b16 a[36:37], v6 offset:5120
    ds_read_b64_tr_b16 a[38:39], v7 offset:5120
    ds_read_b64_tr_b16 a[40:41], v6 offset:6144
    ds_read_b64_tr_b16 a[42:43], v7 offset:6144
    ds_read_b64_tr_b16 a[44:45], v6 offset:7168
    ds_read_b64_tr_b16 a[46:47], v7 offset:7168
    s_add_u32 s89, s55, 4096
    s_waitcnt lgkmcnt(12)
    v_mfma_f32_16x16x32_bf16 v[220:223], a[16:19], v[32:35], 0
    v_mov_b32 v224, v254
    v_exp_f32 v184, v184
    v_mfma_f32_16x16x32_bf16 v[220:223], a[20:23], v[36:39], v[220:223]
    ds_read_b128 v[48:51], v8 offset:8192
    ds_read_b128 v[52:55], v9 offset:8192
    v_exp_f32 v185, v185
    v_mfma_f32_16x16x32_bf16 v[220:223], a[24:27], v[40:43], v[220:223]
    v_permlane16_swap_b32 v254, v224
    v_exp_f32 v186, v186
    v_add_f32 v255, v255, v184
    v_add_f32 v255, v255, v185
    v_mfma_f32_16x16x32_bf16 v[220:223], a[28:31], v[44:47], v[220:223]
    ds_read_b128 v[56:59], v10 offset:8192
    ds_read_b128 v[60:63], v11 offset:8192
    v_add_f32 v254, v254, v224
    v_mov_b32 v224, v254
    v_mfma_f32_16x16x32_bf16 v[216:219], a[16:19], v[16:19], 0
    s_waitcnt lgkmcnt(4)
    buffer_store_dwordx4 a[0:3], v102, s[20:23], s88 offen offset:0 sc1
    v_exp_f32 v187, v187
    v_cvt_pk_bf16_f32 v204, v184, v185
    v_mfma_f32_16x16x32_bf16 v[216:219], a[20:23], v[20:23], v[216:219]
    buffer_store_dwordx4 a[4:7], v102, s[20:23], s88 offen offset:1024 sc1
    v_permlane32_swap_b32 v254, v224
    v_mfma_f32_16x16x32_bf16 v[216:219], a[24:27], v[24:27], v[216:219]
    buffer_store_dwordx4 a[8:11], v102, s[20:23], s88 offen offset:2048 sc1
    v_add_f32 v254, v254, v224
    v_subrev_u32 v224, s57, v254
    v_mfma_f32_16x16x32_bf16 v[216:219], a[28:31], v[28:31], v[216:219]
    buffer_store_dwordx4 a[12:15], v102, s[20:23], s88 offen offset:3072 sc1
    v_cmp_le_u32 vcc, s36, v224
    v_rcp_f32 v254, v254
    v_mfma_f32_16x16x32_bf16 v[176:179], a[128:131], v[80:83], v[232:235]
    ds_read_b128 a[176:179], v240 offset:28672
    ds_read_b128 a[180:183], v241 offset:28672
    ds_bpermute_b32 v224, v4, v254 offset:0
    v_mfma_f32_16x16x32_bf16 v[176:179], a[132:135], v[84:87], v[176:179]
    s_cmp_lg_u64 vcc, 0
    ds_bpermute_b32 v225, v4, v254 offset:4
    v_add_f32 v255, v255, v186
    v_mfma_f32_16x16x32_bf16 v[176:179], a[136:139], v[88:91], v[176:179]
    s_cselect_b32 s56, 4, 0
    ds_read_b128 a[184:187], v242 offset:28672
    ds_read_b128 a[188:191], v243 offset:28672
    ds_bpermute_b32 v226, v4, v254 offset:8
    v_mfma_f32_16x16x32_bf16 v[176:179], a[140:143], v[92:95], v[176:179]
    s_or_b32 s27, s27, s56
    buffer_load_dwordx4 v97, s[16:19], s32 offen offset:1024 nt lds
    ds_bpermute_b32 v227, v4, v254 offset:12
    v_mfma_f32_16x16x32_bf16 v[180:183], a[156:159], v[92:95], v[232:235]
    buffer_load_dwordx4 v96, s[16:19], s32 offen offset:2048 nt lds
    v_sub_f32 v220, s61, v220
    v_mfma_f32_16x16x32_bf16 v[180:183], a[152:155], v[88:91], v[180:183]
    v_exp_f32 v188, v188
    v_add_f32 v255, v255, v187
    v_cvt_pk_bf16_f32 v205, v186, v187
    v_sub_f32 v221, s61, v221
    v_mfma_f32_16x16x32_bf16 v[180:183], a[148:151], v[84:87], v[180:183]
    buffer_load_dwordx4 v97, s[16:19], s32 offen offset:3072 nt lds
    v_sub_f32 v222, s61, v222
    v_mfma_f32_16x16x32_bf16 v[180:183], a[144:147], v[80:83], v[180:183]
    s_add_u32 m0, s34, 36864
    v_exp_f32 v189, v189
    v_exp_f32 v190, v190
    v_add_f32 v255, v255, v188
    v_mfma_f32_16x16x32_bf16 a[64:67], v[212:215], a[224:227], a[64:67]
    buffer_load_dwordx4 v96, s[16:19], s35 offen offset:0 nt lds
    v_add_f32 v255, v255, v189
    v_mfma_f32_16x16x32_bf16 a[64:67], v[196:199], a[192:195], a[64:67]
    buffer_load_dwordx4 v97, s[16:19], s35 offen offset:1024 nt lds
    v_exp_f32 v191, v191
    v_mfma_f32_16x16x32_bf16 a[68:71], v[196:199], a[196:199], a[68:71]
    buffer_load_dwordx4 v96, s[16:19], s35 offen offset:2048 nt lds
    v_cvt_pk_bf16_f32 v206, v188, v189
    v_mfma_f32_16x16x32_bf16 a[68:71], v[212:215], a[228:231], a[68:71]
    v_add_f32 v255, v255, v190
    v_add_f32 v255, v255, v191
    v_cvt_pk_bf16_f32 v207, v190, v191
    v_sub_f32 v223, s61, v223
    v_sub_f32 v216, s61, v216
    v_mfma_f32_16x16x32_bf16 a[72:75], v[212:215], a[232:235], a[72:75]
    buffer_load_dwordx4 v97, s[16:19], s35 offen offset:3072 nt lds
    v_sub_f32 v217, s61, v217
    v_mfma_f32_16x16x32_bf16 a[72:75], v[196:199], a[200:203], a[72:75]
    buffer_store_dwordx4 a[32:35], v102, s[20:23], s89 offen offset:0 sc1
    v_sub_f32 v218, s61, v218
    v_sub_f32 v219, s61, v219
    v_mfma_f32_16x16x32_bf16 a[76:79], v[196:199], a[204:207], a[76:79]
    buffer_store_dwordx4 a[36:39], v102, s[20:23], s89 offen offset:1024 sc1
    v_mfma_f32_16x16x32_bf16 a[76:79], v[212:215], a[236:239], a[76:79]
    s_waitcnt lgkmcnt(0)
    buffer_store_dwordx4 a[40:43], v102, s[20:23], s89 offen offset:2048 sc1
    buffer_store_dwordx4 a[44:47], v102, s[20:23], s89 offen offset:3072 sc1
    s_waitcnt vmcnt(40)
    v_mfma_f32_16x16x32_bf16 v[184:187], a[160:163], v[32:35], v[220:223]
    ds_read_b64_tr_b16 a[224:225], v244 offset:24576
    ds_read_b64_tr_b16 a[226:227], v244 offset:28672
    v_mov_b32 v228, v255
    v_mfma_f32_16x16x32_bf16 v[184:187], a[164:167], v[36:39], v[184:187]
    s_add_u32 s33, s33, 1
    v_exp_f32 v176, v176
    v_mfma_f32_16x16x32_bf16 v[184:187], a[168:171], v[40:43], v[184:187]
    s_add_u32 s32, s32, 8192
    ds_read_b64_tr_b16 a[228:229], v245 offset:24576
    ds_read_b64_tr_b16 a[230:231], v245 offset:28672
    v_permlane16_swap_b32 v255, v228
    v_mfma_f32_16x16x32_bf16 v[184:187], a[172:175], v[44:47], v[184:187]
    s_cmp_eq_u32 s33, 23
    v_add_f32 v255, v255, v228
    v_mov_b32 v228, v255
    v_mfma_f32_16x16x32_bf16 v[188:191], a[188:191], v[44:47], v[220:223]
    s_cselect_b32 s32, s26, s32
    v_exp_f32 v177, v177
    v_mfma_f32_16x16x32_bf16 v[188:191], a[184:187], v[40:43], v[188:191]
    s_cmp_eq_u32 s33, 46
    ds_read_b64_tr_b16 a[232:233], v246 offset:24576
    v_permlane32_swap_b32 v255, v228
    v_mfma_f32_16x16x32_bf16 v[188:191], a[180:183], v[36:39], v[188:191]
    s_cselect_b32 s32, s37, s32
    v_add_f32 v255, v255, v228
    v_subrev_u32 v228, s57, v255
    v_mfma_f32_16x16x32_bf16 v[188:191], a[176:179], v[32:35], v[188:191]
    s_add_u32 s35, s32, 4096
    v_cmp_le_u32 vcc, s36, v228
    v_rcp_f32 v255, v255
    v_mfma_f32_16x16x32_bf16 a[80:83], v[212:215], a[240:243], a[80:83]
    s_add_u32 s34, s34, 8192
    ds_bpermute_b32 v228, v4, v255 offset:0
    v_mfma_f32_16x16x32_bf16 a[80:83], v[196:199], a[208:211], a[80:83]
    s_and_b32 s34, s34, 32767
    ds_read_b64_tr_b16 a[234:235], v246 offset:28672
    ds_bpermute_b32 v229, v4, v255 offset:4
    v_mfma_f32_16x16x32_bf16 a[84:87], v[196:199], a[212:215], a[84:87]
    s_cmp_lg_u64 vcc, 0
    ds_bpermute_b32 v230, v4, v255 offset:8
    v_mfma_f32_16x16x32_bf16 a[84:87], v[212:215], a[244:247], a[84:87]
    s_cselect_b32 s56, 8, 0
    ds_bpermute_b32 v231, v4, v255 offset:12
    v_mfma_f32_16x16x32_bf16 a[88:91], v[212:215], a[248:251], a[88:91]
    s_or_b32 s27, s27, s56
    v_exp_f32 v178, v178
    v_mfma_f32_16x16x32_bf16 a[88:91], v[196:199], a[216:219], a[88:91]
    v_add_f32 v0, v0, v176
    v_add_f32 v0, v0, v177
    v_mfma_f32_16x16x32_bf16 a[92:95], v[196:199], a[220:223], a[92:95]
    v_exp_f32 v179, v179
    v_cvt_pk_bf16_f32 v192, v176, v177
    v_mfma_f32_16x16x32_bf16 a[92:95], v[212:215], a[252:255], a[92:95]
    v_add_f32 v0, v0, v178
    v_mfma_f32_16x16x32_bf16 v[112:115], v[204:207], a[192:195], v[112:115]
    v_exp_f32 v180, v180
    v_add_f32 v0, v0, v179
    v_mfma_f32_16x16x32_bf16 v[116:119], v[204:207], a[196:199], v[116:119]
    ds_read_b128 v[64:67], v8 offset:12288
    ds_read_b128 v[68:71], v9 offset:12288
    v_cvt_pk_bf16_f32 v193, v178, v179
    v_mfma_f32_16x16x32_bf16 v[120:123], v[204:207], a[200:203], v[120:123]
    v_exp_f32 v181, v181
    v_mfma_f32_16x16x32_bf16 v[124:127], v[204:207], a[204:207], v[124:127]
    ds_read_b128 v[72:75], v10 offset:12288
    ds_read_b128 v[76:79], v11 offset:12288
    v_mfma_f32_16x16x32_bf16 v[128:131], v[204:207], a[208:211], v[128:131]
    v_exp_f32 v182, v182
    v_add_f32 v0, v0, v180
    v_mfma_f32_16x16x32_bf16 v[132:135], v[204:207], a[212:215], v[132:135]
    v_add_f32 v0, v0, v181
    v_mfma_f32_16x16x32_bf16 v[136:139], v[204:207], a[216:219], v[136:139]
    v_exp_f32 v183, v183
    v_cvt_pk_bf16_f32 v194, v180, v181
    v_mfma_f32_16x16x32_bf16 v[140:143], v[204:207], a[220:223], v[140:143]
    v_add_f32 v0, v0, v182
    v_add_f32 v0, v0, v183
    v_cvt_pk_bf16_f32 v195, v182, v183
    s_waitcnt lgkmcnt(15)
.p2align 3
    v_mfma_f32_4x4x4_16b_bf16 v[212:215], v[12:13], v[48:49], 0
    v_accvgpr_read_b32 v176, a64
    v_mfma_f32_4x4x4_16b_bf16 v[204:207], v[12:13], v[50:51], 0
    v_accvgpr_read_b32 v177, a68
    v_mfma_f32_4x4x4_16b_bf16 v[212:215], v[14:15], v[48:49], v[212:215]
    v_accvgpr_read_b32 v178, a72
    v_mfma_f32_4x4x4_16b_bf16 v[204:207], v[14:15], v[50:51], v[204:207]
    v_accvgpr_read_b32 v179, a76
    v_accvgpr_read_b32 v180, a80
    v_accvgpr_read_b32 v181, a84
    v_accvgpr_read_b32 v182, a88
    v_accvgpr_read_b32 v183, a92
    s_waitcnt lgkmcnt(14)
.p2align 3
    v_pk_mul_f32 v[176:177], v[176:177], v[224:225] op_sel:[0,0] op_sel_hi:[1,0]
    v_pk_mul_f32 v[178:179], v[178:179], v[224:225] op_sel:[0,0] op_sel_hi:[1,0]
    v_pk_mul_f32 v[180:181], v[180:181], v[224:225] op_sel:[0,0] op_sel_hi:[1,0]
    v_pk_mul_f32 v[182:183], v[182:183], v[224:225] op_sel:[0,0] op_sel_hi:[1,0]
    v_cvt_pk_bf16_f32 v196, v176, v177
    v_cvt_pk_bf16_f32 v197, v178, v179
    v_cvt_pk_bf16_f32 v198, v180, v181
    v_cvt_pk_bf16_f32 v199, v182, v183
    v_cvt_pk_bf16_f32 v48, v212, v213
    v_cvt_pk_bf16_f32 v49, v214, v215
    v_cvt_pk_bf16_f32 v50, v204, v205
    v_cvt_pk_bf16_f32 v51, v206, v207
    v_mfma_f32_4x4x4_16b_bf16 v[212:215], v[12:13], v[52:53], 0
    ds_write_b128 v2, v[196:199] offset:8192
    v_accvgpr_read_b32 v176, a65
    v_mfma_f32_4x4x4_16b_bf16 v[204:207], v[12:13], v[54:55], 0
    v_accvgpr_read_b32 v177, a69
    v_mfma_f32_4x4x4_16b_bf16 v[212:215], v[14:15], v[52:53], v[212:215]
    v_accvgpr_read_b32 v178, a73
    v_mfma_f32_4x4x4_16b_bf16 v[204:207], v[14:15], v[54:55], v[204:207]
    v_accvgpr_read_b32 v179, a77
    v_accvgpr_read_b32 v180, a81
    v_accvgpr_read_b32 v181, a85
    v_accvgpr_read_b32 v182, a89
    v_accvgpr_read_b32 v183, a93
    v_pk_mul_f32 v[176:177], v[176:177], v[224:225] op_sel:[0,1] op_sel_hi:[1,1]
    v_pk_mul_f32 v[178:179], v[178:179], v[224:225] op_sel:[0,1] op_sel_hi:[1,1]
    v_pk_mul_f32 v[180:181], v[180:181], v[224:225] op_sel:[0,1] op_sel_hi:[1,1]
    v_pk_mul_f32 v[182:183], v[182:183], v[224:225] op_sel:[0,1] op_sel_hi:[1,1]
    v_cvt_pk_bf16_f32 v196, v176, v177
    v_cvt_pk_bf16_f32 v197, v178, v179
    v_cvt_pk_bf16_f32 v198, v180, v181
    v_cvt_pk_bf16_f32 v199, v182, v183
    v_cvt_pk_bf16_f32 v52, v212, v213
    v_cvt_pk_bf16_f32 v53, v214, v215
    v_cvt_pk_bf16_f32 v54, v204, v205
    v_cvt_pk_bf16_f32 v55, v206, v207
    v_mfma_f32_4x4x4_16b_bf16 v[212:215], v[12:13], v[56:57], 0
    ds_write_b128 v3, v[196:199] offset:8448
    v_accvgpr_read_b32 v176, a66
    v_mfma_f32_4x4x4_16b_bf16 v[204:207], v[12:13], v[58:59], 0
    v_accvgpr_read_b32 v177, a70
    v_mfma_f32_4x4x4_16b_bf16 v[212:215], v[14:15], v[56:57], v[212:215]
    v_accvgpr_read_b32 v178, a74
    v_mfma_f32_4x4x4_16b_bf16 v[204:207], v[14:15], v[58:59], v[204:207]
    v_accvgpr_read_b32 v179, a78
    v_accvgpr_read_b32 v180, a82
    v_accvgpr_read_b32 v181, a86
    v_accvgpr_read_b32 v182, a90
    v_accvgpr_read_b32 v183, a94
    v_pk_mul_f32 v[176:177], v[176:177], v[226:227] op_sel:[0,0] op_sel_hi:[1,0]
    v_pk_mul_f32 v[178:179], v[178:179], v[226:227] op_sel:[0,0] op_sel_hi:[1,0]
    v_pk_mul_f32 v[180:181], v[180:181], v[226:227] op_sel:[0,0] op_sel_hi:[1,0]
    v_pk_mul_f32 v[182:183], v[182:183], v[226:227] op_sel:[0,0] op_sel_hi:[1,0]
    v_cvt_pk_bf16_f32 v196, v176, v177
    v_cvt_pk_bf16_f32 v197, v178, v179
    v_cvt_pk_bf16_f32 v198, v180, v181
    v_cvt_pk_bf16_f32 v199, v182, v183
    v_cvt_pk_bf16_f32 v56, v212, v213
    v_cvt_pk_bf16_f32 v57, v214, v215
    v_cvt_pk_bf16_f32 v58, v204, v205
    v_cvt_pk_bf16_f32 v59, v206, v207
    v_mfma_f32_4x4x4_16b_bf16 v[212:215], v[12:13], v[60:61], 0
    ds_write_b128 v2, v[196:199] offset:8704
    v_accvgpr_read_b32 v176, a67
    v_mfma_f32_4x4x4_16b_bf16 v[204:207], v[12:13], v[62:63], 0
    v_accvgpr_read_b32 v177, a71
    v_mfma_f32_4x4x4_16b_bf16 v[212:215], v[14:15], v[60:61], v[212:215]
    v_accvgpr_read_b32 v178, a75
    v_mfma_f32_4x4x4_16b_bf16 v[204:207], v[14:15], v[62:63], v[204:207]
    v_accvgpr_read_b32 v179, a79
    v_accvgpr_read_b32 v180, a83
    v_accvgpr_read_b32 v181, a87
    v_accvgpr_read_b32 v182, a91
    v_accvgpr_read_b32 v183, a95
    v_pk_mul_f32 v[176:177], v[176:177], v[226:227] op_sel:[0,1] op_sel_hi:[1,1]
    v_pk_mul_f32 v[178:179], v[178:179], v[226:227] op_sel:[0,1] op_sel_hi:[1,1]
    v_pk_mul_f32 v[180:181], v[180:181], v[226:227] op_sel:[0,1] op_sel_hi:[1,1]
    v_pk_mul_f32 v[182:183], v[182:183], v[226:227] op_sel:[0,1] op_sel_hi:[1,1]
    v_cvt_pk_bf16_f32 v196, v176, v177
    v_cvt_pk_bf16_f32 v197, v178, v179
    v_cvt_pk_bf16_f32 v198, v180, v181
    v_cvt_pk_bf16_f32 v199, v182, v183
    ds_write_b128 v3, v[196:199] offset:8960
    v_cvt_pk_bf16_f32 v60, v212, v213
    v_cvt_pk_bf16_f32 v61, v214, v215
    v_cvt_pk_bf16_f32 v62, v204, v205
    v_cvt_pk_bf16_f32 v63, v206, v207
    ds_read_b64_tr_b16 a[64:65], v6 offset:8192
    ds_read_b64_tr_b16 a[66:67], v7 offset:8192
    ds_read_b64_tr_b16 a[68:69], v6 offset:9216
    ds_read_b64_tr_b16 a[70:71], v7 offset:9216
    ds_read_b64_tr_b16 a[72:73], v6 offset:10240
    ds_read_b64_tr_b16 a[74:75], v7 offset:10240
    ds_read_b64_tr_b16 a[76:77], v6 offset:11264
    ds_read_b64_tr_b16 a[78:79], v7 offset:11264
    s_add_u32 s88, s55, 8192
    s_waitcnt lgkmcnt(12)
    s_waitcnt lgkmcnt(15)
.p2align 3
    v_pk_mul_f32 v[112:113], v[112:113], v[228:229]
    v_pk_mul_f32 v[116:117], v[116:117], v[228:229]
    v_pk_mul_f32 v[120:121], v[120:121], v[228:229]
    v_pk_mul_f32 v[124:125], v[124:125], v[228:229]
    v_pk_mul_f32 v[128:129], v[128:129], v[228:229]
    v_pk_mul_f32 v[132:133], v[132:133], v[228:229]
    v_pk_mul_f32 v[136:137], v[136:137], v[228:229]
    v_pk_mul_f32 v[140:141], v[140:141], v[228:229]
    v_pk_mul_f32 v[114:115], v[114:115], v[230:231]
    v_pk_mul_f32 v[118:119], v[118:119], v[230:231]
    v_pk_mul_f32 v[122:123], v[122:123], v[230:231]
    v_pk_mul_f32 v[126:127], v[126:127], v[230:231]
    v_pk_mul_f32 v[130:131], v[130:131], v[230:231]
    v_pk_mul_f32 v[134:135], v[134:135], v[230:231]
    v_pk_mul_f32 v[138:139], v[138:139], v[230:231]
    v_pk_mul_f32 v[142:143], v[142:143], v[230:231]
    v_mfma_f32_4x4x4_16b_bf16 v[176:179], v[12:13], v[64:65], 0
    v_cvt_pk_bf16_f32 v196, v112, v116
    v_mfma_f32_4x4x4_16b_bf16 v[180:183], v[12:13], v[66:67], 0
    v_cvt_pk_bf16_f32 v197, v120, v124
    v_cvt_pk_bf16_f32 v198, v128, v132
    v_mfma_f32_4x4x4_16b_bf16 v[176:179], v[14:15], v[64:65], v[176:179]
    v_cvt_pk_bf16_f32 v199, v136, v140
    v_mfma_f32_4x4x4_16b_bf16 v[180:183], v[14:15], v[66:67], v[180:183]
    ds_write_b128 v2, v[196:199] offset:12288
    v_mfma_f32_4x4x4_16b_bf16 v[212:215], v[12:13], v[68:69], 0
    v_cvt_pk_bf16_f32 v196, v113, v117
    v_mfma_f32_4x4x4_16b_bf16 v[204:207], v[12:13], v[70:71], 0
    v_cvt_pk_bf16_f32 v197, v121, v125
    v_cvt_pk_bf16_f32 v198, v129, v133
    v_mfma_f32_4x4x4_16b_bf16 v[212:215], v[14:15], v[68:69], v[212:215]
    v_cvt_pk_bf16_f32 v199, v137, v141
    v_mfma_f32_4x4x4_16b_bf16 v[204:207], v[14:15], v[70:71], v[204:207]
    ds_write_b128 v3, v[196:199] offset:12544
    v_cvt_pk_bf16_f32 v64, v176, v177
    v_cvt_pk_bf16_f32 v65, v178, v179
    v_cvt_pk_bf16_f32 v66, v180, v181
    v_cvt_pk_bf16_f32 v67, v182, v183
    v_mfma_f32_4x4x4_16b_bf16 v[176:179], v[12:13], v[72:73], 0
    v_cvt_pk_bf16_f32 v196, v114, v118
    v_mfma_f32_4x4x4_16b_bf16 v[180:183], v[12:13], v[74:75], 0
    v_cvt_pk_bf16_f32 v197, v122, v126
    v_cvt_pk_bf16_f32 v198, v130, v134
    v_mfma_f32_4x4x4_16b_bf16 v[176:179], v[14:15], v[72:73], v[176:179]
    v_cvt_pk_bf16_f32 v199, v138, v142
    v_mfma_f32_4x4x4_16b_bf16 v[180:183], v[14:15], v[74:75], v[180:183]
    ds_write_b128 v2, v[196:199] offset:12800
    v_cvt_pk_bf16_f32 v68, v212, v213
    v_cvt_pk_bf16_f32 v69, v214, v215
    v_cvt_pk_bf16_f32 v70, v204, v205
    v_cvt_pk_bf16_f32 v71, v206, v207
    v_mfma_f32_4x4x4_16b_bf16 v[212:215], v[12:13], v[76:77], 0
    v_cvt_pk_bf16_f32 v196, v115, v119
    v_mfma_f32_4x4x4_16b_bf16 v[204:207], v[12:13], v[78:79], 0
    v_cvt_pk_bf16_f32 v197, v123, v127
    v_cvt_pk_bf16_f32 v198, v131, v135
    v_mfma_f32_4x4x4_16b_bf16 v[212:215], v[14:15], v[76:77], v[212:215]
    v_cvt_pk_bf16_f32 v199, v139, v143
    v_mfma_f32_4x4x4_16b_bf16 v[204:207], v[14:15], v[78:79], v[204:207]
    ds_write_b128 v3, v[196:199] offset:13056
    v_cvt_pk_bf16_f32 v72, v176, v177
    v_cvt_pk_bf16_f32 v73, v178, v179
    v_cvt_pk_bf16_f32 v74, v180, v181
    v_cvt_pk_bf16_f32 v75, v182, v183
    v_cvt_pk_bf16_f32 v76, v212, v213
    v_cvt_pk_bf16_f32 v77, v214, v215
    v_cvt_pk_bf16_f32 v78, v204, v205
    v_cvt_pk_bf16_f32 v79, v206, v207
    ds_read_b64_tr_b16 v[128:129], v6 offset:12288
    ds_read_b64_tr_b16 v[130:131], v7 offset:12288
    ds_read_b64_tr_b16 v[132:133], v6 offset:13312
    ds_read_b64_tr_b16 v[134:135], v7 offset:13312
    ds_read_b64_tr_b16 v[136:137], v6 offset:14336
    ds_read_b64_tr_b16 v[138:139], v7 offset:14336
    ds_read_b64_tr_b16 v[140:141], v6 offset:15360
    ds_read_b64_tr_b16 v[142:143], v7 offset:15360
    s_add_u32 s89, s55, 12288
    s_waitcnt vmcnt(24)
    v_mfma_f32_16x16x32_bf16 v[228:231], a[16:19], v[64:67], 0
    v_mov_b32 v232, v0
    v_exp_f32 v184, v184
    v_mfma_f32_16x16x32_bf16 v[228:231], a[20:23], v[68:71], v[228:231]
    ds_read_b128 v[80:83], v8 offset:16384
    ds_read_b128 v[84:87], v9 offset:16384
    v_exp_f32 v185, v185
    v_mfma_f32_16x16x32_bf16 v[228:231], a[24:27], v[72:75], v[228:231]
    v_permlane16_swap_b32 v0, v232
    v_exp_f32 v186, v186
    v_mov_b32 v253, v184
    v_mfma_f32_16x16x32_bf16 v[228:231], a[28:31], v[76:79], v[228:231]
    ds_read_b128 v[88:91], v10 offset:16384
    ds_read_b128 v[92:95], v11 offset:16384
    v_add_f32 v0, v0, v232
    v_mov_b32 v232, v0
    v_mfma_f32_16x16x32_bf16 v[224:227], a[16:19], v[48:51], 0
    s_waitcnt lgkmcnt(4)
    buffer_store_dwordx4 a[64:67], v102, s[20:23], s88 offen offset:0 sc1
    v_mfma_f32_16x16x32_bf16 v[224:227], a[20:23], v[52:55], v[224:227]
    buffer_store_dwordx4 a[68:71], v102, s[20:23], s88 offen offset:1024 sc1
    v_permlane32_swap_b32 v0, v232
    v_mfma_f32_16x16x32_bf16 v[224:227], a[24:27], v[56:59], v[224:227]
    buffer_store_dwordx4 a[72:75], v102, s[20:23], s88 offen offset:2048 sc1
    v_add_f32 v0, v0, v232
    v_subrev_u32 v232, s57, v0
    v_mfma_f32_16x16x32_bf16 v[224:227], a[28:31], v[60:63], v[224:227]
    buffer_store_dwordx4 a[76:79], v102, s[20:23], s88 offen offset:3072 sc1
    v_cmp_le_u32 vcc, s36, v232
    v_rcp_f32 v0, v0
    v_mfma_f32_16x16x32_bf16 v[176:179], a[160:163], v[16:19], v[216:219]
    ds_read_b64_tr_b16 a[236:237], v247 offset:24576
    ds_read_b64_tr_b16 a[238:239], v247 offset:28672
    ds_bpermute_b32 v232, v4, v0 offset:0
    v_mfma_f32_16x16x32_bf16 v[176:179], a[164:167], v[20:23], v[176:179]
    s_cmp_lg_u64 vcc, 0
    ds_bpermute_b32 v233, v4, v0 offset:4
    v_mfma_f32_16x16x32_bf16 v[176:179], a[168:171], v[24:27], v[176:179]
    s_cselect_b32 s56, 16, 0
    ds_read_b64_tr_b16 a[240:241], v248 offset:24576
    ds_read_b64_tr_b16 a[242:243], v248 offset:28672
    ds_bpermute_b32 v234, v4, v0 offset:8
    v_mfma_f32_16x16x32_bf16 v[176:179], a[172:175], v[28:31], v[176:179]
    s_or_b32 s27, s27, s56
    ds_bpermute_b32 v235, v4, v0 offset:12
    v_mfma_f32_16x16x32_bf16 v[180:183], a[188:191], v[28:31], v[216:219]
    v_add_f32 v253, v253, v185
    v_sub_f32 v228, s61, v228
    v_mfma_f32_16x16x32_bf16 v[180:183], a[184:187], v[24:27], v[180:183]
    ds_read_b64_tr_b16 a[244:245], v249 offset:24576
    v_exp_f32 v187, v187
    v_cvt_pk_bf16_f32 v196, v184, v185
    v_mfma_f32_16x16x32_bf16 v[180:183], a[180:183], v[20:23], v[180:183]
    v_add_f32 v253, v253, v186
    v_exp_f32 v188, v188
    v_add_f32 v253, v253, v187
    v_mfma_f32_16x16x32_bf16 v[180:183], a[176:179], v[16:19], v[180:183]
    v_cvt_pk_bf16_f32 v197, v186, v187
    v_exp_f32 v189, v189
    v_mfma_f32_16x16x32_bf16 v[144:147], v[192:195], a[192:195], v[144:147]
    v_exp_f32 v190, v190
    v_add_f32 v253, v253, v188
    v_add_f32 v253, v253, v189
    v_mfma_f32_16x16x32_bf16 v[148:151], v[192:195], a[196:199], v[148:151]
    ds_read_b64_tr_b16 a[246:247], v249 offset:28672
    v_exp_f32 v191, v191
    v_cvt_pk_bf16_f32 v198, v188, v189
    v_mfma_f32_16x16x32_bf16 v[152:155], v[192:195], a[200:203], v[152:155]
    v_add_f32 v253, v253, v190
    v_add_f32 v253, v253, v191
    v_cvt_pk_bf16_f32 v199, v190, v191
    v_mfma_f32_16x16x32_bf16 v[156:159], v[192:195], a[204:207], v[156:159]
    v_sub_f32 v229, s61, v229
    v_sub_f32 v230, s61, v230
    v_sub_f32 v231, s61, v231
    v_sub_f32 v224, s61, v224
    v_mfma_f32_16x16x32_bf16 v[160:163], v[192:195], a[208:211], v[160:163]
    v_sub_f32 v225, s61, v225
    v_sub_f32 v226, s61, v226
    v_sub_f32 v227, s61, v227
    v_mfma_f32_16x16x32_bf16 v[164:167], v[192:195], a[212:215], v[164:167]
    buffer_store_dwordx4 v[128:131], v102, s[20:23], s89 offen offset:0 sc1
    v_mfma_f32_16x16x32_bf16 v[168:171], v[192:195], a[216:219], v[168:171]
    buffer_store_dwordx4 v[132:135], v102, s[20:23], s89 offen offset:1024 sc1
    v_mfma_f32_16x16x32_bf16 v[172:175], v[192:195], a[220:223], v[172:175]
    buffer_store_dwordx4 v[136:139], v102, s[20:23], s89 offen offset:2048 sc1
    buffer_store_dwordx4 v[140:143], v102, s[20:23], s89 offen offset:3072 sc1
    s_waitcnt lgkmcnt(10)
    s_waitcnt lgkmcnt(2)
.p2align 3
    v_pk_mul_f32 v[144:145], v[144:145], v[232:233]
    v_pk_mul_f32 v[148:149], v[148:149], v[232:233]
    v_pk_mul_f32 v[152:153], v[152:153], v[232:233]
    v_pk_mul_f32 v[156:157], v[156:157], v[232:233]
    v_pk_mul_f32 v[160:161], v[160:161], v[232:233]
    v_pk_mul_f32 v[164:165], v[164:165], v[232:233]
    v_pk_mul_f32 v[168:169], v[168:169], v[232:233]
    v_pk_mul_f32 v[172:173], v[172:173], v[232:233]
    v_pk_mul_f32 v[146:147], v[146:147], v[234:235]
    v_pk_mul_f32 v[150:151], v[150:151], v[234:235]
    v_pk_mul_f32 v[154:155], v[154:155], v[234:235]
    v_pk_mul_f32 v[158:159], v[158:159], v[234:235]
    v_pk_mul_f32 v[162:163], v[162:163], v[234:235]
    v_pk_mul_f32 v[166:167], v[166:167], v[234:235]
    v_pk_mul_f32 v[170:171], v[170:171], v[234:235]
    v_pk_mul_f32 v[174:175], v[174:175], v[234:235]
    v_mfma_f32_4x4x4_16b_bf16 v[184:187], v[12:13], v[80:81], 0
    v_cvt_pk_bf16_f32 v192, v144, v148
    v_mfma_f32_4x4x4_16b_bf16 v[188:191], v[12:13], v[82:83], 0
    v_cvt_pk_bf16_f32 v193, v152, v156
    v_cvt_pk_bf16_f32 v194, v160, v164
    v_mfma_f32_4x4x4_16b_bf16 v[184:187], v[14:15], v[80:81], v[184:187]
    v_cvt_pk_bf16_f32 v195, v168, v172
    v_mfma_f32_4x4x4_16b_bf16 v[188:191], v[14:15], v[82:83], v[188:191]
    ds_write_b128 v2, v[192:195] offset:16384
    v_mfma_f32_4x4x4_16b_bf16 v[212:215], v[12:13], v[84:85], 0
    v_cvt_pk_bf16_f32 v192, v145, v149
    v_mfma_f32_4x4x4_16b_bf16 v[204:207], v[12:13], v[86:87], 0
    v_cvt_pk_bf16_f32 v193, v153, v157
    v_cvt_pk_bf16_f32 v194, v161, v165
    v_mfma_f32_4x4x4_16b_bf16 v[212:215], v[14:15], v[84:85], v[212:215]
    v_cvt_pk_bf16_f32 v195, v169, v173
    v_mfma_f32_4x4x4_16b_bf16 v[204:207], v[14:15], v[86:87], v[204:207]
    ds_write_b128 v3, v[192:195] offset:16640
    v_cvt_pk_bf16_f32 v80, v184, v185
    v_cvt_pk_bf16_f32 v81, v186, v187
    v_cvt_pk_bf16_f32 v82, v188, v189
    v_cvt_pk_bf16_f32 v83, v190, v191
    v_mfma_f32_4x4x4_16b_bf16 v[184:187], v[12:13], v[88:89], 0
    v_cvt_pk_bf16_f32 v192, v146, v150
    v_mfma_f32_4x4x4_16b_bf16 v[188:191], v[12:13], v[90:91], 0
    v_cvt_pk_bf16_f32 v193, v154, v158
    v_cvt_pk_bf16_f32 v194, v162, v166
    v_mfma_f32_4x4x4_16b_bf16 v[184:187], v[14:15], v[88:89], v[184:187]
    v_cvt_pk_bf16_f32 v195, v170, v174
    v_mfma_f32_4x4x4_16b_bf16 v[188:191], v[14:15], v[90:91], v[188:191]
    ds_write_b128 v2, v[192:195] offset:16896
    v_cvt_pk_bf16_f32 v84, v212, v213
    v_cvt_pk_bf16_f32 v85, v214, v215
    v_cvt_pk_bf16_f32 v86, v204, v205
    v_cvt_pk_bf16_f32 v87, v206, v207
    v_mfma_f32_4x4x4_16b_bf16 v[212:215], v[12:13], v[92:93], 0
    v_cvt_pk_bf16_f32 v192, v147, v151
    v_mfma_f32_4x4x4_16b_bf16 v[204:207], v[12:13], v[94:95], 0
    v_cvt_pk_bf16_f32 v193, v155, v159
    v_cvt_pk_bf16_f32 v194, v163, v167
    v_mfma_f32_4x4x4_16b_bf16 v[212:215], v[14:15], v[92:93], v[212:215]
    v_cvt_pk_bf16_f32 v195, v171, v175
    v_mfma_f32_4x4x4_16b_bf16 v[204:207], v[14:15], v[94:95], v[204:207]
    ds_write_b128 v3, v[192:195] offset:17152
    v_cvt_pk_bf16_f32 v88, v184, v185
    v_cvt_pk_bf16_f32 v89, v186, v187
    v_cvt_pk_bf16_f32 v90, v188, v189
    v_cvt_pk_bf16_f32 v91, v190, v191
    v_cvt_pk_bf16_f32 v92, v212, v213
    v_cvt_pk_bf16_f32 v93, v214, v215
    v_cvt_pk_bf16_f32 v94, v204, v205
    v_cvt_pk_bf16_f32 v95, v206, v207
    ds_read_b64_tr_b16 v[160:161], v6 offset:16384
    ds_read_b64_tr_b16 v[162:163], v7 offset:16384
    ds_read_b64_tr_b16 v[164:165], v6 offset:17408
    ds_read_b64_tr_b16 v[166:167], v7 offset:17408
    ds_read_b64_tr_b16 v[168:169], v6 offset:18432
    ds_read_b64_tr_b16 v[170:171], v7 offset:18432
    ds_read_b64_tr_b16 v[172:173], v6 offset:19456
    ds_read_b64_tr_b16 v[174:175], v7 offset:19456
    s_add_u32 s88, s55, 16384
    v_mfma_f32_16x16x32_bf16 v[232:235], a[16:19], v[80:83], 0
    s_add_u32 s53, s25, s63
    v_exp_f32 v176, v176
    v_subrev_u32 v106, 73728, v6
    v_mfma_f32_16x16x32_bf16 v[232:235], a[20:23], v[84:87], v[232:235]
    s_mov_b32 s52, 18
    v_exp_f32 v177, v177
    v_exp_f32 v178, v178
    v_subrev_u32 v107, 73728, v7
    v_mfma_f32_16x16x32_bf16 v[232:235], a[24:27], v[88:91], v[232:235]
    s_add_u32 s55, s26, s50
    v_mov_b32 v252, v176
    v_add_f32 v252, v252, v177
    v_mfma_f32_16x16x32_bf16 v[232:235], a[28:31], v[92:95], v[232:235]
    v_exp_f32 v179, v179
    v_cvt_pk_bf16_f32 v208, v176, v177
    v_add_f32 v252, v252, v178
    v_mfma_f32_16x16x32_bf16 v[184:187], a[160:163], v[64:67], v[228:231]
    ds_read_b64_tr_b16 a[248:249], v250 offset:24576
    ds_read_b64_tr_b16 a[250:251], v250 offset:28672
    v_mfma_f32_16x16x32_bf16 v[184:187], a[164:167], v[68:71], v[184:187]
    v_exp_f32 v180, v180
    v_add_f32 v252, v252, v179
    v_cvt_pk_bf16_f32 v209, v178, v179
    v_mfma_f32_16x16x32_bf16 v[184:187], a[168:171], v[72:75], v[184:187]
    ds_read_b64_tr_b16 a[252:253], v251 offset:24576
    ds_read_b64_tr_b16 a[254:255], v251 offset:28672
    v_mfma_f32_16x16x32_bf16 v[184:187], a[172:175], v[76:79], v[184:187]
    v_exp_f32 v181, v181
    v_exp_f32 v182, v182
    v_mfma_f32_16x16x32_bf16 v[188:191], a[188:191], v[76:79], v[228:231]
    s_waitcnt lgkmcnt(4)
    buffer_store_dwordx4 v[160:163], v102, s[20:23], s88 offen offset:0 sc1
    v_mfma_f32_16x16x32_bf16 v[188:191], a[184:187], v[72:75], v[188:191]
    buffer_store_dwordx4 v[164:167], v102, s[20:23], s88 offen offset:1024 sc1
    v_mfma_f32_16x16x32_bf16 v[188:191], a[180:183], v[68:71], v[188:191]
    v_add_f32 v252, v252, v180
    v_add_f32 v252, v252, v181
    v_sub_f32 v232, s61, v232
    v_mfma_f32_16x16x32_bf16 v[188:191], a[176:179], v[64:67], v[188:191]
    s_waitcnt lgkmcnt(4)
    v_exp_f32 v183, v183
    v_cvt_pk_bf16_f32 v210, v180, v181
    v_mfma_f32_16x16x32_bf16 a[32:35], v[196:199], a[224:227], 0
    buffer_store_dwordx4 v[168:171], v102, s[20:23], s88 offen offset:2048 sc1
    v_mfma_f32_16x16x32_bf16 a[36:39], v[196:199], a[228:231], 0
    buffer_store_dwordx4 v[172:175], v102, s[20:23], s88 offen offset:3072 sc1
    v_mfma_f32_16x16x32_bf16 a[40:43], v[196:199], a[232:235], 0
    v_add_f32 v252, v252, v182
    v_add_f32 v252, v252, v183
    v_cvt_pk_bf16_f32 v211, v182, v183
    v_sub_f32 v233, s61, v233
    v_sub_f32 v234, s61, v234
    v_sub_f32 v235, s61, v235
    v_mfma_f32_16x16x32_bf16 a[44:47], v[196:199], a[236:239], 0
    s_waitcnt vmcnt(32) lgkmcnt(0)
    v_mfma_f32_16x16x32_bf16 v[176:179], a[160:163], v[48:51], v[224:227]
    s_barrier
    ds_read_b128 a[128:131], v240 offset:0
    ds_read_b128 a[132:135], v241 offset:0
    v_mfma_f32_16x16x32_bf16 v[176:179], a[164:167], v[52:55], v[176:179]
    v_exp_f32 v184, v184
    v_mfma_f32_16x16x32_bf16 v[176:179], a[168:171], v[56:59], v[176:179]
    s_add_u32 m0, s34, 0
    ds_read_b128 a[136:139], v242 offset:0
    ds_read_b128 a[140:143], v243 offset:0
    v_exp_f32 v185, v185
    v_mfma_f32_16x16x32_bf16 v[176:179], a[172:175], v[60:63], v[176:179]
    buffer_load_dwordx4 v96, s[12:15], s32 offen offset:0 nt lds
    v_exp_f32 v186, v186
    v_mov_b32 v255, v184
    v_add_f32 v255, v255, v185
    v_mfma_f32_16x16x32_bf16 v[180:183], a[188:191], v[60:63], v[224:227]
    buffer_load_dwordx4 v97, s[12:15], s32 offen offset:1024 nt lds
    v_exp_f32 v187, v187
    v_mfma_f32_16x16x32_bf16 v[180:183], a[184:187], v[56:59], v[180:183]
    buffer_load_dwordx4 v98, s[12:15], s32 offen offset:2048 nt lds
    v_cvt_pk_bf16_f32 v192, v184, v185
    v_add_f32 v255, v255, v186
    v_mfma_f32_16x16x32_bf16 v[180:183], a[180:183], v[52:55], v[180:183]
    buffer_load_dwordx4 v99, s[12:15], s32 offen offset:3072 nt lds
    v_exp_f32 v188, v188
    v_add_f32 v255, v255, v187
    v_cvt_pk_bf16_f32 v193, v186, v187
    v_mfma_f32_16x16x32_bf16 v[180:183], a[176:179], v[48:51], v[180:183]
    s_add_u32 m0, s34, 4096
    v_exp_f32 v189, v189
    v_mfma_f32_16x16x32_bf16 a[48:51], v[196:199], a[240:243], 0
    buffer_load_dwordx4 v96, s[12:15], s35 offen offset:0 nt lds
    v_exp_f32 v190, v190
    v_mfma_f32_16x16x32_bf16 a[52:55], v[196:199], a[244:247], 0
    buffer_load_dwordx4 v97, s[12:15], s35 offen offset:1024 nt lds
    v_add_f32 v255, v255, v188
    v_add_f32 v255, v255, v189
    v_exp_f32 v191, v191
    v_mfma_f32_16x16x32_bf16 a[56:59], v[196:199], a[248:251], 0
    buffer_load_dwordx4 v98, s[12:15], s35 offen offset:2048 nt lds
    v_cvt_pk_bf16_f32 v194, v188, v189
    v_add_f32 v255, v255, v190
    v_mfma_f32_16x16x32_bf16 a[60:63], v[196:199], a[252:255], 0
    buffer_load_dwordx4 v99, s[12:15], s35 offen offset:3072 nt lds
    v_add_f32 v255, v255, v191
    v_cvt_pk_bf16_f32 v195, v190, v191
    v_mfma_f32_16x16x32_bf16 v[184:187], a[160:163], v[80:83], v[232:235]
    ds_read_b128 a[144:147], v240 offset:4096
    ds_read_b128 a[148:151], v241 offset:4096
    v_mfma_f32_16x16x32_bf16 v[184:187], a[164:167], v[84:87], v[184:187]
    v_exp_f32 v176, v176
    v_mfma_f32_16x16x32_bf16 v[184:187], a[168:171], v[88:91], v[184:187]
    s_add_u32 m0, s34, 32768
    ds_read_b128 a[152:155], v242 offset:4096
    ds_read_b128 a[156:159], v243 offset:4096
    v_exp_f32 v177, v177
    v_mfma_f32_16x16x32_bf16 v[184:187], a[172:175], v[92:95], v[184:187]
    buffer_load_dwordx4 v96, s[16:19], s32 offen offset:0 nt lds
    v_exp_f32 v178, v178
    v_mov_b32 v254, v176
    v_add_f32 v254, v254, v177
    v_mfma_f32_16x16x32_bf16 v[188:191], a[188:191], v[92:95], v[232:235]
    buffer_load_dwordx4 v97, s[16:19], s32 offen offset:1024 nt lds
    v_exp_f32 v179, v179
    v_mfma_f32_16x16x32_bf16 v[188:191], a[184:187], v[88:91], v[188:191]
    buffer_load_dwordx4 v96, s[16:19], s32 offen offset:2048 nt lds
    v_cvt_pk_bf16_f32 v212, v176, v177
    v_add_f32 v254, v254, v178
    v_mfma_f32_16x16x32_bf16 v[188:191], a[180:183], v[84:87], v[188:191]
    buffer_load_dwordx4 v97, s[16:19], s32 offen offset:3072 nt lds
    v_exp_f32 v180, v180
    v_add_f32 v254, v254, v179
    v_cvt_pk_bf16_f32 v213, v178, v179
    v_mfma_f32_16x16x32_bf16 v[188:191], a[176:179], v[80:83], v[188:191]
    s_add_u32 m0, s34, 36864
    v_exp_f32 v181, v181
    v_mfma_f32_16x16x32_bf16 v[112:115], v[192:195], a[224:227], 0
    buffer_load_dwordx4 v96, s[16:19], s35 offen offset:0 nt lds
    v_exp_f32 v182, v182
    v_mfma_f32_16x16x32_bf16 v[116:119], v[192:195], a[228:231], 0
    buffer_load_dwordx4 v97, s[16:19], s35 offen offset:1024 nt lds
    v_add_f32 v254, v254, v180
    v_add_f32 v254, v254, v181
    v_exp_f32 v183, v183
    v_mfma_f32_16x16x32_bf16 v[120:123], v[192:195], a[232:235], 0
    buffer_load_dwordx4 v96, s[16:19], s35 offen offset:2048 nt lds
    v_cvt_pk_bf16_f32 v214, v180, v181
    v_add_f32 v254, v254, v182
    v_mfma_f32_16x16x32_bf16 v[124:127], v[192:195], a[236:239], 0
    s_waitcnt lgkmcnt(0)
    buffer_load_dwordx4 v97, s[16:19], s35 offen offset:3072 nt lds
    v_add_f32 v254, v254, v183
    v_cvt_pk_bf16_f32 v215, v182, v183
    v_mfma_f32_16x16x32_bf16 v[176:179], a[128:131], v[16:19], v[216:219]
    ds_read_b64_tr_b16 a[192:193], v244 offset:0
    ds_read_b64_tr_b16 a[194:195], v244 offset:4096
    v_mfma_f32_16x16x32_bf16 v[176:179], a[132:135], v[20:23], v[176:179]
    s_add_u32 s33, s33, 1
    v_exp_f32 v184, v184
    v_mfma_f32_16x16x32_bf16 v[176:179], a[136:139], v[24:27], v[176:179]
    s_add_u32 s32, s32, 8192
    ds_read_b64_tr_b16 a[196:197], v245 offset:0
    ds_read_b64_tr_b16 a[198:199], v245 offset:4096
    v_exp_f32 v185, v185
    v_mfma_f32_16x16x32_bf16 v[176:179], a[140:143], v[28:31], v[176:179]
    s_cmp_eq_u32 s33, 23
    v_exp_f32 v186, v186
    v_mov_b32 v0, v184
    v_add_f32 v0, v0, v185
    v_mfma_f32_16x16x32_bf16 v[180:183], a[156:159], v[28:31], v[216:219]
    s_cselect_b32 s32, s26, s32
    v_exp_f32 v187, v187
    v_mfma_f32_16x16x32_bf16 v[180:183], a[152:155], v[24:27], v[180:183]
    s_cmp_eq_u32 s33, 46
    ds_read_b64_tr_b16 a[200:201], v246 offset:0
    v_cvt_pk_bf16_f32 v196, v184, v185
    v_add_f32 v0, v0, v186
    v_mfma_f32_16x16x32_bf16 v[180:183], a[148:151], v[20:23], v[180:183]
    s_cselect_b32 s32, s37, s32
    v_exp_f32 v188, v188
    v_add_f32 v0, v0, v187
    v_cvt_pk_bf16_f32 v197, v186, v187
    v_mfma_f32_16x16x32_bf16 v[180:183], a[144:147], v[16:19], v[180:183]
    s_add_u32 s35, s32, 4096
    v_exp_f32 v189, v189
    v_mfma_f32_16x16x32_bf16 v[128:131], v[192:195], a[240:243], 0
    s_add_u32 s34, s34, 8192
    v_exp_f32 v190, v190
    v_mfma_f32_16x16x32_bf16 v[132:135], v[192:195], a[244:247], 0
    s_and_b32 s34, s34, 32767
    ds_read_b64_tr_b16 a[202:203], v246 offset:4096
    v_add_f32 v0, v0, v188
    v_add_f32 v0, v0, v189
    v_exp_f32 v191, v191
    v_mfma_f32_16x16x32_bf16 v[136:139], v[192:195], a[248:251], 0
    v_cvt_pk_bf16_f32 v198, v188, v189
    v_add_f32 v0, v0, v190
    v_mfma_f32_16x16x32_bf16 v[140:143], v[192:195], a[252:255], 0
    v_add_f32 v0, v0, v191
    v_cvt_pk_bf16_f32 v199, v190, v191
    v_mfma_f32_16x16x32_bf16 v[184:187], a[128:131], v[32:35], v[220:223]
    ds_read_b64_tr_b16 a[204:205], v247 offset:0
    ds_read_b64_tr_b16 a[206:207], v247 offset:4096
    v_mfma_f32_16x16x32_bf16 v[184:187], a[132:135], v[36:39], v[184:187]
    v_exp_f32 v176, v176
    v_mfma_f32_16x16x32_bf16 v[184:187], a[136:139], v[40:43], v[184:187]
    ds_read_b64_tr_b16 a[208:209], v248 offset:0
    ds_read_b64_tr_b16 a[210:211], v248 offset:4096
    v_mfma_f32_16x16x32_bf16 v[184:187], a[140:143], v[44:47], v[184:187]
    buffer_store_dwordx4 a[96:99], v102, s[20:23], s37 offen
    v_exp_f32 v177, v177
    v_mfma_f32_16x16x32_bf16 v[188:191], a[156:159], v[44:47], v[220:223]
    v_exp_f32 v178, v178
    v_mfma_f32_16x16x32_bf16 v[188:191], a[152:155], v[40:43], v[188:191]
    ds_read_b64_tr_b16 a[212:213], v249 offset:0
    v_add_f32 v252, v252, v176
    v_add_f32 v252, v252, v177
    v_mfma_f32_16x16x32_bf16 v[188:191], a[148:151], v[36:39], v[188:191]
    v_exp_f32 v179, v179
    v_mfma_f32_16x16x32_bf16 v[188:191], a[144:147], v[32:35], v[188:191]
    buffer_store_dwordx4 a[96:99], v102, s[20:23], s37 offen
    v_cvt_pk_bf16_f32 v192, v176, v177
    v_add_f32 v252, v252, v178
    v_mfma_f32_16x16x32_bf16 v[144:147], v[196:199], a[224:227], 0
    v_exp_f32 v180, v180
    v_mfma_f32_16x16x32_bf16 v[148:151], v[196:199], a[228:231], 0
    ds_read_b64_tr_b16 a[214:215], v249 offset:4096
    v_add_f32 v252, v252, v179
    v_cvt_pk_bf16_f32 v193, v178, v179
    v_mfma_f32_16x16x32_bf16 v[152:155], v[196:199], a[232:235], 0
    v_exp_f32 v181, v181
    v_mfma_f32_16x16x32_bf16 v[156:159], v[196:199], a[236:239], 0
    buffer_store_dwordx4 a[96:99], v102, s[20:23], s37 offen
    v_exp_f32 v182, v182
    v_mfma_f32_16x16x32_bf16 v[160:163], v[196:199], a[240:243], 0
    v_add_f32 v252, v252, v180
    v_add_f32 v252, v252, v181
    v_mfma_f32_16x16x32_bf16 v[164:167], v[196:199], a[244:247], 0
    buffer_store_dwordx4 a[96:99], v102, s[20:23], s37 offen
    v_exp_f32 v183, v183
    v_mfma_f32_16x16x32_bf16 v[168:171], v[196:199], a[248:251], 0
    v_cvt_pk_bf16_f32 v194, v180, v181
    v_add_f32 v252, v252, v182
    v_mfma_f32_16x16x32_bf16 v[172:175], v[196:199], a[252:255], 0
    v_add_f32 v252, v252, v183
    v_cvt_pk_bf16_f32 v195, v182, v183
    v_mfma_f32_16x16x32_bf16 v[176:179], a[128:131], v[48:51], v[224:227]
    ds_read_b64_tr_b16 a[216:217], v250 offset:0
    ds_read_b64_tr_b16 a[218:219], v250 offset:4096
    v_mfma_f32_16x16x32_bf16 v[176:179], a[132:135], v[52:55], v[176:179]
    v_exp_f32 v184, v184
    v_mfma_f32_16x16x32_bf16 v[176:179], a[136:139], v[56:59], v[176:179]
    ds_read_b64_tr_b16 a[220:221], v251 offset:0
    ds_read_b64_tr_b16 a[222:223], v251 offset:4096
    v_mfma_f32_16x16x32_bf16 v[176:179], a[140:143], v[60:63], v[176:179]
    v_exp_f32 v185, v185
    v_mfma_f32_16x16x32_bf16 v[180:183], a[156:159], v[60:63], v[224:227]
    v_exp_f32 v186, v186
    v_mfma_f32_16x16x32_bf16 v[180:183], a[152:155], v[56:59], v[180:183]
    v_add_f32 v253, v253, v184
    v_add_f32 v253, v253, v185
    v_mfma_f32_16x16x32_bf16 v[180:183], a[148:151], v[52:55], v[180:183]
    v_exp_f32 v187, v187
    v_mfma_f32_16x16x32_bf16 v[180:183], a[144:147], v[48:51], v[180:183]
    s_waitcnt lgkmcnt(4)
    v_cvt_pk_bf16_f32 v200, v184, v185
    v_add_f32 v253, v253, v186
    v_mfma_f32_16x16x32_bf16 a[0:3], v[208:211], a[224:227], 0
    v_exp_f32 v188, v188
    v_mfma_f32_16x16x32_bf16 a[0:3], v[192:195], a[192:195], a[0:3]
    v_add_f32 v253, v253, v187
    v_cvt_pk_bf16_f32 v201, v186, v187
    v_mfma_f32_16x16x32_bf16 a[4:7], v[192:195], a[196:199], 0
    v_exp_f32 v189, v189
    v_mfma_f32_16x16x32_bf16 a[4:7], v[208:211], a[228:231], a[4:7]
    v_exp_f32 v190, v190
    v_mfma_f32_16x16x32_bf16 a[8:11], v[208:211], a[232:235], 0
    v_add_f32 v253, v253, v188
    v_add_f32 v253, v253, v189
    v_mfma_f32_16x16x32_bf16 a[8:11], v[192:195], a[200:203], a[8:11]
    v_exp_f32 v191, v191
    v_mfma_f32_16x16x32_bf16 a[12:15], v[192:195], a[204:207], 0
    v_cvt_pk_bf16_f32 v202, v188, v189
    v_add_f32 v253, v253, v190
    v_mfma_f32_16x16x32_bf16 a[12:15], v[208:211], a[236:239], a[12:15]
    s_waitcnt vmcnt(44) lgkmcnt(0)
    v_add_f32 v253, v253, v191
    v_cvt_pk_bf16_f32 v203, v190, v191
    v_mfma_f32_16x16x32_bf16 v[184:187], a[128:131], v[64:67], v[228:231]
    s_barrier
    ds_read_b128 a[160:163], v240 offset:8192
    ds_read_b128 a[164:167], v241 offset:8192
    v_mfma_f32_16x16x32_bf16 v[184:187], a[132:135], v[68:71], v[184:187]
    v_exp_f32 v176, v176
    v_mfma_f32_16x16x32_bf16 v[184:187], a[136:139], v[72:75], v[184:187]
    s_add_u32 m0, s34, 0
    ds_read_b128 a[168:171], v242 offset:8192
    ds_read_b128 a[172:175], v243 offset:8192
    v_mfma_f32_16x16x32_bf16 v[184:187], a[140:143], v[76:79], v[184:187]
    buffer_load_dwordx4 v96, s[12:15], s32 offen offset:0 nt lds
    v_exp_f32 v177, v177
    v_mfma_f32_16x16x32_bf16 v[188:191], a[156:159], v[76:79], v[228:231]
    buffer_load_dwordx4 v97, s[12:15], s32 offen offset:1024 nt lds
    v_exp_f32 v178, v178
    v_mfma_f32_16x16x32_bf16 v[188:191], a[152:155], v[72:75], v[188:191]
    ds_read_b64_tr_b16 a[96:97], v106 offset:0
    ds_read_b64_tr_b16 a[98:99], v107 offset:0
    v_add_f32 v254, v254, v176
    v_add_f32 v254, v254, v177
    v_mfma_f32_16x16x32_bf16 v[188:191], a[148:151], v[68:71], v[188:191]
    buffer_load_dwordx4 v98, s[12:15], s32 offen offset:2048 nt lds
    v_exp_f32 v179, v179
    v_mfma_f32_16x16x32_bf16 v[188:191], a[144:147], v[64:67], v[188:191]
    buffer_load_dwordx4 v99, s[12:15], s32 offen offset:3072 nt lds
    v_cvt_pk_bf16_f32 v196, v176, v177
    v_add_f32 v254, v254, v178
    v_mfma_f32_16x16x32_bf16 a[16:19], v[208:211], a[240:243], 0
    s_add_u32 m0, s34, 4096
    ds_read_b64_tr_b16 a[100:101], v106 offset:1024
    ds_read_b64_tr_b16 a[102:103], v107 offset:1024
    v_exp_f32 v180, v180
    v_mfma_f32_16x16x32_bf16 a[16:19], v[192:195], a[208:211], a[16:19]
    buffer_load_dwordx4 v96, s[12:15], s35 offen offset:0 nt lds
    v_add_f32 v254, v254, v179
    v_cvt_pk_bf16_f32 v197, v178, v179
    v_mfma_f32_16x16x32_bf16 a[20:23], v[192:195], a[212:215], 0
    buffer_load_dwordx4 v97, s[12:15], s35 offen offset:1024 nt lds
    v_exp_f32 v181, v181
    v_mfma_f32_16x16x32_bf16 a[20:23], v[208:211], a[244:247], a[20:23]
    ds_read_b64_tr_b16 a[104:105], v106 offset:2048
    ds_read_b64_tr_b16 a[106:107], v107 offset:2048
    v_exp_f32 v182, v182
    v_mfma_f32_16x16x32_bf16 a[24:27], v[208:211], a[248:251], 0
    buffer_load_dwordx4 v98, s[12:15], s35 offen offset:2048 nt lds
    v_add_f32 v254, v254, v180
    v_add_f32 v254, v254, v181
    v_mfma_f32_16x16x32_bf16 a[24:27], v[192:195], a[216:219], a[24:27]
    buffer_load_dwordx4 v99, s[12:15], s35 offen offset:3072 nt lds
    v_exp_f32 v183, v183
    v_mfma_f32_16x16x32_bf16 a[28:31], v[192:195], a[220:223], 0
    s_add_u32 m0, s34, 32768
    ds_read_b64_tr_b16 a[108:109], v106 offset:3072
    ds_read_b64_tr_b16 a[110:111], v107 offset:3072
    v_cvt_pk_bf16_f32 v198, v180, v181
    v_add_f32 v254, v254, v182
    v_mfma_f32_16x16x32_bf16 a[28:31], v[208:211], a[252:255], a[28:31]
    buffer_load_dwordx4 v96, s[16:19], s32 offen offset:0 nt lds
    v_add_f32 v254, v254, v183
    v_cvt_pk_bf16_f32 v199, v182, v183
    v_mfma_f32_16x16x32_bf16 v[176:179], a[128:131], v[80:83], v[232:235]
    ds_read_b128 a[176:179], v240 offset:12288
    ds_read_b128 a[180:183], v241 offset:12288
    v_mfma_f32_16x16x32_bf16 v[176:179], a[132:135], v[84:87], v[176:179]
    v_exp_f32 v184, v184
    v_mfma_f32_16x16x32_bf16 v[176:179], a[136:139], v[88:91], v[176:179]
    ds_read_b128 a[184:187], v242 offset:12288
    ds_read_b128 a[188:191], v243 offset:12288
    v_mfma_f32_16x16x32_bf16 v[176:179], a[140:143], v[92:95], v[176:179]
    buffer_load_dwordx4 v97, s[16:19], s32 offen offset:1024 nt lds
    v_exp_f32 v185, v185
    v_mfma_f32_16x16x32_bf16 v[180:183], a[156:159], v[92:95], v[232:235]
    buffer_load_dwordx4 v96, s[16:19], s32 offen offset:2048 nt lds
    v_exp_f32 v186, v186
    v_mfma_f32_16x16x32_bf16 v[180:183], a[152:155], v[88:91], v[180:183]
    v_add_f32 v255, v255, v184
    v_add_f32 v255, v255, v185
    v_mfma_f32_16x16x32_bf16 v[180:183], a[148:151], v[84:87], v[180:183]
    buffer_load_dwordx4 v97, s[16:19], s32 offen offset:3072 nt lds
    v_exp_f32 v187, v187
    v_mfma_f32_16x16x32_bf16 v[180:183], a[144:147], v[80:83], v[180:183]
    s_add_u32 m0, s34, 36864
    v_cvt_pk_bf16_f32 v204, v184, v185
    v_add_f32 v255, v255, v186
    v_mfma_f32_16x16x32_bf16 a[64:67], v[212:215], a[224:227], 0
    buffer_load_dwordx4 v96, s[16:19], s35 offen offset:0 nt lds
    v_exp_f32 v188, v188
    v_mfma_f32_16x16x32_bf16 a[64:67], v[196:199], a[192:195], a[64:67]
    buffer_load_dwordx4 v97, s[16:19], s35 offen offset:1024 nt lds
    v_add_f32 v255, v255, v187
    v_cvt_pk_bf16_f32 v205, v186, v187
    v_mfma_f32_16x16x32_bf16 a[68:71], v[196:199], a[196:199], 0
    buffer_load_dwordx4 v96, s[16:19], s35 offen offset:2048 nt lds
    v_exp_f32 v189, v189
    v_mfma_f32_16x16x32_bf16 a[68:71], v[212:215], a[228:231], a[68:71]
    v_exp_f32 v190, v190
    v_mfma_f32_16x16x32_bf16 a[72:75], v[212:215], a[232:235], 0
    buffer_load_dwordx4 v97, s[16:19], s35 offen offset:3072 nt lds
    v_add_f32 v255, v255, v188
    v_add_f32 v255, v255, v189
    v_mfma_f32_16x16x32_bf16 a[72:75], v[196:199], a[200:203], a[72:75]
    v_exp_f32 v191, v191
    v_mfma_f32_16x16x32_bf16 a[76:79], v[196:199], a[204:207], 0
    v_cvt_pk_bf16_f32 v206, v188, v189
    v_add_f32 v255, v255, v190
    v_mfma_f32_16x16x32_bf16 a[76:79], v[212:215], a[236:239], a[76:79]
    s_waitcnt lgkmcnt(0)
    v_add_f32 v255, v255, v191
    v_cvt_pk_bf16_f32 v207, v190, v191
    v_mfma_f32_16x16x32_bf16 v[184:187], a[160:163], v[32:35], v[220:223]
    ds_read_b64_tr_b16 a[224:225], v244 offset:8192
    ds_read_b64_tr_b16 a[226:227], v244 offset:12288
    v_mfma_f32_16x16x32_bf16 v[184:187], a[164:167], v[36:39], v[184:187]
    s_add_u32 s33, s33, 1
    v_exp_f32 v176, v176
    v_mfma_f32_16x16x32_bf16 v[184:187], a[168:171], v[40:43], v[184:187]
    s_add_u32 s32, s32, 8192
    ds_read_b64_tr_b16 a[228:229], v245 offset:8192
    ds_read_b64_tr_b16 a[230:231], v245 offset:12288
    v_mfma_f32_16x16x32_bf16 v[184:187], a[172:175], v[44:47], v[184:187]
    s_cmp_eq_u32 s33, 23
    v_exp_f32 v177, v177
    v_mfma_f32_16x16x32_bf16 v[188:191], a[188:191], v[44:47], v[220:223]
    s_cselect_b32 s32, s26, s32
    v_exp_f32 v178, v178
    v_mfma_f32_16x16x32_bf16 v[188:191], a[184:187], v[40:43], v[188:191]
    s_cmp_eq_u32 s33, 46
    ds_read_b64_tr_b16 a[232:233], v246 offset:8192
    v_add_f32 v0, v0, v176
    v_add_f32 v0, v0, v177
    v_mfma_f32_16x16x32_bf16 v[188:191], a[180:183], v[36:39], v[188:191]
    s_cselect_b32 s32, s37, s32
    v_exp_f32 v179, v179
    v_mfma_f32_16x16x32_bf16 v[188:191], a[176:179], v[32:35], v[188:191]
    s_add_u32 s35, s32, 4096
    buffer_store_dwordx4 a[96:99], v102, s[20:23], s53 offen offset:0 sc1
    v_cvt_pk_bf16_f32 v192, v176, v177
    v_add_f32 v0, v0, v178
    v_mfma_f32_16x16x32_bf16 a[80:83], v[212:215], a[240:243], 0
    s_add_u32 s34, s34, 8192
    v_exp_f32 v180, v180
    v_mfma_f32_16x16x32_bf16 a[80:83], v[196:199], a[208:211], a[80:83]
    s_and_b32 s34, s34, 32767
    ds_read_b64_tr_b16 a[234:235], v246 offset:12288
    v_add_f32 v0, v0, v179
    v_cvt_pk_bf16_f32 v193, v178, v179
    v_mfma_f32_16x16x32_bf16 a[84:87], v[196:199], a[212:215], 0
    v_exp_f32 v181, v181
    v_mfma_f32_16x16x32_bf16 a[84:87], v[212:215], a[244:247], a[84:87]
    v_exp_f32 v182, v182
    v_mfma_f32_16x16x32_bf16 a[88:91], v[212:215], a[248:251], 0
    buffer_store_dwordx4 a[100:103], v102, s[20:23], s53 offen offset:1024 sc1
    v_add_f32 v0, v0, v180
    v_add_f32 v0, v0, v181
    v_mfma_f32_16x16x32_bf16 a[88:91], v[196:199], a[216:219], a[88:91]
    v_exp_f32 v183, v183
    v_mfma_f32_16x16x32_bf16 a[92:95], v[196:199], a[220:223], 0
    v_cvt_pk_bf16_f32 v194, v180, v181
    v_add_f32 v0, v0, v182
    v_mfma_f32_16x16x32_bf16 a[92:95], v[212:215], a[252:255], a[92:95]
    v_add_f32 v0, v0, v183
    v_cvt_pk_bf16_f32 v195, v182, v183
    v_mfma_f32_16x16x32_bf16 v[176:179], a[160:163], v[16:19], v[216:219]
    ds_read_b64_tr_b16 a[236:237], v247 offset:8192
    ds_read_b64_tr_b16 a[238:239], v247 offset:12288
    v_mfma_f32_16x16x32_bf16 v[176:179], a[164:167], v[20:23], v[176:179]
    v_exp_f32 v184, v184
    v_mfma_f32_16x16x32_bf16 v[176:179], a[168:171], v[24:27], v[176:179]
    ds_read_b64_tr_b16 a[240:241], v248 offset:8192
    ds_read_b64_tr_b16 a[242:243], v248 offset:12288
    v_mfma_f32_16x16x32_bf16 v[176:179], a[172:175], v[28:31], v[176:179]
    buffer_store_dwordx4 a[104:107], v102, s[20:23], s53 offen offset:2048 sc1
    v_exp_f32 v185, v185
    v_mfma_f32_16x16x32_bf16 v[180:183], a[188:191], v[28:31], v[216:219]
    v_exp_f32 v186, v186
    v_mfma_f32_16x16x32_bf16 v[180:183], a[184:187], v[24:27], v[180:183]
    ds_read_b64_tr_b16 a[244:245], v249 offset:8192
    v_add_f32 v253, v253, v184
    v_add_f32 v253, v253, v185
    v_mfma_f32_16x16x32_bf16 v[180:183], a[180:183], v[20:23], v[180:183]
    v_exp_f32 v187, v187
    v_mfma_f32_16x16x32_bf16 v[180:183], a[176:179], v[16:19], v[180:183]
    buffer_store_dwordx4 a[108:111], v102, s[20:23], s53 offen offset:3072 sc1
    v_cvt_pk_bf16_f32 v196, v184, v185
    v_add_f32 v253, v253, v186
    v_mfma_f32_16x16x32_bf16 v[144:147], v[192:195], a[192:195], v[144:147]
    s_add_u32 s53, s53, 4096
    v_exp_f32 v188, v188
    v_mfma_f32_16x16x32_bf16 v[148:151], v[192:195], a[196:199], v[148:151]
    s_sub_u32 s52, s52, 1
    ds_read_b64_tr_b16 a[246:247], v249 offset:12288
    v_add_f32 v253, v253, v187
    v_cvt_pk_bf16_f32 v197, v186, v187
    v_mfma_f32_16x16x32_bf16 v[152:155], v[192:195], a[200:203], v[152:155]
    s_cmp_le_i32 s52, 0
    v_exp_f32 v189, v189
    v_mfma_f32_16x16x32_bf16 v[156:159], v[192:195], a[204:207], v[156:159]
    s_cselect_b32 s53, s37, s53
    v_exp_f32 v190, v190
    v_mfma_f32_16x16x32_bf16 v[160:163], v[192:195], a[208:211], v[160:163]
    v_add_f32 v253, v253, v188
    v_add_f32 v253, v253, v189
    v_mfma_f32_16x16x32_bf16 v[164:167], v[192:195], a[212:215], v[164:167]
    v_exp_f32 v191, v191
    v_mfma_f32_16x16x32_bf16 v[168:171], v[192:195], a[216:219], v[168:171]
    v_cvt_pk_bf16_f32 v198, v188, v189
    v_add_f32 v253, v253, v190
    v_mfma_f32_16x16x32_bf16 v[172:175], v[192:195], a[220:223], v[172:175]
    v_add_f32 v253, v253, v191
    v_cvt_pk_bf16_f32 v199, v190, v191
    s_branch L_loopb1_w3
.p2align 6
L_loopb_w3:
    v_mfma_f32_16x16x32_bf16 v[176:179], a[128:131], v[48:51], v[224:227]
    ds_read_b64_tr_b16 a[216:217], v250 offset:16384
    ds_read_b64_tr_b16 a[218:219], v250 offset:20480
    v_mfma_f32_16x16x32_bf16 v[176:179], a[132:135], v[52:55], v[176:179]
    v_exp_f32 v184, v184
    v_mfma_f32_16x16x32_bf16 v[176:179], a[136:139], v[56:59], v[176:179]
    ds_read_b64_tr_b16 a[220:221], v251 offset:16384
    ds_read_b64_tr_b16 a[222:223], v251 offset:20480
    v_mfma_f32_16x16x32_bf16 v[176:179], a[140:143], v[60:63], v[176:179]
    v_exp_f32 v185, v185
    v_mfma_f32_16x16x32_bf16 v[180:183], a[156:159], v[60:63], v[224:227]
    v_exp_f32 v186, v186
    v_mfma_f32_16x16x32_bf16 v[180:183], a[152:155], v[56:59], v[180:183]
    v_add_f32 v253, v253, v184
    v_add_f32 v253, v253, v185
    v_mfma_f32_16x16x32_bf16 v[180:183], a[148:151], v[52:55], v[180:183]
    v_exp_f32 v187, v187
    v_mfma_f32_16x16x32_bf16 v[180:183], a[144:147], v[48:51], v[180:183]
    s_waitcnt lgkmcnt(4)
    v_cvt_pk_bf16_f32 v200, v184, v185
    v_add_f32 v253, v253, v186
    v_mfma_f32_16x16x32_bf16 a[0:3], v[208:211], a[224:227], a[0:3]
    v_exp_f32 v188, v188
    v_mfma_f32_16x16x32_bf16 a[0:3], v[192:195], a[192:195], a[0:3]
    v_add_f32 v253, v253, v187
    v_cvt_pk_bf16_f32 v201, v186, v187
    v_mfma_f32_16x16x32_bf16 a[4:7], v[192:195], a[196:199], a[4:7]
    v_exp_f32 v189, v189
    v_mfma_f32_16x16x32_bf16 a[4:7], v[208:211], a[228:231], a[4:7]
    v_exp_f32 v190, v190
    v_mfma_f32_16x16x32_bf16 a[8:11], v[208:211], a[232:235], a[8:11]
    v_add_f32 v253, v253, v188
    v_add_f32 v253, v253, v189
    v_mfma_f32_16x16x32_bf16 a[8:11], v[192:195], a[200:203], a[8:11]
    v_exp_f32 v191, v191
    v_mfma_f32_16x16x32_bf16 a[12:15], v[192:195], a[204:207], a[12:15]
    v_cvt_pk_bf16_f32 v202, v188, v189
    v_add_f32 v253, v253, v190
    v_mfma_f32_16x16x32_bf16 a[12:15], v[208:211], a[236:239], a[12:15]
    s_waitcnt vmcnt(44) lgkmcnt(0)
    v_add_f32 v253, v253, v191
    v_cvt_pk_bf16_f32 v203, v190, v191
    v_mfma_f32_16x16x32_bf16 v[184:187], a[128:131], v[64:67], v[228:231]
    s_barrier
    ds_read_b128 a[160:163], v240 offset:24576
    ds_read_b128 a[164:167], v241 offset:24576
    v_mfma_f32_16x16x32_bf16 v[184:187], a[132:135], v[68:71], v[184:187]
    v_exp_f32 v176, v176
    v_mfma_f32_16x16x32_bf16 v[184:187], a[136:139], v[72:75], v[184:187]
    s_add_u32 m0, s34, 0
    ds_read_b128 a[168:171], v242 offset:24576
    ds_read_b128 a[172:175], v243 offset:24576
    v_mfma_f32_16x16x32_bf16 v[184:187], a[140:143], v[76:79], v[184:187]
    buffer_load_dwordx4 v96, s[12:15], s32 offen offset:0 nt lds
    v_exp_f32 v177, v177
    v_mfma_f32_16x16x32_bf16 v[188:191], a[156:159], v[76:79], v[228:231]
    buffer_load_dwordx4 v97, s[12:15], s32 offen offset:1024 nt lds
    v_exp_f32 v178, v178
    v_mfma_f32_16x16x32_bf16 v[188:191], a[152:155], v[72:75], v[188:191]
    ds_read_b64_tr_b16 a[96:97], v106 offset:8192
    ds_read_b64_tr_b16 a[98:99], v107 offset:8192
    v_add_f32 v254, v254, v176
    v_add_f32 v254, v254, v177
    v_mfma_f32_16x16x32_bf16 v[188:191], a[148:151], v[68:71], v[188:191]
    buffer_load_dwordx4 v98, s[12:15], s32 offen offset:2048 nt lds
    v_exp_f32 v179, v179
    v_mfma_f32_16x16x32_bf16 v[188:191], a[144:147], v[64:67], v[188:191]
    buffer_load_dwordx4 v99, s[12:15], s32 offen offset:3072 nt lds
    v_cvt_pk_bf16_f32 v196, v176, v177
    v_add_f32 v254, v254, v178
    v_mfma_f32_16x16x32_bf16 a[16:19], v[208:211], a[240:243], a[16:19]
    s_add_u32 m0, s34, 4096
    ds_read_b64_tr_b16 a[100:101], v106 offset:9216
    ds_read_b64_tr_b16 a[102:103], v107 offset:9216
    v_exp_f32 v180, v180
    v_mfma_f32_16x16x32_bf16 a[16:19], v[192:195], a[208:211], a[16:19]
    buffer_load_dwordx4 v96, s[12:15], s35 offen offset:0 nt lds
    v_add_f32 v254, v254, v179
    v_cvt_pk_bf16_f32 v197, v178, v179
    v_mfma_f32_16x16x32_bf16 a[20:23], v[192:195], a[212:215], a[20:23]
    buffer_load_dwordx4 v97, s[12:15], s35 offen offset:1024 nt lds
    v_exp_f32 v181, v181
    v_mfma_f32_16x16x32_bf16 a[20:23], v[208:211], a[244:247], a[20:23]
    ds_read_b64_tr_b16 a[104:105], v106 offset:10240
    ds_read_b64_tr_b16 a[106:107], v107 offset:10240
    v_exp_f32 v182, v182
    v_mfma_f32_16x16x32_bf16 a[24:27], v[208:211], a[248:251], a[24:27]
    buffer_load_dwordx4 v98, s[12:15], s35 offen offset:2048 nt lds
    v_add_f32 v254, v254, v180
    v_add_f32 v254, v254, v181
    v_mfma_f32_16x16x32_bf16 a[24:27], v[192:195], a[216:219], a[24:27]
    buffer_load_dwordx4 v99, s[12:15], s35 offen offset:3072 nt lds
    v_exp_f32 v183, v183
    v_mfma_f32_16x16x32_bf16 a[28:31], v[192:195], a[220:223], a[28:31]
    s_add_u32 m0, s34, 32768
    ds_read_b64_tr_b16 a[108:109], v106 offset:11264
    ds_read_b64_tr_b16 a[110:111], v107 offset:11264
    v_cvt_pk_bf16_f32 v198, v180, v181
    v_add_f32 v254, v254, v182
    v_mfma_f32_16x16x32_bf16 a[28:31], v[208:211], a[252:255], a[28:31]
    buffer_load_dwordx4 v96, s[16:19], s32 offen offset:0 nt lds
    v_add_f32 v254, v254, v183
    v_cvt_pk_bf16_f32 v199, v182, v183
    v_mfma_f32_16x16x32_bf16 v[176:179], a[128:131], v[80:83], v[232:235]
    ds_read_b128 a[176:179], v240 offset:28672
    ds_read_b128 a[180:183], v241 offset:28672
    v_mfma_f32_16x16x32_bf16 v[176:179], a[132:135], v[84:87], v[176:179]
    v_exp_f32 v184, v184
    v_mfma_f32_16x16x32_bf16 v[176:179], a[136:139], v[88:91], v[176:179]
    ds_read_b128 a[184:187], v242 offset:28672
    ds_read_b128 a[188:191], v243 offset:28672
    v_mfma_f32_16x16x32_bf16 v[176:179], a[140:143], v[92:95], v[176:179]
    buffer_load_dwordx4 v97, s[16:19], s32 offen offset:1024 nt lds
    v_exp_f32 v185, v185
    v_mfma_f32_16x16x32_bf16 v[180:183], a[156:159], v[92:95], v[232:235]
    buffer_load_dwordx4 v96, s[16:19], s32 offen offset:2048 nt lds
    v_exp_f32 v186, v186
    v_mfma_f32_16x16x32_bf16 v[180:183], a[152:155], v[88:91], v[180:183]
    v_add_f32 v255, v255, v184
    v_add_f32 v255, v255, v185
    v_mfma_f32_16x16x32_bf16 v[180:183], a[148:151], v[84:87], v[180:183]
    buffer_load_dwordx4 v97, s[16:19], s32 offen offset:3072 nt lds
    v_exp_f32 v187, v187
    v_mfma_f32_16x16x32_bf16 v[180:183], a[144:147], v[80:83], v[180:183]
    s_add_u32 m0, s34, 36864
    v_cvt_pk_bf16_f32 v204, v184, v185
    v_add_f32 v255, v255, v186
    v_mfma_f32_16x16x32_bf16 a[64:67], v[212:215], a[224:227], a[64:67]
    buffer_load_dwordx4 v96, s[16:19], s35 offen offset:0 nt lds
    v_exp_f32 v188, v188
    v_mfma_f32_16x16x32_bf16 a[64:67], v[196:199], a[192:195], a[64:67]
    buffer_load_dwordx4 v97, s[16:19], s35 offen offset:1024 nt lds
    v_add_f32 v255, v255, v187
    v_cvt_pk_bf16_f32 v205, v186, v187
    v_mfma_f32_16x16x32_bf16 a[68:71], v[196:199], a[196:199], a[68:71]
    buffer_load_dwordx4 v96, s[16:19], s35 offen offset:2048 nt lds
    v_exp_f32 v189, v189
    v_mfma_f32_16x16x32_bf16 a[68:71], v[212:215], a[228:231], a[68:71]
    v_exp_f32 v190, v190
    v_mfma_f32_16x16x32_bf16 a[72:75], v[212:215], a[232:235], a[72:75]
    buffer_load_dwordx4 v97, s[16:19], s35 offen offset:3072 nt lds
    v_add_f32 v255, v255, v188
    v_add_f32 v255, v255, v189
    v_mfma_f32_16x16x32_bf16 a[72:75], v[196:199], a[200:203], a[72:75]
    v_exp_f32 v191, v191
    v_mfma_f32_16x16x32_bf16 a[76:79], v[196:199], a[204:207], a[76:79]
    v_cvt_pk_bf16_f32 v206, v188, v189
    v_add_f32 v255, v255, v190
    v_mfma_f32_16x16x32_bf16 a[76:79], v[212:215], a[236:239], a[76:79]
    s_waitcnt lgkmcnt(0)
    v_add_f32 v255, v255, v191
    v_cvt_pk_bf16_f32 v207, v190, v191
    v_mfma_f32_16x16x32_bf16 v[184:187], a[160:163], v[32:35], v[220:223]
    ds_read_b64_tr_b16 a[224:225], v244 offset:24576
    ds_read_b64_tr_b16 a[226:227], v244 offset:28672
    v_mfma_f32_16x16x32_bf16 v[184:187], a[164:167], v[36:39], v[184:187]
    s_add_u32 s33, s33, 1
    v_exp_f32 v176, v176
    v_mfma_f32_16x16x32_bf16 v[184:187], a[168:171], v[40:43], v[184:187]
    s_add_u32 s32, s32, 8192
    ds_read_b64_tr_b16 a[228:229], v245 offset:24576
    ds_read_b64_tr_b16 a[230:231], v245 offset:28672
    v_mfma_f32_16x16x32_bf16 v[184:187], a[172:175], v[44:47], v[184:187]
    s_cmp_eq_u32 s33, 23
    v_exp_f32 v177, v177
    v_mfma_f32_16x16x32_bf16 v[188:191], a[188:191], v[44:47], v[220:223]
    s_cselect_b32 s32, s26, s32
    v_exp_f32 v178, v178
    v_mfma_f32_16x16x32_bf16 v[188:191], a[184:187], v[40:43], v[188:191]
    s_cmp_eq_u32 s33, 46
    ds_read_b64_tr_b16 a[232:233], v246 offset:24576
    v_add_f32 v0, v0, v176
    v_add_f32 v0, v0, v177
    v_mfma_f32_16x16x32_bf16 v[188:191], a[180:183], v[36:39], v[188:191]
    s_cselect_b32 s32, s37, s32
    v_exp_f32 v179, v179
    v_mfma_f32_16x16x32_bf16 v[188:191], a[176:179], v[32:35], v[188:191]
    s_add_u32 s35, s32, 4096
    buffer_store_dwordx4 a[96:99], v102, s[20:23], s53 offen offset:0 sc1
    v_cvt_pk_bf16_f32 v192, v176, v177
    v_add_f32 v0, v0, v178
    v_mfma_f32_16x16x32_bf16 a[80:83], v[212:215], a[240:243], a[80:83]
    s_add_u32 s34, s34, 8192
    v_exp_f32 v180, v180
    v_mfma_f32_16x16x32_bf16 a[80:83], v[196:199], a[208:211], a[80:83]
    s_and_b32 s34, s34, 32767
    ds_read_b64_tr_b16 a[234:235], v246 offset:28672
    v_add_f32 v0, v0, v179
    v_cvt_pk_bf16_f32 v193, v178, v179
    v_mfma_f32_16x16x32_bf16 a[84:87], v[196:199], a[212:215], a[84:87]
    v_exp_f32 v181, v181
    v_mfma_f32_16x16x32_bf16 a[84:87], v[212:215], a[244:247], a[84:87]
    v_exp_f32 v182, v182
    v_mfma_f32_16x16x32_bf16 a[88:91], v[212:215], a[248:251], a[88:91]
    buffer_store_dwordx4 a[100:103], v102, s[20:23], s53 offen offset:1024 sc1
    v_add_f32 v0, v0, v180
    v_add_f32 v0, v0, v181
    v_mfma_f32_16x16x32_bf16 a[88:91], v[196:199], a[216:219], a[88:91]
    v_exp_f32 v183, v183
    v_mfma_f32_16x16x32_bf16 a[92:95], v[196:199], a[220:223], a[92:95]
    v_cvt_pk_bf16_f32 v194, v180, v181
    v_add_f32 v0, v0, v182
    v_mfma_f32_16x16x32_bf16 a[92:95], v[212:215], a[252:255], a[92:95]
    v_add_f32 v0, v0, v183
    v_cvt_pk_bf16_f32 v195, v182, v183
    v_mfma_f32_16x16x32_bf16 v[176:179], a[160:163], v[16:19], v[216:219]
    ds_read_b64_tr_b16 a[236:237], v247 offset:24576
    ds_read_b64_tr_b16 a[238:239], v247 offset:28672
    v_mfma_f32_16x16x32_bf16 v[176:179], a[164:167], v[20:23], v[176:179]
    v_exp_f32 v184, v184
    v_mfma_f32_16x16x32_bf16 v[176:179], a[168:171], v[24:27], v[176:179]
    ds_read_b64_tr_b16 a[240:241], v248 offset:24576
    ds_read_b64_tr_b16 a[242:243], v248 offset:28672
    v_mfma_f32_16x16x32_bf16 v[176:179], a[172:175], v[28:31], v[176:179]
    buffer_store_dwordx4 a[104:107], v102, s[20:23], s53 offen offset:2048 sc1
    v_exp_f32 v185, v185
    v_mfma_f32_16x16x32_bf16 v[180:183], a[188:191], v[28:31], v[216:219]
    v_exp_f32 v186, v186
    v_mfma_f32_16x16x32_bf16 v[180:183], a[184:187], v[24:27], v[180:183]
    ds_read_b64_tr_b16 a[244:245], v249 offset:24576
    v_add_f32 v253, v253, v184
    v_add_f32 v253, v253, v185
    v_mfma_f32_16x16x32_bf16 v[180:183], a[180:183], v[20:23], v[180:183]
    v_exp_f32 v187, v187
    v_mfma_f32_16x16x32_bf16 v[180:183], a[176:179], v[16:19], v[180:183]
    buffer_store_dwordx4 a[108:111], v102, s[20:23], s53 offen offset:3072 sc1
    v_cvt_pk_bf16_f32 v196, v184, v185
    v_add_f32 v253, v253, v186
    v_mfma_f32_16x16x32_bf16 v[144:147], v[192:195], a[192:195], v[144:147]
    s_add_u32 s53, s53, 4096
    v_exp_f32 v188, v188
    v_mfma_f32_16x16x32_bf16 v[148:151], v[192:195], a[196:199], v[148:151]
    s_sub_u32 s52, s52, 1
    ds_read_b64_tr_b16 a[246:247], v249 offset:28672
    v_add_f32 v253, v253, v187
    v_cvt_pk_bf16_f32 v197, v186, v187
    v_mfma_f32_16x16x32_bf16 v[152:155], v[192:195], a[200:203], v[152:155]
    s_cmp_le_i32 s52, 0
    v_exp_f32 v189, v189
    v_mfma_f32_16x16x32_bf16 v[156:159], v[192:195], a[204:207], v[156:159]
    s_cselect_b32 s53, s37, s53
    v_exp_f32 v190, v190
    v_mfma_f32_16x16x32_bf16 v[160:163], v[192:195], a[208:211], v[160:163]
    v_add_f32 v253, v253, v188
    v_add_f32 v253, v253, v189
    v_mfma_f32_16x16x32_bf16 v[164:167], v[192:195], a[212:215], v[164:167]
    v_exp_f32 v191, v191
    v_mfma_f32_16x16x32_bf16 v[168:171], v[192:195], a[216:219], v[168:171]
    v_cvt_pk_bf16_f32 v198, v188, v189
    v_add_f32 v253, v253, v190
    v_mfma_f32_16x16x32_bf16 v[172:175], v[192:195], a[220:223], v[172:175]
    v_add_f32 v253, v253, v191
    v_cvt_pk_bf16_f32 v199, v190, v191
    v_mfma_f32_16x16x32_bf16 v[184:187], a[160:163], v[64:67], v[228:231]
    ds_read_b64_tr_b16 a[248:249], v250 offset:24576
    ds_read_b64_tr_b16 a[250:251], v250 offset:28672
    v_mfma_f32_16x16x32_bf16 v[184:187], a[164:167], v[68:71], v[184:187]
    v_exp_f32 v176, v176
    v_mfma_f32_16x16x32_bf16 v[184:187], a[168:171], v[72:75], v[184:187]
    ds_read_b64_tr_b16 a[252:253], v251 offset:24576
    ds_read_b64_tr_b16 a[254:255], v251 offset:28672
    v_mfma_f32_16x16x32_bf16 v[184:187], a[172:175], v[76:79], v[184:187]
    v_exp_f32 v177, v177
    v_mfma_f32_16x16x32_bf16 v[188:191], a[188:191], v[76:79], v[228:231]
    v_exp_f32 v178, v178
    v_mfma_f32_16x16x32_bf16 v[188:191], a[184:187], v[72:75], v[188:191]
    v_add_f32 v252, v252, v176
    v_add_f32 v252, v252, v177
    v_mfma_f32_16x16x32_bf16 v[188:191], a[180:183], v[68:71], v[188:191]
    v_exp_f32 v179, v179
    v_mfma_f32_16x16x32_bf16 v[188:191], a[176:179], v[64:67], v[188:191]
    s_waitcnt lgkmcnt(4)
    v_cvt_pk_bf16_f32 v208, v176, v177
    v_add_f32 v252, v252, v178
    v_mfma_f32_16x16x32_bf16 a[32:35], v[200:203], a[192:195], a[32:35]
    v_exp_f32 v180, v180
    v_mfma_f32_16x16x32_bf16 a[32:35], v[196:199], a[224:227], a[32:35]
    v_add_f32 v252, v252, v179
    v_cvt_pk_bf16_f32 v209, v178, v179
    v_mfma_f32_16x16x32_bf16 a[36:39], v[196:199], a[228:231], a[36:39]
    v_exp_f32 v181, v181
    v_mfma_f32_16x16x32_bf16 a[36:39], v[200:203], a[196:199], a[36:39]
    v_exp_f32 v182, v182
    v_mfma_f32_16x16x32_bf16 a[40:43], v[200:203], a[200:203], a[40:43]
    v_add_f32 v252, v252, v180
    v_add_f32 v252, v252, v181
    v_mfma_f32_16x16x32_bf16 a[40:43], v[196:199], a[232:235], a[40:43]
    v_exp_f32 v183, v183
    v_mfma_f32_16x16x32_bf16 a[44:47], v[196:199], a[236:239], a[44:47]
    v_cvt_pk_bf16_f32 v210, v180, v181
    v_add_f32 v252, v252, v182
    v_mfma_f32_16x16x32_bf16 a[44:47], v[200:203], a[204:207], a[44:47]
    s_waitcnt vmcnt(44) lgkmcnt(0)
    v_add_f32 v252, v252, v183
    v_cvt_pk_bf16_f32 v211, v182, v183
    v_mfma_f32_16x16x32_bf16 v[176:179], a[160:163], v[48:51], v[224:227]
    s_barrier
    ds_read_b128 a[128:131], v240 offset:0
    ds_read_b128 a[132:135], v241 offset:0
    v_mfma_f32_16x16x32_bf16 v[176:179], a[164:167], v[52:55], v[176:179]
    v_exp_f32 v184, v184
    v_mfma_f32_16x16x32_bf16 v[176:179], a[168:171], v[56:59], v[176:179]
    s_add_u32 m0, s34, 0
    ds_read_b128 a[136:139], v242 offset:0
    ds_read_b128 a[140:143], v243 offset:0
    v_mfma_f32_16x16x32_bf16 v[176:179], a[172:175], v[60:63], v[176:179]
    buffer_load_dwordx4 v96, s[12:15], s32 offen offset:0 nt lds
    v_exp_f32 v185, v185
    v_mfma_f32_16x16x32_bf16 v[180:183], a[188:191], v[60:63], v[224:227]
    buffer_load_dwordx4 v97, s[12:15], s32 offen offset:1024 nt lds
    v_exp_f32 v186, v186
    v_mfma_f32_16x16x32_bf16 v[180:183], a[184:187], v[56:59], v[180:183]
    ds_read_b64_tr_b16 a[96:97], v106 offset:12288
    ds_read_b64_tr_b16 a[98:99], v107 offset:12288
    v_add_f32 v255, v255, v184
    v_add_f32 v255, v255, v185
    v_mfma_f32_16x16x32_bf16 v[180:183], a[180:183], v[52:55], v[180:183]
    buffer_load_dwordx4 v98, s[12:15], s32 offen offset:2048 nt lds
    v_exp_f32 v187, v187
    v_mfma_f32_16x16x32_bf16 v[180:183], a[176:179], v[48:51], v[180:183]
    buffer_load_dwordx4 v99, s[12:15], s32 offen offset:3072 nt lds
    v_cvt_pk_bf16_f32 v192, v184, v185
    v_add_f32 v255, v255, v186
    v_mfma_f32_16x16x32_bf16 a[48:51], v[200:203], a[208:211], a[48:51]
    s_add_u32 m0, s34, 4096
    ds_read_b64_tr_b16 a[100:101], v106 offset:13312
    ds_read_b64_tr_b16 a[102:103], v107 offset:13312
    v_exp_f32 v188, v188
    v_mfma_f32_16x16x32_bf16 a[48:51], v[196:199], a[240:243], a[48:51]
    buffer_load_dwordx4 v96, s[12:15], s35 offen offset:0 nt lds
    v_add_f32 v255, v255, v187
    v_cvt_pk_bf16_f32 v193, v186, v187
    v_mfma_f32_16x16x32_bf16 a[52:55], v[196:199], a[244:247], a[52:55]
    buffer_load_dwordx4 v97, s[12:15], s35 offen offset:1024 nt lds
    v_exp_f32 v189, v189
    v_mfma_f32_16x16x32_bf16 a[52:55], v[200:203], a[212:215], a[52:55]
    ds_read_b64_tr_b16 a[104:105], v106 offset:14336
    ds_read_b64_tr_b16 a[106:107], v107 offset:14336
    v_exp_f32 v190, v190
    v_mfma_f32_16x16x32_bf16 a[56:59], v[200:203], a[216:219], a[56:59]
    buffer_load_dwordx4 v98, s[12:15], s35 offen offset:2048 nt lds
    v_add_f32 v255, v255, v188
    v_add_f32 v255, v255, v189
    v_mfma_f32_16x16x32_bf16 a[56:59], v[196:199], a[248:251], a[56:59]
    buffer_load_dwordx4 v99, s[12:15], s35 offen offset:3072 nt lds
    v_exp_f32 v191, v191
    v_mfma_f32_16x16x32_bf16 a[60:63], v[196:199], a[252:255], a[60:63]
    s_add_u32 m0, s34, 32768
    ds_read_b64_tr_b16 a[108:109], v106 offset:15360
    ds_read_b64_tr_b16 a[110:111], v107 offset:15360
    v_cvt_pk_bf16_f32 v194, v188, v189
    v_add_f32 v255, v255, v190
    v_mfma_f32_16x16x32_bf16 a[60:63], v[200:203], a[220:223], a[60:63]
    buffer_load_dwordx4 v96, s[16:19], s32 offen offset:0 nt lds
    v_add_f32 v255, v255, v191
    v_cvt_pk_bf16_f32 v195, v190, v191
    v_mfma_f32_16x16x32_bf16 v[184:187], a[160:163], v[80:83], v[232:235]
    ds_read_b128 a[144:147], v240 offset:4096
    ds_read_b128 a[148:151], v241 offset:4096
    v_mfma_f32_16x16x32_bf16 v[184:187], a[164:167], v[84:87], v[184:187]
    v_exp_f32 v176, v176
    v_mfma_f32_16x16x32_bf16 v[184:187], a[168:171], v[88:91], v[184:187]
    ds_read_b128 a[152:155], v242 offset:4096
    ds_read_b128 a[156:159], v243 offset:4096
    v_mfma_f32_16x16x32_bf16 v[184:187], a[172:175], v[92:95], v[184:187]
    buffer_load_dwordx4 v97, s[16:19], s32 offen offset:1024 nt lds
    v_exp_f32 v177, v177
    v_mfma_f32_16x16x32_bf16 v[188:191], a[188:191], v[92:95], v[232:235]
    buffer_load_dwordx4 v96, s[16:19], s32 offen offset:2048 nt lds
    v_exp_f32 v178, v178
    v_mfma_f32_16x16x32_bf16 v[188:191], a[184:187], v[88:91], v[188:191]
    v_add_f32 v254, v254, v176
    v_add_f32 v254, v254, v177
    v_mfma_f32_16x16x32_bf16 v[188:191], a[180:183], v[84:87], v[188:191]
    buffer_load_dwordx4 v97, s[16:19], s32 offen offset:3072 nt lds
    v_exp_f32 v179, v179
    v_mfma_f32_16x16x32_bf16 v[188:191], a[176:179], v[80:83], v[188:191]
    s_add_u32 m0, s34, 36864
    v_cvt_pk_bf16_f32 v212, v176, v177
    v_add_f32 v254, v254, v178
    v_mfma_f32_16x16x32_bf16 v[112:115], v[204:207], a[192:195], v[112:115]
    buffer_load_dwordx4 v96, s[16:19], s35 offen offset:0 nt lds
    v_exp_f32 v180, v180
    v_mfma_f32_16x16x32_bf16 v[112:115], v[192:195], a[224:227], v[112:115]
    buffer_load_dwordx4 v97, s[16:19], s35 offen offset:1024 nt lds
    v_add_f32 v254, v254, v179
    v_cvt_pk_bf16_f32 v213, v178, v179
    v_mfma_f32_16x16x32_bf16 v[116:119], v[192:195], a[228:231], v[116:119]
    buffer_load_dwordx4 v96, s[16:19], s35 offen offset:2048 nt lds
    v_exp_f32 v181, v181
    v_mfma_f32_16x16x32_bf16 v[116:119], v[204:207], a[196:199], v[116:119]
    v_exp_f32 v182, v182
    v_mfma_f32_16x16x32_bf16 v[120:123], v[204:207], a[200:203], v[120:123]
    buffer_load_dwordx4 v97, s[16:19], s35 offen offset:3072 nt lds
    v_add_f32 v254, v254, v180
    v_add_f32 v254, v254, v181
    v_mfma_f32_16x16x32_bf16 v[120:123], v[192:195], a[232:235], v[120:123]
    v_exp_f32 v183, v183
    v_mfma_f32_16x16x32_bf16 v[124:127], v[192:195], a[236:239], v[124:127]
    s_cmp_eq_u32 s28, 10
    v_cvt_pk_bf16_f32 v214, v180, v181
    v_add_f32 v254, v254, v182
    v_mfma_f32_16x16x32_bf16 v[124:127], v[204:207], a[204:207], v[124:127]
    s_waitcnt lgkmcnt(0)
    v_add_f32 v254, v254, v183
    v_cvt_pk_bf16_f32 v215, v182, v183
    s_cbranch_scc1 L_final_w3
    v_mfma_f32_16x16x32_bf16 v[176:179], a[128:131], v[16:19], v[216:219]
    ds_read_b64_tr_b16 a[192:193], v244 offset:0
    ds_read_b64_tr_b16 a[194:195], v244 offset:4096
    v_mfma_f32_16x16x32_bf16 v[176:179], a[132:135], v[20:23], v[176:179]
    s_add_u32 s33, s33, 1
    v_exp_f32 v184, v184
    v_mfma_f32_16x16x32_bf16 v[176:179], a[136:139], v[24:27], v[176:179]
    s_add_u32 s32, s32, 8192
    ds_read_b64_tr_b16 a[196:197], v245 offset:0
    ds_read_b64_tr_b16 a[198:199], v245 offset:4096
    v_mfma_f32_16x16x32_bf16 v[176:179], a[140:143], v[28:31], v[176:179]
    s_cmp_eq_u32 s33, 23
    v_exp_f32 v185, v185
    v_mfma_f32_16x16x32_bf16 v[180:183], a[156:159], v[28:31], v[216:219]
    s_cselect_b32 s32, s26, s32
    v_exp_f32 v186, v186
    v_add_u32 v106, 16384, v106
    v_mfma_f32_16x16x32_bf16 v[180:183], a[152:155], v[24:27], v[180:183]
    s_cmp_eq_u32 s33, 46
    ds_read_b64_tr_b16 a[200:201], v246 offset:0
    v_add_f32 v0, v0, v184
    v_add_f32 v0, v0, v185
    v_mfma_f32_16x16x32_bf16 v[180:183], a[148:151], v[20:23], v[180:183]
    s_cselect_b32 s32, s37, s32
    v_exp_f32 v187, v187
    v_mfma_f32_16x16x32_bf16 v[180:183], a[144:147], v[16:19], v[180:183]
    s_add_u32 s35, s32, 4096
    buffer_store_dwordx4 a[96:99], v102, s[20:23], s53 offen offset:0 sc1
    v_cvt_pk_bf16_f32 v196, v184, v185
    v_add_f32 v0, v0, v186
    v_mfma_f32_16x16x32_bf16 v[128:131], v[204:207], a[208:211], v[128:131]
    s_add_u32 s34, s34, 8192
    v_exp_f32 v188, v188
    v_mfma_f32_16x16x32_bf16 v[128:131], v[192:195], a[240:243], v[128:131]
    s_and_b32 s34, s34, 32767
    ds_read_b64_tr_b16 a[202:203], v246 offset:4096
    v_add_f32 v0, v0, v187
    v_cvt_pk_bf16_f32 v197, v186, v187
    v_mfma_f32_16x16x32_bf16 v[132:135], v[192:195], a[244:247], v[132:135]
    v_exp_f32 v189, v189
    v_add_u32 v107, 16384, v107
    v_mfma_f32_16x16x32_bf16 v[132:135], v[204:207], a[212:215], v[132:135]
    v_exp_f32 v190, v190
    v_mfma_f32_16x16x32_bf16 v[136:139], v[204:207], a[216:219], v[136:139]
    buffer_store_dwordx4 a[100:103], v102, s[20:23], s53 offen offset:1024 sc1
    v_add_f32 v0, v0, v188
    v_add_f32 v0, v0, v189
    v_mfma_f32_16x16x32_bf16 v[136:139], v[192:195], a[248:251], v[136:139]
    v_exp_f32 v191, v191
    v_mfma_f32_16x16x32_bf16 v[140:143], v[192:195], a[252:255], v[140:143]
    v_cvt_pk_bf16_f32 v198, v188, v189
    v_add_f32 v0, v0, v190
    v_mfma_f32_16x16x32_bf16 v[140:143], v[204:207], a[220:223], v[140:143]
    v_add_f32 v0, v0, v191
    v_cvt_pk_bf16_f32 v199, v190, v191
    v_mfma_f32_16x16x32_bf16 v[184:187], a[128:131], v[32:35], v[220:223]
    ds_read_b64_tr_b16 a[204:205], v247 offset:0
    ds_read_b64_tr_b16 a[206:207], v247 offset:4096
    v_mfma_f32_16x16x32_bf16 v[184:187], a[132:135], v[36:39], v[184:187]
    v_exp_f32 v176, v176
    v_mfma_f32_16x16x32_bf16 v[184:187], a[136:139], v[40:43], v[184:187]
    ds_read_b64_tr_b16 a[208:209], v248 offset:0
    ds_read_b64_tr_b16 a[210:211], v248 offset:4096
    v_mfma_f32_16x16x32_bf16 v[184:187], a[140:143], v[44:47], v[184:187]
    buffer_store_dwordx4 a[104:107], v102, s[20:23], s53 offen offset:2048 sc1
    v_exp_f32 v177, v177
    v_mfma_f32_16x16x32_bf16 v[188:191], a[156:159], v[44:47], v[220:223]
    v_exp_f32 v178, v178
    v_mfma_f32_16x16x32_bf16 v[188:191], a[152:155], v[40:43], v[188:191]
    ds_read_b64_tr_b16 a[212:213], v249 offset:0
    v_add_f32 v252, v252, v176
    v_add_f32 v252, v252, v177
    v_mfma_f32_16x16x32_bf16 v[188:191], a[148:151], v[36:39], v[188:191]
    v_exp_f32 v179, v179
    v_mfma_f32_16x16x32_bf16 v[188:191], a[144:147], v[32:35], v[188:191]
    buffer_store_dwordx4 a[108:111], v102, s[20:23], s53 offen offset:3072 sc1
    v_cvt_pk_bf16_f32 v192, v176, v177
    v_add_f32 v252, v252, v178
    v_mfma_f32_16x16x32_bf16 v[144:147], v[196:199], a[224:227], v[144:147]
    s_add_u32 s53, s53, 4096
    v_exp_f32 v180, v180
    v_mfma_f32_16x16x32_bf16 v[148:151], v[196:199], a[228:231], v[148:151]
    s_sub_u32 s52, s52, 1
    ds_read_b64_tr_b16 a[214:215], v249 offset:4096
    v_add_f32 v252, v252, v179
    v_cvt_pk_bf16_f32 v193, v178, v179
    v_mfma_f32_16x16x32_bf16 v[152:155], v[196:199], a[232:235], v[152:155]
    s_cmp_le_i32 s52, 0
    v_exp_f32 v181, v181
    v_mfma_f32_16x16x32_bf16 v[156:159], v[196:199], a[236:239], v[156:159]
    s_cselect_b32 s53, s37, s53
    v_exp_f32 v182, v182
    v_mfma_f32_16x16x32_bf16 v[160:163], v[196:199], a[240:243], v[160:163]
    v_add_f32 v252, v252, v180
    v_add_f32 v252, v252, v181
    v_mfma_f32_16x16x32_bf16 v[164:167], v[196:199], a[244:247], v[164:167]
    v_exp_f32 v183, v183
    v_mfma_f32_16x16x32_bf16 v[168:171], v[196:199], a[248:251], v[168:171]
    v_cvt_pk_bf16_f32 v194, v180, v181
    v_add_f32 v252, v252, v182
    v_mfma_f32_16x16x32_bf16 v[172:175], v[196:199], a[252:255], v[172:175]
    v_add_f32 v252, v252, v183
    v_cvt_pk_bf16_f32 v195, v182, v183
    v_mfma_f32_16x16x32_bf16 v[176:179], a[128:131], v[48:51], v[224:227]
    ds_read_b64_tr_b16 a[216:217], v250 offset:0
    ds_read_b64_tr_b16 a[218:219], v250 offset:4096
    v_mfma_f32_16x16x32_bf16 v[176:179], a[132:135], v[52:55], v[176:179]
    v_exp_f32 v184, v184
    v_mfma_f32_16x16x32_bf16 v[176:179], a[136:139], v[56:59], v[176:179]
    ds_read_b64_tr_b16 a[220:221], v251 offset:0
    ds_read_b64_tr_b16 a[222:223], v251 offset:4096
    v_mfma_f32_16x16x32_bf16 v[176:179], a[140:143], v[60:63], v[176:179]
    v_exp_f32 v185, v185
    v_mfma_f32_16x16x32_bf16 v[180:183], a[156:159], v[60:63], v[224:227]
    v_exp_f32 v186, v186
    v_mfma_f32_16x16x32_bf16 v[180:183], a[152:155], v[56:59], v[180:183]
    v_add_f32 v253, v253, v184
    v_add_f32 v253, v253, v185
    v_mfma_f32_16x16x32_bf16 v[180:183], a[148:151], v[52:55], v[180:183]
    v_exp_f32 v187, v187
    v_mfma_f32_16x16x32_bf16 v[180:183], a[144:147], v[48:51], v[180:183]
    s_waitcnt lgkmcnt(4)
    v_cvt_pk_bf16_f32 v200, v184, v185
    v_add_f32 v253, v253, v186
    v_mfma_f32_16x16x32_bf16 a[0:3], v[208:211], a[224:227], a[0:3]
    v_exp_f32 v188, v188
    v_mfma_f32_16x16x32_bf16 a[0:3], v[192:195], a[192:195], a[0:3]
    v_add_f32 v253, v253, v187
    v_cvt_pk_bf16_f32 v201, v186, v187
    v_mfma_f32_16x16x32_bf16 a[4:7], v[192:195], a[196:199], a[4:7]
    v_exp_f32 v189, v189
    v_mfma_f32_16x16x32_bf16 a[4:7], v[208:211], a[228:231], a[4:7]
    v_exp_f32 v190, v190
    v_mfma_f32_16x16x32_bf16 a[8:11], v[208:211], a[232:235], a[8:11]
    v_add_f32 v253, v253, v188
    v_add_f32 v253, v253, v189
    v_mfma_f32_16x16x32_bf16 a[8:11], v[192:195], a[200:203], a[8:11]
    v_exp_f32 v191, v191
    v_mfma_f32_16x16x32_bf16 a[12:15], v[192:195], a[204:207], a[12:15]
    v_cvt_pk_bf16_f32 v202, v188, v189
    v_add_f32 v253, v253, v190
    v_mfma_f32_16x16x32_bf16 a[12:15], v[208:211], a[236:239], a[12:15]
    s_waitcnt vmcnt(44) lgkmcnt(0)
    v_add_f32 v253, v253, v191
    v_cvt_pk_bf16_f32 v203, v190, v191
    v_mfma_f32_16x16x32_bf16 v[184:187], a[128:131], v[64:67], v[228:231]
    s_barrier
    ds_read_b128 a[160:163], v240 offset:8192
    ds_read_b128 a[164:167], v241 offset:8192
    v_mfma_f32_16x16x32_bf16 v[184:187], a[132:135], v[68:71], v[184:187]
    v_exp_f32 v176, v176
    v_mfma_f32_16x16x32_bf16 v[184:187], a[136:139], v[72:75], v[184:187]
    s_add_u32 m0, s34, 0
    ds_read_b128 a[168:171], v242 offset:8192
    ds_read_b128 a[172:175], v243 offset:8192
    v_mfma_f32_16x16x32_bf16 v[184:187], a[140:143], v[76:79], v[184:187]
    buffer_load_dwordx4 v96, s[12:15], s32 offen offset:0 nt lds
    v_exp_f32 v177, v177
    v_mfma_f32_16x16x32_bf16 v[188:191], a[156:159], v[76:79], v[228:231]
    buffer_load_dwordx4 v97, s[12:15], s32 offen offset:1024 nt lds
    v_exp_f32 v178, v178
    v_mfma_f32_16x16x32_bf16 v[188:191], a[152:155], v[72:75], v[188:191]
    ds_read_b64_tr_b16 a[96:97], v106 offset:0
    ds_read_b64_tr_b16 a[98:99], v107 offset:0
    v_add_f32 v254, v254, v176
    v_add_f32 v254, v254, v177
    v_mfma_f32_16x16x32_bf16 v[188:191], a[148:151], v[68:71], v[188:191]
    buffer_load_dwordx4 v98, s[12:15], s32 offen offset:2048 nt lds
    v_exp_f32 v179, v179
    v_mfma_f32_16x16x32_bf16 v[188:191], a[144:147], v[64:67], v[188:191]
    buffer_load_dwordx4 v99, s[12:15], s32 offen offset:3072 nt lds
    v_cvt_pk_bf16_f32 v196, v176, v177
    v_add_f32 v254, v254, v178
    v_mfma_f32_16x16x32_bf16 a[16:19], v[208:211], a[240:243], a[16:19]
    s_add_u32 m0, s34, 4096
    ds_read_b64_tr_b16 a[100:101], v106 offset:1024
    ds_read_b64_tr_b16 a[102:103], v107 offset:1024
    v_exp_f32 v180, v180
    v_mfma_f32_16x16x32_bf16 a[16:19], v[192:195], a[208:211], a[16:19]
    buffer_load_dwordx4 v96, s[12:15], s35 offen offset:0 nt lds
    v_add_f32 v254, v254, v179
    v_cvt_pk_bf16_f32 v197, v178, v179
    v_mfma_f32_16x16x32_bf16 a[20:23], v[192:195], a[212:215], a[20:23]
    buffer_load_dwordx4 v97, s[12:15], s35 offen offset:1024 nt lds
    v_exp_f32 v181, v181
    v_mfma_f32_16x16x32_bf16 a[20:23], v[208:211], a[244:247], a[20:23]
    ds_read_b64_tr_b16 a[104:105], v106 offset:2048
    ds_read_b64_tr_b16 a[106:107], v107 offset:2048
    v_exp_f32 v182, v182
    v_mfma_f32_16x16x32_bf16 a[24:27], v[208:211], a[248:251], a[24:27]
    buffer_load_dwordx4 v98, s[12:15], s35 offen offset:2048 nt lds
    v_add_f32 v254, v254, v180
    v_add_f32 v254, v254, v181
    v_mfma_f32_16x16x32_bf16 a[24:27], v[192:195], a[216:219], a[24:27]
    buffer_load_dwordx4 v99, s[12:15], s35 offen offset:3072 nt lds
    v_exp_f32 v183, v183
    v_mfma_f32_16x16x32_bf16 a[28:31], v[192:195], a[220:223], a[28:31]
    s_add_u32 m0, s34, 32768
    ds_read_b64_tr_b16 a[108:109], v106 offset:3072
    ds_read_b64_tr_b16 a[110:111], v107 offset:3072
    v_cvt_pk_bf16_f32 v198, v180, v181
    v_add_f32 v254, v254, v182
    v_mfma_f32_16x16x32_bf16 a[28:31], v[208:211], a[252:255], a[28:31]
    buffer_load_dwordx4 v96, s[16:19], s32 offen offset:0 nt lds
    v_add_f32 v254, v254, v183
    v_cvt_pk_bf16_f32 v199, v182, v183
    v_mfma_f32_16x16x32_bf16 v[176:179], a[128:131], v[80:83], v[232:235]
    ds_read_b128 a[176:179], v240 offset:12288
    ds_read_b128 a[180:183], v241 offset:12288
    v_mfma_f32_16x16x32_bf16 v[176:179], a[132:135], v[84:87], v[176:179]
    v_exp_f32 v184, v184
    v_mfma_f32_16x16x32_bf16 v[176:179], a[136:139], v[88:91], v[176:179]
    ds_read_b128 a[184:187], v242 offset:12288
    ds_read_b128 a[188:191], v243 offset:12288
    v_mfma_f32_16x16x32_bf16 v[176:179], a[140:143], v[92:95], v[176:179]
    buffer_load_dwordx4 v97, s[16:19], s32 offen offset:1024 nt lds
    v_exp_f32 v185, v185
    v_mfma_f32_16x16x32_bf16 v[180:183], a[156:159], v[92:95], v[232:235]
    buffer_load_dwordx4 v96, s[16:19], s32 offen offset:2048 nt lds
    v_exp_f32 v186, v186
    v_mfma_f32_16x16x32_bf16 v[180:183], a[152:155], v[88:91], v[180:183]
    v_add_f32 v255, v255, v184
    v_add_f32 v255, v255, v185
    v_mfma_f32_16x16x32_bf16 v[180:183], a[148:151], v[84:87], v[180:183]
    buffer_load_dwordx4 v97, s[16:19], s32 offen offset:3072 nt lds
    v_exp_f32 v187, v187
    v_mfma_f32_16x16x32_bf16 v[180:183], a[144:147], v[80:83], v[180:183]
    s_add_u32 m0, s34, 36864
    v_cvt_pk_bf16_f32 v204, v184, v185
    v_add_f32 v255, v255, v186
    v_mfma_f32_16x16x32_bf16 a[64:67], v[212:215], a[224:227], a[64:67]
    buffer_load_dwordx4 v96, s[16:19], s35 offen offset:0 nt lds
    v_exp_f32 v188, v188
    v_mfma_f32_16x16x32_bf16 a[64:67], v[196:199], a[192:195], a[64:67]
    buffer_load_dwordx4 v97, s[16:19], s35 offen offset:1024 nt lds
    v_add_f32 v255, v255, v187
    v_cvt_pk_bf16_f32 v205, v186, v187
    v_mfma_f32_16x16x32_bf16 a[68:71], v[196:199], a[196:199], a[68:71]
    buffer_load_dwordx4 v96, s[16:19], s35 offen offset:2048 nt lds
    v_exp_f32 v189, v189
    v_mfma_f32_16x16x32_bf16 a[68:71], v[212:215], a[228:231], a[68:71]
    v_exp_f32 v190, v190
    v_mfma_f32_16x16x32_bf16 a[72:75], v[212:215], a[232:235], a[72:75]
    buffer_load_dwordx4 v97, s[16:19], s35 offen offset:3072 nt lds
    v_add_f32 v255, v255, v188
    v_add_f32 v255, v255, v189
    v_mfma_f32_16x16x32_bf16 a[72:75], v[196:199], a[200:203], a[72:75]
    v_exp_f32 v191, v191
    v_mfma_f32_16x16x32_bf16 a[76:79], v[196:199], a[204:207], a[76:79]
    v_cvt_pk_bf16_f32 v206, v188, v189
    v_add_f32 v255, v255, v190
    v_mfma_f32_16x16x32_bf16 a[76:79], v[212:215], a[236:239], a[76:79]
    s_waitcnt lgkmcnt(0)
    v_add_f32 v255, v255, v191
    v_cvt_pk_bf16_f32 v207, v190, v191
    v_mfma_f32_16x16x32_bf16 v[184:187], a[160:163], v[32:35], v[220:223]
    ds_read_b64_tr_b16 a[224:225], v244 offset:8192
    ds_read_b64_tr_b16 a[226:227], v244 offset:12288
    v_mfma_f32_16x16x32_bf16 v[184:187], a[164:167], v[36:39], v[184:187]
    s_add_u32 s33, s33, 1
    v_exp_f32 v176, v176
    v_mfma_f32_16x16x32_bf16 v[184:187], a[168:171], v[40:43], v[184:187]
    s_add_u32 s32, s32, 8192
    ds_read_b64_tr_b16 a[228:229], v245 offset:8192
    ds_read_b64_tr_b16 a[230:231], v245 offset:12288
    v_mfma_f32_16x16x32_bf16 v[184:187], a[172:175], v[44:47], v[184:187]
    s_cmp_eq_u32 s33, 23
    v_exp_f32 v177, v177
    v_mfma_f32_16x16x32_bf16 v[188:191], a[188:191], v[44:47], v[220:223]
    s_cselect_b32 s32, s26, s32
    v_exp_f32 v178, v178
    v_mfma_f32_16x16x32_bf16 v[188:191], a[184:187], v[40:43], v[188:191]
    s_cmp_eq_u32 s33, 46
    ds_read_b64_tr_b16 a[232:233], v246 offset:8192
    v_add_f32 v0, v0, v176
    v_add_f32 v0, v0, v177
    v_mfma_f32_16x16x32_bf16 v[188:191], a[180:183], v[36:39], v[188:191]
    s_cselect_b32 s32, s37, s32
    v_exp_f32 v179, v179
    v_mfma_f32_16x16x32_bf16 v[188:191], a[176:179], v[32:35], v[188:191]
    s_add_u32 s35, s32, 4096
    buffer_store_dwordx4 a[96:99], v102, s[20:23], s53 offen offset:0 sc1
    v_cvt_pk_bf16_f32 v192, v176, v177
    v_add_f32 v0, v0, v178
    v_mfma_f32_16x16x32_bf16 a[80:83], v[212:215], a[240:243], a[80:83]
    s_add_u32 s34, s34, 8192
    v_exp_f32 v180, v180
    v_mfma_f32_16x16x32_bf16 a[80:83], v[196:199], a[208:211], a[80:83]
    s_and_b32 s34, s34, 32767
    ds_read_b64_tr_b16 a[234:235], v246 offset:12288
    v_add_f32 v0, v0, v179
    v_cvt_pk_bf16_f32 v193, v178, v179
    v_mfma_f32_16x16x32_bf16 a[84:87], v[196:199], a[212:215], a[84:87]
    v_exp_f32 v181, v181
    v_mfma_f32_16x16x32_bf16 a[84:87], v[212:215], a[244:247], a[84:87]
    v_exp_f32 v182, v182
    v_mfma_f32_16x16x32_bf16 a[88:91], v[212:215], a[248:251], a[88:91]
    buffer_store_dwordx4 a[100:103], v102, s[20:23], s53 offen offset:1024 sc1
    v_add_f32 v0, v0, v180
    v_add_f32 v0, v0, v181
    v_mfma_f32_16x16x32_bf16 a[88:91], v[196:199], a[216:219], a[88:91]
    v_exp_f32 v183, v183
    v_mfma_f32_16x16x32_bf16 a[92:95], v[196:199], a[220:223], a[92:95]
    v_cvt_pk_bf16_f32 v194, v180, v181
    v_add_f32 v0, v0, v182
    v_mfma_f32_16x16x32_bf16 a[92:95], v[212:215], a[252:255], a[92:95]
    v_add_f32 v0, v0, v183
    v_cvt_pk_bf16_f32 v195, v182, v183
    v_mfma_f32_16x16x32_bf16 v[176:179], a[160:163], v[16:19], v[216:219]
    ds_read_b64_tr_b16 a[236:237], v247 offset:8192
    ds_read_b64_tr_b16 a[238:239], v247 offset:12288
    v_mfma_f32_16x16x32_bf16 v[176:179], a[164:167], v[20:23], v[176:179]
    v_exp_f32 v184, v184
    v_mfma_f32_16x16x32_bf16 v[176:179], a[168:171], v[24:27], v[176:179]
    ds_read_b64_tr_b16 a[240:241], v248 offset:8192
    ds_read_b64_tr_b16 a[242:243], v248 offset:12288
    v_mfma_f32_16x16x32_bf16 v[176:179], a[172:175], v[28:31], v[176:179]
    buffer_store_dwordx4 a[104:107], v102, s[20:23], s53 offen offset:2048 sc1
    v_exp_f32 v185, v185
    v_mfma_f32_16x16x32_bf16 v[180:183], a[188:191], v[28:31], v[216:219]
    v_exp_f32 v186, v186
    v_mfma_f32_16x16x32_bf16 v[180:183], a[184:187], v[24:27], v[180:183]
    ds_read_b64_tr_b16 a[244:245], v249 offset:8192
    v_add_f32 v253, v253, v184
    v_add_f32 v253, v253, v185
    v_mfma_f32_16x16x32_bf16 v[180:183], a[180:183], v[20:23], v[180:183]
    v_exp_f32 v187, v187
    v_mfma_f32_16x16x32_bf16 v[180:183], a[176:179], v[16:19], v[180:183]
    buffer_store_dwordx4 a[108:111], v102, s[20:23], s53 offen offset:3072 sc1
    v_cvt_pk_bf16_f32 v196, v184, v185
    v_add_f32 v253, v253, v186
    v_mfma_f32_16x16x32_bf16 v[144:147], v[192:195], a[192:195], v[144:147]
    s_add_u32 s53, s53, 4096
    v_exp_f32 v188, v188
    v_mfma_f32_16x16x32_bf16 v[148:151], v[192:195], a[196:199], v[148:151]
    s_sub_u32 s52, s52, 1
    ds_read_b64_tr_b16 a[246:247], v249 offset:12288
    v_add_f32 v253, v253, v187
    v_cvt_pk_bf16_f32 v197, v186, v187
    v_mfma_f32_16x16x32_bf16 v[152:155], v[192:195], a[200:203], v[152:155]
    s_cmp_le_i32 s52, 0
    v_exp_f32 v189, v189
    v_mfma_f32_16x16x32_bf16 v[156:159], v[192:195], a[204:207], v[156:159]
    s_cselect_b32 s53, s37, s53
    v_exp_f32 v190, v190
    v_mfma_f32_16x16x32_bf16 v[160:163], v[192:195], a[208:211], v[160:163]
    v_add_f32 v253, v253, v188
    v_add_f32 v253, v253, v189
    v_mfma_f32_16x16x32_bf16 v[164:167], v[192:195], a[212:215], v[164:167]
    v_exp_f32 v191, v191
    v_mfma_f32_16x16x32_bf16 v[168:171], v[192:195], a[216:219], v[168:171]
    v_cvt_pk_bf16_f32 v198, v188, v189
    v_add_f32 v253, v253, v190
    v_mfma_f32_16x16x32_bf16 v[172:175], v[192:195], a[220:223], v[172:175]
    v_add_f32 v253, v253, v191
    v_cvt_pk_bf16_f32 v199, v190, v191
L_loopb1_w3:
    v_mfma_f32_16x16x32_bf16 v[184:187], a[160:163], v[64:67], v[228:231]
    ds_read_b64_tr_b16 a[248:249], v250 offset:8192
    ds_read_b64_tr_b16 a[250:251], v250 offset:12288
    v_mfma_f32_16x16x32_bf16 v[184:187], a[164:167], v[68:71], v[184:187]
    v_exp_f32 v176, v176
    v_mfma_f32_16x16x32_bf16 v[184:187], a[168:171], v[72:75], v[184:187]
    ds_read_b64_tr_b16 a[252:253], v251 offset:8192
    ds_read_b64_tr_b16 a[254:255], v251 offset:12288
    v_mfma_f32_16x16x32_bf16 v[184:187], a[172:175], v[76:79], v[184:187]
    v_exp_f32 v177, v177
    v_mfma_f32_16x16x32_bf16 v[188:191], a[188:191], v[76:79], v[228:231]
    v_exp_f32 v178, v178
    v_mfma_f32_16x16x32_bf16 v[188:191], a[184:187], v[72:75], v[188:191]
    v_add_f32 v252, v252, v176
    v_add_f32 v252, v252, v177
    v_mfma_f32_16x16x32_bf16 v[188:191], a[180:183], v[68:71], v[188:191]
    v_exp_f32 v179, v179
    v_mfma_f32_16x16x32_bf16 v[188:191], a[176:179], v[64:67], v[188:191]
    s_waitcnt lgkmcnt(4)
    v_cvt_pk_bf16_f32 v208, v176, v177
    v_add_f32 v252, v252, v178
    v_mfma_f32_16x16x32_bf16 a[32:35], v[200:203], a[192:195], a[32:35]
    v_exp_f32 v180, v180
    v_mfma_f32_16x16x32_bf16 a[32:35], v[196:199], a[224:227], a[32:35]
    v_add_f32 v252, v252, v179
    v_cvt_pk_bf16_f32 v209, v178, v179
    v_mfma_f32_16x16x32_bf16 a[36:39], v[196:199], a[228:231], a[36:39]
    v_exp_f32 v181, v181
    v_mfma_f32_16x16x32_bf16 a[36:39], v[200:203], a[196:199], a[36:39]
    v_exp_f32 v182, v182
    v_mfma_f32_16x16x32_bf16 a[40:43], v[200:203], a[200:203], a[40:43]
    v_add_f32 v252, v252, v180
    v_add_f32 v252, v252, v181
    v_mfma_f32_16x16x32_bf16 a[40:43], v[196:199], a[232:235], a[40:43]
    v_exp_f32 v183, v183
    v_mfma_f32_16x16x32_bf16 a[44:47], v[196:199], a[236:239], a[44:47]
    v_cvt_pk_bf16_f32 v210, v180, v181
    v_add_f32 v252, v252, v182
    v_mfma_f32_16x16x32_bf16 a[44:47], v[200:203], a[204:207], a[44:47]
    s_waitcnt vmcnt(44) lgkmcnt(0)
    v_add_f32 v252, v252, v183
    v_cvt_pk_bf16_f32 v211, v182, v183
    v_mfma_f32_16x16x32_bf16 v[176:179], a[160:163], v[48:51], v[224:227]
    s_barrier
    ds_read_b128 a[128:131], v240 offset:16384
    ds_read_b128 a[132:135], v241 offset:16384
    v_mfma_f32_16x16x32_bf16 v[176:179], a[164:167], v[52:55], v[176:179]
    v_exp_f32 v184, v184
    v_mfma_f32_16x16x32_bf16 v[176:179], a[168:171], v[56:59], v[176:179]
    s_add_u32 m0, s34, 0
    ds_read_b128 a[136:139], v242 offset:16384
    ds_read_b128 a[140:143], v243 offset:16384
    v_mfma_f32_16x16x32_bf16 v[176:179], a[172:175], v[60:63], v[176:179]
    buffer_load_dwordx4 v96, s[12:15], s32 offen offset:0 nt lds
    v_exp_f32 v185, v185
    v_mfma_f32_16x16x32_bf16 v[180:183], a[188:191], v[60:63], v[224:227]
    buffer_load_dwordx4 v97, s[12:15], s32 offen offset:1024 nt lds
    v_exp_f32 v186, v186
    v_mfma_f32_16x16x32_bf16 v[180:183], a[184:187], v[56:59], v[180:183]
    ds_read_b64_tr_b16 a[96:97], v106 offset:4096
    ds_read_b64_tr_b16 a[98:99], v107 offset:4096
    v_add_f32 v255, v255, v184
    v_add_f32 v255, v255, v185
    v_mfma_f32_16x16x32_bf16 v[180:183], a[180:183], v[52:55], v[180:183]
    buffer_load_dwordx4 v98, s[12:15], s32 offen offset:2048 nt lds
    v_exp_f32 v187, v187
    v_mfma_f32_16x16x32_bf16 v[180:183], a[176:179], v[48:51], v[180:183]
    buffer_load_dwordx4 v99, s[12:15], s32 offen offset:3072 nt lds
    v_cvt_pk_bf16_f32 v192, v184, v185
    v_add_f32 v255, v255, v186
    v_mfma_f32_16x16x32_bf16 a[48:51], v[200:203], a[208:211], a[48:51]
    s_add_u32 m0, s34, 4096
    ds_read_b64_tr_b16 a[100:101], v106 offset:5120
    ds_read_b64_tr_b16 a[102:103], v107 offset:5120
    v_exp_f32 v188, v188
    v_mfma_f32_16x16x32_bf16 a[48:51], v[196:199], a[240:243], a[48:51]
    buffer_load_dwordx4 v96, s[12:15], s35 offen offset:0 nt lds
    v_add_f32 v255, v255, v187
    v_cvt_pk_bf16_f32 v193, v186, v187
    v_mfma_f32_16x16x32_bf16 a[52:55], v[196:199], a[244:247], a[52:55]
    buffer_load_dwordx4 v97, s[12:15], s35 offen offset:1024 nt lds
    v_exp_f32 v189, v189
    v_mfma_f32_16x16x32_bf16 a[52:55], v[200:203], a[212:215], a[52:55]
    ds_read_b64_tr_b16 a[104:105], v106 offset:6144
    ds_read_b64_tr_b16 a[106:107], v107 offset:6144
    v_exp_f32 v190, v190
    v_mfma_f32_16x16x32_bf16 a[56:59], v[200:203], a[216:219], a[56:59]
    buffer_load_dwordx4 v98, s[12:15], s35 offen offset:2048 nt lds
    v_add_f32 v255, v255, v188
    v_add_f32 v255, v255, v189
    v_mfma_f32_16x16x32_bf16 a[56:59], v[196:199], a[248:251], a[56:59]
    buffer_load_dwordx4 v99, s[12:15], s35 offen offset:3072 nt lds
    v_exp_f32 v191, v191
    v_mfma_f32_16x16x32_bf16 a[60:63], v[196:199], a[252:255], a[60:63]
    s_add_u32 m0, s34, 32768
    ds_read_b64_tr_b16 a[108:109], v106 offset:7168
    ds_read_b64_tr_b16 a[110:111], v107 offset:7168
    v_cvt_pk_bf16_f32 v194, v188, v189
    v_add_f32 v255, v255, v190
    v_mfma_f32_16x16x32_bf16 a[60:63], v[200:203], a[220:223], a[60:63]
    buffer_load_dwordx4 v96, s[16:19], s32 offen offset:0 nt lds
    v_add_f32 v255, v255, v191
    v_cvt_pk_bf16_f32 v195, v190, v191
    v_mfma_f32_16x16x32_bf16 v[184:187], a[160:163], v[80:83], v[232:235]
    ds_read_b128 a[144:147], v240 offset:20480
    ds_read_b128 a[148:151], v241 offset:20480
    v_mfma_f32_16x16x32_bf16 v[184:187], a[164:167], v[84:87], v[184:187]
    v_exp_f32 v176, v176
    v_mfma_f32_16x16x32_bf16 v[184:187], a[168:171], v[88:91], v[184:187]
    ds_read_b128 a[152:155], v242 offset:20480
    ds_read_b128 a[156:159], v243 offset:20480
    v_mfma_f32_16x16x32_bf16 v[184:187], a[172:175], v[92:95], v[184:187]
    buffer_load_dwordx4 v97, s[16:19], s32 offen offset:1024 nt lds
    v_exp_f32 v177, v177
    v_mfma_f32_16x16x32_bf16 v[188:191], a[188:191], v[92:95], v[232:235]
    buffer_load_dwordx4 v96, s[16:19], s32 offen offset:2048 nt lds
    v_exp_f32 v178, v178
    v_mfma_f32_16x16x32_bf16 v[188:191], a[184:187], v[88:91], v[188:191]
    v_add_f32 v254, v254, v176
    v_add_f32 v254, v254, v177
    v_mfma_f32_16x16x32_bf16 v[188:191], a[180:183], v[84:87], v[188:191]
    buffer_load_dwordx4 v97, s[16:19], s32 offen offset:3072 nt lds
    v_exp_f32 v179, v179
    v_mfma_f32_16x16x32_bf16 v[188:191], a[176:179], v[80:83], v[188:191]
    s_add_u32 m0, s34, 36864
    v_cvt_pk_bf16_f32 v212, v176, v177
    v_add_f32 v254, v254, v178
    v_mfma_f32_16x16x32_bf16 v[112:115], v[204:207], a[192:195], v[112:115]
    buffer_load_dwordx4 v96, s[16:19], s35 offen offset:0 nt lds
    v_exp_f32 v180, v180
    v_mfma_f32_16x16x32_bf16 v[112:115], v[192:195], a[224:227], v[112:115]
    buffer_load_dwordx4 v97, s[16:19], s35 offen offset:1024 nt lds
    v_add_f32 v254, v254, v179
    v_cvt_pk_bf16_f32 v213, v178, v179
    v_mfma_f32_16x16x32_bf16 v[116:119], v[192:195], a[228:231], v[116:119]
    buffer_load_dwordx4 v96, s[16:19], s35 offen offset:2048 nt lds
    v_exp_f32 v181, v181
    v_mfma_f32_16x16x32_bf16 v[116:119], v[204:207], a[196:199], v[116:119]
    v_exp_f32 v182, v182
    v_mfma_f32_16x16x32_bf16 v[120:123], v[204:207], a[200:203], v[120:123]
    buffer_load_dwordx4 v97, s[16:19], s35 offen offset:3072 nt lds
    v_add_f32 v254, v254, v180
    v_add_f32 v254, v254, v181
    v_mfma_f32_16x16x32_bf16 v[120:123], v[192:195], a[232:235], v[120:123]
    v_exp_f32 v183, v183
    v_mfma_f32_16x16x32_bf16 v[124:127], v[192:195], a[236:239], v[124:127]
    v_cvt_pk_bf16_f32 v214, v180, v181
    v_add_f32 v254, v254, v182
    v_mfma_f32_16x16x32_bf16 v[124:127], v[204:207], a[204:207], v[124:127]
    s_waitcnt lgkmcnt(0)
    v_add_f32 v254, v254, v183
    v_cvt_pk_bf16_f32 v215, v182, v183
    v_mfma_f32_16x16x32_bf16 v[176:179], a[128:131], v[16:19], v[216:219]
    ds_read_b64_tr_b16 a[192:193], v244 offset:16384
    ds_read_b64_tr_b16 a[194:195], v244 offset:20480
    v_mfma_f32_16x16x32_bf16 v[176:179], a[132:135], v[20:23], v[176:179]
    s_add_u32 s33, s33, 1
    v_exp_f32 v184, v184
    v_mfma_f32_16x16x32_bf16 v[176:179], a[136:139], v[24:27], v[176:179]
    s_add_u32 s32, s32, 8192
    ds_read_b64_tr_b16 a[196:197], v245 offset:16384
    ds_read_b64_tr_b16 a[198:199], v245 offset:20480
    v_mfma_f32_16x16x32_bf16 v[176:179], a[140:143], v[28:31], v[176:179]
    s_cmp_eq_u32 s33, 23
    v_exp_f32 v185, v185
    v_mfma_f32_16x16x32_bf16 v[180:183], a[156:159], v[28:31], v[216:219]
    s_cselect_b32 s32, s26, s32
    v_exp_f32 v186, v186
    v_mfma_f32_16x16x32_bf16 v[180:183], a[152:155], v[24:27], v[180:183]
    s_cmp_eq_u32 s33, 46
    ds_read_b64_tr_b16 a[200:201], v246 offset:16384
    v_add_f32 v0, v0, v184
    v_add_f32 v0, v0, v185
    v_mfma_f32_16x16x32_bf16 v[180:183], a[148:151], v[20:23], v[180:183]
    s_cselect_b32 s32, s37, s32
    v_exp_f32 v187, v187
    v_mfma_f32_16x16x32_bf16 v[180:183], a[144:147], v[16:19], v[180:183]
    s_add_u32 s35, s32, 4096
    buffer_store_dwordx4 a[96:99], v102, s[20:23], s53 offen offset:0 sc1
    v_cvt_pk_bf16_f32 v196, v184, v185
    v_add_f32 v0, v0, v186
    v_mfma_f32_16x16x32_bf16 v[128:131], v[204:207], a[208:211], v[128:131]
    s_add_u32 s34, s34, 8192
    v_exp_f32 v188, v188
    v_mfma_f32_16x16x32_bf16 v[128:131], v[192:195], a[240:243], v[128:131]
    s_and_b32 s34, s34, 32767
    ds_read_b64_tr_b16 a[202:203], v246 offset:20480
    v_add_f32 v0, v0, v187
    v_cvt_pk_bf16_f32 v197, v186, v187
    v_mfma_f32_16x16x32_bf16 v[132:135], v[192:195], a[244:247], v[132:135]
    v_exp_f32 v189, v189
    v_mfma_f32_16x16x32_bf16 v[132:135], v[204:207], a[212:215], v[132:135]
    v_exp_f32 v190, v190
    v_mfma_f32_16x16x32_bf16 v[136:139], v[204:207], a[216:219], v[136:139]
    buffer_store_dwordx4 a[100:103], v102, s[20:23], s53 offen offset:1024 sc1
    v_add_f32 v0, v0, v188
    v_add_f32 v0, v0, v189
    v_mfma_f32_16x16x32_bf16 v[136:139], v[192:195], a[248:251], v[136:139]
    v_exp_f32 v191, v191
    v_mfma_f32_16x16x32_bf16 v[140:143], v[192:195], a[252:255], v[140:143]
    v_cvt_pk_bf16_f32 v198, v188, v189
    v_add_f32 v0, v0, v190
    v_mfma_f32_16x16x32_bf16 v[140:143], v[204:207], a[220:223], v[140:143]
    v_add_f32 v0, v0, v191
    v_cvt_pk_bf16_f32 v199, v190, v191
    v_mfma_f32_16x16x32_bf16 v[184:187], a[128:131], v[32:35], v[220:223]
    ds_read_b64_tr_b16 a[204:205], v247 offset:16384
    ds_read_b64_tr_b16 a[206:207], v247 offset:20480
    v_mfma_f32_16x16x32_bf16 v[184:187], a[132:135], v[36:39], v[184:187]
    v_exp_f32 v176, v176
    v_mfma_f32_16x16x32_bf16 v[184:187], a[136:139], v[40:43], v[184:187]
    ds_read_b64_tr_b16 a[208:209], v248 offset:16384
    ds_read_b64_tr_b16 a[210:211], v248 offset:20480
    v_mfma_f32_16x16x32_bf16 v[184:187], a[140:143], v[44:47], v[184:187]
    buffer_store_dwordx4 a[104:107], v102, s[20:23], s53 offen offset:2048 sc1
    v_exp_f32 v177, v177
    v_mfma_f32_16x16x32_bf16 v[188:191], a[156:159], v[44:47], v[220:223]
    v_exp_f32 v178, v178
    v_mfma_f32_16x16x32_bf16 v[188:191], a[152:155], v[40:43], v[188:191]
    ds_read_b64_tr_b16 a[212:213], v249 offset:16384
    v_add_f32 v252, v252, v176
    v_add_f32 v252, v252, v177
    v_mfma_f32_16x16x32_bf16 v[188:191], a[148:151], v[36:39], v[188:191]
    v_exp_f32 v179, v179
    v_mfma_f32_16x16x32_bf16 v[188:191], a[144:147], v[32:35], v[188:191]
    buffer_store_dwordx4 a[108:111], v102, s[20:23], s53 offen offset:3072 sc1
    v_cvt_pk_bf16_f32 v192, v176, v177
    v_add_f32 v252, v252, v178
    v_mfma_f32_16x16x32_bf16 v[144:147], v[196:199], a[224:227], v[144:147]
    s_add_u32 s53, s53, 4096
    v_exp_f32 v180, v180
    v_mfma_f32_16x16x32_bf16 v[148:151], v[196:199], a[228:231], v[148:151]
    s_sub_u32 s52, s52, 1
    ds_read_b64_tr_b16 a[214:215], v249 offset:20480
    v_add_f32 v252, v252, v179
    v_cvt_pk_bf16_f32 v193, v178, v179
    v_mfma_f32_16x16x32_bf16 v[152:155], v[196:199], a[232:235], v[152:155]
    s_cmp_le_i32 s52, 0
    v_exp_f32 v181, v181
    v_mfma_f32_16x16x32_bf16 v[156:159], v[196:199], a[236:239], v[156:159]
    s_cselect_b32 s53, s37, s53
    v_exp_f32 v182, v182
    v_mfma_f32_16x16x32_bf16 v[160:163], v[196:199], a[240:243], v[160:163]
    v_add_f32 v252, v252, v180
    v_add_f32 v252, v252, v181
    v_mfma_f32_16x16x32_bf16 v[164:167], v[196:199], a[244:247], v[164:167]
    s_add_u32 s28, s28, 1
    v_exp_f32 v183, v183
    v_mfma_f32_16x16x32_bf16 v[168:171], v[196:199], a[248:251], v[168:171]
    v_cvt_pk_bf16_f32 v194, v180, v181
    v_add_f32 v252, v252, v182
    v_mfma_f32_16x16x32_bf16 v[172:175], v[196:199], a[252:255], v[172:175]
    v_add_f32 v252, v252, v183
    v_cvt_pk_bf16_f32 v195, v182, v183
    s_branch L_loopb_w3
L_final_w3:
    s_waitcnt vmcnt(32)
    v_mfma_f32_16x16x32_bf16 v[176:179], a[128:131], v[64:67], v[228:231]
    s_barrier
    ds_read_b128 a[160:163], v240 offset:8192
    ds_read_b128 a[164:167], v241 offset:8192
    v_mfma_f32_16x16x32_bf16 v[176:179], a[132:135], v[68:71], v[176:179]
    v_exp_f32 v184, v184
    v_mfma_f32_16x16x32_bf16 v[176:179], a[136:139], v[72:75], v[176:179]
    s_add_u32 s91, s55, 12288
    ds_read_b128 a[168:171], v242 offset:8192
    ds_read_b128 a[172:175], v243 offset:8192
    v_mfma_f32_16x16x32_bf16 v[176:179], a[140:143], v[76:79], v[176:179]
    s_add_u32 s92, s55, 16384
    v_exp_f32 v185, v185
    v_mfma_f32_16x16x32_bf16 v[180:183], a[156:159], v[76:79], v[228:231]
    s_add_u32 s88, s55, 0
    v_exp_f32 v186, v186
    v_mfma_f32_16x16x32_bf16 v[180:183], a[152:155], v[72:75], v[180:183]
    s_add_u32 s89, s55, 4096
    v_add_f32 v0, v0, v184
    v_add_f32 v0, v0, v185
    v_mfma_f32_16x16x32_bf16 v[180:183], a[148:151], v[68:71], v[180:183]
    s_add_u32 s90, s55, 8192
    v_exp_f32 v187, v187
    v_mfma_f32_16x16x32_bf16 v[180:183], a[144:147], v[64:67], v[180:183]
    v_cvt_pk_bf16_f32 v196, v184, v185
    v_add_f32 v0, v0, v186
    v_mfma_f32_16x16x32_bf16 v[128:131], v[204:207], a[208:211], v[128:131]
    v_exp_f32 v188, v188
    v_mfma_f32_16x16x32_bf16 v[128:131], v[192:195], a[240:243], v[128:131]
    v_add_f32 v0, v0, v187
    v_cvt_pk_bf16_f32 v197, v186, v187
    v_mfma_f32_16x16x32_bf16 v[132:135], v[192:195], a[244:247], v[132:135]
    v_exp_f32 v189, v189
    v_mfma_f32_16x16x32_bf16 v[132:135], v[204:207], a[212:215], v[132:135]
    v_exp_f32 v190, v190
    v_mfma_f32_16x16x32_bf16 v[136:139], v[204:207], a[216:219], v[136:139]
    v_add_f32 v0, v0, v188
    v_add_f32 v0, v0, v189
    v_mfma_f32_16x16x32_bf16 v[136:139], v[192:195], a[248:251], v[136:139]
    v_exp_f32 v191, v191
    v_mfma_f32_16x16x32_bf16 v[140:143], v[192:195], a[252:255], v[140:143]
    v_cvt_pk_bf16_f32 v198, v188, v189
    v_add_f32 v0, v0, v190
    v_mfma_f32_16x16x32_bf16 v[140:143], v[204:207], a[220:223], v[140:143]
    v_add_f32 v0, v0, v191
    v_cvt_pk_bf16_f32 v199, v190, v191
    v_mfma_f32_16x16x32_bf16 a[0:3], v[208:211], a[224:227], a[0:3]
    ds_read_b128 a[176:179], v240 offset:12288
    ds_read_b128 a[180:183], v241 offset:12288
    v_mfma_f32_16x16x32_bf16 a[4:7], v[208:211], a[228:231], a[4:7]
    ds_read_b128 a[184:187], v242 offset:12288
    ds_read_b128 a[188:191], v243 offset:12288
    v_mfma_f32_16x16x32_bf16 a[8:11], v[208:211], a[232:235], a[8:11]
    ds_read_b64_tr_b16 a[192:193], v244 offset:0
    ds_read_b64_tr_b16 a[194:195], v244 offset:4096
    v_mfma_f32_16x16x32_bf16 a[12:15], v[208:211], a[236:239], a[12:15]
    ds_read_b64_tr_b16 a[196:197], v245 offset:0
    ds_read_b64_tr_b16 a[198:199], v245 offset:4096
    v_mfma_f32_16x16x32_bf16 a[16:19], v[208:211], a[240:243], a[16:19]
    ds_read_b64_tr_b16 a[200:201], v246 offset:0
    ds_read_b64_tr_b16 a[202:203], v246 offset:4096
    v_mfma_f32_16x16x32_bf16 a[20:23], v[208:211], a[244:247], a[20:23]
    ds_read_b64_tr_b16 a[204:205], v247 offset:0
    ds_read_b64_tr_b16 a[206:207], v247 offset:4096
    v_mfma_f32_16x16x32_bf16 a[24:27], v[208:211], a[248:251], a[24:27]
    v_mfma_f32_16x16x32_bf16 a[28:31], v[208:211], a[252:255], a[28:31]
    s_waitcnt lgkmcnt(8)
    v_mfma_f32_16x16x32_bf16 v[184:187], a[160:163], v[64:67], v[228:231]
    ds_read_b64_tr_b16 a[208:209], v248 offset:0
    ds_read_b64_tr_b16 a[210:211], v248 offset:4096
    v_mfma_f32_16x16x32_bf16 v[184:187], a[164:167], v[68:71], v[184:187]
    v_exp_f32 v176, v176
    v_mfma_f32_16x16x32_bf16 v[184:187], a[168:171], v[72:75], v[184:187]
    ds_read_b64_tr_b16 a[212:213], v249 offset:0
    ds_read_b64_tr_b16 a[214:215], v249 offset:4096
    v_mfma_f32_16x16x32_bf16 v[184:187], a[172:175], v[76:79], v[184:187]
    v_exp_f32 v177, v177
    v_mfma_f32_16x16x32_bf16 v[188:191], a[188:191], v[76:79], v[228:231]
    v_exp_f32 v178, v178
    v_mfma_f32_16x16x32_bf16 v[188:191], a[184:187], v[72:75], v[188:191]
    v_add_f32 v255, v255, v176
    v_add_f32 v255, v255, v177
    v_mfma_f32_16x16x32_bf16 v[188:191], a[180:183], v[68:71], v[188:191]
    v_exp_f32 v179, v179
    v_mfma_f32_16x16x32_bf16 v[188:191], a[176:179], v[64:67], v[188:191]
    v_cvt_pk_bf16_f32 v192, v176, v177
    v_add_f32 v255, v255, v178
    v_mfma_f32_16x16x32_bf16 v[144:147], v[196:199], a[224:227], v[144:147]
    v_exp_f32 v180, v180
    v_mfma_f32_16x16x32_bf16 v[148:151], v[196:199], a[228:231], v[148:151]
    v_add_f32 v255, v255, v179
    v_cvt_pk_bf16_f32 v193, v178, v179
    v_mfma_f32_16x16x32_bf16 v[152:155], v[196:199], a[232:235], v[152:155]
    v_exp_f32 v181, v181
    v_mfma_f32_16x16x32_bf16 v[156:159], v[196:199], a[236:239], v[156:159]
    v_exp_f32 v182, v182
    v_mfma_f32_16x16x32_bf16 v[160:163], v[196:199], a[240:243], v[160:163]
    v_add_f32 v255, v255, v180
    v_add_f32 v255, v255, v181
    v_mfma_f32_16x16x32_bf16 v[164:167], v[196:199], a[244:247], v[164:167]
    v_exp_f32 v183, v183
    v_mfma_f32_16x16x32_bf16 v[168:171], v[196:199], a[248:251], v[168:171]
    v_cvt_pk_bf16_f32 v194, v180, v181
    v_add_f32 v255, v255, v182
    v_mfma_f32_16x16x32_bf16 v[172:175], v[196:199], a[252:255], v[172:175]
    v_add_f32 v255, v255, v183
    v_cvt_pk_bf16_f32 v195, v182, v183
    v_mfma_f32_16x16x32_bf16 a[64:67], v[212:215], a[224:227], a[64:67]
    ds_read_b64_tr_b16 a[216:217], v250 offset:0
    ds_read_b64_tr_b16 a[218:219], v250 offset:4096
    v_mfma_f32_16x16x32_bf16 a[68:71], v[212:215], a[228:231], a[68:71]
    ds_read_b64_tr_b16 a[220:221], v251 offset:0
    ds_read_b64_tr_b16 a[222:223], v251 offset:4096
    v_mfma_f32_16x16x32_bf16 a[72:75], v[212:215], a[232:235], a[72:75]
    v_mfma_f32_16x16x32_bf16 a[76:79], v[212:215], a[236:239], a[76:79]
    v_mfma_f32_16x16x32_bf16 a[80:83], v[212:215], a[240:243], a[80:83]
    ds_read_b64_tr_b16 a[224:225], v244 offset:8192
    v_mfma_f32_16x16x32_bf16 a[84:87], v[212:215], a[244:247], a[84:87]
    ds_read_b64_tr_b16 a[226:227], v244 offset:12288
    v_mfma_f32_16x16x32_bf16 a[88:91], v[212:215], a[248:251], a[88:91]
    ds_read_b64_tr_b16 a[228:229], v245 offset:8192
    ds_read_b64_tr_b16 a[230:231], v245 offset:12288
    v_mfma_f32_16x16x32_bf16 a[92:95], v[212:215], a[252:255], a[92:95]
    ds_read_b64_tr_b16 a[232:233], v246 offset:8192
    ds_read_b64_tr_b16 a[234:235], v246 offset:12288
    v_mfma_f32_16x16x32_bf16 v[176:179], a[128:131], v[80:83], v[232:235]
    ds_read_b64_tr_b16 a[236:237], v247 offset:8192
    ds_read_b64_tr_b16 a[238:239], v247 offset:12288
    v_mfma_f32_16x16x32_bf16 v[176:179], a[132:135], v[84:87], v[176:179]
    ds_read_b64_tr_b16 a[240:241], v248 offset:8192
    v_exp_f32 v184, v184
    v_mfma_f32_16x16x32_bf16 v[176:179], a[136:139], v[88:91], v[176:179]
    ds_read_b64_tr_b16 a[242:243], v248 offset:12288
    ds_read_b64_tr_b16 a[244:245], v249 offset:8192
    v_mfma_f32_16x16x32_bf16 v[176:179], a[140:143], v[92:95], v[176:179]
    ds_read_b64_tr_b16 a[246:247], v249 offset:12288
    v_exp_f32 v185, v185
    v_mfma_f32_16x16x32_bf16 v[180:183], a[156:159], v[92:95], v[232:235]
    ds_read_b64_tr_b16 a[248:249], v250 offset:8192
    v_exp_f32 v186, v186
    v_mfma_f32_16x16x32_bf16 v[180:183], a[152:155], v[88:91], v[180:183]
    v_add_f32 v255, v255, v184
    v_add_f32 v255, v255, v185
    v_mfma_f32_16x16x32_bf16 v[180:183], a[148:151], v[84:87], v[180:183]
    ds_read_b64_tr_b16 a[250:251], v250 offset:12288
    v_exp_f32 v187, v187
    v_mfma_f32_16x16x32_bf16 v[180:183], a[144:147], v[80:83], v[180:183]
    s_waitcnt lgkmcnt(14)
    v_cvt_pk_bf16_f32 v196, v184, v185
    v_add_f32 v255, v255, v186
    v_mfma_f32_16x16x32_bf16 v[112:115], v[192:195], a[192:195], v[112:115]
    ds_read_b64_tr_b16 a[252:253], v251 offset:8192
    v_exp_f32 v188, v188
    v_mfma_f32_16x16x32_bf16 v[116:119], v[192:195], a[196:199], v[116:119]
    v_add_f32 v255, v255, v187
    v_cvt_pk_bf16_f32 v197, v186, v187
    v_mfma_f32_16x16x32_bf16 v[120:123], v[192:195], a[200:203], v[120:123]
    ds_read_b64_tr_b16 a[254:255], v251 offset:12288
    v_exp_f32 v189, v189
    v_mfma_f32_16x16x32_bf16 v[124:127], v[192:195], a[204:207], v[124:127]
    v_exp_f32 v190, v190
    v_mfma_f32_16x16x32_bf16 v[128:131], v[192:195], a[208:211], v[128:131]
    v_add_f32 v255, v255, v188
    v_add_f32 v255, v255, v189
    v_mfma_f32_16x16x32_bf16 v[132:135], v[192:195], a[212:215], v[132:135]
    v_exp_f32 v191, v191
    v_mfma_f32_16x16x32_bf16 v[136:139], v[192:195], a[216:219], v[136:139]
    v_cvt_pk_bf16_f32 v198, v188, v189
    v_add_f32 v255, v255, v190
    v_mfma_f32_16x16x32_bf16 v[140:143], v[192:195], a[220:223], v[140:143]
    v_add_f32 v255, v255, v191
    v_cvt_pk_bf16_f32 v199, v190, v191
    v_mfma_f32_16x16x32_bf16 v[184:187], a[160:163], v[80:83], v[232:235]
    v_mov_b32 v228, v255
    v_mfma_f32_16x16x32_bf16 v[184:187], a[164:167], v[84:87], v[184:187]
    v_exp_f32 v176, v176
    v_exp_f32 v177, v177
    v_mfma_f32_16x16x32_bf16 v[184:187], a[168:171], v[88:91], v[184:187]
    v_permlane16_swap_b32 v255, v228
    v_exp_f32 v178, v178
    v_mfma_f32_16x16x32_bf16 v[184:187], a[172:175], v[92:95], v[184:187]
    v_add_f32 v255, v255, v228
    v_mov_b32 v228, v255
    v_add_f32 v0, v0, v176
    v_mfma_f32_16x16x32_bf16 v[188:191], a[188:191], v[92:95], v[232:235]
    v_add_f32 v0, v0, v177
    v_exp_f32 v179, v179
    v_mfma_f32_16x16x32_bf16 v[188:191], a[184:187], v[88:91], v[188:191]
    v_permlane32_swap_b32 v255, v228
    v_cvt_pk_bf16_f32 v192, v176, v177
    v_add_f32 v0, v0, v178
    v_mfma_f32_16x16x32_bf16 v[188:191], a[180:183], v[84:87], v[188:191]
    v_add_f32 v255, v255, v228
    v_subrev_u32 v228, s57, v255
    v_mfma_f32_16x16x32_bf16 v[188:191], a[176:179], v[80:83], v[188:191]
    s_waitcnt lgkmcnt(0)
    v_cmp_le_u32 vcc, s36, v228
    v_rcp_f32 v255, v255
    v_mfma_f32_16x16x32_bf16 v[112:115], v[196:199], a[224:227], v[112:115]
    ds_bpermute_b32 v228, v4, v255 offset:0
    v_mfma_f32_16x16x32_bf16 v[116:119], v[196:199], a[228:231], v[116:119]
    s_cmp_lg_u64 vcc, 0
    ds_bpermute_b32 v229, v4, v255 offset:4
    v_exp_f32 v180, v180
    v_mfma_f32_16x16x32_bf16 v[120:123], v[196:199], a[232:235], v[120:123]
    s_cselect_b32 s56, 512, 0
    ds_bpermute_b32 v230, v4, v255 offset:8
    v_add_f32 v0, v0, v179
    v_mfma_f32_16x16x32_bf16 v[124:127], v[196:199], a[236:239], v[124:127]
    s_or_b32 s27, s27, s56
    ds_bpermute_b32 v231, v4, v255 offset:12
    v_cvt_pk_bf16_f32 v193, v178, v179
    v_mfma_f32_16x16x32_bf16 v[128:131], v[196:199], a[240:243], v[128:131]
    v_exp_f32 v181, v181
    v_mfma_f32_16x16x32_bf16 v[132:135], v[196:199], a[244:247], v[132:135]
    v_exp_f32 v182, v182
    v_add_f32 v0, v0, v180
    v_add_f32 v0, v0, v181
    v_mfma_f32_16x16x32_bf16 v[136:139], v[196:199], a[248:251], v[136:139]
    v_exp_f32 v183, v183
    v_cvt_pk_bf16_f32 v194, v180, v181
    v_mfma_f32_16x16x32_bf16 v[140:143], v[196:199], a[252:255], v[140:143]
    v_add_f32 v0, v0, v182
    v_add_f32 v0, v0, v183
    v_cvt_pk_bf16_f32 v195, v182, v183
    s_waitcnt lgkmcnt(0)
.p2align 3
    v_pk_mul_f32 v[112:113], v[112:113], v[228:229]
    v_pk_mul_f32 v[116:117], v[116:117], v[228:229]
    v_pk_mul_f32 v[120:121], v[120:121], v[228:229]
    v_pk_mul_f32 v[124:125], v[124:125], v[228:229]
    v_pk_mul_f32 v[128:129], v[128:129], v[228:229]
    v_pk_mul_f32 v[132:133], v[132:133], v[228:229]
    v_pk_mul_f32 v[136:137], v[136:137], v[228:229]
    v_pk_mul_f32 v[140:141], v[140:141], v[228:229]
    v_pk_mul_f32 v[114:115], v[114:115], v[230:231]
    v_pk_mul_f32 v[118:119], v[118:119], v[230:231]
    v_pk_mul_f32 v[122:123], v[122:123], v[230:231]
    v_pk_mul_f32 v[126:127], v[126:127], v[230:231]
    v_pk_mul_f32 v[130:131], v[130:131], v[230:231]
    v_pk_mul_f32 v[134:135], v[134:135], v[230:231]
    v_pk_mul_f32 v[138:139], v[138:139], v[230:231]
    v_pk_mul_f32 v[142:143], v[142:143], v[230:231]
    v_cvt_pk_bf16_f32 v64, v112, v116
    v_cvt_pk_bf16_f32 v65, v120, v124
    v_cvt_pk_bf16_f32 v66, v128, v132
    v_cvt_pk_bf16_f32 v67, v136, v140
    v_cvt_pk_bf16_f32 v68, v113, v117
    v_cvt_pk_bf16_f32 v69, v121, v125
    v_cvt_pk_bf16_f32 v70, v129, v133
    v_cvt_pk_bf16_f32 v71, v137, v141
    v_cvt_pk_bf16_f32 v72, v114, v118
    v_cvt_pk_bf16_f32 v73, v122, v126
    v_cvt_pk_bf16_f32 v74, v130, v134
    v_cvt_pk_bf16_f32 v75, v138, v142
    v_cvt_pk_bf16_f32 v76, v115, v119
    v_cvt_pk_bf16_f32 v77, v123, v127
    v_cvt_pk_bf16_f32 v78, v131, v135
    v_cvt_pk_bf16_f32 v79, v139, v143
    v_mfma_f32_16x16x32_bf16 v[176:179], a[128:131], v[16:19], v[216:219]
    ds_write_b128 v2, v[64:67] offset:12288
    v_mfma_f32_16x16x32_bf16 v[176:179], a[132:135], v[20:23], v[176:179]
    v_exp_f32 v184, v184
    v_mfma_f32_16x16x32_bf16 v[176:179], a[136:139], v[24:27], v[176:179]
    ds_write_b128 v3, v[68:71] offset:12544
    v_mfma_f32_16x16x32_bf16 v[176:179], a[140:143], v[28:31], v[176:179]
    v_exp_f32 v185, v185
    v_mfma_f32_16x16x32_bf16 v[180:183], a[156:159], v[28:31], v[216:219]
    ds_write_b128 v2, v[72:75] offset:12800
    v_exp_f32 v186, v186
    v_mfma_f32_16x16x32_bf16 v[180:183], a[152:155], v[24:27], v[180:183]
    v_add_f32 v0, v0, v184
    v_add_f32 v0, v0, v185
    v_mfma_f32_16x16x32_bf16 v[180:183], a[148:151], v[20:23], v[180:183]
    ds_write_b128 v3, v[76:79] offset:13056
    v_exp_f32 v187, v187
    v_mfma_f32_16x16x32_bf16 v[180:183], a[144:147], v[16:19], v[180:183]
    v_cvt_pk_bf16_f32 v196, v184, v185
    v_add_f32 v0, v0, v186
    v_mfma_f32_16x16x32_bf16 v[144:147], v[192:195], a[192:195], v[144:147]
    v_exp_f32 v188, v188
    v_mfma_f32_16x16x32_bf16 v[148:151], v[192:195], a[196:199], v[148:151]
    ds_read_b64_tr_b16 v[128:129], v6 offset:12288
    ds_read_b64_tr_b16 v[130:131], v7 offset:12288
    v_add_f32 v0, v0, v187
    v_cvt_pk_bf16_f32 v197, v186, v187
    v_mfma_f32_16x16x32_bf16 v[152:155], v[192:195], a[200:203], v[152:155]
    ds_read_b64_tr_b16 v[132:133], v6 offset:13312
    v_exp_f32 v189, v189
    v_mfma_f32_16x16x32_bf16 v[156:159], v[192:195], a[204:207], v[156:159]
    ds_read_b64_tr_b16 v[134:135], v7 offset:13312
    ds_read_b64_tr_b16 v[136:137], v6 offset:14336
    v_exp_f32 v190, v190
    v_mfma_f32_16x16x32_bf16 v[160:163], v[192:195], a[208:211], v[160:163]
    ds_read_b64_tr_b16 v[138:139], v7 offset:14336
    v_add_f32 v0, v0, v188
    v_add_f32 v0, v0, v189
    v_mfma_f32_16x16x32_bf16 v[164:167], v[192:195], a[212:215], v[164:167]
    ds_read_b64_tr_b16 v[140:141], v6 offset:15360
    ds_read_b64_tr_b16 v[142:143], v7 offset:15360
    v_exp_f32 v191, v191
    v_mfma_f32_16x16x32_bf16 v[168:171], v[192:195], a[216:219], v[168:171]
    v_cvt_pk_bf16_f32 v198, v188, v189
    v_add_f32 v0, v0, v190
    v_mfma_f32_16x16x32_bf16 v[172:175], v[192:195], a[220:223], v[172:175]
    v_add_f32 v0, v0, v191
    v_cvt_pk_bf16_f32 v199, v190, v191
    v_mfma_f32_16x16x32_bf16 v[184:187], a[160:163], v[16:19], v[216:219]
    v_mov_b32 v232, v0
    v_exp_f32 v176, v176
    v_mfma_f32_16x16x32_bf16 v[184:187], a[164:167], v[20:23], v[184:187]
    s_waitcnt lgkmcnt(0)
    buffer_store_dwordx4 v[128:131], v102, s[20:23], s91 offen offset:0 sc1
    v_mfma_f32_16x16x32_bf16 v[184:187], a[168:171], v[24:27], v[184:187]
    v_permlane16_swap_b32 v0, v232
    v_exp_f32 v177, v177
    v_mfma_f32_16x16x32_bf16 v[184:187], a[172:175], v[28:31], v[184:187]
    v_add_f32 v0, v0, v232
    v_mov_b32 v232, v0
    v_exp_f32 v178, v178
    v_add_f32 v252, v252, v176
    v_mfma_f32_16x16x32_bf16 v[188:191], a[188:191], v[28:31], v[216:219]
    v_add_f32 v252, v252, v177
    v_exp_f32 v179, v179
    v_cvt_pk_bf16_f32 v192, v176, v177
    v_mfma_f32_16x16x32_bf16 v[188:191], a[184:187], v[24:27], v[188:191]
    buffer_store_dwordx4 v[132:135], v102, s[20:23], s91 offen offset:1024 sc1
    v_permlane32_swap_b32 v0, v232
    v_mfma_f32_16x16x32_bf16 v[188:191], a[180:183], v[20:23], v[188:191]
    v_add_f32 v0, v0, v232
    v_subrev_u32 v232, s57, v0
    v_add_f32 v252, v252, v178
    v_mfma_f32_16x16x32_bf16 v[188:191], a[176:179], v[16:19], v[188:191]
    v_cmp_le_u32 vcc, s36, v232
    v_rcp_f32 v0, v0
    v_mfma_f32_16x16x32_bf16 v[144:147], v[196:199], a[224:227], v[144:147]
    ds_bpermute_b32 v232, v4, v0 offset:0
    v_exp_f32 v180, v180
    v_mfma_f32_16x16x32_bf16 v[148:151], v[196:199], a[228:231], v[148:151]
    s_cmp_lg_u64 vcc, 0
    buffer_store_dwordx4 v[136:139], v102, s[20:23], s91 offen offset:2048 sc1
    ds_bpermute_b32 v233, v4, v0 offset:4
    v_mfma_f32_16x16x32_bf16 v[152:155], v[196:199], a[232:235], v[152:155]
    s_cselect_b32 s56, 1024, 0
    ds_bpermute_b32 v234, v4, v0 offset:8
    v_mfma_f32_16x16x32_bf16 v[156:159], v[196:199], a[236:239], v[156:159]
    s_or_b32 s27, s27, s56
    ds_bpermute_b32 v235, v4, v0 offset:12
    v_add_f32 v252, v252, v179
    v_cvt_pk_bf16_f32 v193, v178, v179
    v_mfma_f32_16x16x32_bf16 v[160:163], v[196:199], a[240:243], v[160:163]
    v_exp_f32 v181, v181
    v_exp_f32 v182, v182
    v_mfma_f32_16x16x32_bf16 v[164:167], v[196:199], a[244:247], v[164:167]
    v_add_f32 v252, v252, v180
    v_add_f32 v252, v252, v181
    v_mfma_f32_16x16x32_bf16 v[168:171], v[196:199], a[248:251], v[168:171]
    v_exp_f32 v183, v183
    v_cvt_pk_bf16_f32 v194, v180, v181
    v_add_f32 v252, v252, v182
    v_add_f32 v252, v252, v183
    v_mfma_f32_16x16x32_bf16 v[172:175], v[196:199], a[252:255], v[172:175]
    buffer_store_dwordx4 v[140:143], v102, s[20:23], s91 offen offset:3072 sc1
    v_cvt_pk_bf16_f32 v195, v182, v183
    s_waitcnt lgkmcnt(0)
.p2align 3
    v_pk_mul_f32 v[144:145], v[144:145], v[232:233]
    v_pk_mul_f32 v[148:149], v[148:149], v[232:233]
    v_pk_mul_f32 v[152:153], v[152:153], v[232:233]
    v_pk_mul_f32 v[156:157], v[156:157], v[232:233]
    v_pk_mul_f32 v[160:161], v[160:161], v[232:233]
    v_pk_mul_f32 v[164:165], v[164:165], v[232:233]
    v_pk_mul_f32 v[168:169], v[168:169], v[232:233]
    v_pk_mul_f32 v[172:173], v[172:173], v[232:233]
    v_pk_mul_f32 v[146:147], v[146:147], v[234:235]
    v_pk_mul_f32 v[150:151], v[150:151], v[234:235]
    v_pk_mul_f32 v[154:155], v[154:155], v[234:235]
    v_pk_mul_f32 v[158:159], v[158:159], v[234:235]
    v_pk_mul_f32 v[162:163], v[162:163], v[234:235]
    v_pk_mul_f32 v[166:167], v[166:167], v[234:235]
    v_pk_mul_f32 v[170:171], v[170:171], v[234:235]
    v_pk_mul_f32 v[174:175], v[174:175], v[234:235]
    v_cvt_pk_bf16_f32 v80, v144, v148
    v_cvt_pk_bf16_f32 v81, v152, v156
    v_cvt_pk_bf16_f32 v82, v160, v164
    v_cvt_pk_bf16_f32 v83, v168, v172
    v_cvt_pk_bf16_f32 v84, v145, v149
    v_cvt_pk_bf16_f32 v85, v153, v157
    v_cvt_pk_bf16_f32 v86, v161, v165
    v_cvt_pk_bf16_f32 v87, v169, v173
    v_cvt_pk_bf16_f32 v88, v146, v150
    v_cvt_pk_bf16_f32 v89, v154, v158
    v_cvt_pk_bf16_f32 v90, v162, v166
    v_cvt_pk_bf16_f32 v91, v170, v174
    v_cvt_pk_bf16_f32 v92, v147, v151
    v_cvt_pk_bf16_f32 v93, v155, v159
    v_cvt_pk_bf16_f32 v94, v163, v167
    v_cvt_pk_bf16_f32 v95, v171, v175
    v_mfma_f32_16x16x32_bf16 v[176:179], a[128:131], v[32:35], v[220:223]
    ds_write_b128 v2, v[80:83] offset:16384
    v_mfma_f32_16x16x32_bf16 v[176:179], a[132:135], v[36:39], v[176:179]
    v_exp_f32 v184, v184
    v_mfma_f32_16x16x32_bf16 v[176:179], a[136:139], v[40:43], v[176:179]
    ds_write_b128 v3, v[84:87] offset:16640
    v_mfma_f32_16x16x32_bf16 v[176:179], a[140:143], v[44:47], v[176:179]
    v_exp_f32 v185, v185
    v_mfma_f32_16x16x32_bf16 v[180:183], a[156:159], v[44:47], v[220:223]
    ds_write_b128 v2, v[88:91] offset:16896
    v_exp_f32 v186, v186
    v_mfma_f32_16x16x32_bf16 v[180:183], a[152:155], v[40:43], v[180:183]
    v_add_f32 v252, v252, v184
    v_add_f32 v252, v252, v185
    v_mfma_f32_16x16x32_bf16 v[180:183], a[148:151], v[36:39], v[180:183]
    ds_write_b128 v3, v[92:95] offset:17152
    v_exp_f32 v187, v187
    v_mfma_f32_16x16x32_bf16 v[180:183], a[144:147], v[32:35], v[180:183]
    v_cvt_pk_bf16_f32 v196, v184, v185
    v_add_f32 v252, v252, v186
    v_mfma_f32_16x16x32_bf16 a[0:3], v[192:195], a[192:195], a[0:3]
    v_exp_f32 v188, v188
    v_mfma_f32_16x16x32_bf16 a[4:7], v[192:195], a[196:199], a[4:7]
    ds_read_b64_tr_b16 v[160:161], v6 offset:16384
    ds_read_b64_tr_b16 v[162:163], v7 offset:16384
    v_add_f32 v252, v252, v187
    v_cvt_pk_bf16_f32 v197, v186, v187
    v_mfma_f32_16x16x32_bf16 a[8:11], v[192:195], a[200:203], a[8:11]
    ds_read_b64_tr_b16 v[164:165], v6 offset:17408
    v_exp_f32 v189, v189
    v_mfma_f32_16x16x32_bf16 a[12:15], v[192:195], a[204:207], a[12:15]
    ds_read_b64_tr_b16 v[166:167], v7 offset:17408
    ds_read_b64_tr_b16 v[168:169], v6 offset:18432
    v_exp_f32 v190, v190
    v_mfma_f32_16x16x32_bf16 a[16:19], v[192:195], a[208:211], a[16:19]
    ds_read_b64_tr_b16 v[170:171], v7 offset:18432
    v_add_f32 v252, v252, v188
    v_add_f32 v252, v252, v189
    v_mfma_f32_16x16x32_bf16 a[20:23], v[192:195], a[212:215], a[20:23]
    ds_read_b64_tr_b16 v[172:173], v6 offset:19456
    ds_read_b64_tr_b16 v[174:175], v7 offset:19456
    v_exp_f32 v191, v191
    v_mfma_f32_16x16x32_bf16 a[24:27], v[192:195], a[216:219], a[24:27]
    v_cvt_pk_bf16_f32 v198, v188, v189
    v_add_f32 v252, v252, v190
    v_mfma_f32_16x16x32_bf16 a[28:31], v[192:195], a[220:223], a[28:31]
    v_add_f32 v252, v252, v191
    v_cvt_pk_bf16_f32 v199, v190, v191
    v_mfma_f32_16x16x32_bf16 v[184:187], a[160:163], v[32:35], v[220:223]
    v_mov_b32 v216, v252
    v_exp_f32 v176, v176
    v_mfma_f32_16x16x32_bf16 v[184:187], a[164:167], v[36:39], v[184:187]
    s_waitcnt lgkmcnt(0)
    buffer_store_dwordx4 v[160:163], v102, s[20:23], s92 offen offset:0 sc1
    v_mfma_f32_16x16x32_bf16 v[184:187], a[168:171], v[40:43], v[184:187]
    v_permlane16_swap_b32 v252, v216
    v_exp_f32 v177, v177
    v_mfma_f32_16x16x32_bf16 v[184:187], a[172:175], v[44:47], v[184:187]
    v_add_f32 v252, v252, v216
    v_mov_b32 v216, v252
    v_exp_f32 v178, v178
    v_add_f32 v253, v253, v176
    v_mfma_f32_16x16x32_bf16 v[188:191], a[188:191], v[44:47], v[220:223]
    v_add_f32 v253, v253, v177
    v_exp_f32 v179, v179
    v_cvt_pk_bf16_f32 v192, v176, v177
    v_mfma_f32_16x16x32_bf16 v[188:191], a[184:187], v[40:43], v[188:191]
    buffer_store_dwordx4 v[164:167], v102, s[20:23], s92 offen offset:1024 sc1
    v_permlane32_swap_b32 v252, v216
    v_mfma_f32_16x16x32_bf16 v[188:191], a[180:183], v[36:39], v[188:191]
    v_add_f32 v252, v252, v216
    v_subrev_u32 v216, s57, v252
    v_add_f32 v253, v253, v178
    v_mfma_f32_16x16x32_bf16 v[188:191], a[176:179], v[32:35], v[188:191]
    v_cmp_le_u32 vcc, s36, v216
    v_rcp_f32 v252, v252
    v_mfma_f32_16x16x32_bf16 a[0:3], v[196:199], a[224:227], a[0:3]
    ds_bpermute_b32 v216, v4, v252 offset:0
    v_exp_f32 v180, v180
    v_mfma_f32_16x16x32_bf16 a[4:7], v[196:199], a[228:231], a[4:7]
    s_cmp_lg_u64 vcc, 0
    buffer_store_dwordx4 v[168:171], v102, s[20:23], s92 offen offset:2048 sc1
    ds_bpermute_b32 v217, v4, v252 offset:4
    v_mfma_f32_16x16x32_bf16 a[8:11], v[196:199], a[232:235], a[8:11]
    s_cselect_b32 s56, 64, 0
    ds_bpermute_b32 v218, v4, v252 offset:8
    v_mfma_f32_16x16x32_bf16 a[12:15], v[196:199], a[236:239], a[12:15]
    s_or_b32 s27, s27, s56
    ds_bpermute_b32 v219, v4, v252 offset:12
    v_add_f32 v253, v253, v179
    v_cvt_pk_bf16_f32 v193, v178, v179
    v_mfma_f32_16x16x32_bf16 a[16:19], v[196:199], a[240:243], a[16:19]
    v_exp_f32 v181, v181
    v_exp_f32 v182, v182
    v_mfma_f32_16x16x32_bf16 a[20:23], v[196:199], a[244:247], a[20:23]
    v_add_f32 v253, v253, v180
    v_add_f32 v253, v253, v181
    v_mfma_f32_16x16x32_bf16 a[24:27], v[196:199], a[248:251], a[24:27]
    v_exp_f32 v183, v183
    v_cvt_pk_bf16_f32 v194, v180, v181
    v_add_f32 v253, v253, v182
    v_add_f32 v253, v253, v183
    v_mfma_f32_16x16x32_bf16 a[28:31], v[196:199], a[252:255], a[28:31]
    buffer_store_dwordx4 v[172:175], v102, s[20:23], s92 offen offset:3072 sc1
    v_cvt_pk_bf16_f32 v195, v182, v183
    s_nop 3
.p2align 3
    v_accvgpr_read_b32 v176, a0
    v_accvgpr_read_b32 v177, a4
    v_accvgpr_read_b32 v178, a8
    v_accvgpr_read_b32 v179, a12
    v_accvgpr_read_b32 v180, a16
    v_accvgpr_read_b32 v181, a20
    v_accvgpr_read_b32 v182, a24
    v_accvgpr_read_b32 v183, a28
    s_waitcnt lgkmcnt(0)
.p2align 3
    v_pk_mul_f32 v[176:177], v[176:177], v[216:217] op_sel:[0,0] op_sel_hi:[1,0]
    v_pk_mul_f32 v[178:179], v[178:179], v[216:217] op_sel:[0,0] op_sel_hi:[1,0]
    v_pk_mul_f32 v[180:181], v[180:181], v[216:217] op_sel:[0,0] op_sel_hi:[1,0]
    v_pk_mul_f32 v[182:183], v[182:183], v[216:217] op_sel:[0,0] op_sel_hi:[1,0]
    v_cvt_pk_bf16_f32 v16, v176, v177
    v_cvt_pk_bf16_f32 v17, v178, v179
    v_cvt_pk_bf16_f32 v18, v180, v181
    v_cvt_pk_bf16_f32 v19, v182, v183
    v_accvgpr_read_b32 v176, a1
    v_accvgpr_read_b32 v177, a5
    v_accvgpr_read_b32 v178, a9
    v_accvgpr_read_b32 v179, a13
    v_accvgpr_read_b32 v180, a17
    v_accvgpr_read_b32 v181, a21
    v_accvgpr_read_b32 v182, a25
    v_accvgpr_read_b32 v183, a29
    v_pk_mul_f32 v[176:177], v[176:177], v[216:217] op_sel:[0,1] op_sel_hi:[1,1]
    v_pk_mul_f32 v[178:179], v[178:179], v[216:217] op_sel:[0,1] op_sel_hi:[1,1]
    v_pk_mul_f32 v[180:181], v[180:181], v[216:217] op_sel:[0,1] op_sel_hi:[1,1]
    v_pk_mul_f32 v[182:183], v[182:183], v[216:217] op_sel:[0,1] op_sel_hi:[1,1]
    v_cvt_pk_bf16_f32 v20, v176, v177
    v_cvt_pk_bf16_f32 v21, v178, v179
    v_cvt_pk_bf16_f32 v22, v180, v181
    v_cvt_pk_bf16_f32 v23, v182, v183
    v_accvgpr_read_b32 v176, a2
    v_accvgpr_read_b32 v177, a6
    v_accvgpr_read_b32 v178, a10
    v_accvgpr_read_b32 v179, a14
    v_accvgpr_read_b32 v180, a18
    v_accvgpr_read_b32 v181, a22
    v_accvgpr_read_b32 v182, a26
    v_accvgpr_read_b32 v183, a30
    v_pk_mul_f32 v[176:177], v[176:177], v[218:219] op_sel:[0,0] op_sel_hi:[1,0]
    v_pk_mul_f32 v[178:179], v[178:179], v[218:219] op_sel:[0,0] op_sel_hi:[1,0]
    v_pk_mul_f32 v[180:181], v[180:181], v[218:219] op_sel:[0,0] op_sel_hi:[1,0]
    v_pk_mul_f32 v[182:183], v[182:183], v[218:219] op_sel:[0,0] op_sel_hi:[1,0]
    v_cvt_pk_bf16_f32 v24, v176, v177
    v_cvt_pk_bf16_f32 v25, v178, v179
    v_cvt_pk_bf16_f32 v26, v180, v181
    v_cvt_pk_bf16_f32 v27, v182, v183
    v_accvgpr_read_b32 v176, a3
    v_accvgpr_read_b32 v177, a7
    v_accvgpr_read_b32 v178, a11
    v_accvgpr_read_b32 v179, a15
    v_accvgpr_read_b32 v180, a19
    v_accvgpr_read_b32 v181, a23
    v_accvgpr_read_b32 v182, a27
    v_accvgpr_read_b32 v183, a31
    v_pk_mul_f32 v[176:177], v[176:177], v[218:219] op_sel:[0,1] op_sel_hi:[1,1]
    v_pk_mul_f32 v[178:179], v[178:179], v[218:219] op_sel:[0,1] op_sel_hi:[1,1]
    v_pk_mul_f32 v[180:181], v[180:181], v[218:219] op_sel:[0,1] op_sel_hi:[1,1]
    v_pk_mul_f32 v[182:183], v[182:183], v[218:219] op_sel:[0,1] op_sel_hi:[1,1]
    v_cvt_pk_bf16_f32 v28, v176, v177
    v_cvt_pk_bf16_f32 v29, v178, v179
    v_cvt_pk_bf16_f32 v30, v180, v181
    v_cvt_pk_bf16_f32 v31, v182, v183
    v_mfma_f32_16x16x32_bf16 v[176:179], a[128:131], v[48:51], v[224:227]
    ds_write_b128 v2, v[16:19] offset:0
    v_mfma_f32_16x16x32_bf16 v[176:179], a[132:135], v[52:55], v[176:179]
    v_exp_f32 v184, v184
    v_mfma_f32_16x16x32_bf16 v[176:179], a[136:139], v[56:59], v[176:179]
    ds_write_b128 v3, v[20:23] offset:256
    v_mfma_f32_16x16x32_bf16 v[176:179], a[140:143], v[60:63], v[176:179]
    v_exp_f32 v185, v185
    v_mfma_f32_16x16x32_bf16 v[180:183], a[156:159], v[60:63], v[224:227]
    ds_write_b128 v2, v[24:27] offset:512
    v_exp_f32 v186, v186
    v_mfma_f32_16x16x32_bf16 v[180:183], a[152:155], v[56:59], v[180:183]
    v_add_f32 v253, v253, v184
    v_add_f32 v253, v253, v185
    v_mfma_f32_16x16x32_bf16 v[180:183], a[148:151], v[52:55], v[180:183]
    ds_write_b128 v3, v[28:31] offset:768
    v_exp_f32 v187, v187
    v_mfma_f32_16x16x32_bf16 v[180:183], a[144:147], v[48:51], v[180:183]
    v_cvt_pk_bf16_f32 v196, v184, v185
    v_add_f32 v253, v253, v186
    v_mfma_f32_16x16x32_bf16 a[32:35], v[192:195], a[192:195], a[32:35]
    v_exp_f32 v188, v188
    v_mfma_f32_16x16x32_bf16 a[36:39], v[192:195], a[196:199], a[36:39]
    ds_read_b64_tr_b16 a[0:1], v6 offset:0
    ds_read_b64_tr_b16 a[2:3], v7 offset:0
    v_add_f32 v253, v253, v187
    v_cvt_pk_bf16_f32 v197, v186, v187
    v_mfma_f32_16x16x32_bf16 a[40:43], v[192:195], a[200:203], a[40:43]
    ds_read_b64_tr_b16 a[4:5], v6 offset:1024
    v_exp_f32 v189, v189
    v_mfma_f32_16x16x32_bf16 a[44:47], v[192:195], a[204:207], a[44:47]
    ds_read_b64_tr_b16 a[6:7], v7 offset:1024
    ds_read_b64_tr_b16 a[8:9], v6 offset:2048
    v_exp_f32 v190, v190
    v_mfma_f32_16x16x32_bf16 a[48:51], v[192:195], a[208:211], a[48:51]
    ds_read_b64_tr_b16 a[10:11], v7 offset:2048
    v_add_f32 v253, v253, v188
    v_add_f32 v253, v253, v189
    v_mfma_f32_16x16x32_bf16 a[52:55], v[192:195], a[212:215], a[52:55]
    ds_read_b64_tr_b16 a[12:13], v6 offset:3072
    ds_read_b64_tr_b16 a[14:15], v7 offset:3072
    v_exp_f32 v191, v191
    v_mfma_f32_16x16x32_bf16 a[56:59], v[192:195], a[216:219], a[56:59]
    v_cvt_pk_bf16_f32 v198, v188, v189
    v_add_f32 v253, v253, v190
    v_mfma_f32_16x16x32_bf16 a[60:63], v[192:195], a[220:223], a[60:63]
    v_add_f32 v253, v253, v191
    v_cvt_pk_bf16_f32 v199, v190, v191
    v_mfma_f32_16x16x32_bf16 v[184:187], a[160:163], v[48:51], v[224:227]
    v_mov_b32 v220, v253
    v_exp_f32 v176, v176
    v_mfma_f32_16x16x32_bf16 v[184:187], a[164:167], v[52:55], v[184:187]
    s_waitcnt lgkmcnt(0)
    buffer_store_dwordx4 a[0:3], v102, s[20:23], s88 offen offset:0 sc1
    v_mfma_f32_16x16x32_bf16 v[184:187], a[168:171], v[56:59], v[184:187]
    v_permlane16_swap_b32 v253, v220
    v_exp_f32 v177, v177
    v_mfma_f32_16x16x32_bf16 v[184:187], a[172:175], v[60:63], v[184:187]
    v_add_f32 v253, v253, v220
    v_mov_b32 v220, v253
    v_exp_f32 v178, v178
    v_add_f32 v254, v254, v176
    v_mfma_f32_16x16x32_bf16 v[188:191], a[188:191], v[60:63], v[224:227]
    v_add_f32 v254, v254, v177
    v_exp_f32 v179, v179
    v_cvt_pk_bf16_f32 v192, v176, v177
    v_mfma_f32_16x16x32_bf16 v[188:191], a[184:187], v[56:59], v[188:191]
    buffer_store_dwordx4 a[4:7], v102, s[20:23], s88 offen offset:1024 sc1
    v_permlane32_swap_b32 v253, v220
    v_mfma_f32_16x16x32_bf16 v[188:191], a[180:183], v[52:55], v[188:191]
    v_add_f32 v253, v253, v220
    v_subrev_u32 v220, s57, v253
    v_add_f32 v254, v254, v178
    v_mfma_f32_16x16x32_bf16 v[188:191], a[176:179], v[48:51], v[188:191]
    v_cmp_le_u32 vcc, s36, v220
    v_rcp_f32 v253, v253
    v_mfma_f32_16x16x32_bf16 a[32:35], v[196:199], a[224:227], a[32:35]
    ds_bpermute_b32 v220, v4, v253 offset:0
    v_exp_f32 v180, v180
    v_mfma_f32_16x16x32_bf16 a[36:39], v[196:199], a[228:231], a[36:39]
    s_cmp_lg_u64 vcc, 0
    buffer_store_dwordx4 a[8:11], v102, s[20:23], s88 offen offset:2048 sc1
    ds_bpermute_b32 v221, v4, v253 offset:4
    v_mfma_f32_16x16x32_bf16 a[40:43], v[196:199], a[232:235], a[40:43]
    s_cselect_b32 s56, 128, 0
    ds_bpermute_b32 v222, v4, v253 offset:8
    v_mfma_f32_16x16x32_bf16 a[44:47], v[196:199], a[236:239], a[44:47]
    s_or_b32 s27, s27, s56
    ds_bpermute_b32 v223, v4, v253 offset:12
    v_add_f32 v254, v254, v179
    v_cvt_pk_bf16_f32 v193, v178, v179
    v_mfma_f32_16x16x32_bf16 a[48:51], v[196:199], a[240:243], a[48:51]
    v_exp_f32 v181, v181
    v_exp_f32 v182, v182
    v_mfma_f32_16x16x32_bf16 a[52:55], v[196:199], a[244:247], a[52:55]
    v_add_f32 v254, v254, v180
    v_add_f32 v254, v254, v181
    v_mfma_f32_16x16x32_bf16 a[56:59], v[196:199], a[248:251], a[56:59]
    v_exp_f32 v183, v183
    v_cvt_pk_bf16_f32 v194, v180, v181
    v_add_f32 v254, v254, v182
    v_add_f32 v254, v254, v183
    v_mfma_f32_16x16x32_bf16 a[60:63], v[196:199], a[252:255], a[60:63]
    buffer_store_dwordx4 a[12:15], v102, s[20:23], s88 offen offset:3072 sc1
    v_cvt_pk_bf16_f32 v195, v182, v183
    s_nop 3
.p2align 3
    v_accvgpr_read_b32 v176, a32
    v_accvgpr_read_b32 v177, a36
    v_accvgpr_read_b32 v178, a40
    v_accvgpr_read_b32 v179, a44
    v_accvgpr_read_b32 v180, a48
    v_accvgpr_read_b32 v181, a52
    v_accvgpr_read_b32 v182, a56
    v_accvgpr_read_b32 v183, a60
    s_waitcnt lgkmcnt(0)
.p2align 3
    v_pk_mul_f32 v[176:177], v[176:177], v[220:221] op_sel:[0,0] op_sel_hi:[1,0]
    v_pk_mul_f32 v[178:179], v[178:179], v[220:221] op_sel:[0,0] op_sel_hi:[1,0]
    v_pk_mul_f32 v[180:181], v[180:181], v[220:221] op_sel:[0,0] op_sel_hi:[1,0]
    v_pk_mul_f32 v[182:183], v[182:183], v[220:221] op_sel:[0,0] op_sel_hi:[1,0]
    v_cvt_pk_bf16_f32 v32, v176, v177
    v_cvt_pk_bf16_f32 v33, v178, v179
    v_cvt_pk_bf16_f32 v34, v180, v181
    v_cvt_pk_bf16_f32 v35, v182, v183
    v_accvgpr_read_b32 v176, a33
    v_accvgpr_read_b32 v177, a37
    v_accvgpr_read_b32 v178, a41
    v_accvgpr_read_b32 v179, a45
    v_accvgpr_read_b32 v180, a49
    v_accvgpr_read_b32 v181, a53
    v_accvgpr_read_b32 v182, a57
    v_accvgpr_read_b32 v183, a61
    v_pk_mul_f32 v[176:177], v[176:177], v[220:221] op_sel:[0,1] op_sel_hi:[1,1]
    v_pk_mul_f32 v[178:179], v[178:179], v[220:221] op_sel:[0,1] op_sel_hi:[1,1]
    v_pk_mul_f32 v[180:181], v[180:181], v[220:221] op_sel:[0,1] op_sel_hi:[1,1]
    v_pk_mul_f32 v[182:183], v[182:183], v[220:221] op_sel:[0,1] op_sel_hi:[1,1]
    v_cvt_pk_bf16_f32 v36, v176, v177
    v_cvt_pk_bf16_f32 v37, v178, v179
    v_cvt_pk_bf16_f32 v38, v180, v181
    v_cvt_pk_bf16_f32 v39, v182, v183
    v_accvgpr_read_b32 v176, a34
    v_accvgpr_read_b32 v177, a38
    v_accvgpr_read_b32 v178, a42
    v_accvgpr_read_b32 v179, a46
    v_accvgpr_read_b32 v180, a50
    v_accvgpr_read_b32 v181, a54
    v_accvgpr_read_b32 v182, a58
    v_accvgpr_read_b32 v183, a62
    v_pk_mul_f32 v[176:177], v[176:177], v[222:223] op_sel:[0,0] op_sel_hi:[1,0]
    v_pk_mul_f32 v[178:179], v[178:179], v[222:223] op_sel:[0,0] op_sel_hi:[1,0]
    v_pk_mul_f32 v[180:181], v[180:181], v[222:223] op_sel:[0,0] op_sel_hi:[1,0]
    v_pk_mul_f32 v[182:183], v[182:183], v[222:223] op_sel:[0,0] op_sel_hi:[1,0]
    v_cvt_pk_bf16_f32 v40, v176, v177
    v_cvt_pk_bf16_f32 v41, v178, v179
    v_cvt_pk_bf16_f32 v42, v180, v181
    v_cvt_pk_bf16_f32 v43, v182, v183
    v_accvgpr_read_b32 v176, a35
    v_accvgpr_read_b32 v177, a39
    v_accvgpr_read_b32 v178, a43
    v_accvgpr_read_b32 v179, a47
    v_accvgpr_read_b32 v180, a51
    v_accvgpr_read_b32 v181, a55
    v_accvgpr_read_b32 v182, a59
    v_accvgpr_read_b32 v183, a63
    v_pk_mul_f32 v[176:177], v[176:177], v[222:223] op_sel:[0,1] op_sel_hi:[1,1]
    v_pk_mul_f32 v[178:179], v[178:179], v[222:223] op_sel:[0,1] op_sel_hi:[1,1]
    v_pk_mul_f32 v[180:181], v[180:181], v[222:223] op_sel:[0,1] op_sel_hi:[1,1]
    v_pk_mul_f32 v[182:183], v[182:183], v[222:223] op_sel:[0,1] op_sel_hi:[1,1]
    v_cvt_pk_bf16_f32 v44, v176, v177
    v_cvt_pk_bf16_f32 v45, v178, v179
    v_cvt_pk_bf16_f32 v46, v180, v181
    v_cvt_pk_bf16_f32 v47, v182, v183
    ds_write_b128 v2, v[32:35] offset:4096
    ds_write_b128 v3, v[36:39] offset:4352
    ds_write_b128 v2, v[40:43] offset:4608
    ds_write_b128 v3, v[44:47] offset:4864
    ds_read_b64_tr_b16 a[32:33], v6 offset:4096
    ds_read_b64_tr_b16 a[34:35], v7 offset:4096
    ds_read_b64_tr_b16 a[36:37], v6 offset:5120
    ds_read_b64_tr_b16 a[38:39], v7 offset:5120
    ds_read_b64_tr_b16 a[40:41], v6 offset:6144
    ds_read_b64_tr_b16 a[42:43], v7 offset:6144
    ds_read_b64_tr_b16 a[44:45], v6 offset:7168
    ds_read_b64_tr_b16 a[46:47], v7 offset:7168
    s_nop 1
    v_mfma_f32_16x16x32_bf16 a[64:67], v[192:195], a[192:195], a[64:67]
    v_mfma_f32_16x16x32_bf16 a[68:71], v[192:195], a[196:199], a[68:71]
    v_exp_f32 v184, v184
    v_exp_f32 v185, v185
    v_mfma_f32_16x16x32_bf16 a[72:75], v[192:195], a[200:203], a[72:75]
    v_exp_f32 v186, v186
    v_add_f32 v254, v254, v184
    v_add_f32 v254, v254, v185
    v_mfma_f32_16x16x32_bf16 a[76:79], v[192:195], a[204:207], a[76:79]
    s_waitcnt lgkmcnt(0)
    buffer_store_dwordx4 a[32:35], v102, s[20:23], s89 offen offset:0 sc1
    v_exp_f32 v187, v187
    v_cvt_pk_bf16_f32 v196, v184, v185
    v_add_f32 v254, v254, v186
    v_mfma_f32_16x16x32_bf16 a[80:83], v[192:195], a[208:211], a[80:83]
    buffer_store_dwordx4 a[36:39], v102, s[20:23], s89 offen offset:1024 sc1
    v_exp_f32 v188, v188
    v_add_f32 v254, v254, v187
    v_cvt_pk_bf16_f32 v197, v186, v187
    v_mfma_f32_16x16x32_bf16 a[84:87], v[192:195], a[212:215], a[84:87]
    buffer_store_dwordx4 a[40:43], v102, s[20:23], s89 offen offset:2048 sc1
    v_exp_f32 v189, v189
    v_exp_f32 v190, v190
    v_mfma_f32_16x16x32_bf16 a[88:91], v[192:195], a[216:219], a[88:91]
    buffer_store_dwordx4 a[44:47], v102, s[20:23], s89 offen offset:3072 sc1
    v_add_f32 v254, v254, v188
    v_add_f32 v254, v254, v189
    v_exp_f32 v191, v191
    v_mfma_f32_16x16x32_bf16 a[92:95], v[192:195], a[220:223], a[92:95]
    v_cvt_pk_bf16_f32 v198, v188, v189
    v_add_f32 v254, v254, v190
    v_add_f32 v254, v254, v191
    v_cvt_pk_bf16_f32 v199, v190, v191
    s_nop 1
    v_mfma_f32_16x16x32_bf16 a[64:67], v[196:199], a[224:227], a[64:67]
    v_mov_b32 v224, v254
    v_mfma_f32_16x16x32_bf16 a[68:71], v[196:199], a[228:231], a[68:71]
    s_nop 1
    v_permlane16_swap_b32 v254, v224
    v_mfma_f32_16x16x32_bf16 a[72:75], v[196:199], a[232:235], a[72:75]
    v_add_f32 v254, v254, v224
    v_mov_b32 v224, v254
    v_mfma_f32_16x16x32_bf16 a[76:79], v[196:199], a[236:239], a[76:79]
    s_nop 1
    v_permlane32_swap_b32 v254, v224
    v_mfma_f32_16x16x32_bf16 a[80:83], v[196:199], a[240:243], a[80:83]
    v_add_f32 v254, v254, v224
    v_subrev_u32 v224, s57, v254
    v_mfma_f32_16x16x32_bf16 a[84:87], v[196:199], a[244:247], a[84:87]
    v_cmp_le_u32 vcc, s36, v224
    v_rcp_f32 v254, v254
    v_mfma_f32_16x16x32_bf16 a[88:91], v[196:199], a[248:251], a[88:91]
    ds_bpermute_b32 v224, v4, v254 offset:0
    ds_bpermute_b32 v225, v4, v254 offset:4
    v_mfma_f32_16x16x32_bf16 a[92:95], v[196:199], a[252:255], a[92:95]
    ds_bpermute_b32 v226, v4, v254 offset:8
    ds_bpermute_b32 v227, v4, v254 offset:12
    s_cmp_lg_u64 vcc, 0
    s_cselect_b32 s56, 256, 0
    s_or_b32 s27, s27, s56
    s_nop 3
.p2align 3
    v_accvgpr_read_b32 v176, a64
    v_accvgpr_read_b32 v177, a68
    v_accvgpr_read_b32 v178, a72
    v_accvgpr_read_b32 v179, a76
    v_accvgpr_read_b32 v180, a80
    v_accvgpr_read_b32 v181, a84
    v_accvgpr_read_b32 v182, a88
    v_accvgpr_read_b32 v183, a92
    s_waitcnt lgkmcnt(0)
.p2align 3
    v_pk_mul_f32 v[176:177], v[176:177], v[224:225] op_sel:[0,0] op_sel_hi:[1,0]
    v_pk_mul_f32 v[178:179], v[178:179], v[224:225] op_sel:[0,0] op_sel_hi:[1,0]
    v_pk_mul_f32 v[180:181], v[180:181], v[224:225] op_sel:[0,0] op_sel_hi:[1,0]
    v_pk_mul_f32 v[182:183], v[182:183], v[224:225] op_sel:[0,0] op_sel_hi:[1,0]
    v_cvt_pk_bf16_f32 v48, v176, v177
    v_cvt_pk_bf16_f32 v49, v178, v179
    v_cvt_pk_bf16_f32 v50, v180, v181
    v_cvt_pk_bf16_f32 v51, v182, v183
    v_accvgpr_read_b32 v176, a65
    v_accvgpr_read_b32 v177, a69
    v_accvgpr_read_b32 v178, a73
    v_accvgpr_read_b32 v179, a77
    v_accvgpr_read_b32 v180, a81
    v_accvgpr_read_b32 v181, a85
    v_accvgpr_read_b32 v182, a89
    v_accvgpr_read_b32 v183, a93
    v_pk_mul_f32 v[176:177], v[176:177], v[224:225] op_sel:[0,1] op_sel_hi:[1,1]
    v_pk_mul_f32 v[178:179], v[178:179], v[224:225] op_sel:[0,1] op_sel_hi:[1,1]
    v_pk_mul_f32 v[180:181], v[180:181], v[224:225] op_sel:[0,1] op_sel_hi:[1,1]
    v_pk_mul_f32 v[182:183], v[182:183], v[224:225] op_sel:[0,1] op_sel_hi:[1,1]
    v_cvt_pk_bf16_f32 v52, v176, v177
    v_cvt_pk_bf16_f32 v53, v178, v179
    v_cvt_pk_bf16_f32 v54, v180, v181
    v_cvt_pk_bf16_f32 v55, v182, v183
    v_accvgpr_read_b32 v176, a66
    v_accvgpr_read_b32 v177, a70
    v_accvgpr_read_b32 v178, a74
    v_accvgpr_read_b32 v179, a78
    v_accvgpr_read_b32 v180, a82
    v_accvgpr_read_b32 v181, a86
    v_accvgpr_read_b32 v182, a90
    v_accvgpr_read_b32 v183, a94
    v_pk_mul_f32 v[176:177], v[176:177], v[226:227] op_sel:[0,0] op_sel_hi:[1,0]
    v_pk_mul_f32 v[178:179], v[178:179], v[226:227] op_sel:[0,0] op_sel_hi:[1,0]
    v_pk_mul_f32 v[180:181], v[180:181], v[226:227] op_sel:[0,0] op_sel_hi:[1,0]
    v_pk_mul_f32 v[182:183], v[182:183], v[226:227] op_sel:[0,0] op_sel_hi:[1,0]
    v_cvt_pk_bf16_f32 v56, v176, v177
    v_cvt_pk_bf16_f32 v57, v178, v179
    v_cvt_pk_bf16_f32 v58, v180, v181
    v_cvt_pk_bf16_f32 v59, v182, v183
    v_accvgpr_read_b32 v176, a67
    v_accvgpr_read_b32 v177, a71
    v_accvgpr_read_b32 v178, a75
    v_accvgpr_read_b32 v179, a79
    v_accvgpr_read_b32 v180, a83
    v_accvgpr_read_b32 v181, a87
    v_accvgpr_read_b32 v182, a91
    v_accvgpr_read_b32 v183, a95
    v_pk_mul_f32 v[176:177], v[176:177], v[226:227] op_sel:[0,1] op_sel_hi:[1,1]
    v_pk_mul_f32 v[178:179], v[178:179], v[226:227] op_sel:[0,1] op_sel_hi:[1,1]
    v_pk_mul_f32 v[180:181], v[180:181], v[226:227] op_sel:[0,1] op_sel_hi:[1,1]
    v_pk_mul_f32 v[182:183], v[182:183], v[226:227] op_sel:[0,1] op_sel_hi:[1,1]
    v_cvt_pk_bf16_f32 v60, v176, v177
    v_cvt_pk_bf16_f32 v61, v178, v179
    v_cvt_pk_bf16_f32 v62, v180, v181
    v_cvt_pk_bf16_f32 v63, v182, v183
    ds_write_b128 v2, v[48:51] offset:8192
    ds_write_b128 v3, v[52:55] offset:8448
    ds_write_b128 v2, v[56:59] offset:8704
    ds_write_b128 v3, v[60:63] offset:8960
    ds_read_b64_tr_b16 a[64:65], v6 offset:8192
    ds_read_b64_tr_b16 a[66:67], v7 offset:8192
    ds_read_b64_tr_b16 a[68:69], v6 offset:9216
    ds_read_b64_tr_b16 a[70:71], v7 offset:9216
    ds_read_b64_tr_b16 a[72:73], v6 offset:10240
    ds_read_b64_tr_b16 a[74:75], v7 offset:10240
    ds_read_b64_tr_b16 a[76:77], v6 offset:11264
    ds_read_b64_tr_b16 a[78:79], v7 offset:11264
    s_waitcnt lgkmcnt(0)
    buffer_store_dwordx4 a[64:67], v102, s[20:23], s90 offen offset:0 sc1
    buffer_store_dwordx4 a[68:71], v102, s[20:23], s90 offen offset:1024 sc1
    buffer_store_dwordx4 a[72:75], v102, s[20:23], s90 offen offset:2048 sc1
    buffer_store_dwordx4 a[76:79], v102, s[20:23], s90 offen offset:3072 sc1
    s_cmp_lg_u32 s27, 0
    s_cbranch_scc1 L_slow
    s_endpgm
L_slow:
    s_waitcnt vmcnt(0) lgkmcnt(0)
    v_mbcnt_lo_u32_b32 v48, -1, 0
    v_mbcnt_hi_u32_b32 v48, -1, v48
    v_lshlrev_b32 v102, 4, v48
    v_and_b32 v49, 15, v48
    v_lshrrev_b32 v50, 4, v48
    v_lshlrev_b32 v52, 8, v50
    v_add_u32 v51, 0, v50
    v_xor_b32 v51, v51, v49
    v_lshl_add_u32 v96, v51, 4, v52
    v_add_u32 v51, 4, v50
    v_xor_b32 v51, v51, v49
    v_lshl_add_u32 v97, v51, 4, v52
    v_add_u32 v51, 8, v50
    v_xor_b32 v51, v51, v49
    v_lshl_add_u32 v98, v51, 4, v52
    v_add_u32 v51, 12, v50
    v_xor_b32 v51, v51, v49
    v_lshl_add_u32 v99, v51, 4, v52
    s_sub_u32 s58, s51, 20480
    v_add_u32 v32, s58, v244
    v_add_u32 v33, s58, v245
    v_add_u32 v34, s58, v246
    v_add_u32 v35, s58, v247
    v_add_u32 v36, s58, v248
    v_add_u32 v37, s58, v249
    v_add_u32 v38, s58, v250
    v_add_u32 v39, s58, v251
L_slow_next:
    s_waitcnt vmcnt(0) lgkmcnt(0)
    s_ff1_i32_b32 s60, s27
    s_bitset0_b32 s27, s60
    s_cmp_ge_u32 s60, 6
    s_cselect_b32 s62, s26, s25
    s_cselect_b32 s58, 6, 0
    s_sub_u32 s60, s60, s58
    s_lshl_b32 s60, s60, 12
    s_add_u32 s63, s62, s50
    s_add_u32 s63, s63, s60
    s_mov_b32 m0, s51
    s_nop 0
    buffer_load_dwordx4 v96, s[8:11], s63 offen offset:0 lds
    buffer_load_dwordx4 v97, s[8:11], s63 offen offset:1024 lds
    buffer_load_dwordx4 v98, s[8:11], s63 offen offset:2048 lds
    buffer_load_dwordx4 v99, s[8:11], s63 offen offset:3072 lds
    s_waitcnt vmcnt(0)
    ds_read_b128 v[16:19], v8 offset:0
    ds_read_b128 v[20:23], v9 offset:0
    ds_read_b128 v[24:27], v10 offset:0
    ds_read_b128 v[28:31], v11 offset:0
    s_waitcnt lgkmcnt(0)
    v_mfma_f32_4x4x4_16b_bf16 v[176:179], v[12:13], v[16:17], 0
    v_mfma_f32_4x4x4_16b_bf16 v[180:183], v[12:13], v[18:19], 0
    s_nop 0
    v_mfma_f32_4x4x4_16b_bf16 v[176:179], v[14:15], v[16:17], v[176:179]
    v_mfma_f32_4x4x4_16b_bf16 v[184:187], v[12:13], v[20:21], 0
    v_mfma_f32_4x4x4_16b_bf16 v[180:183], v[14:15], v[18:19], v[180:183]
    v_mfma_f32_4x4x4_16b_bf16 v[188:191], v[12:13], v[22:23], 0
    s_nop 1
    v_cvt_pk_bf16_f32 v16, v176, v177
    v_mfma_f32_4x4x4_16b_bf16 v[184:187], v[14:15], v[20:21], v[184:187]
    v_cvt_pk_bf16_f32 v17, v178, v179
    v_mfma_f32_4x4x4_16b_bf16 v[176:179], v[12:13], v[24:25], 0
    v_cvt_pk_bf16_f32 v18, v180, v181
    v_mfma_f32_4x4x4_16b_bf16 v[188:191], v[14:15], v[22:23], v[188:191]
    v_cvt_pk_bf16_f32 v19, v182, v183
    v_mfma_f32_4x4x4_16b_bf16 v[180:183], v[12:13], v[26:27], 0
    v_cvt_pk_bf16_f32 v20, v184, v185
    v_mfma_f32_4x4x4_16b_bf16 v[176:179], v[14:15], v[24:25], v[176:179]
    v_cvt_pk_bf16_f32 v21, v186, v187
    v_mfma_f32_4x4x4_16b_bf16 v[184:187], v[12:13], v[28:29], 0
    v_cvt_pk_bf16_f32 v22, v188, v189
    v_mfma_f32_4x4x4_16b_bf16 v[180:183], v[14:15], v[26:27], v[180:183]
    v_cvt_pk_bf16_f32 v23, v190, v191
    v_mfma_f32_4x4x4_16b_bf16 v[188:191], v[12:13], v[30:31], 0
    v_cvt_pk_bf16_f32 v24, v176, v177
    v_mfma_f32_4x4x4_16b_bf16 v[184:187], v[14:15], v[28:29], v[184:187]
    v_cvt_pk_bf16_f32 v25, v178, v179
    v_cvt_pk_bf16_f32 v26, v180, v181
    v_mfma_f32_4x4x4_16b_bf16 v[188:191], v[14:15], v[30:31], v[188:191]
    v_cvt_pk_bf16_f32 v27, v182, v183
    s_nop 0
    v_cvt_pk_bf16_f32 v28, v184, v185
    v_cvt_pk_bf16_f32 v29, v186, v187
    s_nop 0
    v_cvt_pk_bf16_f32 v30, v188, v189
    v_cvt_pk_bf16_f32 v31, v190, v191
    v_mov_b32 v48, 0xff800000
    s_mov_b32 s61, s62
    s_add_u32 s60, s62, 188416
L_slow_p1:
    s_add_u32 m0, s51, 4096
    s_add_u32 s58, s61, 0
    buffer_load_dwordx4 v96, s[12:15], s58 offen offset:0 lds
    buffer_load_dwordx4 v97, s[12:15], s58 offen offset:1024 lds
    buffer_load_dwordx4 v98, s[12:15], s58 offen offset:2048 lds
    buffer_load_dwordx4 v99, s[12:15], s58 offen offset:3072 lds
    s_add_u32 m0, s51, 8192
    s_add_u32 s58, s61, 4096
    buffer_load_dwordx4 v96, s[12:15], s58 offen offset:0 lds
    buffer_load_dwordx4 v97, s[12:15], s58 offen offset:1024 lds
    buffer_load_dwordx4 v98, s[12:15], s58 offen offset:2048 lds
    buffer_load_dwordx4 v99, s[12:15], s58 offen offset:3072 lds
    s_waitcnt vmcnt(0)
    ds_read_b128 a[128:131], v8 offset:4096
    ds_read_b128 a[132:135], v9 offset:4096
    ds_read_b128 a[136:139], v10 offset:4096
    ds_read_b128 a[140:143], v11 offset:4096
    ds_read_b128 a[144:147], v8 offset:8192
    ds_read_b128 a[148:151], v9 offset:8192
    ds_read_b128 a[152:155], v10 offset:8192
    ds_read_b128 a[156:159], v11 offset:8192
    s_waitcnt lgkmcnt(0)
    v_mfma_f32_16x16x32_bf16 v[176:179], a[128:131], v[16:19], 0
    v_mfma_f32_16x16x32_bf16 v[176:179], a[132:135], v[20:23], v[176:179]
    v_mfma_f32_16x16x32_bf16 v[176:179], a[136:139], v[24:27], v[176:179]
    v_mfma_f32_16x16x32_bf16 v[176:179], a[140:143], v[28:31], v[176:179]
    v_mfma_f32_16x16x32_bf16 v[180:183], a[144:147], v[16:19], 0
    v_mfma_f32_16x16x32_bf16 v[180:183], a[148:151], v[20:23], v[180:183]
    v_mfma_f32_16x16x32_bf16 v[180:183], a[152:155], v[24:27], v[180:183]
    v_mfma_f32_16x16x32_bf16 v[180:183], a[156:159], v[28:31], v[180:183]
    s_nop 7
    v_max3_f32 v48, v48, v176, v177
    v_max3_f32 v48, v48, v178, v179
    v_max3_f32 v48, v48, v180, v181
    v_max3_f32 v48, v48, v182, v183
    s_add_u32 s61, s61, 8192
    s_cmp_lt_u32 s61, s60
    s_cbranch_scc1 L_slow_p1
    v_mov_b32 v49, v48
    s_nop 1
    v_permlane16_swap_b32 v48, v49
    s_nop 1
    v_max_f32 v48, v48, v49
    v_mov_b32 v49, v48
    s_nop 1
    v_permlane32_swap_b32 v48, v49
    s_nop 1
    v_max_f32 v48, v48, v49
    v_mov_b32 v112, 0
    v_mov_b32 v113, 0
    v_mov_b32 v114, 0
    v_mov_b32 v115, 0
    v_mov_b32 v116, 0
    v_mov_b32 v117, 0
    v_mov_b32 v118, 0
    v_mov_b32 v119, 0
    v_mov_b32 v120, 0
    v_mov_b32 v121, 0
    v_mov_b32 v122, 0
    v_mov_b32 v123, 0
    v_mov_b32 v124, 0
    v_mov_b32 v125, 0
    v_mov_b32 v126, 0
    v_mov_b32 v127, 0
    v_mov_b32 v128, 0
    v_mov_b32 v129, 0
    v_mov_b32 v130, 0
    v_mov_b32 v131, 0
    v_mov_b32 v132, 0
    v_mov_b32 v133, 0
    v_mov_b32 v134, 0
    v_mov_b32 v135, 0
    v_mov_b32 v136, 0
    v_mov_b32 v137, 0
    v_mov_b32 v138, 0
    v_mov_b32 v139, 0
    v_mov_b32 v140, 0
    v_mov_b32 v141, 0
    v_mov_b32 v142, 0
    v_mov_b32 v143, 0
    v_mov_b32 v252, 0
    s_mov_b32 s61, s62
L_slow_p2:
    s_add_u32 m0, s51, 4096
    s_add_u32 s58, s61, 0
    buffer_load_dwordx4 v96, s[12:15], s58 offen offset:0 lds
    buffer_load_dwordx4 v97, s[12:15], s58 offen offset:1024 lds
    buffer_load_dwordx4 v98, s[12:15], s58 offen offset:2048 lds
    buffer_load_dwordx4 v99, s[12:15], s58 offen offset:3072 lds
    s_add_u32 m0, s51, 8192
    s_add_u32 s58, s61, 4096
    buffer_load_dwordx4 v96, s[12:15], s58 offen offset:0 lds
    buffer_load_dwordx4 v97, s[12:15], s58 offen offset:1024 lds
    buffer_load_dwordx4 v98, s[12:15], s58 offen offset:2048 lds
    buffer_load_dwordx4 v99, s[12:15], s58 offen offset:3072 lds
    s_add_u32 m0, s51, 12288
    s_add_u32 s58, s61, 0
    buffer_load_dwordx4 v96, s[16:19], s58 offen offset:0 lds
    buffer_load_dwordx4 v97, s[16:19], s58 offen offset:1024 lds
    buffer_load_dwordx4 v96, s[16:19], s58 offen offset:2048 lds
    buffer_load_dwordx4 v97, s[16:19], s58 offen offset:3072 lds
    s_add_u32 m0, s51, 16384
    s_add_u32 s58, s61, 4096
    buffer_load_dwordx4 v96, s[16:19], s58 offen offset:0 lds
    buffer_load_dwordx4 v97, s[16:19], s58 offen offset:1024 lds
    buffer_load_dwordx4 v96, s[16:19], s58 offen offset:2048 lds
    buffer_load_dwordx4 v97, s[16:19], s58 offen offset:3072 lds
    s_waitcnt vmcnt(0)
    ds_read_b128 a[128:131], v8 offset:4096
    ds_read_b128 a[132:135], v9 offset:4096
    ds_read_b128 a[136:139], v10 offset:4096
    ds_read_b128 a[140:143], v11 offset:4096
    ds_read_b128 a[144:147], v8 offset:8192
    ds_read_b128 a[148:151], v9 offset:8192
    ds_read_b128 a[152:155], v10 offset:8192
    ds_read_b128 a[156:159], v11 offset:8192
    s_waitcnt lgkmcnt(0)
    ds_read_b64_tr_b16 a[192:193], v32 offset:0
    ds_read_b64_tr_b16 a[194:195], v32 offset:4096
    ds_read_b64_tr_b16 a[196:197], v33 offset:0
    ds_read_b64_tr_b16 a[198:199], v33 offset:4096
    ds_read_b64_tr_b16 a[200:201], v34 offset:0
    ds_read_b64_tr_b16 a[202:203], v34 offset:4096
    ds_read_b64_tr_b16 a[204:205], v35 offset:0
    ds_read_b64_tr_b16 a[206:207], v35 offset:4096
    ds_read_b64_tr_b16 a[208:209], v36 offset:0
    ds_read_b64_tr_b16 a[210:211], v36 offset:4096
    ds_read_b64_tr_b16 a[212:213], v37 offset:0
    ds_read_b64_tr_b16 a[214:215], v37 offset:4096
    ds_read_b64_tr_b16 a[216:217], v38 offset:0
    ds_read_b64_tr_b16 a[218:219], v38 offset:4096
    ds_read_b64_tr_b16 a[220:221], v39 offset:0
    ds_read_b64_tr_b16 a[222:223], v39 offset:4096
    v_mfma_f32_16x16x32_bf16 v[176:179], a[128:131], v[16:19], 0
    v_mfma_f32_16x16x32_bf16 v[176:179], a[132:135], v[20:23], v[176:179]
    v_mfma_f32_16x16x32_bf16 v[176:179], a[136:139], v[24:27], v[176:179]
    v_mfma_f32_16x16x32_bf16 v[176:179], a[140:143], v[28:31], v[176:179]
    v_mfma_f32_16x16x32_bf16 v[180:183], a[144:147], v[16:19], 0
    v_mfma_f32_16x16x32_bf16 v[180:183], a[148:151], v[20:23], v[180:183]
    v_mfma_f32_16x16x32_bf16 v[180:183], a[152:155], v[24:27], v[180:183]
    v_mfma_f32_16x16x32_bf16 v[180:183], a[156:159], v[28:31], v[180:183]
    s_nop 7
    v_sub_f32 v176, v176, v48
    v_sub_f32 v177, v177, v48
    v_sub_f32 v178, v178, v48
    v_sub_f32 v179, v179, v48
    v_sub_f32 v180, v180, v48
    v_sub_f32 v181, v181, v48
    v_sub_f32 v182, v182, v48
    v_sub_f32 v183, v183, v48
    v_exp_f32 v176, v176
    v_exp_f32 v177, v177
    v_exp_f32 v178, v178
    v_exp_f32 v179, v179
    v_exp_f32 v180, v180
    v_exp_f32 v181, v181
    v_exp_f32 v182, v182
    v_exp_f32 v183, v183
    s_nop 0
    v_add_f32 v252, v252, v176
    v_add_f32 v252, v252, v177
    v_add_f32 v252, v252, v178
    v_add_f32 v252, v252, v179
    v_add_f32 v252, v252, v180
    v_add_f32 v252, v252, v181
    v_add_f32 v252, v252, v182
    v_add_f32 v252, v252, v183
    v_cvt_pk_bf16_f32 v192, v176, v177
    v_cvt_pk_bf16_f32 v193, v178, v179
    v_cvt_pk_bf16_f32 v194, v180, v181
    v_cvt_pk_bf16_f32 v195, v182, v183
    s_waitcnt lgkmcnt(0)
    s_nop 1
    v_mfma_f32_16x16x32_bf16 v[112:115], v[192:195], a[192:195], v[112:115]
    v_mfma_f32_16x16x32_bf16 v[116:119], v[192:195], a[196:199], v[116:119]
    v_mfma_f32_16x16x32_bf16 v[120:123], v[192:195], a[200:203], v[120:123]
    v_mfma_f32_16x16x32_bf16 v[124:127], v[192:195], a[204:207], v[124:127]
    v_mfma_f32_16x16x32_bf16 v[128:131], v[192:195], a[208:211], v[128:131]
    v_mfma_f32_16x16x32_bf16 v[132:135], v[192:195], a[212:215], v[132:135]
    v_mfma_f32_16x16x32_bf16 v[136:139], v[192:195], a[216:219], v[136:139]
    v_mfma_f32_16x16x32_bf16 v[140:143], v[192:195], a[220:223], v[140:143]
    s_add_u32 s61, s61, 8192
    s_cmp_lt_u32 s61, s60
    s_cbranch_scc1 L_slow_p2
    v_mov_b32 v49, v252
    s_nop 1
    v_permlane16_swap_b32 v252, v49
    s_nop 1
    v_add_f32 v252, v252, v49
    v_mov_b32 v49, v252
    s_nop 1
    v_permlane32_swap_b32 v252, v49
    s_nop 1
    v_add_f32 v252, v252, v49
    v_rcp_f32 v252, v252
    s_nop 7
    ds_bpermute_b32 v216, v4, v252 offset:0
    ds_bpermute_b32 v217, v4, v252 offset:4
    ds_bpermute_b32 v218, v4, v252 offset:8
    ds_bpermute_b32 v219, v4, v252 offset:12
    s_waitcnt lgkmcnt(0)
    v_pk_mul_f32 v[112:113], v[112:113], v[216:217]
    v_pk_mul_f32 v[116:117], v[116:117], v[216:217]
    v_pk_mul_f32 v[120:121], v[120:121], v[216:217]
    v_pk_mul_f32 v[124:125], v[124:125], v[216:217]
    v_pk_mul_f32 v[128:129], v[128:129], v[216:217]
    v_pk_mul_f32 v[132:133], v[132:133], v[216:217]
    v_pk_mul_f32 v[136:137], v[136:137], v[216:217]
    v_pk_mul_f32 v[140:141], v[140:141], v[216:217]
    v_pk_mul_f32 v[114:115], v[114:115], v[218:219]
    v_pk_mul_f32 v[118:119], v[118:119], v[218:219]
    v_pk_mul_f32 v[122:123], v[122:123], v[218:219]
    v_pk_mul_f32 v[126:127], v[126:127], v[218:219]
    v_pk_mul_f32 v[130:131], v[130:131], v[218:219]
    v_pk_mul_f32 v[134:135], v[134:135], v[218:219]
    v_pk_mul_f32 v[138:139], v[138:139], v[218:219]
    v_pk_mul_f32 v[142:143], v[142:143], v[218:219]
    v_cvt_pk_bf16_f32 v16, v112, v116
    v_cvt_pk_bf16_f32 v17, v120, v124
    v_cvt_pk_bf16_f32 v18, v128, v132
    v_cvt_pk_bf16_f32 v19, v136, v140
    v_cvt_pk_bf16_f32 v20, v113, v117
    v_cvt_pk_bf16_f32 v21, v121, v125
    v_cvt_pk_bf16_f32 v22, v129, v133
    v_cvt_pk_bf16_f32 v23, v137, v141
    v_cvt_pk_bf16_f32 v24, v114, v118
    v_cvt_pk_bf16_f32 v25, v122, v126
    v_cvt_pk_bf16_f32 v26, v130, v134
    v_cvt_pk_bf16_f32 v27, v138, v142
    v_cvt_pk_bf16_f32 v28, v115, v119
    v_cvt_pk_bf16_f32 v29, v123, v127
    v_cvt_pk_bf16_f32 v30, v131, v135
    v_cvt_pk_bf16_f32 v31, v139, v143
    ds_write_b128 v2, v[16:19] offset:0
    ds_write_b128 v3, v[20:23] offset:256
    ds_write_b128 v2, v[24:27] offset:512
    ds_write_b128 v3, v[28:31] offset:768
    ds_read_b64_tr_b16 v[128:129], v6 offset:0
    ds_read_b64_tr_b16 v[130:131], v7 offset:0
    ds_read_b64_tr_b16 v[132:133], v6 offset:1024
    ds_read_b64_tr_b16 v[134:135], v7 offset:1024
    ds_read_b64_tr_b16 v[136:137], v6 offset:2048
    ds_read_b64_tr_b16 v[138:139], v7 offset:2048
    ds_read_b64_tr_b16 v[140:141], v6 offset:3072
    ds_read_b64_tr_b16 v[142:143], v7 offset:3072
    s_waitcnt lgkmcnt(0)
    buffer_store_dwordx4 v[128:131], v102, s[20:23], s63 offen offset:0
    buffer_store_dwordx4 v[132:135], v102, s[20:23], s63 offen offset:1024
    buffer_store_dwordx4 v[136:139], v102, s[20:23], s63 offen offset:2048
    buffer_store_dwordx4 v[140:143], v102, s[20:23], s63 offen offset:3072
    s_cmp_lg_u32 s27, 0
    s_cbranch_scc1 L_slow_next
    s_endpgm
L_done:
    s_endpgm
.fill 2048, 4, 0xbf810000
.section .rodata,"a"
.p2align 6
.amdhsa_kernel standalone__gqa_softmax__near_ridge_kernel
  .amdhsa_next_free_vgpr 512
  .amdhsa_next_free_sgpr 96
  .amdhsa_accum_offset 256
  .amdhsa_group_segment_fixed_size 0
  .amdhsa_kernarg_size 48
  .amdhsa_user_sgpr_count 2
  .amdhsa_user_sgpr_kernarg_segment_ptr 1
  .amdhsa_system_sgpr_workgroup_id_x 1
.end_amdhsa_kernel
```
